```python
import torch

def _softmax(x, axis=-1):
    return torch.softmax(x, dim=axis)

def _gelu(x):
    return torch.nn.functional.gelu(x, approximate='tanh')

def _silu(x):
    return torch.nn.functional.silu(x)

def _sigmoid(x):
    return torch.sigmoid(x)

def _layernorm(x, axis=-1, eps=1e-05):
    m = x.mean(dim=axis, keepdim=True)
    v = x.var(dim=axis, keepdim=True, unbiased=False)
    return (x - m) / torch.sqrt(v + eps)

def _scatter_add(tgt, idx, src, axis=0):
    return tgt.clone().index_add_(axis, idx, src)

def _segment_sum(src, seg, n):
    out = torch.zeros((n,) + src.shape[1:], dtype=src.dtype)
    return out.index_add_(0, seg, src)

def _pad(x, pw):
    flat = tuple((v for pair in reversed(pw) for v in pair))
    return torch.nn.functional.pad(x, flat)
kernel_name = 'interleave_layers__grouped_kv_mqa__memory_aug_recurrent_mem_tr__prompt'

def setup_inputs():

    _w = lambda a: (lambda t: t.to(torch.bfloat16) if t.is_floating_point() else t)(torch.as_tensor(a))

    def _A_setup():
        B, S, D, H = (1, 2048, 640, 32)
        Dh = D // H
        return {'x': _w((lambda *s: torch.randn(*s, dtype=torch.bfloat16) * 0.05)(B, S, D)), 'wq': _w((lambda *s: torch.randn(*s, dtype=torch.bfloat16) * 0.05)(D, H * Dh)), 'wk': _w((lambda *s: torch.randn(*s, dtype=torch.bfloat16) * 0.05)(D, Dh)), 'wv': _w((lambda *s: torch.randn(*s, dtype=torch.bfloat16) * 0.05)(D, Dh)), 'wo': _w((lambda *s: torch.randn(*s, dtype=torch.bfloat16) * 0.05)(H * Dh, D))}
    _A_in = _A_setup()

    def _B_setup():
        B, S, Dm = (1, 2048, 640)
        H, Dh = (32, 128)
        M, seg = (8, 32)
        seg = min(seg, S)
        S = S // seg * seg
        return {'x': _w((lambda *s: torch.randn(*s, dtype=torch.bfloat16) * 0.05)(B, S, Dm)), 'mem0': _w((lambda *s: torch.randn(*s, dtype=torch.bfloat16) * 0.8)(B, M, Dm)), 'Wq': _w((lambda *s: torch.randn(*s, dtype=torch.bfloat16) * 1.6)(Dm, H, Dh) * Dm ** (-0.5)), 'Wk': _w((lambda *s: torch.randn(*s, dtype=torch.bfloat16) * 1.6)(Dm, H, Dh) * Dm ** (-0.5)), 'Wv': _w((lambda *s: torch.randn(*s, dtype=torch.bfloat16) * 0.8)(Dm, H, Dh) * Dm ** (-0.5)), 'Wo': _w((lambda *s: torch.randn(*s, dtype=torch.bfloat16) * 0.8)(H, Dh, Dm) * (H * Dh) ** (-0.5)), 'seg_len': seg}
    _B_in = _B_setup()
    return {'A_x': _A_in['x'], 'A_wq': _A_in['wq'], 'A_wk': _A_in['wk'], 'A_wv': _A_in['wv'], 'A_wo': _A_in['wo'], 'B_x': _B_in['x'], 'B_mem0': _B_in['mem0'], 'B_Wq': _B_in['Wq'], 'B_Wk': _B_in['Wk'], 'B_Wv': _B_in['Wv'], 'B_Wo': _B_in['Wo'], 'B_seg_len': _B_in['seg_len']}

def reference(A_x, A_wq, A_wk, A_wv, A_wo, B_x, B_mem0, B_Wq, B_Wk, B_Wv, B_Wo, B_seg_len):

    def _A_ref(x, wq, wk, wv, wo):
        B, S, D = x.shape
        H = 32
        Dh = D // H
        q = (lambda x, *d: x.permute(*d))((x @ wq).reshape(B, S, H, Dh), 0, 2, 1, 3)
        k = x @ wk
        v = x @ wv
        scores = torch.einsum('bhqd,bkd->bhqk', q, k) * Dh ** (-0.5)
        p = _softmax(scores, axis=-1)
        o = torch.einsum('bhqk,bkd->bhqd', p, v)
        return (lambda x, *d: x.permute(*d))(o, 0, 2, 1, 3).reshape(B, S, H * Dh) @ wo

    def _B_ref(x, mem0, Wq, Wk, Wv, Wo, seg_len):
        B, S, Dm = x.shape
        H, Dh = (Wq.shape[1], Wq.shape[2])
        M = mem0.shape[1]
        scale = Dh ** (-0.5)
        n_seg = S // seg_len
        L = M + seg_len
        idx = torch.arange(L)
        mask = (idx[:, None] < M) | (idx[:, None] >= idx[None, :])
        mem = mem0
        outs = []
        for s in range(n_seg):
            xs = x[:, s * seg_len:(s + 1) * seg_len, :].clone()
            h = torch.concatenate([mem, xs], axis=1)
            q = torch.einsum('btd,dhe->bhte', h, Wq)
            k = torch.einsum('btd,dhe->bhte', h, Wk)
            v = torch.einsum('btd,dhe->bhte', h, Wv)
            scores = torch.einsum('bhqe,bhke->bhqk', q, k) * scale
            scores = torch.where(mask[None, None], scores, -1000000000.0)
            p = _softmax(scores, axis=-1)
            o = torch.einsum('bhqk,bhke->bhqe', p, v)
            o = torch.einsum('bhte,hed->btd', o, Wo)
            mem = o[:, :M, :].clone()
            outs.append(o[:, M:, :])
        return torch.concatenate(outs, axis=1)
    x = A_x
    x = x + _A_ref(_layernorm(x, axis=-1), A_wq, A_wk, A_wv, A_wo)
    x = x + _B_ref(_layernorm(x, axis=-1), B_mem0, B_Wq, B_Wk, B_Wv, B_Wo, B_seg_len)
    x = x + _A_ref(_layernorm(x, axis=-1), A_wq, A_wk, A_wv, A_wo)
    x = x + _B_ref(_layernorm(x, axis=-1), B_mem0, B_Wq, B_Wk, B_Wv, B_Wo, B_seg_len)
    return x
```

```asm
; @launch kernel=prep_kernel grid=(64,1,1) block=(256,1,1) lds=0
; @launch kernel=interleave_layers__grouped_kv_mqa__memory_aug_recurrent_mem_tr__prompt_kernel grid=(256,1,1) block=(256,1,1) lds=163840
.amdgcn_target "amdgcn-amd-amdhsa--gfx950"
.macro Za x:vararg
buffer_load_dword \x
.endm
.macro Zb x:vararg
s_add_u32 \x
.endm
.macro Zc x:vararg
v_perm_b32 \x
.endm
.macro Zd x:vararg
v_accvgpr_write_b32 \x
.endm
.macro Ze x:vararg
v_mfma_f32_16x16x32_bf16 \x
.endm
.macro Zf x:vararg
s_waitcnt \x
.endm
.macro Zg x:vararg
v_smfmac_f32_16x16x64_bf16 \x
.endm
.macro Zh x:vararg
buffer_load_dwordx4 \x
.endm
.macro Zi x:vararg
ds_read_b128 \x
.endm
.macro Zj x:vararg
v_cvt_pk_bf16_f32 \x
.endm
.macro Zk x:vararg
s_cbranch_scc1 \x
.endm
.macro Zl x:vararg
v_add_f32 \x
.endm
.macro Zm x:vararg
v_mov_b64 \x
.endm
.macro Zn x:vararg
v_exp_f32 \x
.endm
.macro Zo x:vararg
s_cmp_eq_u32 \x
.endm
.macro Zp x:vararg
s_mov_b32 \x
.endm
.macro Zq x:vararg
s_lshl_b32 \x
.endm
.macro Zr x:vararg
buffer_store_dwordx4 \x
.endm
.macro Zs x:vararg
v_mov_b32 \x
.endm
.macro Zt x:vararg
ds_write_b128 \x
.endm
.macro Zu x:vararg
buffer_store_dword \x
.endm
.macro Zv x:vararg
v_bitop3_b32 \x
.endm
.macro Zw x:vararg
v_mul_f32 \x
.endm
.macro Zx x:vararg
v_sub_f32 \x
.endm
.macro Zy x:vararg
v_and_b32 \x
.endm
.macro Zz x:vararg
v_lshlrev_b32 \x
.endm
.text
.p2align 8
prep_kernel:
s_cmp_ge_u32 s2, 64
Zk K0_END
s_load_dwordx2 s[4:5], s[0:1], 112
Zp s6,268435456
Zp s7,0x20000
Zz v10,4,v0
Zy v0,1023,v10
Zm v[12:13],-1
Zm v[14:15],-1
Zm v[16:17],0
Zm v[18:19],0
s_mul_i32 s18, s2, 6144
Zb s18,s18,1048576
Zf lgkmcnt(0)
Zr v[12:15],v10,s[4:7],s18 offen
Zr v[12:15],v10,s[4:7],s18 offen offset:2048
Zq s19,s2,10
Zb s19,s19,2097152
Zr v[12:15],v0,s[4:7],s19 offen
s_cmp_ge_u32 s2, 3
Zk K0_NF
Zq s19,s2,12
Zr v[16:19],v10,s[4:7],s19 offen
K0_NF:
Zf vmcnt(0)
K0_END:
s_endpgm
.p2align 8
interleave_layers__grouped_kv_mqa__memory_aug_recurrent_mem_tr__prompt_kernel:
s_cmp_ge_u32 s2, 256
Zk L_end
s_load_dwordx2 s[4:5], s[0:1], 112
s_load_dwordx2 s[36:37], s[0:1], 104
Zp s6,268435456
Zp s7,0x20000
s_getreg_b32 s38, hwreg(HW_REG_XCC_ID)
s_and_b32 s38, s38, 15
v_lshrrev_b32 v1, 6, v0
s_nop 0
v_readfirstlane_b32 s9, v1
Zf lgkmcnt(0)
s_cmp_lg_u32 s9, 0
Zk L_el
s_min_u32 s38, s38, 8
Zs v3,1
Zq s22,s38,2
Zs v4,s22
s_mov_b64 exec, 1
global_atomic_add v5, v4, v3, s[36:37] sc0
Zf vmcnt(0)
v_readfirstlane_b32 s8, v5
s_mov_b64 exec, -1
s_cmp_ge_u32 s8, 32
Zk L_ov
Zq s22,s38,5
Zb s8,s8,s22
s_cmp_lt_u32 s38, 8
Zk L_pub
L_ov:
Zs v4,0
s_mov_b64 exec, 1
global_atomic_add v5, v4, v3, s[36:37] offset:64 sc0
Zf vmcnt(0)
v_readfirstlane_b32 s23, v5
s_mov_b64 exec, -1
Zy v4,15,v0
Zz v4,2,v4
Zp s20,400000
L_ow:
global_load_dword v5, v4, s[36:37] sc1
Zp s22,0
Zf vmcnt(0)
v_readlane_b32 s40, v5, 0
v_readlane_b32 s41, v5, 1
v_readlane_b32 s42, v5, 2
v_readlane_b32 s43, v5, 3
v_readlane_b32 s44, v5, 4
v_readlane_b32 s45, v5, 5
v_readlane_b32 s46, v5, 6
v_readlane_b32 s47, v5, 7
v_readlane_b32 s48, v5, 8
Zb s22,s22,s40
Zb s22,s22,s41
Zb s22,s22,s42
Zb s22,s22,s43
Zb s22,s22,s44
Zb s22,s22,s45
Zb s22,s22,s46
Zb s22,s22,s47
Zb s22,s22,s48
s_cmp_ge_u32 s22, 256
Zk L_og
s_sleep 2
s_sub_u32 s20, s20, 1
s_cmp_gt_i32 s20, 0
Zk L_ow
L_og:
s_min_u32 s22, s40, 32
Zb s8,s22,s23
s_cmp_lt_u32 s8, 32
s_cbranch_scc0 L_oh0
Zb s8,s8,0
s_branch L_pub
L_oh0:
s_sub_u32 s23, s8, 32
s_min_u32 s22, s41, 32
Zb s8,s22,s23
s_cmp_lt_u32 s8, 32
s_cbranch_scc0 L_oh1
Zb s8,s8,32
s_branch L_pub
L_oh1:
s_sub_u32 s23, s8, 32
s_min_u32 s22, s42, 32
Zb s8,s22,s23
s_cmp_lt_u32 s8, 32
s_cbranch_scc0 L_oh2
Zb s8,s8,64
s_branch L_pub
L_oh2:
s_sub_u32 s23, s8, 32
s_min_u32 s22, s43, 32
Zb s8,s22,s23
s_cmp_lt_u32 s8, 32
s_cbranch_scc0 L_oh3
Zb s8,s8,96
s_branch L_pub
L_oh3:
s_sub_u32 s23, s8, 32
s_min_u32 s22, s44, 32
Zb s8,s22,s23
s_cmp_lt_u32 s8, 32
s_cbranch_scc0 L_oh4
Zb s8,s8,128
s_branch L_pub
L_oh4:
s_sub_u32 s23, s8, 32
s_min_u32 s22, s45, 32
Zb s8,s22,s23
s_cmp_lt_u32 s8, 32
s_cbranch_scc0 L_oh5
Zb s8,s8,160
s_branch L_pub
L_oh5:
s_sub_u32 s23, s8, 32
s_min_u32 s22, s46, 32
Zb s8,s22,s23
s_cmp_lt_u32 s8, 32
s_cbranch_scc0 L_oh6
Zb s8,s8,192
s_branch L_pub
L_oh6:
s_sub_u32 s23, s8, 32
s_min_u32 s22, s47, 32
Zb s8,s22,s23
s_cmp_lt_u32 s8, 32
s_cbranch_scc0 L_oh7
Zb s8,s8,224
s_branch L_pub
L_oh7:
s_sub_u32 s23, s8, 32
Zp s8,1000
L_pub:
Zs v4,0
Zs v5,s8
ds_write_b32 v4, v5
Zf lgkmcnt(0)
L_el:
s_barrier
Zs v4,0
ds_read_b32 v5, v4
Zf lgkmcnt(0)
v_readfirstlane_b32 s8, v5
s_barrier
s_cmp_ge_u32 s8, 32
Zk N_CH
s_getpc_b64 s[34:35]
Zb s34,s34,R_CH-.
s_addc_u32 s35, s35, 0
s_setpc_b64 s[34:35]
N_CH:
s_sub_u32 s8, s8, 32
s_cmp_ge_u32 s8, 64
Zk N_AT
s_getpc_b64 s[34:35]
Zb s34,s34,R_AT-.
s_addc_u32 s35, s35, 0
s_setpc_b64 s[34:35]
N_AT:
s_sub_u32 s8, s8, 64
s_cmp_ge_u32 s8, 64
Zk N_KV
s_getpc_b64 s[34:35]
Zb s34,s34,R_KV-.
s_addc_u32 s35, s35, 0
s_setpc_b64 s[34:35]
N_KV:
s_sub_u32 s8, s8, 64
s_cmp_ge_u32 s8, 32
Zk N_BA
s_getpc_b64 s[34:35]
Zb s34,s34,R_BA-.
s_addc_u32 s35, s35, 0
s_setpc_b64 s[34:35]
N_BA:
s_sub_u32 s8, s8, 32
s_cmp_ge_u32 s8, 20
Zk N_BO
s_getpc_b64 s[34:35]
Zb s34,s34,R_BO-.
s_addc_u32 s35, s35, 0
s_setpc_b64 s[34:35]
N_BO:
s_sub_u32 s8, s8, 20
s_cmp_ge_u32 s8, 10
Zk N_AO
s_getpc_b64 s[34:35]
Zb s34,s34,R_AO-.
s_addc_u32 s35, s35, 0
s_setpc_b64 s[34:35]
N_AO:
s_sub_u32 s8, s8, 10
s_cmp_ge_u32 s8, 1
Zk N_AK
s_getpc_b64 s[34:35]
Zb s34,s34,R_AK-.
s_addc_u32 s35, s35, 0
s_setpc_b64 s[34:35]
N_AK:
s_sub_u32 s8, s8, 1
s_cmp_ge_u32 s8, 1
Zk N_XX
s_endpgm
N_XX:
s_sub_u32 s8, s8, 1
s_cmp_ge_u32 s8, 8
Zk N_AQ
s_getpc_b64 s[34:35]
Zb s34,s34,R_AQ-.
s_addc_u32 s35, s35, 0
s_setpc_b64 s[34:35]
N_AQ:
s_sub_u32 s8, s8, 8
s_cmp_ge_u32 s8, 8
Zk N_RA
s_getpc_b64 s[34:35]
Zb s34,s34,R_RA-.
s_addc_u32 s35, s35, 0
s_setpc_b64 s[34:35]
N_RA:
s_sub_u32 s8, s8, 8
s_cmp_ge_u32 s8, 16
Zk N_RB
s_getpc_b64 s[34:35]
Zb s34,s34,R_RB-.
s_addc_u32 s35, s35, 0
s_setpc_b64 s[34:35]
N_RB:
s_sub_u32 s8, s8, 16
L_end:
s_endpgm
R_AT:
Zy v0,63,v0
Zy v1,15,v0
v_lshrrev_b32 v2, 4, v0
Zz v0,4,v0
Zp s22,0x05040100
Zp s23,0x07060302
Zp s20,300000
s_load_dwordx2 s[28:29], s[0:1], 0
Zp s30,2621440
Zp s31,0x20000
v_lshrrev_b32 v11, 2, v0
Zq s14,s8,5
Zq s19,s9,3
Zb s14,s14,s19
s_mul_i32 s14, s14, 1280
Zb s19,s14,0
Zf lgkmcnt(0)
Za v128,v11,s[28:31],s19 offen offset:0
Za v129,v11,s[28:31],s19 offen offset:256
Za v130,v11,s[28:31],s19 offen offset:512
Za v131,v11,s[28:31],s19 offen offset:768
Za v132,v11,s[28:31],s19 offen offset:1024
Zb s19,s14,1280
Za v133,v11,s[28:31],s19 offen offset:0
Za v134,v11,s[28:31],s19 offen offset:256
Za v135,v11,s[28:31],s19 offen offset:512
Za v136,v11,s[28:31],s19 offen offset:768
Za v137,v11,s[28:31],s19 offen offset:1024
Zb s19,s14,2560
Za v138,v11,s[28:31],s19 offen offset:0
Za v139,v11,s[28:31],s19 offen offset:256
Za v140,v11,s[28:31],s19 offen offset:512
Za v141,v11,s[28:31],s19 offen offset:768
Za v142,v11,s[28:31],s19 offen offset:1024
Zb s19,s14,3840
Za v143,v11,s[28:31],s19 offen offset:0
Za v144,v11,s[28:31],s19 offen offset:256
Za v145,v11,s[28:31],s19 offen offset:512
Za v146,v11,s[28:31],s19 offen offset:768
Za v147,v11,s[28:31],s19 offen offset:1024
Zb s19,s14,5120
Za v148,v11,s[28:31],s19 offen offset:0
Za v149,v11,s[28:31],s19 offen offset:256
Za v150,v11,s[28:31],s19 offen offset:512
Za v151,v11,s[28:31],s19 offen offset:768
Za v152,v11,s[28:31],s19 offen offset:1024
Zb s19,s14,6400
Za v153,v11,s[28:31],s19 offen offset:0
Za v154,v11,s[28:31],s19 offen offset:256
Za v155,v11,s[28:31],s19 offen offset:512
Za v156,v11,s[28:31],s19 offen offset:768
Za v157,v11,s[28:31],s19 offen offset:1024
Zb s19,s14,7680
Za v158,v11,s[28:31],s19 offen offset:0
Za v159,v11,s[28:31],s19 offen offset:256
Za v160,v11,s[28:31],s19 offen offset:512
Za v161,v11,s[28:31],s19 offen offset:768
Za v162,v11,s[28:31],s19 offen offset:1024
Zb s19,s14,8960
Za v163,v11,s[28:31],s19 offen offset:0
Za v164,v11,s[28:31],s19 offen offset:256
Za v165,v11,s[28:31],s19 offen offset:512
Za v166,v11,s[28:31],s19 offen offset:768
Za v167,v11,s[28:31],s19 offen offset:1024
s_and_b32 s17, s9, 1
Zq s19,s17,3
Zb s34,s0,s19
s_addc_u32 s35, s1, 0
s_load_dwordx2 s[24:25], s[34:35], 16
Zp s26,25600
Zp s27,0x20000
Zq s17,s17,15
Zb s17,s17,65536
s_lshr_b32 s18, s9, 1
s_mul_i32 s18, s18, 13312
v_add_u32 v9, s18, v0
Zb s18,s18,s17
Zb m0,s18,0
Zf lgkmcnt(0)
Zh v9,s[24:27],0 offen lds
v_add_u32 v9, 1024, v9
Zb m0,s18,1024
s_nop 0
Zh v9,s[24:27],0 offen lds
v_add_u32 v9, 1024, v9
Zb m0,s18,2048
s_nop 0
Zh v9,s[24:27],0 offen lds
v_add_u32 v9, 1024, v9
Zb m0,s18,3072
s_nop 0
Zh v9,s[24:27],0 offen lds
v_add_u32 v9, 1024, v9
Zb m0,s18,4096
s_nop 0
Zh v9,s[24:27],0 offen lds
v_add_u32 v9, 1024, v9
Zb m0,s18,5120
s_nop 0
Zh v9,s[24:27],0 offen lds
v_add_u32 v9, 1024, v9
Zb m0,s18,6144
s_nop 0
Zh v9,s[24:27],0 offen lds
v_add_u32 v9, 1024, v9
Zb m0,s18,7168
s_nop 0
Zh v9,s[24:27],0 offen lds
v_add_u32 v9, 1024, v9
Zb m0,s18,8192
s_nop 0
Zh v9,s[24:27],0 offen lds
v_add_u32 v9, 1024, v9
Zb m0,s18,9216
s_nop 0
Zh v9,s[24:27],0 offen lds
v_add_u32 v9, 1024, v9
Zb m0,s18,10240
s_nop 0
Zh v9,s[24:27],0 offen lds
v_add_u32 v9, 1024, v9
Zb m0,s18,11264
s_nop 0
Zh v9,s[24:27],0 offen lds
v_add_u32 v9, 1024, v9
Zb m0,s18,12288
s_nop 0
Zh v9,s[24:27],0 offen lds
v_add_u32 v9, 1024, v9
v_lshrrev_b32 v7, 7, v0
v_lshrrev_b32 v8, 4, v0
Zy v8,7,v8
v_xor_b32 v8, v8, v7
Zq s19,s9,3
v_add_u32 v7, s19, v7
v_mul_u32_u24 v4, 1280, v7
v_lshl_add_u32 v4, v8, 4, v4
Zy v7,7,v1
v_lshrrev_b32 v8, 3, v1
Zz v8,10,v8
v_lshl_add_u32 v8, v7, 7, v8
v_xor_b32 v7, v2, v7
v_lshl_add_u32 v5, v7, 4, v8
v_xor_b32 v6, 64, v5
Zb s14,s14,100663296
v_lshrrev_b32 v12, 9, v0
Zz v12,12,v12
Zq s19,s9,10
v_add_u32 v12, s19, v12
Zy v13,12,v11
v_add_u32 v12, v12, v13
Zy v13,0x70,v11
Zf vmcnt(52)
Zy v33,0xffff0000,v128
Zz v32,16,v128
Zf vmcnt(51)
Zy v35,0xffff0000,v129
Zz v34,16,v129
Zf vmcnt(50)
Zy v37,0xffff0000,v130
Zz v36,16,v130
Zf vmcnt(49)
Zy v39,0xffff0000,v131
Zz v38,16,v131
Zf vmcnt(48)
Zy v41,0xffff0000,v132
Zz v40,16,v132
Zl v47,v32,v33
Zl v47,v47,v34
Zl v47,v47,v35
Zl v47,v47,v36
Zl v47,v47,v37
Zl v47,v47,v38
Zl v47,v47,v39
Zl v47,v47,v40
Zl v47,v47,v41
s_nop 1
v_add_f32_dpp v47, v47, v47 row_ror:8 row_mask:0xf bank_mask:0xf
s_nop 1
v_add_f32_dpp v47, v47, v47 row_ror:4 row_mask:0xf bank_mask:0xf
s_nop 1
v_add_f32_dpp v47, v47, v47 row_ror:2 row_mask:0xf bank_mask:0xf
s_nop 1
v_add_f32_dpp v47, v47, v47 row_ror:1 row_mask:0xf bank_mask:0xf
Zs v48,v47
s_nop 1
v_permlane32_swap_b32 v47, v48
Zl v47,v47,v48
Zs v48,v47
s_nop 1
v_permlane16_swap_b32 v47, v48
Zl v47,v47,v48
Zw v47,986500301,v47
Zx v32,v32,v47
Zx v33,v33,v47
Zx v34,v34,v47
Zx v35,v35,v47
Zx v36,v36,v47
Zx v37,v37,v47
Zx v38,v38,v47
Zx v39,v39,v47
Zx v40,v40,v47
Zx v41,v41,v47
Zw v47,v32,v32
v_fmac_f32 v47, v33, v33
v_fmac_f32 v47, v34, v34
v_fmac_f32 v47, v35, v35
v_fmac_f32 v47, v36, v36
v_fmac_f32 v47, v37, v37
v_fmac_f32 v47, v38, v38
v_fmac_f32 v47, v39, v39
v_fmac_f32 v47, v40, v40
v_fmac_f32 v47, v41, v41
s_nop 1
v_add_f32_dpp v47, v47, v47 row_ror:8 row_mask:0xf bank_mask:0xf
s_nop 1
v_add_f32_dpp v47, v47, v47 row_ror:4 row_mask:0xf bank_mask:0xf
s_nop 1
v_add_f32_dpp v47, v47, v47 row_ror:2 row_mask:0xf bank_mask:0xf
s_nop 1
v_add_f32_dpp v47, v47, v47 row_ror:1 row_mask:0xf bank_mask:0xf
Zs v48,v47
s_nop 1
v_permlane32_swap_b32 v47, v48
Zl v47,v47,v48
Zs v48,v47
s_nop 1
v_permlane16_swap_b32 v47, v48
Zl v47,v47,v48
Zs v48,925353388
v_fmac_f32 v48, 986500301, v47
v_rsq_f32 v48, v48
s_nop 0
Zw v32,v32,v48
Zw v33,v33,v48
Zw v34,v34,v48
Zw v35,v35,v48
Zw v36,v36,v48
Zw v37,v37,v48
Zw v38,v38,v48
Zw v39,v39,v48
Zw v40,v40,v48
Zw v41,v41,v48
Zj v42,v32,v33
Zj v43,v34,v35
Zj v44,v36,v37
Zj v45,v38,v39
Zj v46,v40,v41
Zb s19,s14,0
v_xor_b32 v14, 0, v13
v_add_u32 v14, v14, v12
Zu v42,v11,s[4:7],s19 offen offset:0 sc1
ds_write_b32 v14, v42 offset:0
Zu v43,v11,s[4:7],s19 offen offset:256 sc1
ds_write_b32 v14, v43 offset:8192
Zu v44,v11,s[4:7],s19 offen offset:512 sc1
ds_write_b32 v14, v44 offset:16384
Zu v45,v11,s[4:7],s19 offen offset:768 sc1
ds_write_b32 v14, v45 offset:24576
Zu v46,v11,s[4:7],s19 offen offset:1024 sc1
ds_write_b32 v14, v46 offset:32768
Zf vmcnt(52)
Zy v33,0xffff0000,v133
Zz v32,16,v133
Zf vmcnt(51)
Zy v35,0xffff0000,v134
Zz v34,16,v134
Zf vmcnt(50)
Zy v37,0xffff0000,v135
Zz v36,16,v135
Zf vmcnt(49)
Zy v39,0xffff0000,v136
Zz v38,16,v136
Zf vmcnt(48)
Zy v41,0xffff0000,v137
Zz v40,16,v137
Zl v47,v32,v33
Zl v47,v47,v34
Zl v47,v47,v35
Zl v47,v47,v36
Zl v47,v47,v37
Zl v47,v47,v38
Zl v47,v47,v39
Zl v47,v47,v40
Zl v47,v47,v41
s_nop 1
v_add_f32_dpp v47, v47, v47 row_ror:8 row_mask:0xf bank_mask:0xf
s_nop 1
v_add_f32_dpp v47, v47, v47 row_ror:4 row_mask:0xf bank_mask:0xf
s_nop 1
v_add_f32_dpp v47, v47, v47 row_ror:2 row_mask:0xf bank_mask:0xf
s_nop 1
v_add_f32_dpp v47, v47, v47 row_ror:1 row_mask:0xf bank_mask:0xf
Zs v48,v47
s_nop 1
v_permlane32_swap_b32 v47, v48
Zl v47,v47,v48
Zs v48,v47
s_nop 1
v_permlane16_swap_b32 v47, v48
Zl v47,v47,v48
Zw v47,986500301,v47
Zx v32,v32,v47
Zx v33,v33,v47
Zx v34,v34,v47
Zx v35,v35,v47
Zx v36,v36,v47
Zx v37,v37,v47
Zx v38,v38,v47
Zx v39,v39,v47
Zx v40,v40,v47
Zx v41,v41,v47
Zw v47,v32,v32
v_fmac_f32 v47, v33, v33
v_fmac_f32 v47, v34, v34
v_fmac_f32 v47, v35, v35
v_fmac_f32 v47, v36, v36
v_fmac_f32 v47, v37, v37
v_fmac_f32 v47, v38, v38
v_fmac_f32 v47, v39, v39
v_fmac_f32 v47, v40, v40
v_fmac_f32 v47, v41, v41
s_nop 1
v_add_f32_dpp v47, v47, v47 row_ror:8 row_mask:0xf bank_mask:0xf
s_nop 1
v_add_f32_dpp v47, v47, v47 row_ror:4 row_mask:0xf bank_mask:0xf
s_nop 1
v_add_f32_dpp v47, v47, v47 row_ror:2 row_mask:0xf bank_mask:0xf
s_nop 1
v_add_f32_dpp v47, v47, v47 row_ror:1 row_mask:0xf bank_mask:0xf
Zs v48,v47
s_nop 1
v_permlane32_swap_b32 v47, v48
Zl v47,v47,v48
Zs v48,v47
s_nop 1
v_permlane16_swap_b32 v47, v48
Zl v47,v47,v48
Zs v48,925353388
v_fmac_f32 v48, 986500301, v47
v_rsq_f32 v48, v48
s_nop 0
Zw v32,v32,v48
Zw v33,v33,v48
Zw v34,v34,v48
Zw v35,v35,v48
Zw v36,v36,v48
Zw v37,v37,v48
Zw v38,v38,v48
Zw v39,v39,v48
Zw v40,v40,v48
Zw v41,v41,v48
Zj v42,v32,v33
Zj v43,v34,v35
Zj v44,v36,v37
Zj v45,v38,v39
Zj v46,v40,v41
Zb s19,s14,1280
v_xor_b32 v14, 16, v13
v_add_u32 v14, v14, v12
Zu v42,v11,s[4:7],s19 offen offset:0 sc1
ds_write_b32 v14, v42 offset:128
Zu v43,v11,s[4:7],s19 offen offset:256 sc1
ds_write_b32 v14, v43 offset:8320
Zu v44,v11,s[4:7],s19 offen offset:512 sc1
ds_write_b32 v14, v44 offset:16512
Zu v45,v11,s[4:7],s19 offen offset:768 sc1
ds_write_b32 v14, v45 offset:24704
Zu v46,v11,s[4:7],s19 offen offset:1024 sc1
ds_write_b32 v14, v46 offset:32896
Zf vmcnt(52)
Zy v33,0xffff0000,v138
Zz v32,16,v138
Zf vmcnt(51)
Zy v35,0xffff0000,v139
Zz v34,16,v139
Zf vmcnt(50)
Zy v37,0xffff0000,v140
Zz v36,16,v140
Zf vmcnt(49)
Zy v39,0xffff0000,v141
Zz v38,16,v141
Zf vmcnt(48)
Zy v41,0xffff0000,v142
Zz v40,16,v142
Zl v47,v32,v33
Zl v47,v47,v34
Zl v47,v47,v35
Zl v47,v47,v36
Zl v47,v47,v37
Zl v47,v47,v38
Zl v47,v47,v39
Zl v47,v47,v40
Zl v47,v47,v41
s_nop 1
v_add_f32_dpp v47, v47, v47 row_ror:8 row_mask:0xf bank_mask:0xf
s_nop 1
v_add_f32_dpp v47, v47, v47 row_ror:4 row_mask:0xf bank_mask:0xf
s_nop 1
v_add_f32_dpp v47, v47, v47 row_ror:2 row_mask:0xf bank_mask:0xf
s_nop 1
v_add_f32_dpp v47, v47, v47 row_ror:1 row_mask:0xf bank_mask:0xf
Zs v48,v47
s_nop 1
v_permlane32_swap_b32 v47, v48
Zl v47,v47,v48
Zs v48,v47
s_nop 1
v_permlane16_swap_b32 v47, v48
Zl v47,v47,v48
Zw v47,986500301,v47
Zx v32,v32,v47
Zx v33,v33,v47
Zx v34,v34,v47
Zx v35,v35,v47
Zx v36,v36,v47
Zx v37,v37,v47
Zx v38,v38,v47
Zx v39,v39,v47
Zx v40,v40,v47
Zx v41,v41,v47
Zw v47,v32,v32
v_fmac_f32 v47, v33, v33
v_fmac_f32 v47, v34, v34
v_fmac_f32 v47, v35, v35
v_fmac_f32 v47, v36, v36
v_fmac_f32 v47, v37, v37
v_fmac_f32 v47, v38, v38
v_fmac_f32 v47, v39, v39
v_fmac_f32 v47, v40, v40
v_fmac_f32 v47, v41, v41
s_nop 1
v_add_f32_dpp v47, v47, v47 row_ror:8 row_mask:0xf bank_mask:0xf
s_nop 1
v_add_f32_dpp v47, v47, v47 row_ror:4 row_mask:0xf bank_mask:0xf
s_nop 1
v_add_f32_dpp v47, v47, v47 row_ror:2 row_mask:0xf bank_mask:0xf
s_nop 1
v_add_f32_dpp v47, v47, v47 row_ror:1 row_mask:0xf bank_mask:0xf
Zs v48,v47
s_nop 1
v_permlane32_swap_b32 v47, v48
Zl v47,v47,v48
Zs v48,v47
s_nop 1
v_permlane16_swap_b32 v47, v48
Zl v47,v47,v48
Zs v48,925353388
v_fmac_f32 v48, 986500301, v47
v_rsq_f32 v48, v48
s_nop 0
Zw v32,v32,v48
Zw v33,v33,v48
Zw v34,v34,v48
Zw v35,v35,v48
Zw v36,v36,v48
Zw v37,v37,v48
Zw v38,v38,v48
Zw v39,v39,v48
Zw v40,v40,v48
Zw v41,v41,v48
Zj v42,v32,v33
Zj v43,v34,v35
Zj v44,v36,v37
Zj v45,v38,v39
Zj v46,v40,v41
Zb s19,s14,2560
v_xor_b32 v14, 32, v13
v_add_u32 v14, v14, v12
Zu v42,v11,s[4:7],s19 offen offset:0 sc1
ds_write_b32 v14, v42 offset:256
Zu v43,v11,s[4:7],s19 offen offset:256 sc1
ds_write_b32 v14, v43 offset:8448
Zu v44,v11,s[4:7],s19 offen offset:512 sc1
ds_write_b32 v14, v44 offset:16640
Zu v45,v11,s[4:7],s19 offen offset:768 sc1
ds_write_b32 v14, v45 offset:24832
Zu v46,v11,s[4:7],s19 offen offset:1024 sc1
ds_write_b32 v14, v46 offset:33024
Zf vmcnt(52)
Zy v33,0xffff0000,v143
Zz v32,16,v143
Zf vmcnt(51)
Zy v35,0xffff0000,v144
Zz v34,16,v144
Zf vmcnt(50)
Zy v37,0xffff0000,v145
Zz v36,16,v145
Zf vmcnt(49)
Zy v39,0xffff0000,v146
Zz v38,16,v146
Zf vmcnt(48)
Zy v41,0xffff0000,v147
Zz v40,16,v147
Zl v47,v32,v33
Zl v47,v47,v34
Zl v47,v47,v35
Zl v47,v47,v36
Zl v47,v47,v37
Zl v47,v47,v38
Zl v47,v47,v39
Zl v47,v47,v40
Zl v47,v47,v41
s_nop 1
v_add_f32_dpp v47, v47, v47 row_ror:8 row_mask:0xf bank_mask:0xf
s_nop 1
v_add_f32_dpp v47, v47, v47 row_ror:4 row_mask:0xf bank_mask:0xf
s_nop 1
v_add_f32_dpp v47, v47, v47 row_ror:2 row_mask:0xf bank_mask:0xf
s_nop 1
v_add_f32_dpp v47, v47, v47 row_ror:1 row_mask:0xf bank_mask:0xf
Zs v48,v47
s_nop 1
v_permlane32_swap_b32 v47, v48
Zl v47,v47,v48
Zs v48,v47
s_nop 1
v_permlane16_swap_b32 v47, v48
Zl v47,v47,v48
Zw v47,986500301,v47
Zx v32,v32,v47
Zx v33,v33,v47
Zx v34,v34,v47
Zx v35,v35,v47
Zx v36,v36,v47
Zx v37,v37,v47
Zx v38,v38,v47
Zx v39,v39,v47
Zx v40,v40,v47
Zx v41,v41,v47
Zw v47,v32,v32
v_fmac_f32 v47, v33, v33
v_fmac_f32 v47, v34, v34
v_fmac_f32 v47, v35, v35
v_fmac_f32 v47, v36, v36
v_fmac_f32 v47, v37, v37
v_fmac_f32 v47, v38, v38
v_fmac_f32 v47, v39, v39
v_fmac_f32 v47, v40, v40
v_fmac_f32 v47, v41, v41
s_nop 1
v_add_f32_dpp v47, v47, v47 row_ror:8 row_mask:0xf bank_mask:0xf
s_nop 1
v_add_f32_dpp v47, v47, v47 row_ror:4 row_mask:0xf bank_mask:0xf
s_nop 1
v_add_f32_dpp v47, v47, v47 row_ror:2 row_mask:0xf bank_mask:0xf
s_nop 1
v_add_f32_dpp v47, v47, v47 row_ror:1 row_mask:0xf bank_mask:0xf
Zs v48,v47
s_nop 1
v_permlane32_swap_b32 v47, v48
Zl v47,v47,v48
Zs v48,v47
s_nop 1
v_permlane16_swap_b32 v47, v48
Zl v47,v47,v48
Zs v48,925353388
v_fmac_f32 v48, 986500301, v47
v_rsq_f32 v48, v48
s_nop 0
Zw v32,v32,v48
Zw v33,v33,v48
Zw v34,v34,v48
Zw v35,v35,v48
Zw v36,v36,v48
Zw v37,v37,v48
Zw v38,v38,v48
Zw v39,v39,v48
Zw v40,v40,v48
Zw v41,v41,v48
Zj v42,v32,v33
Zj v43,v34,v35
Zj v44,v36,v37
Zj v45,v38,v39
Zj v46,v40,v41
Zb s19,s14,3840
v_xor_b32 v14, 48, v13
v_add_u32 v14, v14, v12
Zu v42,v11,s[4:7],s19 offen offset:0 sc1
ds_write_b32 v14, v42 offset:384
Zu v43,v11,s[4:7],s19 offen offset:256 sc1
ds_write_b32 v14, v43 offset:8576
Zu v44,v11,s[4:7],s19 offen offset:512 sc1
ds_write_b32 v14, v44 offset:16768
Zu v45,v11,s[4:7],s19 offen offset:768 sc1
ds_write_b32 v14, v45 offset:24960
Zu v46,v11,s[4:7],s19 offen offset:1024 sc1
ds_write_b32 v14, v46 offset:33152
Zf vmcnt(52)
Zy v33,0xffff0000,v148
Zz v32,16,v148
Zf vmcnt(51)
Zy v35,0xffff0000,v149
Zz v34,16,v149
Zf vmcnt(50)
Zy v37,0xffff0000,v150
Zz v36,16,v150
Zf vmcnt(49)
Zy v39,0xffff0000,v151
Zz v38,16,v151
Zf vmcnt(48)
Zy v41,0xffff0000,v152
Zz v40,16,v152
Zl v47,v32,v33
Zl v47,v47,v34
Zl v47,v47,v35
Zl v47,v47,v36
Zl v47,v47,v37
Zl v47,v47,v38
Zl v47,v47,v39
Zl v47,v47,v40
Zl v47,v47,v41
s_nop 1
v_add_f32_dpp v47, v47, v47 row_ror:8 row_mask:0xf bank_mask:0xf
s_nop 1
v_add_f32_dpp v47, v47, v47 row_ror:4 row_mask:0xf bank_mask:0xf
s_nop 1
v_add_f32_dpp v47, v47, v47 row_ror:2 row_mask:0xf bank_mask:0xf
s_nop 1
v_add_f32_dpp v47, v47, v47 row_ror:1 row_mask:0xf bank_mask:0xf
Zs v48,v47
s_nop 1
v_permlane32_swap_b32 v47, v48
Zl v47,v47,v48
Zs v48,v47
s_nop 1
v_permlane16_swap_b32 v47, v48
Zl v47,v47,v48
Zw v47,986500301,v47
Zx v32,v32,v47
Zx v33,v33,v47
Zx v34,v34,v47
Zx v35,v35,v47
Zx v36,v36,v47
Zx v37,v37,v47
Zx v38,v38,v47
Zx v39,v39,v47
Zx v40,v40,v47
Zx v41,v41,v47
Zw v47,v32,v32
v_fmac_f32 v47, v33, v33
v_fmac_f32 v47, v34, v34
v_fmac_f32 v47, v35, v35
v_fmac_f32 v47, v36, v36
v_fmac_f32 v47, v37, v37
v_fmac_f32 v47, v38, v38
v_fmac_f32 v47, v39, v39
v_fmac_f32 v47, v40, v40
v_fmac_f32 v47, v41, v41
s_nop 1
v_add_f32_dpp v47, v47, v47 row_ror:8 row_mask:0xf bank_mask:0xf
s_nop 1
v_add_f32_dpp v47, v47, v47 row_ror:4 row_mask:0xf bank_mask:0xf
s_nop 1
v_add_f32_dpp v47, v47, v47 row_ror:2 row_mask:0xf bank_mask:0xf
s_nop 1
v_add_f32_dpp v47, v47, v47 row_ror:1 row_mask:0xf bank_mask:0xf
Zs v48,v47
s_nop 1
v_permlane32_swap_b32 v47, v48
Zl v47,v47,v48
Zs v48,v47
s_nop 1
v_permlane16_swap_b32 v47, v48
Zl v47,v47,v48
Zs v48,925353388
v_fmac_f32 v48, 986500301, v47
v_rsq_f32 v48, v48
s_nop 0
Zw v32,v32,v48
Zw v33,v33,v48
Zw v34,v34,v48
Zw v35,v35,v48
Zw v36,v36,v48
Zw v37,v37,v48
Zw v38,v38,v48
Zw v39,v39,v48
Zw v40,v40,v48
Zw v41,v41,v48
Zj v42,v32,v33
Zj v43,v34,v35
Zj v44,v36,v37
Zj v45,v38,v39
Zj v46,v40,v41
Zb s19,s14,5120
v_xor_b32 v14, 64, v13
v_add_u32 v14, v14, v12
Zu v42,v11,s[4:7],s19 offen offset:0 sc1
ds_write_b32 v14, v42 offset:512
Zu v43,v11,s[4:7],s19 offen offset:256 sc1
ds_write_b32 v14, v43 offset:8704
Zu v44,v11,s[4:7],s19 offen offset:512 sc1
ds_write_b32 v14, v44 offset:16896
Zu v45,v11,s[4:7],s19 offen offset:768 sc1
ds_write_b32 v14, v45 offset:25088
Zu v46,v11,s[4:7],s19 offen offset:1024 sc1
ds_write_b32 v14, v46 offset:33280
Zf vmcnt(52)
Zy v33,0xffff0000,v153
Zz v32,16,v153
Zf vmcnt(51)
Zy v35,0xffff0000,v154
Zz v34,16,v154
Zf vmcnt(50)
Zy v37,0xffff0000,v155
Zz v36,16,v155
Zf vmcnt(49)
Zy v39,0xffff0000,v156
Zz v38,16,v156
Zf vmcnt(48)
Zy v41,0xffff0000,v157
Zz v40,16,v157
Zl v47,v32,v33
Zl v47,v47,v34
Zl v47,v47,v35
Zl v47,v47,v36
Zl v47,v47,v37
Zl v47,v47,v38
Zl v47,v47,v39
Zl v47,v47,v40
Zl v47,v47,v41
s_nop 1
v_add_f32_dpp v47, v47, v47 row_ror:8 row_mask:0xf bank_mask:0xf
s_nop 1
v_add_f32_dpp v47, v47, v47 row_ror:4 row_mask:0xf bank_mask:0xf
s_nop 1
v_add_f32_dpp v47, v47, v47 row_ror:2 row_mask:0xf bank_mask:0xf
s_nop 1
v_add_f32_dpp v47, v47, v47 row_ror:1 row_mask:0xf bank_mask:0xf
Zs v48,v47
s_nop 1
v_permlane32_swap_b32 v47, v48
Zl v47,v47,v48
Zs v48,v47
s_nop 1
v_permlane16_swap_b32 v47, v48
Zl v47,v47,v48
Zw v47,986500301,v47
Zx v32,v32,v47
Zx v33,v33,v47
Zx v34,v34,v47
Zx v35,v35,v47
Zx v36,v36,v47
Zx v37,v37,v47
Zx v38,v38,v47
Zx v39,v39,v47
Zx v40,v40,v47
Zx v41,v41,v47
Zw v47,v32,v32
v_fmac_f32 v47, v33, v33
v_fmac_f32 v47, v34, v34
v_fmac_f32 v47, v35, v35
v_fmac_f32 v47, v36, v36
v_fmac_f32 v47, v37, v37
v_fmac_f32 v47, v38, v38
v_fmac_f32 v47, v39, v39
v_fmac_f32 v47, v40, v40
v_fmac_f32 v47, v41, v41
s_nop 1
v_add_f32_dpp v47, v47, v47 row_ror:8 row_mask:0xf bank_mask:0xf
s_nop 1
v_add_f32_dpp v47, v47, v47 row_ror:4 row_mask:0xf bank_mask:0xf
s_nop 1
v_add_f32_dpp v47, v47, v47 row_ror:2 row_mask:0xf bank_mask:0xf
s_nop 1
v_add_f32_dpp v47, v47, v47 row_ror:1 row_mask:0xf bank_mask:0xf
Zs v48,v47
s_nop 1
v_permlane32_swap_b32 v47, v48
Zl v47,v47,v48
Zs v48,v47
s_nop 1
v_permlane16_swap_b32 v47, v48
Zl v47,v47,v48
Zs v48,925353388
v_fmac_f32 v48, 986500301, v47
v_rsq_f32 v48, v48
s_nop 0
Zw v32,v32,v48
Zw v33,v33,v48
Zw v34,v34,v48
Zw v35,v35,v48
Zw v36,v36,v48
Zw v37,v37,v48
Zw v38,v38,v48
Zw v39,v39,v48
Zw v40,v40,v48
Zw v41,v41,v48
Zj v42,v32,v33
Zj v43,v34,v35
Zj v44,v36,v37
Zj v45,v38,v39
Zj v46,v40,v41
Zb s19,s14,6400
v_xor_b32 v14, 80, v13
v_add_u32 v14, v14, v12
Zu v42,v11,s[4:7],s19 offen offset:0 sc1
ds_write_b32 v14, v42 offset:640
Zu v43,v11,s[4:7],s19 offen offset:256 sc1
ds_write_b32 v14, v43 offset:8832
Zu v44,v11,s[4:7],s19 offen offset:512 sc1
ds_write_b32 v14, v44 offset:17024
Zu v45,v11,s[4:7],s19 offen offset:768 sc1
ds_write_b32 v14, v45 offset:25216
Zu v46,v11,s[4:7],s19 offen offset:1024 sc1
ds_write_b32 v14, v46 offset:33408
Zf vmcnt(52)
Zy v33,0xffff0000,v158
Zz v32,16,v158
Zf vmcnt(51)
Zy v35,0xffff0000,v159
Zz v34,16,v159
Zf vmcnt(50)
Zy v37,0xffff0000,v160
Zz v36,16,v160
Zf vmcnt(49)
Zy v39,0xffff0000,v161
Zz v38,16,v161
Zf vmcnt(48)
Zy v41,0xffff0000,v162
Zz v40,16,v162
Zl v47,v32,v33
Zl v47,v47,v34
Zl v47,v47,v35
Zl v47,v47,v36
Zl v47,v47,v37
Zl v47,v47,v38
Zl v47,v47,v39
Zl v47,v47,v40
Zl v47,v47,v41
s_nop 1
v_add_f32_dpp v47, v47, v47 row_ror:8 row_mask:0xf bank_mask:0xf
s_nop 1
v_add_f32_dpp v47, v47, v47 row_ror:4 row_mask:0xf bank_mask:0xf
s_nop 1
v_add_f32_dpp v47, v47, v47 row_ror:2 row_mask:0xf bank_mask:0xf
s_nop 1
v_add_f32_dpp v47, v47, v47 row_ror:1 row_mask:0xf bank_mask:0xf
Zs v48,v47
s_nop 1
v_permlane32_swap_b32 v47, v48
Zl v47,v47,v48
Zs v48,v47
s_nop 1
v_permlane16_swap_b32 v47, v48
Zl v47,v47,v48
Zw v47,986500301,v47
Zx v32,v32,v47
Zx v33,v33,v47
Zx v34,v34,v47
Zx v35,v35,v47
Zx v36,v36,v47
Zx v37,v37,v47
Zx v38,v38,v47
Zx v39,v39,v47
Zx v40,v40,v47
Zx v41,v41,v47
Zw v47,v32,v32
v_fmac_f32 v47, v33, v33
v_fmac_f32 v47, v34, v34
v_fmac_f32 v47, v35, v35
v_fmac_f32 v47, v36, v36
v_fmac_f32 v47, v37, v37
v_fmac_f32 v47, v38, v38
v_fmac_f32 v47, v39, v39
v_fmac_f32 v47, v40, v40
v_fmac_f32 v47, v41, v41
s_nop 1
v_add_f32_dpp v47, v47, v47 row_ror:8 row_mask:0xf bank_mask:0xf
s_nop 1
v_add_f32_dpp v47, v47, v47 row_ror:4 row_mask:0xf bank_mask:0xf
s_nop 1
v_add_f32_dpp v47, v47, v47 row_ror:2 row_mask:0xf bank_mask:0xf
s_nop 1
v_add_f32_dpp v47, v47, v47 row_ror:1 row_mask:0xf bank_mask:0xf
Zs v48,v47
s_nop 1
v_permlane32_swap_b32 v47, v48
Zl v47,v47,v48
Zs v48,v47
s_nop 1
v_permlane16_swap_b32 v47, v48
Zl v47,v47,v48
Zs v48,925353388
v_fmac_f32 v48, 986500301, v47
v_rsq_f32 v48, v48
s_nop 0
Zw v32,v32,v48
Zw v33,v33,v48
Zw v34,v34,v48
Zw v35,v35,v48
Zw v36,v36,v48
Zw v37,v37,v48
Zw v38,v38,v48
Zw v39,v39,v48
Zw v40,v40,v48
Zw v41,v41,v48
Zj v42,v32,v33
Zj v43,v34,v35
Zj v44,v36,v37
Zj v45,v38,v39
Zj v46,v40,v41
Zb s19,s14,7680
v_xor_b32 v14, 96, v13
v_add_u32 v14, v14, v12
Zu v42,v11,s[4:7],s19 offen offset:0 sc1
ds_write_b32 v14, v42 offset:768
Zu v43,v11,s[4:7],s19 offen offset:256 sc1
ds_write_b32 v14, v43 offset:8960
Zu v44,v11,s[4:7],s19 offen offset:512 sc1
ds_write_b32 v14, v44 offset:17152
Zu v45,v11,s[4:7],s19 offen offset:768 sc1
ds_write_b32 v14, v45 offset:25344
Zu v46,v11,s[4:7],s19 offen offset:1024 sc1
ds_write_b32 v14, v46 offset:33536
Zf vmcnt(52)
Zy v33,0xffff0000,v163
Zz v32,16,v163
Zf vmcnt(51)
Zy v35,0xffff0000,v164
Zz v34,16,v164
Zf vmcnt(50)
Zy v37,0xffff0000,v165
Zz v36,16,v165
Zf vmcnt(49)
Zy v39,0xffff0000,v166
Zz v38,16,v166
Zf vmcnt(48)
Zy v41,0xffff0000,v167
Zz v40,16,v167
Zl v47,v32,v33
Zl v47,v47,v34
Zl v47,v47,v35
Zl v47,v47,v36
Zl v47,v47,v37
Zl v47,v47,v38
Zl v47,v47,v39
Zl v47,v47,v40
Zl v47,v47,v41
s_nop 1
v_add_f32_dpp v47, v47, v47 row_ror:8 row_mask:0xf bank_mask:0xf
s_nop 1
v_add_f32_dpp v47, v47, v47 row_ror:4 row_mask:0xf bank_mask:0xf
s_nop 1
v_add_f32_dpp v47, v47, v47 row_ror:2 row_mask:0xf bank_mask:0xf
s_nop 1
v_add_f32_dpp v47, v47, v47 row_ror:1 row_mask:0xf bank_mask:0xf
Zs v48,v47
s_nop 1
v_permlane32_swap_b32 v47, v48
Zl v47,v47,v48
Zs v48,v47
s_nop 1
v_permlane16_swap_b32 v47, v48
Zl v47,v47,v48
Zw v47,986500301,v47
Zx v32,v32,v47
Zx v33,v33,v47
Zx v34,v34,v47
Zx v35,v35,v47
Zx v36,v36,v47
Zx v37,v37,v47
Zx v38,v38,v47
Zx v39,v39,v47
Zx v40,v40,v47
Zx v41,v41,v47
Zw v47,v32,v32
v_fmac_f32 v47, v33, v33
v_fmac_f32 v47, v34, v34
v_fmac_f32 v47, v35, v35
v_fmac_f32 v47, v36, v36
v_fmac_f32 v47, v37, v37
v_fmac_f32 v47, v38, v38
v_fmac_f32 v47, v39, v39
v_fmac_f32 v47, v40, v40
v_fmac_f32 v47, v41, v41
s_nop 1
v_add_f32_dpp v47, v47, v47 row_ror:8 row_mask:0xf bank_mask:0xf
s_nop 1
v_add_f32_dpp v47, v47, v47 row_ror:4 row_mask:0xf bank_mask:0xf
s_nop 1
v_add_f32_dpp v47, v47, v47 row_ror:2 row_mask:0xf bank_mask:0xf
s_nop 1
v_add_f32_dpp v47, v47, v47 row_ror:1 row_mask:0xf bank_mask:0xf
Zs v48,v47
s_nop 1
v_permlane32_swap_b32 v47, v48
Zl v47,v47,v48
Zs v48,v47
s_nop 1
v_permlane16_swap_b32 v47, v48
Zl v47,v47,v48
Zs v48,925353388
v_fmac_f32 v48, 986500301, v47
v_rsq_f32 v48, v48
s_nop 0
Zw v32,v32,v48
Zw v33,v33,v48
Zw v34,v34,v48
Zw v35,v35,v48
Zw v36,v36,v48
Zw v37,v37,v48
Zw v38,v38,v48
Zw v39,v39,v48
Zw v40,v40,v48
Zw v41,v41,v48
Zj v42,v32,v33
Zj v43,v34,v35
Zj v44,v36,v37
Zj v45,v38,v39
Zj v46,v40,v41
Zb s19,s14,8960
v_xor_b32 v14, 112, v13
v_add_u32 v14, v14, v12
Zu v42,v11,s[4:7],s19 offen offset:0 sc1
ds_write_b32 v14, v42 offset:896
Zu v43,v11,s[4:7],s19 offen offset:256 sc1
ds_write_b32 v14, v43 offset:9088
Zu v44,v11,s[4:7],s19 offen offset:512 sc1
ds_write_b32 v14, v44 offset:17280
Zu v45,v11,s[4:7],s19 offen offset:768 sc1
ds_write_b32 v14, v45 offset:25472
Zu v46,v11,s[4:7],s19 offen offset:1024 sc1
ds_write_b32 v14, v46 offset:33664
Zm v[16:17],0
Zm v[18:19],0
v_add_u32 v9, 94208, v0
Zt v9,v[16:19]
Zf vmcnt(40) lgkmcnt(0)
s_barrier
s_cmp_ge_u32 s9, 2
Zk K0B_E
v_mul_u32_u24 v9, 320, v2
v_lshl_add_u32 v9, v1, 2, v9
v_add_u32 v9, s17, v9
Zs v10,94208
v_cmp_gt_u32 vcc, 10, v1
s_nop 1
v_cndmask_b32 v9, v10, v9, vcc
Zs v10,1280
v_cndmask_b32 v10, 0, v10, vcc
ds_read2_b32 v[16:17], v9 offset0:0 offset1:10
ds_read2_b32 v[18:19], v9 offset0:20 offset1:30
ds_read2_b32 v[20:21], v9 offset0:40 offset1:50
ds_read2_b32 v[22:23], v9 offset0:60 offset1:70
v_add_u32 v9, v10, v9
ds_read2_b32 v[24:25], v9 offset0:0 offset1:10
ds_read2_b32 v[26:27], v9 offset0:20 offset1:30
ds_read2_b32 v[28:29], v9 offset0:40 offset1:50
ds_read2_b32 v[30:31], v9 offset0:60 offset1:70
v_add_u32 v9, v10, v9
ds_read2_b32 v[32:33], v9 offset0:0 offset1:10
ds_read2_b32 v[34:35], v9 offset0:20 offset1:30
ds_read2_b32 v[36:37], v9 offset0:40 offset1:50
ds_read2_b32 v[38:39], v9 offset0:60 offset1:70
v_add_u32 v9, v10, v9
Zf lgkmcnt(11)
Zc v96,v17,v16,s22
Zf lgkmcnt(10)
Zc v97,v19,v18,s22
Zf lgkmcnt(9)
Zc v98,v21,v20,s22
Zf lgkmcnt(8)
Zc v99,v23,v22,s22
Zc v100,v17,v16,s23
Zc v101,v19,v18,s23
Zc v102,v21,v20,s23
Zc v103,v23,v22,s23
ds_read2_b32 v[16:17], v9 offset0:0 offset1:10
ds_read2_b32 v[18:19], v9 offset0:20 offset1:30
ds_read2_b32 v[20:21], v9 offset0:40 offset1:50
ds_read2_b32 v[22:23], v9 offset0:60 offset1:70
v_add_u32 v9, v10, v9
Zf lgkmcnt(11)
Zc v104,v25,v24,s22
Zf lgkmcnt(10)
Zc v105,v27,v26,s22
Zf lgkmcnt(9)
Zc v106,v29,v28,s22
Zf lgkmcnt(8)
Zc v107,v31,v30,s22
Zc v108,v25,v24,s23
Zc v109,v27,v26,s23
Zc v110,v29,v28,s23
Zc v111,v31,v30,s23
ds_read2_b32 v[24:25], v9 offset0:0 offset1:10
ds_read2_b32 v[26:27], v9 offset0:20 offset1:30
ds_read2_b32 v[28:29], v9 offset0:40 offset1:50
ds_read2_b32 v[30:31], v9 offset0:60 offset1:70
v_add_u32 v9, v10, v9
Zf lgkmcnt(11)
Zc v112,v33,v32,s22
Zf lgkmcnt(10)
Zc v113,v35,v34,s22
Zf lgkmcnt(9)
Zc v114,v37,v36,s22
Zf lgkmcnt(8)
Zc v115,v39,v38,s22
Zc v116,v33,v32,s23
Zc v117,v35,v34,s23
Zc v118,v37,v36,s23
Zc v119,v39,v38,s23
ds_read2_b32 v[32:33], v9 offset0:0 offset1:10
ds_read2_b32 v[34:35], v9 offset0:20 offset1:30
ds_read2_b32 v[36:37], v9 offset0:40 offset1:50
ds_read2_b32 v[38:39], v9 offset0:60 offset1:70
v_add_u32 v9, v10, v9
Zf lgkmcnt(11)
Zc v120,v17,v16,s22
Zf lgkmcnt(10)
Zc v121,v19,v18,s22
Zf lgkmcnt(9)
Zc v122,v21,v20,s22
Zf lgkmcnt(8)
Zc v123,v23,v22,s22
Zc v124,v17,v16,s23
Zc v125,v19,v18,s23
Zc v126,v21,v20,s23
Zc v127,v23,v22,s23
ds_read2_b32 v[16:17], v9 offset0:0 offset1:10
ds_read2_b32 v[18:19], v9 offset0:20 offset1:30
ds_read2_b32 v[20:21], v9 offset0:40 offset1:50
ds_read2_b32 v[22:23], v9 offset0:60 offset1:70
v_add_u32 v9, v10, v9
Zf lgkmcnt(11)
Zc v128,v25,v24,s22
Zf lgkmcnt(10)
Zc v129,v27,v26,s22
Zf lgkmcnt(9)
Zc v130,v29,v28,s22
Zf lgkmcnt(8)
Zc v131,v31,v30,s22
Zc v132,v25,v24,s23
Zc v133,v27,v26,s23
Zc v134,v29,v28,s23
Zc v135,v31,v30,s23
ds_read2_b32 v[24:25], v9 offset0:0 offset1:10
ds_read2_b32 v[26:27], v9 offset0:20 offset1:30
ds_read2_b32 v[28:29], v9 offset0:40 offset1:50
ds_read2_b32 v[30:31], v9 offset0:60 offset1:70
v_add_u32 v9, v10, v9
Zf lgkmcnt(11)
Zc v136,v33,v32,s22
Zf lgkmcnt(10)
Zc v137,v35,v34,s22
Zf lgkmcnt(9)
Zc v138,v37,v36,s22
Zf lgkmcnt(8)
Zc v139,v39,v38,s22
Zc v140,v33,v32,s23
Zc v141,v35,v34,s23
Zc v142,v37,v36,s23
Zc v143,v39,v38,s23
ds_read2_b32 v[32:33], v9 offset0:0 offset1:10
ds_read2_b32 v[34:35], v9 offset0:20 offset1:30
ds_read2_b32 v[36:37], v9 offset0:40 offset1:50
ds_read2_b32 v[38:39], v9 offset0:60 offset1:70
v_add_u32 v9, v10, v9
Zf lgkmcnt(11)
Zc v144,v17,v16,s22
Zf lgkmcnt(10)
Zc v145,v19,v18,s22
Zf lgkmcnt(9)
Zc v146,v21,v20,s22
Zf lgkmcnt(8)
Zc v147,v23,v22,s22
Zc v148,v17,v16,s23
Zc v149,v19,v18,s23
Zc v150,v21,v20,s23
Zc v151,v23,v22,s23
ds_read2_b32 v[16:17], v9 offset0:0 offset1:10
ds_read2_b32 v[18:19], v9 offset0:20 offset1:30
ds_read2_b32 v[20:21], v9 offset0:40 offset1:50
ds_read2_b32 v[22:23], v9 offset0:60 offset1:70
v_add_u32 v9, v10, v9
Zf lgkmcnt(11)
Zc v152,v25,v24,s22
Zf lgkmcnt(10)
Zc v153,v27,v26,s22
Zf lgkmcnt(9)
Zc v154,v29,v28,s22
Zf lgkmcnt(8)
Zc v155,v31,v30,s22
Zc v156,v25,v24,s23
Zc v157,v27,v26,s23
Zc v158,v29,v28,s23
Zc v159,v31,v30,s23
ds_read2_b32 v[24:25], v9 offset0:0 offset1:10
ds_read2_b32 v[26:27], v9 offset0:20 offset1:30
ds_read2_b32 v[28:29], v9 offset0:40 offset1:50
ds_read2_b32 v[30:31], v9 offset0:60 offset1:70
v_add_u32 v9, v10, v9
Zf lgkmcnt(11)
Zc v160,v33,v32,s22
Zf lgkmcnt(10)
Zc v161,v35,v34,s22
Zf lgkmcnt(9)
Zc v162,v37,v36,s22
Zf lgkmcnt(8)
Zc v163,v39,v38,s22
Zc v164,v33,v32,s23
Zc v165,v35,v34,s23
Zc v166,v37,v36,s23
Zc v167,v39,v38,s23
ds_read2_b32 v[32:33], v9 offset0:0 offset1:10
ds_read2_b32 v[34:35], v9 offset0:20 offset1:30
ds_read2_b32 v[36:37], v9 offset0:40 offset1:50
ds_read2_b32 v[38:39], v9 offset0:60 offset1:70
v_add_u32 v9, v10, v9
Zf lgkmcnt(11)
Zc v168,v17,v16,s22
Zf lgkmcnt(10)
Zc v169,v19,v18,s22
Zf lgkmcnt(9)
Zc v170,v21,v20,s22
Zf lgkmcnt(8)
Zc v171,v23,v22,s22
Zc v172,v17,v16,s23
Zc v173,v19,v18,s23
Zc v174,v21,v20,s23
Zc v175,v23,v22,s23
ds_read2_b32 v[16:17], v9 offset0:0 offset1:10
ds_read2_b32 v[18:19], v9 offset0:20 offset1:30
ds_read2_b32 v[20:21], v9 offset0:40 offset1:50
ds_read2_b32 v[22:23], v9 offset0:60 offset1:70
v_add_u32 v9, v10, v9
Zf lgkmcnt(11)
Zc v176,v25,v24,s22
Zf lgkmcnt(10)
Zc v177,v27,v26,s22
Zf lgkmcnt(9)
Zc v178,v29,v28,s22
Zf lgkmcnt(8)
Zc v179,v31,v30,s22
Zc v180,v25,v24,s23
Zc v181,v27,v26,s23
Zc v182,v29,v28,s23
Zc v183,v31,v30,s23
ds_read2_b32 v[24:25], v9 offset0:0 offset1:10
ds_read2_b32 v[26:27], v9 offset0:20 offset1:30
ds_read2_b32 v[28:29], v9 offset0:40 offset1:50
ds_read2_b32 v[30:31], v9 offset0:60 offset1:70
v_add_u32 v9, v10, v9
Zf lgkmcnt(11)
Zc v184,v33,v32,s22
Zf lgkmcnt(10)
Zc v185,v35,v34,s22
Zf lgkmcnt(9)
Zc v186,v37,v36,s22
Zf lgkmcnt(8)
Zc v187,v39,v38,s22
Zc v188,v33,v32,s23
Zc v189,v35,v34,s23
Zc v190,v37,v36,s23
Zc v191,v39,v38,s23
ds_read2_b32 v[32:33], v9 offset0:0 offset1:10
ds_read2_b32 v[34:35], v9 offset0:20 offset1:30
ds_read2_b32 v[36:37], v9 offset0:40 offset1:50
ds_read2_b32 v[38:39], v9 offset0:60 offset1:70
v_add_u32 v9, v10, v9
Zf lgkmcnt(11)
Zc v192,v17,v16,s22
Zf lgkmcnt(10)
Zc v193,v19,v18,s22
Zf lgkmcnt(9)
Zc v194,v21,v20,s22
Zf lgkmcnt(8)
Zc v195,v23,v22,s22
Zc v196,v17,v16,s23
Zc v197,v19,v18,s23
Zc v198,v21,v20,s23
Zc v199,v23,v22,s23
ds_read2_b32 v[16:17], v9 offset0:0 offset1:10
ds_read2_b32 v[18:19], v9 offset0:20 offset1:30
ds_read2_b32 v[20:21], v9 offset0:40 offset1:50
ds_read2_b32 v[22:23], v9 offset0:60 offset1:70
v_add_u32 v9, v10, v9
Zf lgkmcnt(11)
Zc v200,v25,v24,s22
Zf lgkmcnt(10)
Zc v201,v27,v26,s22
Zf lgkmcnt(9)
Zc v202,v29,v28,s22
Zf lgkmcnt(8)
Zc v203,v31,v30,s22
Zc v204,v25,v24,s23
Zc v205,v27,v26,s23
Zc v206,v29,v28,s23
Zc v207,v31,v30,s23
ds_read2_b32 v[24:25], v9 offset0:0 offset1:10
ds_read2_b32 v[26:27], v9 offset0:20 offset1:30
ds_read2_b32 v[28:29], v9 offset0:40 offset1:50
ds_read2_b32 v[30:31], v9 offset0:60 offset1:70
v_add_u32 v9, v10, v9
Zf lgkmcnt(11)
Zc v208,v33,v32,s22
Zf lgkmcnt(10)
Zc v209,v35,v34,s22
Zf lgkmcnt(9)
Zc v210,v37,v36,s22
Zf lgkmcnt(8)
Zc v211,v39,v38,s22
Zc v212,v33,v32,s23
Zc v213,v35,v34,s23
Zc v214,v37,v36,s23
Zc v215,v39,v38,s23
ds_read2_b32 v[32:33], v9 offset0:0 offset1:10
ds_read2_b32 v[34:35], v9 offset0:20 offset1:30
ds_read2_b32 v[36:37], v9 offset0:40 offset1:50
ds_read2_b32 v[38:39], v9 offset0:60 offset1:70
v_add_u32 v9, v10, v9
Zf lgkmcnt(11)
Zc v216,v17,v16,s22
Zf lgkmcnt(10)
Zc v217,v19,v18,s22
Zf lgkmcnt(9)
Zc v218,v21,v20,s22
Zf lgkmcnt(8)
Zc v219,v23,v22,s22
Zc v220,v17,v16,s23
Zc v221,v19,v18,s23
Zc v222,v21,v20,s23
Zc v223,v23,v22,s23
ds_read2_b32 v[16:17], v9 offset0:0 offset1:10
ds_read2_b32 v[18:19], v9 offset0:20 offset1:30
ds_read2_b32 v[20:21], v9 offset0:40 offset1:50
ds_read2_b32 v[22:23], v9 offset0:60 offset1:70
v_add_u32 v9, v10, v9
Zf lgkmcnt(11)
Zc v224,v25,v24,s22
Zf lgkmcnt(10)
Zc v225,v27,v26,s22
Zf lgkmcnt(9)
Zc v226,v29,v28,s22
Zf lgkmcnt(8)
Zc v227,v31,v30,s22
Zc v228,v25,v24,s23
Zc v229,v27,v26,s23
Zc v230,v29,v28,s23
Zc v231,v31,v30,s23
ds_read2_b32 v[24:25], v9 offset0:0 offset1:10
ds_read2_b32 v[26:27], v9 offset0:20 offset1:30
ds_read2_b32 v[28:29], v9 offset0:40 offset1:50
ds_read2_b32 v[30:31], v9 offset0:60 offset1:70
v_add_u32 v9, v10, v9
Zf lgkmcnt(11)
Zc v232,v33,v32,s22
Zf lgkmcnt(10)
Zc v233,v35,v34,s22
Zf lgkmcnt(9)
Zc v234,v37,v36,s22
Zf lgkmcnt(8)
Zc v235,v39,v38,s22
Zc v236,v33,v32,s23
Zc v237,v35,v34,s23
Zc v238,v37,v36,s23
Zc v239,v39,v38,s23
Zf lgkmcnt(7)
Zc v240,v17,v16,s22
Zf lgkmcnt(6)
Zc v241,v19,v18,s22
Zf lgkmcnt(5)
Zc v242,v21,v20,s22
Zf lgkmcnt(4)
Zc v243,v23,v22,s22
Zc v244,v17,v16,s23
Zc v245,v19,v18,s23
Zc v246,v21,v20,s23
Zc v247,v23,v22,s23
Zf lgkmcnt(3)
Zc v248,v25,v24,s22
Zf lgkmcnt(2)
Zc v249,v27,v26,s22
Zf lgkmcnt(1)
Zc v250,v29,v28,s22
Zf lgkmcnt(0)
Zc v251,v31,v30,s22
Zc v252,v25,v24,s23
Zc v253,v27,v26,s23
Zc v254,v29,v28,s23
Zc v255,v31,v30,s23
Zp s10,s8
Zq s18,s10,12
Zb s18,s18,130023424
s_cmp_lt_u32 s9, 2
Zk K0B_W
s_branch K0B_E
K0B_W:
Zo s9,1
Zk K0B_V
Zi v[32:35],v5 offset:0
Zi v[36:39],v5 offset:2048
Zi v[40:43],v6 offset:0
Zi v[44:47],v6 offset:2048
Zi v[48:51],v5 offset:4096
Zi v[52:55],v5 offset:6144
Zf lgkmcnt(5)
Ze v[16:19],v[96:99],v[32:35],0
Ze v[20:23],v[100:103],v[32:35],0
Zi v[32:35],v6 offset:4096
Zf lgkmcnt(5)
Ze v[24:27],v[96:99],v[36:39],0
Ze v[28:31],v[100:103],v[36:39],0
Zi v[36:39],v6 offset:6144
Zf lgkmcnt(5)
Ze v[16:19],v[104:107],v[40:43],v[16:19]
Ze v[20:23],v[108:111],v[40:43],v[20:23]
Zi v[40:43],v5 offset:8192
Zf lgkmcnt(5)
Ze v[24:27],v[104:107],v[44:47],v[24:27]
Ze v[28:31],v[108:111],v[44:47],v[28:31]
Zi v[44:47],v5 offset:10240
Zf lgkmcnt(5)
Ze v[16:19],v[112:115],v[48:51],v[16:19]
Ze v[20:23],v[116:119],v[48:51],v[20:23]
Zi v[48:51],v6 offset:8192
Zf lgkmcnt(5)
Ze v[24:27],v[112:115],v[52:55],v[24:27]
Ze v[28:31],v[116:119],v[52:55],v[28:31]
Zi v[52:55],v6 offset:10240
Zf lgkmcnt(5)
Ze v[16:19],v[120:123],v[32:35],v[16:19]
Ze v[20:23],v[124:127],v[32:35],v[20:23]
Zi v[32:35],v5 offset:12288
Zf lgkmcnt(5)
Ze v[24:27],v[120:123],v[36:39],v[24:27]
Ze v[28:31],v[124:127],v[36:39],v[28:31]
Zi v[36:39],v5 offset:14336
Zf lgkmcnt(5)
Ze v[16:19],v[128:131],v[40:43],v[16:19]
Ze v[20:23],v[132:135],v[40:43],v[20:23]
Zi v[40:43],v6 offset:12288
Zf lgkmcnt(5)
Ze v[24:27],v[128:131],v[44:47],v[24:27]
Ze v[28:31],v[132:135],v[44:47],v[28:31]
Zi v[44:47],v6 offset:14336
Zf lgkmcnt(5)
Ze v[16:19],v[136:139],v[48:51],v[16:19]
Ze v[20:23],v[140:143],v[48:51],v[20:23]
Zi v[48:51],v5 offset:16384
Zf lgkmcnt(5)
Ze v[24:27],v[136:139],v[52:55],v[24:27]
Ze v[28:31],v[140:143],v[52:55],v[28:31]
Zi v[52:55],v5 offset:18432
Zf lgkmcnt(5)
Ze v[16:19],v[144:147],v[32:35],v[16:19]
Ze v[20:23],v[148:151],v[32:35],v[20:23]
Zi v[32:35],v6 offset:16384
Zf lgkmcnt(5)
Ze v[24:27],v[144:147],v[36:39],v[24:27]
Ze v[28:31],v[148:151],v[36:39],v[28:31]
Zi v[36:39],v6 offset:18432
Zf lgkmcnt(5)
Ze v[16:19],v[152:155],v[40:43],v[16:19]
Ze v[20:23],v[156:159],v[40:43],v[20:23]
Zi v[40:43],v5 offset:20480
Zf lgkmcnt(5)
Ze v[24:27],v[152:155],v[44:47],v[24:27]
Ze v[28:31],v[156:159],v[44:47],v[28:31]
Zi v[44:47],v5 offset:22528
Zf lgkmcnt(5)
Ze v[16:19],v[160:163],v[48:51],v[16:19]
Ze v[20:23],v[164:167],v[48:51],v[20:23]
Zi v[48:51],v6 offset:20480
Zf lgkmcnt(5)
Ze v[24:27],v[160:163],v[52:55],v[24:27]
Ze v[28:31],v[164:167],v[52:55],v[28:31]
Zi v[52:55],v6 offset:22528
Zf lgkmcnt(5)
Ze v[16:19],v[168:171],v[32:35],v[16:19]
Ze v[20:23],v[172:175],v[32:35],v[20:23]
Zi v[32:35],v5 offset:24576
Zf lgkmcnt(5)
Ze v[24:27],v[168:171],v[36:39],v[24:27]
Ze v[28:31],v[172:175],v[36:39],v[28:31]
Zi v[36:39],v5 offset:26624
Zf lgkmcnt(5)
Ze v[16:19],v[176:179],v[40:43],v[16:19]
Ze v[20:23],v[180:183],v[40:43],v[20:23]
Zi v[40:43],v6 offset:24576
Zf lgkmcnt(5)
Ze v[24:27],v[176:179],v[44:47],v[24:27]
Ze v[28:31],v[180:183],v[44:47],v[28:31]
Zi v[44:47],v6 offset:26624
Zf lgkmcnt(5)
Ze v[16:19],v[184:187],v[48:51],v[16:19]
Ze v[20:23],v[188:191],v[48:51],v[20:23]
Zi v[48:51],v5 offset:28672
Zf lgkmcnt(5)
Ze v[24:27],v[184:187],v[52:55],v[24:27]
Ze v[28:31],v[188:191],v[52:55],v[28:31]
Zi v[52:55],v5 offset:30720
Zf lgkmcnt(5)
Ze v[16:19],v[192:195],v[32:35],v[16:19]
Ze v[20:23],v[196:199],v[32:35],v[20:23]
Zi v[32:35],v6 offset:28672
Zf lgkmcnt(5)
Ze v[24:27],v[192:195],v[36:39],v[24:27]
Ze v[28:31],v[196:199],v[36:39],v[28:31]
Zi v[36:39],v6 offset:30720
Zf lgkmcnt(5)
Ze v[16:19],v[200:203],v[40:43],v[16:19]
Ze v[20:23],v[204:207],v[40:43],v[20:23]
Zi v[40:43],v5 offset:32768
Zf lgkmcnt(5)
Ze v[24:27],v[200:203],v[44:47],v[24:27]
Ze v[28:31],v[204:207],v[44:47],v[28:31]
Zi v[44:47],v5 offset:34816
Zf lgkmcnt(5)
Ze v[16:19],v[208:211],v[48:51],v[16:19]
Ze v[20:23],v[212:215],v[48:51],v[20:23]
Zi v[48:51],v6 offset:32768
Zf lgkmcnt(5)
Ze v[24:27],v[208:211],v[52:55],v[24:27]
Ze v[28:31],v[212:215],v[52:55],v[28:31]
Zi v[52:55],v6 offset:34816
Zf lgkmcnt(5)
Ze v[16:19],v[216:219],v[32:35],v[16:19]
Ze v[20:23],v[220:223],v[32:35],v[20:23]
Zi v[32:35],v5 offset:36864
Zf lgkmcnt(5)
Ze v[24:27],v[216:219],v[36:39],v[24:27]
Ze v[28:31],v[220:223],v[36:39],v[28:31]
Zi v[36:39],v5 offset:38912
Zf lgkmcnt(5)
Ze v[16:19],v[224:227],v[40:43],v[16:19]
Ze v[20:23],v[228:231],v[40:43],v[20:23]
Zi v[40:43],v6 offset:36864
Zf lgkmcnt(5)
Ze v[24:27],v[224:227],v[44:47],v[24:27]
Ze v[28:31],v[228:231],v[44:47],v[28:31]
Zi v[44:47],v6 offset:38912
Zf lgkmcnt(5)
Ze v[16:19],v[232:235],v[48:51],v[16:19]
Ze v[20:23],v[236:239],v[48:51],v[20:23]
Zf lgkmcnt(4)
Ze v[24:27],v[232:235],v[52:55],v[24:27]
Ze v[28:31],v[236:239],v[52:55],v[28:31]
Zf lgkmcnt(3)
Ze v[16:19],v[240:243],v[32:35],v[16:19]
Ze v[20:23],v[244:247],v[32:35],v[20:23]
Zf lgkmcnt(2)
Ze v[24:27],v[240:243],v[36:39],v[24:27]
Ze v[28:31],v[244:247],v[36:39],v[28:31]
Zf lgkmcnt(1)
Ze v[16:19],v[248:251],v[40:43],v[16:19]
Ze v[20:23],v[252:255],v[40:43],v[20:23]
Zf lgkmcnt(0)
Ze v[24:27],v[248:251],v[44:47],v[24:27]
Ze v[28:31],v[252:255],v[44:47],v[28:31]
Zj v32,v16,v20
Zj v33,v17,v21
Zj v34,v18,v22
Zj v35,v19,v23
s_nop 3
Zj v36,v24,v28
Zj v37,v25,v29
Zj v38,v26,v30
Zj v39,v27,v31
s_branch K0B_S
K0B_V:
Zi v[32:35],v5 offset:0
Zi v[36:39],v5 offset:2048
Zi v[40:43],v6 offset:0
Zi v[44:47],v6 offset:2048
Zi v[48:51],v5 offset:4096
Zi v[52:55],v5 offset:6144
Zf lgkmcnt(5)
Ze v[16:19],v[32:35],v[96:99],0
Ze v[20:23],v[32:35],v[100:103],0
Zi v[32:35],v6 offset:4096
Zf lgkmcnt(5)
Ze v[24:27],v[36:39],v[96:99],0
Ze v[28:31],v[36:39],v[100:103],0
Zi v[36:39],v6 offset:6144
Zf lgkmcnt(5)
Ze v[16:19],v[40:43],v[104:107],v[16:19]
Ze v[20:23],v[40:43],v[108:111],v[20:23]
Zi v[40:43],v5 offset:8192
Zf lgkmcnt(5)
Ze v[24:27],v[44:47],v[104:107],v[24:27]
Ze v[28:31],v[44:47],v[108:111],v[28:31]
Zi v[44:47],v5 offset:10240
Zf lgkmcnt(5)
Ze v[16:19],v[48:51],v[112:115],v[16:19]
Ze v[20:23],v[48:51],v[116:119],v[20:23]
Zi v[48:51],v6 offset:8192
Zf lgkmcnt(5)
Ze v[24:27],v[52:55],v[112:115],v[24:27]
Ze v[28:31],v[52:55],v[116:119],v[28:31]
Zi v[52:55],v6 offset:10240
Zf lgkmcnt(5)
Ze v[16:19],v[32:35],v[120:123],v[16:19]
Ze v[20:23],v[32:35],v[124:127],v[20:23]
Zi v[32:35],v5 offset:12288
Zf lgkmcnt(5)
Ze v[24:27],v[36:39],v[120:123],v[24:27]
Ze v[28:31],v[36:39],v[124:127],v[28:31]
Zi v[36:39],v5 offset:14336
Zf lgkmcnt(5)
Ze v[16:19],v[40:43],v[128:131],v[16:19]
Ze v[20:23],v[40:43],v[132:135],v[20:23]
Zi v[40:43],v6 offset:12288
Zf lgkmcnt(5)
Ze v[24:27],v[44:47],v[128:131],v[24:27]
Ze v[28:31],v[44:47],v[132:135],v[28:31]
Zi v[44:47],v6 offset:14336
Zf lgkmcnt(5)
Ze v[16:19],v[48:51],v[136:139],v[16:19]
Ze v[20:23],v[48:51],v[140:143],v[20:23]
Zi v[48:51],v5 offset:16384
Zf lgkmcnt(5)
Ze v[24:27],v[52:55],v[136:139],v[24:27]
Ze v[28:31],v[52:55],v[140:143],v[28:31]
Zi v[52:55],v5 offset:18432
Zf lgkmcnt(5)
Ze v[16:19],v[32:35],v[144:147],v[16:19]
Ze v[20:23],v[32:35],v[148:151],v[20:23]
Zi v[32:35],v6 offset:16384
Zf lgkmcnt(5)
Ze v[24:27],v[36:39],v[144:147],v[24:27]
Ze v[28:31],v[36:39],v[148:151],v[28:31]
Zi v[36:39],v6 offset:18432
Zf lgkmcnt(5)
Ze v[16:19],v[40:43],v[152:155],v[16:19]
Ze v[20:23],v[40:43],v[156:159],v[20:23]
Zi v[40:43],v5 offset:20480
Zf lgkmcnt(5)
Ze v[24:27],v[44:47],v[152:155],v[24:27]
Ze v[28:31],v[44:47],v[156:159],v[28:31]
Zi v[44:47],v5 offset:22528
Zf lgkmcnt(5)
Ze v[16:19],v[48:51],v[160:163],v[16:19]
Ze v[20:23],v[48:51],v[164:167],v[20:23]
Zi v[48:51],v6 offset:20480
Zf lgkmcnt(5)
Ze v[24:27],v[52:55],v[160:163],v[24:27]
Ze v[28:31],v[52:55],v[164:167],v[28:31]
Zi v[52:55],v6 offset:22528
Zf lgkmcnt(5)
Ze v[16:19],v[32:35],v[168:171],v[16:19]
Ze v[20:23],v[32:35],v[172:175],v[20:23]
Zi v[32:35],v5 offset:24576
Zf lgkmcnt(5)
Ze v[24:27],v[36:39],v[168:171],v[24:27]
Ze v[28:31],v[36:39],v[172:175],v[28:31]
Zi v[36:39],v5 offset:26624
Zf lgkmcnt(5)
Ze v[16:19],v[40:43],v[176:179],v[16:19]
Ze v[20:23],v[40:43],v[180:183],v[20:23]
Zi v[40:43],v6 offset:24576
Zf lgkmcnt(5)
Ze v[24:27],v[44:47],v[176:179],v[24:27]
Ze v[28:31],v[44:47],v[180:183],v[28:31]
Zi v[44:47],v6 offset:26624
Zf lgkmcnt(5)
Ze v[16:19],v[48:51],v[184:187],v[16:19]
Ze v[20:23],v[48:51],v[188:191],v[20:23]
Zi v[48:51],v5 offset:28672
Zf lgkmcnt(5)
Ze v[24:27],v[52:55],v[184:187],v[24:27]
Ze v[28:31],v[52:55],v[188:191],v[28:31]
Zi v[52:55],v5 offset:30720
Zf lgkmcnt(5)
Ze v[16:19],v[32:35],v[192:195],v[16:19]
Ze v[20:23],v[32:35],v[196:199],v[20:23]
Zi v[32:35],v6 offset:28672
Zf lgkmcnt(5)
Ze v[24:27],v[36:39],v[192:195],v[24:27]
Ze v[28:31],v[36:39],v[196:199],v[28:31]
Zi v[36:39],v6 offset:30720
Zf lgkmcnt(5)
Ze v[16:19],v[40:43],v[200:203],v[16:19]
Ze v[20:23],v[40:43],v[204:207],v[20:23]
Zi v[40:43],v5 offset:32768
Zf lgkmcnt(5)
Ze v[24:27],v[44:47],v[200:203],v[24:27]
Ze v[28:31],v[44:47],v[204:207],v[28:31]
Zi v[44:47],v5 offset:34816
Zf lgkmcnt(5)
Ze v[16:19],v[48:51],v[208:211],v[16:19]
Ze v[20:23],v[48:51],v[212:215],v[20:23]
Zi v[48:51],v6 offset:32768
Zf lgkmcnt(5)
Ze v[24:27],v[52:55],v[208:211],v[24:27]
Ze v[28:31],v[52:55],v[212:215],v[28:31]
Zi v[52:55],v6 offset:34816
Zf lgkmcnt(5)
Ze v[16:19],v[32:35],v[216:219],v[16:19]
Ze v[20:23],v[32:35],v[220:223],v[20:23]
Zi v[32:35],v5 offset:36864
Zf lgkmcnt(5)
Ze v[24:27],v[36:39],v[216:219],v[24:27]
Ze v[28:31],v[36:39],v[220:223],v[28:31]
Zi v[36:39],v5 offset:38912
Zf lgkmcnt(5)
Ze v[16:19],v[40:43],v[224:227],v[16:19]
Ze v[20:23],v[40:43],v[228:231],v[20:23]
Zi v[40:43],v6 offset:36864
Zf lgkmcnt(5)
Ze v[24:27],v[44:47],v[224:227],v[24:27]
Ze v[28:31],v[44:47],v[228:231],v[28:31]
Zi v[44:47],v6 offset:38912
Zf lgkmcnt(5)
Ze v[16:19],v[48:51],v[232:235],v[16:19]
Ze v[20:23],v[48:51],v[236:239],v[20:23]
Zf lgkmcnt(4)
Ze v[24:27],v[52:55],v[232:235],v[24:27]
Ze v[28:31],v[52:55],v[236:239],v[28:31]
Zf lgkmcnt(3)
Ze v[16:19],v[32:35],v[240:243],v[16:19]
Ze v[20:23],v[32:35],v[244:247],v[20:23]
Zf lgkmcnt(2)
Ze v[24:27],v[36:39],v[240:243],v[24:27]
Ze v[28:31],v[36:39],v[244:247],v[28:31]
Zf lgkmcnt(1)
Ze v[16:19],v[40:43],v[248:251],v[16:19]
Ze v[20:23],v[40:43],v[252:255],v[20:23]
Zf lgkmcnt(0)
Ze v[24:27],v[44:47],v[248:251],v[24:27]
Ze v[28:31],v[44:47],v[252:255],v[28:31]
Zj v32,v16,v17
Zj v33,v18,v19
s_nop 1
Zj v34,v24,v25
Zj v35,v26,v27
Zj v36,v20,v21
Zj v37,v22,v23
Zj v38,v28,v29
Zj v39,v30,v31
Zs v40,0x3f803f80
v_cmp_eq_u32 vcc, 10, v1
s_nop 1
v_cndmask_b32 v32, v32, v40, vcc
v_cndmask_b32 v33, v33, v40, vcc
v_cndmask_b32 v34, v34, v40, vcc
v_cndmask_b32 v35, v35, v40, vcc
Zb s18,s18,2048
K0B_S:
Zr v[32:35],v0,s[4:7],s18 offen sc1
Zr v[36:39],v0,s[4:7],s18 offen offset:1024 sc1
K0B_E:
Zf vmcnt(0) lgkmcnt(0)
s_barrier
s_cmp_lg_u32 s9, 0
Zk L0_E
Zs v9,1
Zp s19,8832
s_mov_b64 exec, 1
buffer_atomic_add v9, off, s[4:7], s19 sc0 sc1
Zf vmcnt(0)
s_mov_b64 exec, -1
v_readfirstlane_b32 s16, v9
s_cmp_lg_u32 s16, 63
Zk L0_E
Zs v9,64
Zp s19,8192
Zp s18,8704
Zu v9,v11,s[4:7],s19 offen sc1
Zu v9,off,s[4:7],s18 sc1
Zf vmcnt(0)
L0_E:
s_lshr_b32 s31, s8, 1
s_and_b32 s30, s8, 1
s_lshr_b32 s12, s31, 2
Zq s12,s12,2
Zb s12,s12,8448
Zq s13,s30,7
Zq s19,s31,2
Zb s13,s13,s19
Zb s13,s13,8960
Zp s14,8704
Zp s25,0
Zp s26,0
Zq s19,s9,12
v_add_u32 v4, s19, v0
Zz v5,12,v2
v_lshl_add_u32 v5, v1, 4, v5
Zq s19,s9,11
v_add_u32 v6, s19, v0
Zq s19,s9,7
Zz v7,3,v1
v_add_u32 v7, s19, v7
Zz v8,7,v2
v_lshl_add_u32 v8, v1, 3, v8
Zp s28,394264576
Zp s29,1736441856
Zm v[24:25],0
Zm v[26:27],0
Zm v[28:29],0
Zm v[30:31],0
Zp s24,0
Zq s40,s31,7
Zb s40,s40,4096
Zp s11,0
AT_LAY:
Zq s17,s8,2
Zo s11,0
s_cselect_b32 s17, s17, 0
Zb s17,s17,s9
s_and_b32 s17, s17, 63
Zb s16,s11,s17
Zq s18,s16,12
Zb s18,s18,130023424
Zb s16,s16,1
s_cmp_ge_u32 s25, s16
Zk ND_2
NP_1:
Za v9,off,s[4:7],s14 sc1
Zf vmcnt(0)
v_readfirstlane_b32 s25, v9
s_cmp_ge_u32 s25, s16
Zk ND_2
s_sleep 2
s_sub_u32 s20, s20, 1
s_cmp_gt_i32 s20, 0
Zk NP_1
ND_2:
Zh a[0:3],v0,s[4:7],s18 offen offset:0 sc1
Zh a[4:7],v0,s[4:7],s18 offen offset:1024 sc1
Zh a[8:11],v0,s[4:7],s18 offen offset:2048 sc1
Zh a[12:15],v0,s[4:7],s18 offen offset:3072 sc1
Zb s17,s17,4
s_and_b32 s17, s17, 63
Zb s16,s11,s17
Zq s18,s16,12
Zb s18,s18,130023424
Zb s16,s16,1
s_cmp_ge_u32 s25, s16
Zk ND_4
NP_3:
Za v9,off,s[4:7],s14 sc1
Zf vmcnt(0)
v_readfirstlane_b32 s25, v9
s_cmp_ge_u32 s25, s16
Zk ND_4
s_sleep 32
s_sub_u32 s20, s20, 1
s_cmp_gt_i32 s20, 0
Zk NP_3
ND_4:
Zh a[16:19],v0,s[4:7],s18 offen offset:0 sc1
Zh a[20:23],v0,s[4:7],s18 offen offset:1024 sc1
Zh a[24:27],v0,s[4:7],s18 offen offset:2048 sc1
Zh a[28:31],v0,s[4:7],s18 offen offset:3072 sc1
Zb s17,s17,4
s_and_b32 s17, s17, 63
Zb s16,s11,s17
Zq s18,s16,12
Zb s18,s18,130023424
Zb s16,s16,1
s_cmp_ge_u32 s25, s16
Zk ND_6
NP_5:
Za v9,off,s[4:7],s14 sc1
Zf vmcnt(0)
v_readfirstlane_b32 s25, v9
s_cmp_ge_u32 s25, s16
Zk ND_6
s_sleep 32
s_sub_u32 s20, s20, 1
s_cmp_gt_i32 s20, 0
Zk NP_5
ND_6:
Zh a[32:35],v0,s[4:7],s18 offen offset:0 sc1
Zh a[36:39],v0,s[4:7],s18 offen offset:1024 sc1
Zh a[40:43],v0,s[4:7],s18 offen offset:2048 sc1
Zh a[44:47],v0,s[4:7],s18 offen offset:3072 sc1
Zb s17,s17,4
s_and_b32 s17, s17, 63
Zb s16,s11,s17
Zq s18,s16,12
Zb s18,s18,130023424
Zb s16,s16,1
s_cmp_ge_u32 s25, s16
Zk ND_8
NP_7:
Za v9,off,s[4:7],s14 sc1
Zf vmcnt(0)
v_readfirstlane_b32 s25, v9
s_cmp_ge_u32 s25, s16
Zk ND_8
s_sleep 32
s_sub_u32 s20, s20, 1
s_cmp_gt_i32 s20, 0
Zk NP_7
ND_8:
Zh a[48:51],v0,s[4:7],s18 offen offset:0 sc1
Zh a[52:55],v0,s[4:7],s18 offen offset:1024 sc1
Zh a[56:59],v0,s[4:7],s18 offen offset:2048 sc1
Zh a[60:63],v0,s[4:7],s18 offen offset:3072 sc1
Zb s17,s17,4
s_and_b32 s17, s17, 63
Zb s16,s11,s17
Zq s18,s16,12
Zb s18,s18,130023424
Zb s16,s16,1
s_cmp_ge_u32 s25, s16
Zk ND_10
NP_9:
Za v9,off,s[4:7],s14 sc1
Zf vmcnt(0)
v_readfirstlane_b32 s25, v9
s_cmp_ge_u32 s25, s16
Zk ND_10
s_sleep 32
s_sub_u32 s20, s20, 1
s_cmp_gt_i32 s20, 0
Zk NP_9
ND_10:
Zh a[64:67],v0,s[4:7],s18 offen offset:0 sc1
Zh a[68:71],v0,s[4:7],s18 offen offset:1024 sc1
Zh a[72:75],v0,s[4:7],s18 offen offset:2048 sc1
Zh a[76:79],v0,s[4:7],s18 offen offset:3072 sc1
Zb s17,s17,4
s_and_b32 s17, s17, 63
Zb s16,s11,s17
Zq s18,s16,12
Zb s18,s18,130023424
Zb s16,s16,1
s_cmp_ge_u32 s25, s16
Zk ND_12
NP_11:
Za v9,off,s[4:7],s14 sc1
Zf vmcnt(0)
v_readfirstlane_b32 s25, v9
s_cmp_ge_u32 s25, s16
Zk ND_12
s_sleep 32
s_sub_u32 s20, s20, 1
s_cmp_gt_i32 s20, 0
Zk NP_11
ND_12:
Zh a[80:83],v0,s[4:7],s18 offen offset:0 sc1
Zh a[84:87],v0,s[4:7],s18 offen offset:1024 sc1
Zh a[88:91],v0,s[4:7],s18 offen offset:2048 sc1
Zh a[92:95],v0,s[4:7],s18 offen offset:3072 sc1
Zb s17,s17,4
s_and_b32 s17, s17, 63
Zb s16,s11,s17
Zq s18,s16,12
Zb s18,s18,130023424
Zb s16,s16,1
s_cmp_ge_u32 s25, s16
Zk ND_14
NP_13:
Za v9,off,s[4:7],s14 sc1
Zf vmcnt(0)
v_readfirstlane_b32 s25, v9
s_cmp_ge_u32 s25, s16
Zk ND_14
s_sleep 32
s_sub_u32 s20, s20, 1
s_cmp_gt_i32 s20, 0
Zk NP_13
ND_14:
Zh a[96:99],v0,s[4:7],s18 offen offset:0 sc1
Zh a[100:103],v0,s[4:7],s18 offen offset:1024 sc1
Zh a[104:107],v0,s[4:7],s18 offen offset:2048 sc1
Zh a[108:111],v0,s[4:7],s18 offen offset:3072 sc1
Zb s17,s17,4
s_and_b32 s17, s17, 63
Zb s16,s11,s17
Zq s18,s16,12
Zb s18,s18,130023424
Zb s16,s16,1
s_cmp_ge_u32 s25, s16
Zk ND_16
NP_15:
Za v9,off,s[4:7],s14 sc1
Zf vmcnt(0)
v_readfirstlane_b32 s25, v9
s_cmp_ge_u32 s25, s16
Zk ND_16
s_sleep 32
s_sub_u32 s20, s20, 1
s_cmp_gt_i32 s20, 0
Zk NP_15
ND_16:
Zh a[112:115],v0,s[4:7],s18 offen offset:0 sc1
Zh a[116:119],v0,s[4:7],s18 offen offset:1024 sc1
Zh a[120:123],v0,s[4:7],s18 offen offset:2048 sc1
Zh a[124:127],v0,s[4:7],s18 offen offset:3072 sc1
Zb s17,s17,4
Zf vmcnt(0)
s_and_b32 s17, s17, 63
Zb s16,s11,s17
Zq s18,s16,12
Zb s18,s18,130023424
Zb s16,s16,1
s_cmp_ge_u32 s25, s16
Zk ND_18
NP_17:
Za v9,off,s[4:7],s14 sc1
Zf vmcnt(0)
v_readfirstlane_b32 s25, v9
s_cmp_ge_u32 s25, s16
Zk ND_18
s_sleep 32
s_sub_u32 s20, s20, 1
s_cmp_gt_i32 s20, 0
Zk NP_17
ND_18:
Zh a[128:131],v0,s[4:7],s18 offen offset:0 sc1
Zh a[132:135],v0,s[4:7],s18 offen offset:1024 sc1
Zh a[136:139],v0,s[4:7],s18 offen offset:2048 sc1
Zh a[140:143],v0,s[4:7],s18 offen offset:3072 sc1
Zb s17,s17,4
s_and_b32 s17, s17, 63
Zb s16,s11,s17
Zq s18,s16,12
Zb s18,s18,130023424
Zb s16,s16,1
s_cmp_ge_u32 s25, s16
Zk ND_20
NP_19:
Za v9,off,s[4:7],s14 sc1
Zf vmcnt(0)
v_readfirstlane_b32 s25, v9
s_cmp_ge_u32 s25, s16
Zk ND_20
s_sleep 32
s_sub_u32 s20, s20, 1
s_cmp_gt_i32 s20, 0
Zk NP_19
ND_20:
Zh a[144:147],v0,s[4:7],s18 offen offset:0 sc1
Zh a[148:151],v0,s[4:7],s18 offen offset:1024 sc1
Zh a[152:155],v0,s[4:7],s18 offen offset:2048 sc1
Zh a[156:159],v0,s[4:7],s18 offen offset:3072 sc1
Zb s17,s17,4
s_and_b32 s17, s17, 63
Zb s16,s11,s17
Zq s18,s16,12
Zb s18,s18,130023424
Zb s16,s16,1
s_cmp_ge_u32 s25, s16
Zk ND_22
NP_21:
Za v9,off,s[4:7],s14 sc1
Zf vmcnt(0)
v_readfirstlane_b32 s25, v9
s_cmp_ge_u32 s25, s16
Zk ND_22
s_sleep 32
s_sub_u32 s20, s20, 1
s_cmp_gt_i32 s20, 0
Zk NP_21
ND_22:
Zh a[160:163],v0,s[4:7],s18 offen offset:0 sc1
Zh a[164:167],v0,s[4:7],s18 offen offset:1024 sc1
Zh a[168:171],v0,s[4:7],s18 offen offset:2048 sc1
Zh a[172:175],v0,s[4:7],s18 offen offset:3072 sc1
Zb s17,s17,4
s_and_b32 s17, s17, 63
Zb s16,s11,s17
Zq s18,s16,12
Zb s18,s18,130023424
Zb s16,s16,1
s_cmp_ge_u32 s25, s16
Zk ND_24
NP_23:
Za v9,off,s[4:7],s14 sc1
Zf vmcnt(0)
v_readfirstlane_b32 s25, v9
s_cmp_ge_u32 s25, s16
Zk ND_24
s_sleep 32
s_sub_u32 s20, s20, 1
s_cmp_gt_i32 s20, 0
Zk NP_23
ND_24:
Zh a[176:179],v0,s[4:7],s18 offen offset:0 sc1
Zh a[180:183],v0,s[4:7],s18 offen offset:1024 sc1
Zh a[184:187],v0,s[4:7],s18 offen offset:2048 sc1
Zh a[188:191],v0,s[4:7],s18 offen offset:3072 sc1
Zb s17,s17,4
s_and_b32 s17, s17, 63
Zb s16,s11,s17
Zq s18,s16,12
Zb s18,s18,130023424
Zb s16,s16,1
s_cmp_ge_u32 s25, s16
Zk ND_26
NP_25:
Za v9,off,s[4:7],s14 sc1
Zf vmcnt(0)
v_readfirstlane_b32 s25, v9
s_cmp_ge_u32 s25, s16
Zk ND_26
s_sleep 32
s_sub_u32 s20, s20, 1
s_cmp_gt_i32 s20, 0
Zk NP_25
ND_26:
Zh a[192:195],v0,s[4:7],s18 offen offset:0 sc1
Zh a[196:199],v0,s[4:7],s18 offen offset:1024 sc1
Zh a[200:203],v0,s[4:7],s18 offen offset:2048 sc1
Zh a[204:207],v0,s[4:7],s18 offen offset:3072 sc1
Zb s17,s17,4
s_and_b32 s17, s17, 63
Zb s16,s11,s17
Zq s18,s16,12
Zb s18,s18,130023424
Zb s16,s16,1
s_cmp_ge_u32 s25, s16
Zk ND_28
NP_27:
Za v9,off,s[4:7],s14 sc1
Zf vmcnt(0)
v_readfirstlane_b32 s25, v9
s_cmp_ge_u32 s25, s16
Zk ND_28
s_sleep 32
s_sub_u32 s20, s20, 1
s_cmp_gt_i32 s20, 0
Zk NP_27
ND_28:
Zh a[208:211],v0,s[4:7],s18 offen offset:0 sc1
Zh a[212:215],v0,s[4:7],s18 offen offset:1024 sc1
Zh a[216:219],v0,s[4:7],s18 offen offset:2048 sc1
Zh a[220:223],v0,s[4:7],s18 offen offset:3072 sc1
Zb s17,s17,4
s_and_b32 s17, s17, 63
Zb s16,s11,s17
Zq s18,s16,12
Zb s18,s18,130023424
Zb s16,s16,1
s_cmp_ge_u32 s25, s16
Zk ND_30
NP_29:
Za v9,off,s[4:7],s14 sc1
Zf vmcnt(0)
v_readfirstlane_b32 s25, v9
s_cmp_ge_u32 s25, s16
Zk ND_30
s_sleep 32
s_sub_u32 s20, s20, 1
s_cmp_gt_i32 s20, 0
Zk NP_29
ND_30:
Zh a[224:227],v0,s[4:7],s18 offen offset:0 sc1
Zh a[228:231],v0,s[4:7],s18 offen offset:1024 sc1
Zh a[232:235],v0,s[4:7],s18 offen offset:2048 sc1
Zh a[236:239],v0,s[4:7],s18 offen offset:3072 sc1
Zb s17,s17,4
Zp s27,1
s_cmp_lg_u32 s11, 0
Zk AT_D
s_and_b32 s17, s17, 63
Zb s16,s11,s17
Zq s18,s16,12
Zb s18,s18,130023424
Zb s16,s16,1
s_cmp_ge_u32 s25, s16
Zk ND_32
NP_31:
Za v9,off,s[4:7],s14 sc1
Zf vmcnt(0)
v_readfirstlane_b32 s25, v9
s_cmp_ge_u32 s25, s16
Zk ND_32
s_sleep 2
s_sub_u32 s20, s20, 1
s_cmp_gt_i32 s20, 0
Zk NP_31
ND_32:
Zh a[240:243],v0,s[4:7],s18 offen offset:0 sc1
Zh a[244:247],v0,s[4:7],s18 offen offset:1024 sc1
Zh a[248:251],v0,s[4:7],s18 offen offset:2048 sc1
Zh a[252:255],v0,s[4:7],s18 offen offset:3072 sc1
Zb s17,s17,4
Zp s27,0
AT_D:
Zb s10,s11,s30
AT_U:
Zb s16,s10,1
s_cmp_ge_u32 s26, s16
Zk ND_34
NP_33:
Za v9,off,s[4:7],s12 sc1
Zf vmcnt(0)
v_readfirstlane_b32 s26, v9
s_cmp_ge_u32 s26, s16
Zk ND_34
s_sleep 2
s_sub_u32 s20, s20, 1
s_cmp_gt_i32 s20, 0
Zk NP_33
ND_34:
Zq s18,s10,5
Zb s18,s18,s31
Zq s18,s18,11
Zb s19,s18,121634816
Zh v[16:19],v0,s[4:7],s19 offen sc1
Zh v[20:23],v0,s[4:7],s19 offen offset:1024 sc1
Zp s15,0
Zf vmcnt(0)
AT_M:
Ze v[32:35],a[0:3],v[16:19],v[24:27]
Ze v[36:39],a[4:7],v[16:19],v[24:27]
Ze v[40:43],a[0:3],v[20:23],v[28:31]
Ze v[44:47],a[4:7],v[20:23],v[28:31]
Zn v32,v32
Zn v33,v33
Zn v34,v34
Zn v35,v35
Zn v36,v36
Ze v[48:51],a[16:19],v[16:19],v[24:27]
Zn v37,v37
Zn v38,v38
Ze v[52:55],a[20:23],v[16:19],v[24:27]
Zn v39,v39
Zj v64,v32,v33
Zj v65,v34,v35
Zj v66,v36,v37
Zj v67,v38,v39
Zn v40,v40
Zn v41,v41
Ze v[72:75],a[8:11],v[64:67],0
Zn v42,v42
Zn v43,v43
Ze v[76:79],a[12:15],v[64:67],0
Zn v44,v44
Zn v45,v45
Ze v[56:59],a[16:19],v[20:23],v[28:31]
Zn v46,v46
Zn v47,v47
Ze v[60:63],a[20:23],v[20:23],v[28:31]
Zj v68,v40,v41
Zj v69,v42,v43
Zj v70,v44,v45
Zj v71,v46,v47
Zn v48,v48
s_nop 0
Ze v[80:83],a[8:11],v[68:71],0
Zn v49,v49
Zn v50,v50
Ze v[84:87],a[12:15],v[68:71],0
Zn v51,v51
Zn v52,v52
Ze v[32:35],a[32:35],v[16:19],v[24:27]
Zn v53,v53
Zn v54,v54
Ze v[36:39],a[36:39],v[16:19],v[24:27]
Zn v55,v55
Zj v64,v48,v49
Zj v65,v50,v51
Zj v66,v52,v53
Zj v67,v54,v55
Zn v56,v56
Zn v57,v57
Ze v[72:75],a[24:27],v[64:67],v[72:75]
Zn v58,v58
Zn v59,v59
Ze v[76:79],a[28:31],v[64:67],v[76:79]
Zn v60,v60
Zn v61,v61
Ze v[40:43],a[32:35],v[20:23],v[28:31]
Zn v62,v62
Zn v63,v63
Ze v[44:47],a[36:39],v[20:23],v[28:31]
Zj v68,v56,v57
Zj v69,v58,v59
Zj v70,v60,v61
Zj v71,v62,v63
Zn v32,v32
s_nop 0
Ze v[80:83],a[24:27],v[68:71],v[80:83]
Zn v33,v33
Zn v34,v34
Ze v[84:87],a[28:31],v[68:71],v[84:87]
Zn v35,v35
Zn v36,v36
Ze v[48:51],a[48:51],v[16:19],v[24:27]
Zn v37,v37
Zn v38,v38
Ze v[52:55],a[52:55],v[16:19],v[24:27]
Zn v39,v39
Zj v64,v32,v33
Zj v65,v34,v35
Zj v66,v36,v37
Zj v67,v38,v39
Zn v40,v40
Zn v41,v41
Ze v[72:75],a[40:43],v[64:67],v[72:75]
Zn v42,v42
Zn v43,v43
Ze v[76:79],a[44:47],v[64:67],v[76:79]
Zn v44,v44
Zn v45,v45
Ze v[56:59],a[48:51],v[20:23],v[28:31]
Zn v46,v46
Zn v47,v47
Ze v[60:63],a[52:55],v[20:23],v[28:31]
Zj v68,v40,v41
Zj v69,v42,v43
Zj v70,v44,v45
Zj v71,v46,v47
Zn v48,v48
s_nop 0
Ze v[80:83],a[40:43],v[68:71],v[80:83]
Zn v49,v49
Zn v50,v50
Ze v[84:87],a[44:47],v[68:71],v[84:87]
Zn v51,v51
Zn v52,v52
Ze v[32:35],a[64:67],v[16:19],v[24:27]
Zn v53,v53
Zn v54,v54
Ze v[36:39],a[68:71],v[16:19],v[24:27]
Zn v55,v55
Zj v64,v48,v49
Zj v65,v50,v51
Zj v66,v52,v53
Zj v67,v54,v55
Zn v56,v56
Zn v57,v57
Ze v[72:75],a[56:59],v[64:67],v[72:75]
Zn v58,v58
Zn v59,v59
Ze v[76:79],a[60:63],v[64:67],v[76:79]
Zn v60,v60
Zn v61,v61
Ze v[40:43],a[64:67],v[20:23],v[28:31]
Zn v62,v62
Zn v63,v63
Ze v[44:47],a[68:71],v[20:23],v[28:31]
Zj v68,v56,v57
Zj v69,v58,v59
Zj v70,v60,v61
Zj v71,v62,v63
Zn v32,v32
s_nop 0
Ze v[80:83],a[56:59],v[68:71],v[80:83]
Zn v33,v33
Zn v34,v34
Ze v[84:87],a[60:63],v[68:71],v[84:87]
Zn v35,v35
Zn v36,v36
Ze v[48:51],a[80:83],v[16:19],v[24:27]
Zn v37,v37
Zn v38,v38
Ze v[52:55],a[84:87],v[16:19],v[24:27]
Zn v39,v39
Zj v64,v32,v33
Zj v65,v34,v35
Zj v66,v36,v37
Zj v67,v38,v39
Zn v40,v40
Zn v41,v41
Ze v[72:75],a[72:75],v[64:67],v[72:75]
Zn v42,v42
Zn v43,v43
Ze v[76:79],a[76:79],v[64:67],v[76:79]
Zn v44,v44
Zn v45,v45
Ze v[56:59],a[80:83],v[20:23],v[28:31]
Zn v46,v46
Zn v47,v47
Ze v[60:63],a[84:87],v[20:23],v[28:31]
Zj v68,v40,v41
Zj v69,v42,v43
Zj v70,v44,v45
Zj v71,v46,v47
Zn v48,v48
s_nop 0
Ze v[80:83],a[72:75],v[68:71],v[80:83]
Zn v49,v49
Zn v50,v50
Ze v[84:87],a[76:79],v[68:71],v[84:87]
Zn v51,v51
Zn v52,v52
Ze v[32:35],a[96:99],v[16:19],v[24:27]
Zn v53,v53
Zn v54,v54
Ze v[36:39],a[100:103],v[16:19],v[24:27]
Zn v55,v55
Zj v64,v48,v49
Zj v65,v50,v51
Zj v66,v52,v53
Zj v67,v54,v55
Zn v56,v56
Zn v57,v57
Ze v[72:75],a[88:91],v[64:67],v[72:75]
Zn v58,v58
Zn v59,v59
Ze v[76:79],a[92:95],v[64:67],v[76:79]
Zn v60,v60
Zn v61,v61
Ze v[40:43],a[96:99],v[20:23],v[28:31]
Zn v62,v62
Zn v63,v63
Ze v[44:47],a[100:103],v[20:23],v[28:31]
Zj v68,v56,v57
Zj v69,v58,v59
Zj v70,v60,v61
Zj v71,v62,v63
Zn v32,v32
s_nop 0
Ze v[80:83],a[88:91],v[68:71],v[80:83]
Zn v33,v33
Zn v34,v34
Ze v[84:87],a[92:95],v[68:71],v[84:87]
Zn v35,v35
Zn v36,v36
Ze v[48:51],a[112:115],v[16:19],v[24:27]
Zn v37,v37
Zn v38,v38
Ze v[52:55],a[116:119],v[16:19],v[24:27]
Zn v39,v39
Zj v64,v32,v33
Zj v65,v34,v35
Zj v66,v36,v37
Zj v67,v38,v39
Zn v40,v40
Zn v41,v41
Ze v[72:75],a[104:107],v[64:67],v[72:75]
Zn v42,v42
Zn v43,v43
Ze v[76:79],a[108:111],v[64:67],v[76:79]
Zn v44,v44
Zn v45,v45
Ze v[56:59],a[112:115],v[20:23],v[28:31]
Zn v46,v46
Zn v47,v47
Ze v[60:63],a[116:119],v[20:23],v[28:31]
Zj v68,v40,v41
Zj v69,v42,v43
Zj v70,v44,v45
Zj v71,v46,v47
Zn v48,v48
s_nop 0
Ze v[80:83],a[104:107],v[68:71],v[80:83]
Zn v49,v49
Zn v50,v50
Ze v[84:87],a[108:111],v[68:71],v[84:87]
Zn v51,v51
Zn v52,v52
Ze v[32:35],a[128:131],v[16:19],v[24:27]
Zn v53,v53
Zn v54,v54
Ze v[36:39],a[132:135],v[16:19],v[24:27]
Zn v55,v55
Zj v64,v48,v49
Zj v65,v50,v51
Zj v66,v52,v53
Zj v67,v54,v55
Zn v56,v56
Zn v57,v57
Ze v[72:75],a[120:123],v[64:67],v[72:75]
Zn v58,v58
Zn v59,v59
Ze v[76:79],a[124:127],v[64:67],v[76:79]
Zn v60,v60
Zn v61,v61
Ze v[40:43],a[128:131],v[20:23],v[28:31]
Zn v62,v62
Zn v63,v63
Ze v[44:47],a[132:135],v[20:23],v[28:31]
Zj v68,v56,v57
Zj v69,v58,v59
Zj v70,v60,v61
Zj v71,v62,v63
Zn v32,v32
s_nop 0
Ze v[80:83],a[120:123],v[68:71],v[80:83]
Zn v33,v33
Zn v34,v34
Ze v[84:87],a[124:127],v[68:71],v[84:87]
Zn v35,v35
Zn v36,v36
Ze v[48:51],a[144:147],v[16:19],v[24:27]
Zn v37,v37
Zn v38,v38
Ze v[52:55],a[148:151],v[16:19],v[24:27]
Zn v39,v39
Zj v64,v32,v33
Zj v65,v34,v35
Zj v66,v36,v37
Zj v67,v38,v39
Zn v40,v40
Zn v41,v41
Ze v[72:75],a[136:139],v[64:67],v[72:75]
Zn v42,v42
Zn v43,v43
Ze v[76:79],a[140:143],v[64:67],v[76:79]
Zn v44,v44
Zn v45,v45
Ze v[56:59],a[144:147],v[20:23],v[28:31]
Zn v46,v46
Zn v47,v47
Ze v[60:63],a[148:151],v[20:23],v[28:31]
Zj v68,v40,v41
Zj v69,v42,v43
Zj v70,v44,v45
Zj v71,v46,v47
Zn v48,v48
s_nop 0
Ze v[80:83],a[136:139],v[68:71],v[80:83]
Zn v49,v49
Zn v50,v50
Ze v[84:87],a[140:143],v[68:71],v[84:87]
Zn v51,v51
Zn v52,v52
Ze v[32:35],a[160:163],v[16:19],v[24:27]
Zn v53,v53
Zn v54,v54
Ze v[36:39],a[164:167],v[16:19],v[24:27]
Zn v55,v55
Zj v64,v48,v49
Zj v65,v50,v51
Zj v66,v52,v53
Zj v67,v54,v55
Zn v56,v56
Zn v57,v57
Ze v[72:75],a[152:155],v[64:67],v[72:75]
Zn v58,v58
Zn v59,v59
Ze v[76:79],a[156:159],v[64:67],v[76:79]
Zn v60,v60
Zn v61,v61
Ze v[40:43],a[160:163],v[20:23],v[28:31]
Zn v62,v62
Zn v63,v63
Ze v[44:47],a[164:167],v[20:23],v[28:31]
Zj v68,v56,v57
Zj v69,v58,v59
Zj v70,v60,v61
Zj v71,v62,v63
Zn v32,v32
s_nop 0
Ze v[80:83],a[152:155],v[68:71],v[80:83]
Zn v33,v33
Zn v34,v34
Ze v[84:87],a[156:159],v[68:71],v[84:87]
Zn v35,v35
Zn v36,v36
Ze v[48:51],a[176:179],v[16:19],v[24:27]
Zn v37,v37
Zn v38,v38
Ze v[52:55],a[180:183],v[16:19],v[24:27]
Zn v39,v39
Zj v64,v32,v33
Zj v65,v34,v35
Zj v66,v36,v37
Zj v67,v38,v39
Zn v40,v40
Zn v41,v41
Ze v[72:75],a[168:171],v[64:67],v[72:75]
Zn v42,v42
Zn v43,v43
Ze v[76:79],a[172:175],v[64:67],v[76:79]
Zn v44,v44
Zn v45,v45
Ze v[56:59],a[176:179],v[20:23],v[28:31]
Zn v46,v46
Zn v47,v47
Ze v[60:63],a[180:183],v[20:23],v[28:31]
Zj v68,v40,v41
Zj v69,v42,v43
Zj v70,v44,v45
Zj v71,v46,v47
Zn v48,v48
s_nop 0
Ze v[80:83],a[168:171],v[68:71],v[80:83]
Zn v49,v49
Zn v50,v50
Ze v[84:87],a[172:175],v[68:71],v[84:87]
Zn v51,v51
Zn v52,v52
Ze v[32:35],a[192:195],v[16:19],v[24:27]
Zn v53,v53
Zn v54,v54
Ze v[36:39],a[196:199],v[16:19],v[24:27]
Zn v55,v55
Zj v64,v48,v49
Zj v65,v50,v51
Zj v66,v52,v53
Zj v67,v54,v55
Zn v56,v56
Zn v57,v57
Ze v[72:75],a[184:187],v[64:67],v[72:75]
Zn v58,v58
Zn v59,v59
Ze v[76:79],a[188:191],v[64:67],v[76:79]
Zn v60,v60
Zn v61,v61
Ze v[40:43],a[192:195],v[20:23],v[28:31]
Zn v62,v62
Zn v63,v63
Ze v[44:47],a[196:199],v[20:23],v[28:31]
Zj v68,v56,v57
Zj v69,v58,v59
Zj v70,v60,v61
Zj v71,v62,v63
Zn v32,v32
s_nop 0
Ze v[80:83],a[184:187],v[68:71],v[80:83]
Zn v33,v33
Zn v34,v34
Ze v[84:87],a[188:191],v[68:71],v[84:87]
Zn v35,v35
Zn v36,v36
Ze v[48:51],a[208:211],v[16:19],v[24:27]
Zn v37,v37
Zn v38,v38
Ze v[52:55],a[212:215],v[16:19],v[24:27]
Zn v39,v39
Zj v64,v32,v33
Zj v65,v34,v35
Zj v66,v36,v37
Zj v67,v38,v39
Zn v40,v40
Zn v41,v41
Ze v[72:75],a[200:203],v[64:67],v[72:75]
Zn v42,v42
Zn v43,v43
Ze v[76:79],a[204:207],v[64:67],v[76:79]
Zn v44,v44
Zn v45,v45
Ze v[56:59],a[208:211],v[20:23],v[28:31]
Zn v46,v46
Zn v47,v47
Ze v[60:63],a[212:215],v[20:23],v[28:31]
Zj v68,v40,v41
Zj v69,v42,v43
Zj v70,v44,v45
Zj v71,v46,v47
Zn v48,v48
s_nop 0
Ze v[80:83],a[200:203],v[68:71],v[80:83]
Zn v49,v49
Zn v50,v50
Ze v[84:87],a[204:207],v[68:71],v[84:87]
Zn v51,v51
Zn v52,v52
Ze v[32:35],a[224:227],v[16:19],v[24:27]
Zn v53,v53
Zn v54,v54
Ze v[36:39],a[228:231],v[16:19],v[24:27]
Zn v55,v55
Zj v64,v48,v49
Zj v65,v50,v51
Zj v66,v52,v53
Zj v67,v54,v55
Zn v56,v56
Zn v57,v57
Ze v[72:75],a[216:219],v[64:67],v[72:75]
Zn v58,v58
Zn v59,v59
Ze v[76:79],a[220:223],v[64:67],v[76:79]
Zn v60,v60
Zn v61,v61
Ze v[40:43],a[224:227],v[20:23],v[28:31]
Zn v62,v62
Zn v63,v63
Ze v[44:47],a[228:231],v[20:23],v[28:31]
Zj v68,v56,v57
Zj v69,v58,v59
Zj v70,v60,v61
Zj v71,v62,v63
Zo s27,0
Zk AT_DN
s_and_b32 s17, s17, 63
Zb s21,s11,s17
Zq s19,s21,12
Zb s19,s19,130023424
Zb s21,s21,1
s_cmp_ge_u32 s25, s21
Zk ND_36
NP_35:
Za v9,off,s[4:7],s14 sc1
Zf vmcnt(0)
v_readfirstlane_b32 s25, v9
s_cmp_ge_u32 s25, s21
Zk ND_36
s_sleep 2
s_sub_u32 s20, s20, 1
s_cmp_gt_i32 s20, 0
Zk NP_35
ND_36:
Zh a[240:243],v0,s[4:7],s19 offen offset:0 sc1
Zh a[244:247],v0,s[4:7],s19 offen offset:1024 sc1
Zh a[248:251],v0,s[4:7],s19 offen offset:2048 sc1
Zh a[252:255],v0,s[4:7],s19 offen offset:3072 sc1
Zb s17,s17,4
Zp s27,0
Zf vmcnt(0)
AT_DN:
Zn v32,v32
Ze v[80:83],a[216:219],v[68:71],v[80:83]
Zn v33,v33
Zn v34,v34
Ze v[84:87],a[220:223],v[68:71],v[84:87]
Zn v35,v35
Zn v36,v36
Ze v[48:51],a[240:243],v[16:19],v[24:27]
Zn v37,v37
Zn v38,v38
Ze v[52:55],a[244:247],v[16:19],v[24:27]
Zn v39,v39
Zj v64,v32,v33
Zj v65,v34,v35
Zj v66,v36,v37
Zj v67,v38,v39
Zn v40,v40
Zn v41,v41
Ze v[72:75],a[232:235],v[64:67],v[72:75]
Zn v42,v42
Zn v43,v43
Ze v[76:79],a[236:239],v[64:67],v[76:79]
Zn v44,v44
Zn v45,v45
Ze v[56:59],a[240:243],v[20:23],v[28:31]
Zn v46,v46
Zn v47,v47
Ze v[60:63],a[244:247],v[20:23],v[28:31]
Zj v68,v40,v41
Zj v69,v42,v43
Zj v70,v44,v45
Zj v71,v46,v47
Zn v48,v48
s_nop 0
Ze v[80:83],a[232:235],v[68:71],v[80:83]
Zn v49,v49
Zn v50,v50
Ze v[84:87],a[236:239],v[68:71],v[84:87]
Zn v51,v51
Zn v52,v52
Zn v53,v53
Zn v54,v54
Zn v55,v55
Zj v64,v48,v49
Zj v65,v50,v51
Zj v66,v52,v53
Zj v67,v54,v55
Zn v56,v56
Zn v57,v57
Ze v[72:75],a[248:251],v[64:67],v[72:75]
Zn v58,v58
Zn v59,v59
Ze v[76:79],a[252:255],v[64:67],v[76:79]
Zn v60,v60
Zn v61,v61
Zn v62,v62
Zn v63,v63
Zj v68,v56,v57
Zj v69,v58,v59
Zj v70,v60,v61
Zj v71,v62,v63
s_nop 1
Ze v[80:83],a[248:251],v[68:71],v[80:83]
Ze v[84:87],a[252:255],v[68:71],v[84:87]
Zt v4,v[72:75] offset:0
Zt v4,v[76:79] offset:1024
s_nop 1
Zt v4,v[80:83] offset:2048
s_nop 2
Zt v4,v[84:87] offset:3072
Zf lgkmcnt(0)
s_barrier
ds_read_b32 v32, v5 offset:520
ds_read_b32 v33, v5 offset:2568
Zi v[40:43],v6 offset:0
Zi v[44:47],v6 offset:1024
Zi v[48:51],v6 offset:4096
Zi v[52:55],v6 offset:5120
Zi v[56:59],v6 offset:8192
Zi v[60:63],v6 offset:9216
Zi v[64:67],v6 offset:12288
Zi v[68:71],v6 offset:13312
Zf lgkmcnt(9)
Zs v34,v32
s_nop 1
v_permlane32_swap_b32 v32, v34
Zl v32,v32,v34
Zs v34,v32
s_nop 1
v_permlane16_swap_b32 v32, v34
Zl v32,v32,v34
Zf lgkmcnt(8)
Zs v34,v33
s_nop 1
v_permlane32_swap_b32 v33, v34
Zl v33,v33,v34
Zs v34,v33
s_nop 1
v_permlane16_swap_b32 v33, v34
Zl v33,v33,v34
v_cmp_lt_f32 s[32:33], s28, v32
v_cmp_lt_f32 s[34:35], s28, v33
v_cmp_gt_f32 s[36:37], s29, v32
v_cmp_gt_f32 s[38:39], s29, v33
s_nop 1
s_and_b64 s[32:33], s[32:33], s[34:35]
s_and_b64 s[36:37], s[36:37], s[38:39]
s_and_b64 s[32:33], s[32:33], s[36:37]
s_cmp_eq_u64 s[32:33], -1
Zk AT_OK
s_cmp_lg_u32 s15, 0
Zk AT_OK
Zf lgkmcnt(0)
Zp s15,1
Zs v10,0xff800000
Zs v11,0xff800000
Ze v[32:35],a[0:3],v[16:19],0
Ze v[36:39],a[4:7],v[16:19],0
Ze v[40:43],a[0:3],v[20:23],0
Ze v[44:47],a[4:7],v[20:23],0
v_max3_f32 v10, v10, v32, v33
v_max3_f32 v10, v10, v34, v35
v_max3_f32 v10, v10, v36, v37
v_max3_f32 v10, v10, v38, v39
v_max3_f32 v11, v11, v40, v41
v_max3_f32 v11, v11, v42, v43
s_nop 1
v_max3_f32 v11, v11, v44, v45
v_max3_f32 v11, v11, v46, v47
Ze v[48:51],a[16:19],v[16:19],0
Ze v[52:55],a[20:23],v[16:19],0
Ze v[56:59],a[16:19],v[20:23],0
Ze v[60:63],a[20:23],v[20:23],0
v_max3_f32 v10, v10, v48, v49
v_max3_f32 v10, v10, v50, v51
v_max3_f32 v10, v10, v52, v53
v_max3_f32 v10, v10, v54, v55
v_max3_f32 v11, v11, v56, v57
v_max3_f32 v11, v11, v58, v59
s_nop 1
v_max3_f32 v11, v11, v60, v61
v_max3_f32 v11, v11, v62, v63
Ze v[32:35],a[32:35],v[16:19],0
Ze v[36:39],a[36:39],v[16:19],0
Ze v[40:43],a[32:35],v[20:23],0
Ze v[44:47],a[36:39],v[20:23],0
v_max3_f32 v10, v10, v32, v33
v_max3_f32 v10, v10, v34, v35
v_max3_f32 v10, v10, v36, v37
v_max3_f32 v10, v10, v38, v39
v_max3_f32 v11, v11, v40, v41
v_max3_f32 v11, v11, v42, v43
s_nop 1
v_max3_f32 v11, v11, v44, v45
v_max3_f32 v11, v11, v46, v47
Ze v[48:51],a[48:51],v[16:19],0
Ze v[52:55],a[52:55],v[16:19],0
Ze v[56:59],a[48:51],v[20:23],0
Ze v[60:63],a[52:55],v[20:23],0
v_max3_f32 v10, v10, v48, v49
v_max3_f32 v10, v10, v50, v51
v_max3_f32 v10, v10, v52, v53
v_max3_f32 v10, v10, v54, v55
v_max3_f32 v11, v11, v56, v57
v_max3_f32 v11, v11, v58, v59
s_nop 1
v_max3_f32 v11, v11, v60, v61
v_max3_f32 v11, v11, v62, v63
Ze v[32:35],a[64:67],v[16:19],0
Ze v[36:39],a[68:71],v[16:19],0
Ze v[40:43],a[64:67],v[20:23],0
Ze v[44:47],a[68:71],v[20:23],0
v_max3_f32 v10, v10, v32, v33
v_max3_f32 v10, v10, v34, v35
v_max3_f32 v10, v10, v36, v37
v_max3_f32 v10, v10, v38, v39
v_max3_f32 v11, v11, v40, v41
v_max3_f32 v11, v11, v42, v43
s_nop 1
v_max3_f32 v11, v11, v44, v45
v_max3_f32 v11, v11, v46, v47
Ze v[48:51],a[80:83],v[16:19],0
Ze v[52:55],a[84:87],v[16:19],0
Ze v[56:59],a[80:83],v[20:23],0
Ze v[60:63],a[84:87],v[20:23],0
v_max3_f32 v10, v10, v48, v49
v_max3_f32 v10, v10, v50, v51
v_max3_f32 v10, v10, v52, v53
v_max3_f32 v10, v10, v54, v55
v_max3_f32 v11, v11, v56, v57
v_max3_f32 v11, v11, v58, v59
s_nop 1
v_max3_f32 v11, v11, v60, v61
v_max3_f32 v11, v11, v62, v63
Ze v[32:35],a[96:99],v[16:19],0
Ze v[36:39],a[100:103],v[16:19],0
Ze v[40:43],a[96:99],v[20:23],0
Ze v[44:47],a[100:103],v[20:23],0
v_max3_f32 v10, v10, v32, v33
v_max3_f32 v10, v10, v34, v35
v_max3_f32 v10, v10, v36, v37
v_max3_f32 v10, v10, v38, v39
v_max3_f32 v11, v11, v40, v41
v_max3_f32 v11, v11, v42, v43
s_nop 1
v_max3_f32 v11, v11, v44, v45
v_max3_f32 v11, v11, v46, v47
Ze v[48:51],a[112:115],v[16:19],0
Ze v[52:55],a[116:119],v[16:19],0
Ze v[56:59],a[112:115],v[20:23],0
Ze v[60:63],a[116:119],v[20:23],0
v_max3_f32 v10, v10, v48, v49
v_max3_f32 v10, v10, v50, v51
v_max3_f32 v10, v10, v52, v53
v_max3_f32 v10, v10, v54, v55
v_max3_f32 v11, v11, v56, v57
v_max3_f32 v11, v11, v58, v59
s_nop 1
v_max3_f32 v11, v11, v60, v61
v_max3_f32 v11, v11, v62, v63
Ze v[32:35],a[128:131],v[16:19],0
Ze v[36:39],a[132:135],v[16:19],0
Ze v[40:43],a[128:131],v[20:23],0
Ze v[44:47],a[132:135],v[20:23],0
v_max3_f32 v10, v10, v32, v33
v_max3_f32 v10, v10, v34, v35
v_max3_f32 v10, v10, v36, v37
v_max3_f32 v10, v10, v38, v39
v_max3_f32 v11, v11, v40, v41
v_max3_f32 v11, v11, v42, v43
s_nop 1
v_max3_f32 v11, v11, v44, v45
v_max3_f32 v11, v11, v46, v47
Ze v[48:51],a[144:147],v[16:19],0
Ze v[52:55],a[148:151],v[16:19],0
Ze v[56:59],a[144:147],v[20:23],0
Ze v[60:63],a[148:151],v[20:23],0
v_max3_f32 v10, v10, v48, v49
v_max3_f32 v10, v10, v50, v51
v_max3_f32 v10, v10, v52, v53
v_max3_f32 v10, v10, v54, v55
v_max3_f32 v11, v11, v56, v57
v_max3_f32 v11, v11, v58, v59
s_nop 1
v_max3_f32 v11, v11, v60, v61
v_max3_f32 v11, v11, v62, v63
Ze v[32:35],a[160:163],v[16:19],0
Ze v[36:39],a[164:167],v[16:19],0
Ze v[40:43],a[160:163],v[20:23],0
Ze v[44:47],a[164:167],v[20:23],0
v_max3_f32 v10, v10, v32, v33
v_max3_f32 v10, v10, v34, v35
v_max3_f32 v10, v10, v36, v37
v_max3_f32 v10, v10, v38, v39
v_max3_f32 v11, v11, v40, v41
v_max3_f32 v11, v11, v42, v43
s_nop 1
v_max3_f32 v11, v11, v44, v45
v_max3_f32 v11, v11, v46, v47
Ze v[48:51],a[176:179],v[16:19],0
Ze v[52:55],a[180:183],v[16:19],0
Ze v[56:59],a[176:179],v[20:23],0
Ze v[60:63],a[180:183],v[20:23],0
v_max3_f32 v10, v10, v48, v49
v_max3_f32 v10, v10, v50, v51
v_max3_f32 v10, v10, v52, v53
v_max3_f32 v10, v10, v54, v55
v_max3_f32 v11, v11, v56, v57
v_max3_f32 v11, v11, v58, v59
s_nop 1
v_max3_f32 v11, v11, v60, v61
v_max3_f32 v11, v11, v62, v63
Ze v[32:35],a[192:195],v[16:19],0
Ze v[36:39],a[196:199],v[16:19],0
Ze v[40:43],a[192:195],v[20:23],0
Ze v[44:47],a[196:199],v[20:23],0
v_max3_f32 v10, v10, v32, v33
v_max3_f32 v10, v10, v34, v35
v_max3_f32 v10, v10, v36, v37
v_max3_f32 v10, v10, v38, v39
v_max3_f32 v11, v11, v40, v41
v_max3_f32 v11, v11, v42, v43
s_nop 1
v_max3_f32 v11, v11, v44, v45
v_max3_f32 v11, v11, v46, v47
Ze v[48:51],a[208:211],v[16:19],0
Ze v[52:55],a[212:215],v[16:19],0
Ze v[56:59],a[208:211],v[20:23],0
Ze v[60:63],a[212:215],v[20:23],0
v_max3_f32 v10, v10, v48, v49
v_max3_f32 v10, v10, v50, v51
v_max3_f32 v10, v10, v52, v53
v_max3_f32 v10, v10, v54, v55
v_max3_f32 v11, v11, v56, v57
v_max3_f32 v11, v11, v58, v59
s_nop 1
v_max3_f32 v11, v11, v60, v61
v_max3_f32 v11, v11, v62, v63
Ze v[32:35],a[224:227],v[16:19],0
Ze v[36:39],a[228:231],v[16:19],0
Ze v[40:43],a[224:227],v[20:23],0
Ze v[44:47],a[228:231],v[20:23],0
v_max3_f32 v10, v10, v32, v33
v_max3_f32 v10, v10, v34, v35
v_max3_f32 v10, v10, v36, v37
v_max3_f32 v10, v10, v38, v39
v_max3_f32 v11, v11, v40, v41
v_max3_f32 v11, v11, v42, v43
s_nop 1
v_max3_f32 v11, v11, v44, v45
v_max3_f32 v11, v11, v46, v47
Ze v[48:51],a[240:243],v[16:19],0
Ze v[52:55],a[244:247],v[16:19],0
Ze v[56:59],a[240:243],v[20:23],0
Ze v[60:63],a[244:247],v[20:23],0
v_max3_f32 v10, v10, v48, v49
v_max3_f32 v10, v10, v50, v51
v_max3_f32 v10, v10, v52, v53
v_max3_f32 v10, v10, v54, v55
v_max3_f32 v11, v11, v56, v57
v_max3_f32 v11, v11, v58, v59
s_nop 1
v_max3_f32 v11, v11, v60, v61
v_max3_f32 v11, v11, v62, v63
Zs v12,v10
s_nop 1
v_permlane32_swap_b32 v10, v12
v_max_f32 v10, v10, v12
Zs v12,v10
s_nop 1
v_permlane16_swap_b32 v10, v12
v_max_f32 v10, v10, v12
Zs v12,v11
s_nop 1
v_permlane32_swap_b32 v11, v12
v_max_f32 v11, v11, v12
Zs v12,v11
s_nop 1
v_permlane16_swap_b32 v11, v12
v_max_f32 v11, v11, v12
ds_write_b64 v7, v[10:11] offset:16384
Zf lgkmcnt(0)
s_barrier
ds_read_b64 v[10:11], v8 offset:16384
Zf lgkmcnt(0)
Zs v12,v10
s_nop 1
v_permlane32_swap_b32 v10, v12
v_max_f32 v10, v10, v12
Zs v12,v10
s_nop 1
v_permlane16_swap_b32 v10, v12
v_max_f32 v10, v10, v12
Zs v12,v11
s_nop 1
v_permlane32_swap_b32 v11, v12
v_max_f32 v11, v11, v12
Zs v12,v11
s_nop 1
v_permlane16_swap_b32 v11, v12
v_max_f32 v11, v11, v12
Zx v24,0,v10
Zx v25,0,v10
Zx v26,0,v10
Zx v27,0,v10
Zx v28,0,v11
Zx v29,0,v11
Zx v30,0,v11
Zx v31,0,v11
s_nop 1
s_branch AT_M
AT_OK:
Zm v[24:25],0
Zm v[26:27],0
Zm v[28:29],0
Zm v[30:31],0
s_cmp_ge_u32 s9, 2
Zk AT_F
Zo s9,1
s_cselect_b64 vcc, -1, 0
v_cndmask_b32 v32, v32, v33, vcc
v_rcp_f32 v32, v32
Zf lgkmcnt(5)
Zl v40,v40,v48
Zl v41,v41,v49
Zl v42,v42,v50
Zl v43,v43,v51
Zf lgkmcnt(4)
Zl v44,v44,v52
Zl v45,v45,v53
Zl v46,v46,v54
Zl v47,v47,v55
Zf lgkmcnt(3)
Zl v40,v40,v56
Zl v41,v41,v57
Zl v42,v42,v58
Zl v43,v43,v59
Zf lgkmcnt(2)
Zl v44,v44,v60
Zl v45,v45,v61
Zl v46,v46,v62
Zl v47,v47,v63
Zf lgkmcnt(1)
Zl v40,v40,v64
Zl v41,v41,v65
Zl v42,v42,v66
Zl v43,v43,v67
Zf lgkmcnt(0)
Zl v44,v44,v68
Zl v45,v45,v69
Zl v46,v46,v70
Zl v47,v47,v71
Zw v40,v40,v32
Zw v41,v41,v32
Zw v42,v42,v32
Zw v43,v43,v32
Zw v44,v44,v32
Zw v45,v45,v32
Zw v46,v46,v32
Zw v47,v47,v32
Zj v36,v40,v44
Zj v37,v41,v45
Zj v38,v42,v46
Zj v39,v43,v47
Zq s19,s9,10
Zb s18,s18,s19
Zb s18,s18,6291456
Zr v[36:39],v0,s[4:7],s18 offen sc1
AT_F:
Zf vmcnt(0) lgkmcnt(0)
s_barrier
s_cmp_lg_u32 s9, 0
Zk SF_37
Zs v9,s16
Zu v9,off,s[4:7],s13 sc1
SF_37:
Zb s10,s10,2
s_sub_u32 s19, s10, s11
s_cmp_lt_u32 s19, 64
Zk AT_U
Zb s11,s11,64
s_cmp_lt_u32 s11, 128
Zk AT_LAY
Zf vmcnt(0)
s_endpgm
R_AQ:
Zy v0,63,v0
Zy v1,15,v0
v_lshrrev_b32 v2, 4, v0
Zz v0,4,v0
Zp s22,0x05040100
Zp s23,0x07060302
Zp s20,300000
Zs v9,2130706432
s_load_dwordx2 s[24:25], s[0:1], 8
Zp s26,819200
Zp s27,0x20000
Zq s17,s8,2
Zb s17,s17,s9
s_mul_i32 s17, s17, 40
v_mul_u32_u24 v4, 10240, v2
v_lshl_add_u32 v4, v1, 2, v4
v_cmp_le_u32 vcc, 10, v1
s_nop 1
v_cndmask_b32 v4, v4, v9, vcc
Zb s19,s17,0
Zf lgkmcnt(0)
Za v64,v4,s[24:27],s19 offen
Zb s19,s17,1280
Za v65,v4,s[24:27],s19 offen
Zb s19,s17,2560
Za v66,v4,s[24:27],s19 offen
Zb s19,s17,3840
Za v67,v4,s[24:27],s19 offen
Zb s19,s17,5120
Za v68,v4,s[24:27],s19 offen
Zb s19,s17,6400
Za v69,v4,s[24:27],s19 offen
Zb s19,s17,7680
Za v70,v4,s[24:27],s19 offen
Zb s19,s17,8960
Za v71,v4,s[24:27],s19 offen
Zb s19,s17,40960
Za v72,v4,s[24:27],s19 offen
Zb s19,s17,42240
Za v73,v4,s[24:27],s19 offen
Zb s19,s17,43520
Za v74,v4,s[24:27],s19 offen
Zb s19,s17,44800
Za v75,v4,s[24:27],s19 offen
Zb s19,s17,46080
Za v76,v4,s[24:27],s19 offen
Zb s19,s17,47360
Za v77,v4,s[24:27],s19 offen
Zb s19,s17,48640
Za v78,v4,s[24:27],s19 offen
Zb s19,s17,49920
Za v79,v4,s[24:27],s19 offen
Zb s19,s17,81920
Za v80,v4,s[24:27],s19 offen
Zb s19,s17,83200
Za v81,v4,s[24:27],s19 offen
Zb s19,s17,84480
Za v82,v4,s[24:27],s19 offen
Zb s19,s17,85760
Za v83,v4,s[24:27],s19 offen
Zb s19,s17,87040
Za v84,v4,s[24:27],s19 offen
Zb s19,s17,88320
Za v85,v4,s[24:27],s19 offen
Zb s19,s17,89600
Za v86,v4,s[24:27],s19 offen
Zb s19,s17,90880
Za v87,v4,s[24:27],s19 offen
Zb s19,s17,122880
Za v88,v4,s[24:27],s19 offen
Zb s19,s17,124160
Za v89,v4,s[24:27],s19 offen
Zb s19,s17,125440
Za v90,v4,s[24:27],s19 offen
Zb s19,s17,126720
Za v91,v4,s[24:27],s19 offen
Zb s19,s17,128000
Za v92,v4,s[24:27],s19 offen
Zb s19,s17,129280
Za v93,v4,s[24:27],s19 offen
Zb s19,s17,130560
Za v94,v4,s[24:27],s19 offen
Zb s19,s17,131840
Za v95,v4,s[24:27],s19 offen
Zb s19,s17,163840
Za v96,v4,s[24:27],s19 offen
Zb s19,s17,165120
Za v97,v4,s[24:27],s19 offen
Zb s19,s17,166400
Za v98,v4,s[24:27],s19 offen
Zb s19,s17,167680
Za v99,v4,s[24:27],s19 offen
Zb s19,s17,168960
Za v100,v4,s[24:27],s19 offen
Zb s19,s17,170240
Za v101,v4,s[24:27],s19 offen
Zb s19,s17,171520
Za v102,v4,s[24:27],s19 offen
Zb s19,s17,172800
Za v103,v4,s[24:27],s19 offen
Zb s19,s17,204800
Za v104,v4,s[24:27],s19 offen
Zb s19,s17,206080
Za v105,v4,s[24:27],s19 offen
Zb s19,s17,207360
Za v106,v4,s[24:27],s19 offen
Zb s19,s17,208640
Za v107,v4,s[24:27],s19 offen
Zb s19,s17,209920
Za v108,v4,s[24:27],s19 offen
Zb s19,s17,211200
Za v109,v4,s[24:27],s19 offen
Zb s19,s17,212480
Za v110,v4,s[24:27],s19 offen
Zb s19,s17,213760
Za v111,v4,s[24:27],s19 offen
Zf vmcnt(46)
Zc v56,v65,v64,s22
Zf vmcnt(44)
Zc v57,v67,v66,s22
Zf vmcnt(42)
Zc v58,v69,v68,s22
Zf vmcnt(40)
Zc v59,v71,v70,s22
Zc v60,v65,v64,s23
Zc v61,v67,v66,s23
Zc v62,v69,v68,s23
Zc v63,v71,v70,s23
Zd a0,v56
Zd a1,v57
Zd a2,v58
Zd a3,v59
Zd a4,v60
Zd a5,v61
Zd a6,v62
Zd a7,v63
Zb s19,s17,245760
Za v64,v4,s[24:27],s19 offen
Zb s19,s17,247040
Za v65,v4,s[24:27],s19 offen
Zb s19,s17,248320
Za v66,v4,s[24:27],s19 offen
Zb s19,s17,249600
Za v67,v4,s[24:27],s19 offen
Zb s19,s17,250880
Za v68,v4,s[24:27],s19 offen
Zb s19,s17,252160
Za v69,v4,s[24:27],s19 offen
Zb s19,s17,253440
Za v70,v4,s[24:27],s19 offen
Zb s19,s17,254720
Za v71,v4,s[24:27],s19 offen
Zf vmcnt(46)
Zc v56,v73,v72,s22
Zf vmcnt(44)
Zc v57,v75,v74,s22
Zf vmcnt(42)
Zc v58,v77,v76,s22
Zf vmcnt(40)
Zc v59,v79,v78,s22
Zc v60,v73,v72,s23
Zc v61,v75,v74,s23
Zc v62,v77,v76,s23
Zc v63,v79,v78,s23
Zd a8,v56
Zd a9,v57
Zd a10,v58
Zd a11,v59
Zd a12,v60
Zd a13,v61
Zd a14,v62
Zd a15,v63
Zb s19,s17,286720
Za v72,v4,s[24:27],s19 offen
Zb s19,s17,288000
Za v73,v4,s[24:27],s19 offen
Zb s19,s17,289280
Za v74,v4,s[24:27],s19 offen
Zb s19,s17,290560
Za v75,v4,s[24:27],s19 offen
Zb s19,s17,291840
Za v76,v4,s[24:27],s19 offen
Zb s19,s17,293120
Za v77,v4,s[24:27],s19 offen
Zb s19,s17,294400
Za v78,v4,s[24:27],s19 offen
Zb s19,s17,295680
Za v79,v4,s[24:27],s19 offen
Zf vmcnt(46)
Zc v56,v81,v80,s22
Zf vmcnt(44)
Zc v57,v83,v82,s22
Zf vmcnt(42)
Zc v58,v85,v84,s22
Zf vmcnt(40)
Zc v59,v87,v86,s22
Zc v60,v81,v80,s23
Zc v61,v83,v82,s23
Zc v62,v85,v84,s23
Zc v63,v87,v86,s23
Zd a16,v56
Zd a17,v57
Zd a18,v58
Zd a19,v59
Zd a20,v60
Zd a21,v61
Zd a22,v62
Zd a23,v63
Zb s19,s17,327680
Za v80,v4,s[24:27],s19 offen
Zb s19,s17,328960
Za v81,v4,s[24:27],s19 offen
Zb s19,s17,330240
Za v82,v4,s[24:27],s19 offen
Zb s19,s17,331520
Za v83,v4,s[24:27],s19 offen
Zb s19,s17,332800
Za v84,v4,s[24:27],s19 offen
Zb s19,s17,334080
Za v85,v4,s[24:27],s19 offen
Zb s19,s17,335360
Za v86,v4,s[24:27],s19 offen
Zb s19,s17,336640
Za v87,v4,s[24:27],s19 offen
Zf vmcnt(46)
Zc v56,v89,v88,s22
Zf vmcnt(44)
Zc v57,v91,v90,s22
Zf vmcnt(42)
Zc v58,v93,v92,s22
Zf vmcnt(40)
Zc v59,v95,v94,s22
Zc v60,v89,v88,s23
Zc v61,v91,v90,s23
Zc v62,v93,v92,s23
Zc v63,v95,v94,s23
Zd a24,v56
Zd a25,v57
Zd a26,v58
Zd a27,v59
Zd a28,v60
Zd a29,v61
Zd a30,v62
Zd a31,v63
Zb s19,s17,368640
Za v88,v4,s[24:27],s19 offen
Zb s19,s17,369920
Za v89,v4,s[24:27],s19 offen
Zb s19,s17,371200
Za v90,v4,s[24:27],s19 offen
Zb s19,s17,372480
Za v91,v4,s[24:27],s19 offen
Zb s19,s17,373760
Za v92,v4,s[24:27],s19 offen
Zb s19,s17,375040
Za v93,v4,s[24:27],s19 offen
Zb s19,s17,376320
Za v94,v4,s[24:27],s19 offen
Zb s19,s17,377600
Za v95,v4,s[24:27],s19 offen
Zf vmcnt(46)
Zc v56,v97,v96,s22
Zf vmcnt(44)
Zc v57,v99,v98,s22
Zf vmcnt(42)
Zc v58,v101,v100,s22
Zf vmcnt(40)
Zc v59,v103,v102,s22
Zc v60,v97,v96,s23
Zc v61,v99,v98,s23
Zc v62,v101,v100,s23
Zc v63,v103,v102,s23
Zd a32,v56
Zd a33,v57
Zd a34,v58
Zd a35,v59
Zd a36,v60
Zd a37,v61
Zd a38,v62
Zd a39,v63
Zb s19,s17,409600
Za v96,v4,s[24:27],s19 offen
Zb s19,s17,410880
Za v97,v4,s[24:27],s19 offen
Zb s19,s17,412160
Za v98,v4,s[24:27],s19 offen
Zb s19,s17,413440
Za v99,v4,s[24:27],s19 offen
Zb s19,s17,414720
Za v100,v4,s[24:27],s19 offen
Zb s19,s17,416000
Za v101,v4,s[24:27],s19 offen
Zb s19,s17,417280
Za v102,v4,s[24:27],s19 offen
Zb s19,s17,418560
Za v103,v4,s[24:27],s19 offen
Zf vmcnt(46)
Zc v56,v105,v104,s22
Zf vmcnt(44)
Zc v57,v107,v106,s22
Zf vmcnt(42)
Zc v58,v109,v108,s22
Zf vmcnt(40)
Zc v59,v111,v110,s22
Zc v60,v105,v104,s23
Zc v61,v107,v106,s23
Zc v62,v109,v108,s23
Zc v63,v111,v110,s23
Zd a40,v56
Zd a41,v57
Zd a42,v58
Zd a43,v59
Zd a44,v60
Zd a45,v61
Zd a46,v62
Zd a47,v63
Zb s19,s17,450560
Za v104,v4,s[24:27],s19 offen
Zb s19,s17,451840
Za v105,v4,s[24:27],s19 offen
Zb s19,s17,453120
Za v106,v4,s[24:27],s19 offen
Zb s19,s17,454400
Za v107,v4,s[24:27],s19 offen
Zb s19,s17,455680
Za v108,v4,s[24:27],s19 offen
Zb s19,s17,456960
Za v109,v4,s[24:27],s19 offen
Zb s19,s17,458240
Za v110,v4,s[24:27],s19 offen
Zb s19,s17,459520
Za v111,v4,s[24:27],s19 offen
Zf vmcnt(46)
Zc v56,v65,v64,s22
Zf vmcnt(44)
Zc v57,v67,v66,s22
Zf vmcnt(42)
Zc v58,v69,v68,s22
Zf vmcnt(40)
Zc v59,v71,v70,s22
Zc v60,v65,v64,s23
Zc v61,v67,v66,s23
Zc v62,v69,v68,s23
Zc v63,v71,v70,s23
Zd a48,v56
Zd a49,v57
Zd a50,v58
Zd a51,v59
Zd a52,v60
Zd a53,v61
Zd a54,v62
Zd a55,v63
Zb s19,s17,491520
Za v64,v4,s[24:27],s19 offen
Zb s19,s17,492800
Za v65,v4,s[24:27],s19 offen
Zb s19,s17,494080
Za v66,v4,s[24:27],s19 offen
Zb s19,s17,495360
Za v67,v4,s[24:27],s19 offen
Zb s19,s17,496640
Za v68,v4,s[24:27],s19 offen
Zb s19,s17,497920
Za v69,v4,s[24:27],s19 offen
Zb s19,s17,499200
Za v70,v4,s[24:27],s19 offen
Zb s19,s17,500480
Za v71,v4,s[24:27],s19 offen
Zf vmcnt(46)
Zc v56,v73,v72,s22
Zf vmcnt(44)
Zc v57,v75,v74,s22
Zf vmcnt(42)
Zc v58,v77,v76,s22
Zf vmcnt(40)
Zc v59,v79,v78,s22
Zc v60,v73,v72,s23
Zc v61,v75,v74,s23
Zc v62,v77,v76,s23
Zc v63,v79,v78,s23
Zd a56,v56
Zd a57,v57
Zd a58,v58
Zd a59,v59
Zd a60,v60
Zd a61,v61
Zd a62,v62
Zd a63,v63
Zb s19,s17,532480
Za v72,v4,s[24:27],s19 offen
Zb s19,s17,533760
Za v73,v4,s[24:27],s19 offen
Zb s19,s17,535040
Za v74,v4,s[24:27],s19 offen
Zb s19,s17,536320
Za v75,v4,s[24:27],s19 offen
Zb s19,s17,537600
Za v76,v4,s[24:27],s19 offen
Zb s19,s17,538880
Za v77,v4,s[24:27],s19 offen
Zb s19,s17,540160
Za v78,v4,s[24:27],s19 offen
Zb s19,s17,541440
Za v79,v4,s[24:27],s19 offen
Zf vmcnt(46)
Zc v56,v81,v80,s22
Zf vmcnt(44)
Zc v57,v83,v82,s22
Zf vmcnt(42)
Zc v58,v85,v84,s22
Zf vmcnt(40)
Zc v59,v87,v86,s22
Zc v60,v81,v80,s23
Zc v61,v83,v82,s23
Zc v62,v85,v84,s23
Zc v63,v87,v86,s23
Zd a64,v56
Zd a65,v57
Zd a66,v58
Zd a67,v59
Zd a68,v60
Zd a69,v61
Zd a70,v62
Zd a71,v63
Zb s19,s17,573440
Za v80,v4,s[24:27],s19 offen
Zb s19,s17,574720
Za v81,v4,s[24:27],s19 offen
Zb s19,s17,576000
Za v82,v4,s[24:27],s19 offen
Zb s19,s17,577280
Za v83,v4,s[24:27],s19 offen
Zb s19,s17,578560
Za v84,v4,s[24:27],s19 offen
Zb s19,s17,579840
Za v85,v4,s[24:27],s19 offen
Zb s19,s17,581120
Za v86,v4,s[24:27],s19 offen
Zb s19,s17,582400
Za v87,v4,s[24:27],s19 offen
Zf vmcnt(46)
Zc v56,v89,v88,s22
Zf vmcnt(44)
Zc v57,v91,v90,s22
Zf vmcnt(42)
Zc v58,v93,v92,s22
Zf vmcnt(40)
Zc v59,v95,v94,s22
Zc v60,v89,v88,s23
Zc v61,v91,v90,s23
Zc v62,v93,v92,s23
Zc v63,v95,v94,s23
Zd a72,v56
Zd a73,v57
Zd a74,v58
Zd a75,v59
Zd a76,v60
Zd a77,v61
Zd a78,v62
Zd a79,v63
Zb s19,s17,614400
Za v88,v4,s[24:27],s19 offen
Zb s19,s17,615680
Za v89,v4,s[24:27],s19 offen
Zb s19,s17,616960
Za v90,v4,s[24:27],s19 offen
Zb s19,s17,618240
Za v91,v4,s[24:27],s19 offen
Zb s19,s17,619520
Za v92,v4,s[24:27],s19 offen
Zb s19,s17,620800
Za v93,v4,s[24:27],s19 offen
Zb s19,s17,622080
Za v94,v4,s[24:27],s19 offen
Zb s19,s17,623360
Za v95,v4,s[24:27],s19 offen
Zf vmcnt(46)
Zc v56,v97,v96,s22
Zf vmcnt(44)
Zc v57,v99,v98,s22
Zf vmcnt(42)
Zc v58,v101,v100,s22
Zf vmcnt(40)
Zc v59,v103,v102,s22
Zc v60,v97,v96,s23
Zc v61,v99,v98,s23
Zc v62,v101,v100,s23
Zc v63,v103,v102,s23
Zd a80,v56
Zd a81,v57
Zd a82,v58
Zd a83,v59
Zd a84,v60
Zd a85,v61
Zd a86,v62
Zd a87,v63
Zb s19,s17,655360
Za v96,v4,s[24:27],s19 offen
Zb s19,s17,656640
Za v97,v4,s[24:27],s19 offen
Zb s19,s17,657920
Za v98,v4,s[24:27],s19 offen
Zb s19,s17,659200
Za v99,v4,s[24:27],s19 offen
Zb s19,s17,660480
Za v100,v4,s[24:27],s19 offen
Zb s19,s17,661760
Za v101,v4,s[24:27],s19 offen
Zb s19,s17,663040
Za v102,v4,s[24:27],s19 offen
Zb s19,s17,664320
Za v103,v4,s[24:27],s19 offen
Zf vmcnt(46)
Zc v56,v105,v104,s22
Zf vmcnt(44)
Zc v57,v107,v106,s22
Zf vmcnt(42)
Zc v58,v109,v108,s22
Zf vmcnt(40)
Zc v59,v111,v110,s22
Zc v60,v105,v104,s23
Zc v61,v107,v106,s23
Zc v62,v109,v108,s23
Zc v63,v111,v110,s23
Zd a88,v56
Zd a89,v57
Zd a90,v58
Zd a91,v59
Zd a92,v60
Zd a93,v61
Zd a94,v62
Zd a95,v63
Zb s19,s17,696320
Za v104,v4,s[24:27],s19 offen
Zb s19,s17,697600
Za v105,v4,s[24:27],s19 offen
Zb s19,s17,698880
Za v106,v4,s[24:27],s19 offen
Zb s19,s17,700160
Za v107,v4,s[24:27],s19 offen
Zb s19,s17,701440
Za v108,v4,s[24:27],s19 offen
Zb s19,s17,702720
Za v109,v4,s[24:27],s19 offen
Zb s19,s17,704000
Za v110,v4,s[24:27],s19 offen
Zb s19,s17,705280
Za v111,v4,s[24:27],s19 offen
Zf vmcnt(46)
Zc v56,v65,v64,s22
Zf vmcnt(44)
Zc v57,v67,v66,s22
Zf vmcnt(42)
Zc v58,v69,v68,s22
Zf vmcnt(40)
Zc v59,v71,v70,s22
Zc v60,v65,v64,s23
Zc v61,v67,v66,s23
Zc v62,v69,v68,s23
Zc v63,v71,v70,s23
Zd a96,v56
Zd a97,v57
Zd a98,v58
Zd a99,v59
Zd a100,v60
Zd a101,v61
Zd a102,v62
Zd a103,v63
Zb s19,s17,737280
Za v64,v4,s[24:27],s19 offen
Zb s19,s17,738560
Za v65,v4,s[24:27],s19 offen
Zb s19,s17,739840
Za v66,v4,s[24:27],s19 offen
Zb s19,s17,741120
Za v67,v4,s[24:27],s19 offen
Zb s19,s17,742400
Za v68,v4,s[24:27],s19 offen
Zb s19,s17,743680
Za v69,v4,s[24:27],s19 offen
Zb s19,s17,744960
Za v70,v4,s[24:27],s19 offen
Zb s19,s17,746240
Za v71,v4,s[24:27],s19 offen
Zf vmcnt(46)
Zc v56,v73,v72,s22
Zf vmcnt(44)
Zc v57,v75,v74,s22
Zf vmcnt(42)
Zc v58,v77,v76,s22
Zf vmcnt(40)
Zc v59,v79,v78,s22
Zc v60,v73,v72,s23
Zc v61,v75,v74,s23
Zc v62,v77,v76,s23
Zc v63,v79,v78,s23
Zd a104,v56
Zd a105,v57
Zd a106,v58
Zd a107,v59
Zd a108,v60
Zd a109,v61
Zd a110,v62
Zd a111,v63
Zb s19,s17,778240
Za v72,v4,s[24:27],s19 offen
Zb s19,s17,779520
Za v73,v4,s[24:27],s19 offen
Zb s19,s17,780800
Za v74,v4,s[24:27],s19 offen
Zb s19,s17,782080
Za v75,v4,s[24:27],s19 offen
Zb s19,s17,783360
Za v76,v4,s[24:27],s19 offen
Zb s19,s17,784640
Za v77,v4,s[24:27],s19 offen
Zb s19,s17,785920
Za v78,v4,s[24:27],s19 offen
Zb s19,s17,787200
Za v79,v4,s[24:27],s19 offen
Zf vmcnt(46)
Zc v56,v81,v80,s22
Zf vmcnt(44)
Zc v57,v83,v82,s22
Zf vmcnt(42)
Zc v58,v85,v84,s22
Zf vmcnt(40)
Zc v59,v87,v86,s22
Zc v60,v81,v80,s23
Zc v61,v83,v82,s23
Zc v62,v85,v84,s23
Zc v63,v87,v86,s23
Zd a112,v56
Zd a113,v57
Zd a114,v58
Zd a115,v59
Zd a116,v60
Zd a117,v61
Zd a118,v62
Zd a119,v63
Zf vmcnt(38)
Zc v56,v89,v88,s22
Zf vmcnt(36)
Zc v57,v91,v90,s22
Zf vmcnt(34)
Zc v58,v93,v92,s22
Zf vmcnt(32)
Zc v59,v95,v94,s22
Zc v60,v89,v88,s23
Zc v61,v91,v90,s23
Zc v62,v93,v92,s23
Zc v63,v95,v94,s23
Zd a120,v56
Zd a121,v57
Zd a122,v58
Zd a123,v59
Zd a124,v60
Zd a125,v61
Zd a126,v62
Zd a127,v63
Zf vmcnt(30)
Zc v56,v97,v96,s22
Zf vmcnt(28)
Zc v57,v99,v98,s22
Zf vmcnt(26)
Zc v58,v101,v100,s22
Zf vmcnt(24)
Zc v59,v103,v102,s22
Zc v60,v97,v96,s23
Zc v61,v99,v98,s23
Zc v62,v101,v100,s23
Zc v63,v103,v102,s23
Zd a128,v56
Zd a129,v57
Zd a130,v58
Zd a131,v59
Zd a132,v60
Zd a133,v61
Zd a134,v62
Zd a135,v63
Zf vmcnt(22)
Zc v56,v105,v104,s22
Zf vmcnt(20)
Zc v57,v107,v106,s22
Zf vmcnt(18)
Zc v58,v109,v108,s22
Zf vmcnt(16)
Zc v59,v111,v110,s22
Zc v60,v105,v104,s23
Zc v61,v107,v106,s23
Zc v62,v109,v108,s23
Zc v63,v111,v110,s23
Zd a136,v56
Zd a137,v57
Zd a138,v58
Zd a139,v59
Zd a140,v60
Zd a141,v61
Zd a142,v62
Zd a143,v63
Zf vmcnt(14)
Zc v56,v65,v64,s22
Zf vmcnt(12)
Zc v57,v67,v66,s22
Zf vmcnt(10)
Zc v58,v69,v68,s22
Zf vmcnt(8)
Zc v59,v71,v70,s22
Zc v60,v65,v64,s23
Zc v61,v67,v66,s23
Zc v62,v69,v68,s23
Zc v63,v71,v70,s23
Zd a144,v56
Zd a145,v57
Zd a146,v58
Zd a147,v59
Zd a148,v60
Zd a149,v61
Zd a150,v62
Zd a151,v63
Zf vmcnt(6)
Zc v56,v73,v72,s22
Zf vmcnt(4)
Zc v57,v75,v74,s22
Zf vmcnt(2)
Zc v58,v77,v76,s22
Zf vmcnt(0)
Zc v59,v79,v78,s22
Zc v60,v73,v72,s23
Zc v61,v75,v74,s23
Zc v62,v77,v76,s23
Zc v63,v79,v78,s23
Zd a152,v56
Zd a153,v57
Zd a154,v58
Zd a155,v59
Zd a156,v60
Zd a157,v61
Zd a158,v62
Zd a159,v63
Zp s12,8192
Zq s13,s8,2
Zb s13,s13,8448
Zp s14,0
Zp s29,1051011932
Zq s31,s8,2
Zb s31,s31,s9
v_lshrrev_b32 v3, 2, v0
v_min_u32 v3, 28, v3
v_lshrrev_b32 v7, 7, v0
v_lshrrev_b32 v8, 4, v0
Zy v8,7,v8
v_xor_b32 v8, v8, v7
Zq s19,s9,3
v_add_u32 v7, s19, v7
v_mul_u32_u24 v4, 1280, v7
v_lshl_add_u32 v4, v8, 4, v4
Zy v7,7,v1
v_lshrrev_b32 v8, 3, v1
Zz v8,10,v8
v_lshl_add_u32 v8, v7, 7, v8
v_xor_b32 v7, v2, v7
v_lshl_add_u32 v5, v7, 4, v8
v_xor_b32 v6, 64, v5
Zp s10,0
s_and_b32 s35, s8, 31
s_mul_i32 s34, s35, 26
s_lshr_b32 s34, s34, 8
s_mul_i32 s34, s34, 10
s_sub_u32 s35, s35, s34
Zq s35,s35,7
Zq s11,s9,10
Zp s15,0
Zp s33,0
Zp s32,131072
v_lshrrev_b32 v11, 2, v0
v_add_u32 v11, 131072, v11
Zf vmcnt(0) lgkmcnt(0)
AQ_L:
s_cmp_lg_u32 s15, 0
Zk AQ_H
Zb s16,s10,1
s_and_b32 s21, s10, 1
Zq s21,s21,7
Zb s21,s21,8192
WF_38:
Za v9,v3,s[4:7],s21 offen sc1
Zf vmcnt(0)
v_cmp_gt_u32 vcc, s16, v9
s_cbranch_vccz WD_39
s_sleep 3
s_sub_u32 s20, s20, 1
s_cmp_gt_i32 s20, 0
Zk WF_38
WD_39:
s_mul_i32 s36, s10, 40960
Zb s36,s36,100663296
Zb s36,s36,s14
Zb s16,s10,1
s_and_b32 s21, s16, 1
Zq s21,s21,7
Zb s21,s21,8192
Zq s34,s35,5
Zb m0,s11,s34
Zb s37,s36,s35
Zh v4,s[4:7],s37 offen sc1 lds
Zb s35,s35,128
Zo s35,1280
s_cselect_b32 s35, 0, s35
Zq s34,s35,5
Zb m0,s11,s34
Zb s37,s36,s35
Zh v4,s[4:7],s37 offen sc1 lds
Zb s35,s35,128
Zo s35,1280
s_cselect_b32 s35, 0, s35
Zq s34,s35,5
Zb m0,s11,s34
Zb s37,s36,s35
Zh v4,s[4:7],s37 offen sc1 lds
Zb s35,s35,128
Zo s35,1280
s_cselect_b32 s35, 0, s35
Zq s34,s35,5
Zb m0,s11,s34
Zb s37,s36,s35
Zh v4,s[4:7],s37 offen sc1 lds
Zb s35,s35,128
Zo s35,1280
s_cselect_b32 s35, 0, s35
Zq s34,s35,5
Zb m0,s11,s34
Zb s37,s36,s35
Zh v4,s[4:7],s37 offen sc1 lds
Zb s35,s35,128
Zo s35,1280
s_cselect_b32 s35, 0, s35
Zq s34,s35,5
Zb m0,s11,s34
Zb s37,s36,s35
Zh v4,s[4:7],s37 offen sc1 lds
Zb s35,s35,128
Zo s35,1280
s_cselect_b32 s35, 0, s35
Zq s34,s35,5
Zb m0,s11,s34
Zb s37,s36,s35
Zh v4,s[4:7],s37 offen sc1 lds
Zb s35,s35,128
Zo s35,1280
s_cselect_b32 s35, 0, s35
Zq s34,s35,5
Zb m0,s11,s34
Zb s37,s36,s35
Zh v4,s[4:7],s37 offen sc1 lds
Zb s35,s35,128
Zo s35,1280
s_cselect_b32 s35, 0, s35
Zq s34,s35,5
Zb m0,s11,s34
Zb s37,s36,s35
Zh v4,s[4:7],s37 offen sc1 lds
Zb s35,s35,128
Zo s35,1280
s_cselect_b32 s35, 0, s35
Zq s34,s35,5
Zb m0,s11,s34
Zb s37,s36,s35
Zh v4,s[4:7],s37 offen sc1 lds
Zb s35,s35,128
Zo s35,1280
s_cselect_b32 s35, 0, s35
Zp m0,s32
s_nop 0
Za v3,s[4:7],s21 offen sc1 lds
s_xor_b32 s11, s11, 0x10000
s_xor_b32 s32, s32, 256
Zf vmcnt(0)
AQ_H:
Zf vmcnt(2)
AQ_I:
s_barrier
ds_read_b32 v9, v11
Zb s28,s10,1
Zb s16,s28,1
Zf lgkmcnt(0)
v_cmp_gt_u32 vcc, s16, v9
s_cmp_eq_u64 vcc, 0
s_cselect_b32 s15, 1, 0
s_mul_i32 s36, s28, 40960
Zb s36,s36,100663296
Zb s36,s36,s14
Zb s16,s28,1
s_and_b32 s21, s16, 1
Zq s21,s21,7
Zb s21,s21,8192
Zq s18,s10,5
Zb s18,s18,s31
Zq s18,s18,11
Zb s18,s18,121634816
Zi v[32:35],v5 offset:0
Zi v[36:39],v5 offset:2048
Zi v[40:43],v6 offset:0
Zi v[44:47],v6 offset:2048
Zi v[48:51],v5 offset:4096
Zi v[52:55],v5 offset:6144
Zf lgkmcnt(5)
Ze v[16:19],a[0:3],v[32:35],0
Ze v[20:23],a[4:7],v[32:35],0
Zi v[32:35],v6 offset:4096
Zo s15,0
Zk ST_40
Zq s34,s35,5
Zb m0,s11,s34
Zb s37,s36,s35
Zh v4,s[4:7],s37 offen sc1 lds
Zb s35,s35,128
Zo s35,1280
s_cselect_b32 s35, 0, s35
ST_40:
Zf lgkmcnt(5)
Ze v[24:27],a[0:3],v[36:39],0
Ze v[28:31],a[4:7],v[36:39],0
Zi v[36:39],v6 offset:6144
Zf lgkmcnt(5)
Ze v[16:19],a[8:11],v[40:43],v[16:19]
Ze v[20:23],a[12:15],v[40:43],v[20:23]
Zi v[40:43],v5 offset:8192
Zo s15,0
Zk ST_41
Zq s34,s35,5
Zb m0,s11,s34
Zb s37,s36,s35
Zh v4,s[4:7],s37 offen sc1 lds
Zb s35,s35,128
Zo s35,1280
s_cselect_b32 s35, 0, s35
ST_41:
Zf lgkmcnt(5)
Ze v[24:27],a[8:11],v[44:47],v[24:27]
Ze v[28:31],a[12:15],v[44:47],v[28:31]
Zi v[44:47],v5 offset:10240
Zf lgkmcnt(5)
Ze v[16:19],a[16:19],v[48:51],v[16:19]
Ze v[20:23],a[20:23],v[48:51],v[20:23]
Zi v[48:51],v6 offset:8192
Zo s15,0
Zk ST_42
Zq s34,s35,5
Zb m0,s11,s34
Zb s37,s36,s35
Zh v4,s[4:7],s37 offen sc1 lds
Zb s35,s35,128
Zo s35,1280
s_cselect_b32 s35, 0, s35
ST_42:
Zf lgkmcnt(5)
Ze v[24:27],a[16:19],v[52:55],v[24:27]
Ze v[28:31],a[20:23],v[52:55],v[28:31]
Zi v[52:55],v6 offset:10240
Zf lgkmcnt(5)
Ze v[16:19],a[24:27],v[32:35],v[16:19]
Ze v[20:23],a[28:31],v[32:35],v[20:23]
Zi v[32:35],v5 offset:12288
Zo s15,0
Zk ST_43
Zq s34,s35,5
Zb m0,s11,s34
Zb s37,s36,s35
Zh v4,s[4:7],s37 offen sc1 lds
Zb s35,s35,128
Zo s35,1280
s_cselect_b32 s35, 0, s35
ST_43:
Zf lgkmcnt(5)
Ze v[24:27],a[24:27],v[36:39],v[24:27]
Ze v[28:31],a[28:31],v[36:39],v[28:31]
Zi v[36:39],v5 offset:14336
Zf lgkmcnt(5)
Ze v[16:19],a[32:35],v[40:43],v[16:19]
Ze v[20:23],a[36:39],v[40:43],v[20:23]
Zi v[40:43],v6 offset:12288
Zo s15,0
Zk ST_44
Zq s34,s35,5
Zb m0,s11,s34
Zb s37,s36,s35
Zh v4,s[4:7],s37 offen sc1 lds
Zb s35,s35,128
Zo s35,1280
s_cselect_b32 s35, 0, s35
ST_44:
Zf lgkmcnt(5)
Ze v[24:27],a[32:35],v[44:47],v[24:27]
Ze v[28:31],a[36:39],v[44:47],v[28:31]
Zi v[44:47],v6 offset:14336
Zf lgkmcnt(5)
Ze v[16:19],a[40:43],v[48:51],v[16:19]
Ze v[20:23],a[44:47],v[48:51],v[20:23]
Zi v[48:51],v5 offset:16384
Zo s15,0
Zk ST_45
Zq s34,s35,5
Zb m0,s11,s34
Zb s37,s36,s35
Zh v4,s[4:7],s37 offen sc1 lds
Zb s35,s35,128
Zo s35,1280
s_cselect_b32 s35, 0, s35
ST_45:
Zf lgkmcnt(5)
Ze v[24:27],a[40:43],v[52:55],v[24:27]
Ze v[28:31],a[44:47],v[52:55],v[28:31]
Zi v[52:55],v5 offset:18432
Zf lgkmcnt(5)
Ze v[16:19],a[48:51],v[32:35],v[16:19]
Ze v[20:23],a[52:55],v[32:35],v[20:23]
Zi v[32:35],v6 offset:16384
Zo s15,0
Zk ST_46
Zq s34,s35,5
Zb m0,s11,s34
Zb s37,s36,s35
Zh v4,s[4:7],s37 offen sc1 lds
Zb s35,s35,128
Zo s35,1280
s_cselect_b32 s35, 0, s35
ST_46:
Zf lgkmcnt(5)
Ze v[24:27],a[48:51],v[36:39],v[24:27]
Ze v[28:31],a[52:55],v[36:39],v[28:31]
Zi v[36:39],v6 offset:18432
Zf lgkmcnt(5)
Ze v[16:19],a[56:59],v[40:43],v[16:19]
Ze v[20:23],a[60:63],v[40:43],v[20:23]
Zi v[40:43],v5 offset:20480
Zo s15,0
Zk ST_47
Zq s34,s35,5
Zb m0,s11,s34
Zb s37,s36,s35
Zh v4,s[4:7],s37 offen sc1 lds
Zb s35,s35,128
Zo s35,1280
s_cselect_b32 s35, 0, s35
ST_47:
Zo s33,0
Zk MD_48
Zf vmcnt(8)
s_cmp_lg_u32 s15, 0
Zk ME_49
Zf vmcnt(0)
ME_49:
s_barrier
s_cmp_lg_u32 s9, 0
Zk SF_50
Zs v9,s33
Zu v9,off,s[4:7],s13 sc1
SF_50:
MD_48:
Zf lgkmcnt(5)
Ze v[24:27],a[56:59],v[44:47],v[24:27]
Ze v[28:31],a[60:63],v[44:47],v[28:31]
Zi v[44:47],v5 offset:22528
Zf lgkmcnt(5)
Ze v[16:19],a[64:67],v[48:51],v[16:19]
Ze v[20:23],a[68:71],v[48:51],v[20:23]
Zi v[48:51],v6 offset:20480
Zo s15,0
Zk ST_51
Zq s34,s35,5
Zb m0,s11,s34
Zb s37,s36,s35
Zh v4,s[4:7],s37 offen sc1 lds
Zb s35,s35,128
Zo s35,1280
s_cselect_b32 s35, 0, s35
ST_51:
Zf lgkmcnt(5)
Ze v[24:27],a[64:67],v[52:55],v[24:27]
Ze v[28:31],a[68:71],v[52:55],v[28:31]
Zi v[52:55],v6 offset:22528
Zf lgkmcnt(5)
Ze v[16:19],a[72:75],v[32:35],v[16:19]
Ze v[20:23],a[76:79],v[32:35],v[20:23]
Zi v[32:35],v5 offset:24576
Zo s15,0
Zk ST_52
Zq s34,s35,5
Zb m0,s11,s34
Zb s37,s36,s35
Zh v4,s[4:7],s37 offen sc1 lds
Zb s35,s35,128
Zo s35,1280
s_cselect_b32 s35, 0, s35
ST_52:
Zf lgkmcnt(5)
Ze v[24:27],a[72:75],v[36:39],v[24:27]
Ze v[28:31],a[76:79],v[36:39],v[28:31]
Zi v[36:39],v5 offset:26624
Zf lgkmcnt(5)
Ze v[16:19],a[80:83],v[40:43],v[16:19]
Ze v[20:23],a[84:87],v[40:43],v[20:23]
Zi v[40:43],v6 offset:24576
Zo s15,0
Zk ST_53
Zp m0,s32
s_nop 0
Za v3,s[4:7],s21 offen sc1 lds
s_xor_b32 s11, s11, 0x10000
s_xor_b32 s32, s32, 256
ST_53:
Zf lgkmcnt(5)
Ze v[24:27],a[80:83],v[44:47],v[24:27]
Ze v[28:31],a[84:87],v[44:47],v[28:31]
Zi v[44:47],v6 offset:26624
Zf lgkmcnt(5)
Ze v[16:19],a[88:91],v[48:51],v[16:19]
Ze v[20:23],a[92:95],v[48:51],v[20:23]
Zi v[48:51],v5 offset:28672
Zf lgkmcnt(5)
Ze v[24:27],a[88:91],v[52:55],v[24:27]
Ze v[28:31],a[92:95],v[52:55],v[28:31]
Zi v[52:55],v5 offset:30720
Zf lgkmcnt(5)
Ze v[16:19],a[96:99],v[32:35],v[16:19]
Ze v[20:23],a[100:103],v[32:35],v[20:23]
Zi v[32:35],v6 offset:28672
Zf lgkmcnt(5)
Ze v[24:27],a[96:99],v[36:39],v[24:27]
Ze v[28:31],a[100:103],v[36:39],v[28:31]
Zi v[36:39],v6 offset:30720
Zf lgkmcnt(5)
Ze v[16:19],a[104:107],v[40:43],v[16:19]
Ze v[20:23],a[108:111],v[40:43],v[20:23]
Zi v[40:43],v5 offset:32768
Zf lgkmcnt(5)
Ze v[24:27],a[104:107],v[44:47],v[24:27]
Ze v[28:31],a[108:111],v[44:47],v[28:31]
Zi v[44:47],v5 offset:34816
Zf lgkmcnt(5)
Ze v[16:19],a[112:115],v[48:51],v[16:19]
Ze v[20:23],a[116:119],v[48:51],v[20:23]
Zi v[48:51],v6 offset:32768
Zf lgkmcnt(5)
Ze v[24:27],a[112:115],v[52:55],v[24:27]
Ze v[28:31],a[116:119],v[52:55],v[28:31]
Zi v[52:55],v6 offset:34816
Zf lgkmcnt(5)
Ze v[16:19],a[120:123],v[32:35],v[16:19]
Ze v[20:23],a[124:127],v[32:35],v[20:23]
Zi v[32:35],v5 offset:36864
Zf lgkmcnt(5)
Ze v[24:27],a[120:123],v[36:39],v[24:27]
Ze v[28:31],a[124:127],v[36:39],v[28:31]
Zi v[36:39],v5 offset:38912
Zf lgkmcnt(5)
Ze v[16:19],a[128:131],v[40:43],v[16:19]
Ze v[20:23],a[132:135],v[40:43],v[20:23]
Zi v[40:43],v6 offset:36864
Zf lgkmcnt(5)
Ze v[24:27],a[128:131],v[44:47],v[24:27]
Ze v[28:31],a[132:135],v[44:47],v[28:31]
Zi v[44:47],v6 offset:38912
Zf lgkmcnt(5)
Ze v[16:19],a[136:139],v[48:51],v[16:19]
Ze v[20:23],a[140:143],v[48:51],v[20:23]
Zf lgkmcnt(4)
Ze v[24:27],a[136:139],v[52:55],v[24:27]
Ze v[28:31],a[140:143],v[52:55],v[28:31]
Zf lgkmcnt(3)
Ze v[16:19],a[144:147],v[32:35],v[16:19]
Ze v[20:23],a[148:151],v[32:35],v[20:23]
Zf lgkmcnt(2)
Ze v[24:27],a[144:147],v[36:39],v[24:27]
Ze v[28:31],a[148:151],v[36:39],v[28:31]
Zf lgkmcnt(1)
Ze v[16:19],a[152:155],v[40:43],v[16:19]
Ze v[20:23],a[156:159],v[40:43],v[20:23]
Zf lgkmcnt(0)
Ze v[24:27],a[152:155],v[44:47],v[24:27]
Ze v[28:31],a[156:159],v[44:47],v[28:31]
Zw v16,s29,v16
Zw v17,s29,v17
Zw v18,s29,v18
Zw v19,s29,v19
Zw v20,s29,v20
Zw v21,s29,v21
Zw v22,s29,v22
Zw v23,s29,v23
Zj v32,v16,v20
Zj v33,v17,v21
Zj v34,v18,v22
Zj v35,v19,v23
Zw v24,s29,v24
Zw v25,s29,v25
Zw v26,s29,v26
Zw v27,s29,v27
Zw v28,s29,v28
Zw v29,s29,v29
Zw v30,s29,v30
Zw v31,s29,v31
Zj v36,v24,v28
Zj v37,v25,v29
Zj v38,v26,v30
Zj v39,v27,v31
Zr v[32:35],v0,s[4:7],s18 offen sc1
Zr v[36:39],v0,s[4:7],s18 offen offset:1024 sc1
Zb s33,s10,1
s_and_b32 s16, s10, 63
s_cselect_b32 s16, s15, 0
s_cmp_lg_u32 s16, 0
Zk AQ_N
Zf vmcnt(0)
s_barrier
s_cmp_lg_u32 s9, 0
Zk SF_54
Zs v9,s33
Zu v9,off,s[4:7],s13 sc1
SF_54:
Zp s33,0
AQ_N:
v_xor_b32 v5, 0x10000, v5
v_xor_b32 v11, 256, v11
v_xor_b32 v6, 0x10000, v6
Zp s10,s28
s_cmp_lt_u32 s10, 128
Zk AQ_L
Zf vmcnt(0)
s_endpgm
R_KV:
Zy v0,63,v0
Zy v1,15,v0
v_lshrrev_b32 v2, 4, v0
Zz v0,4,v0
Zp s22,0x05040100
Zp s23,0x07060302
Zp s20,300000
s_and_b32 s30, s8, 1
s_lshr_b32 s31, s8, 1
Zq s19,s30,3
Zb s34,s0,s19
s_addc_u32 s35, s1, 0
s_load_dwordx2 s[24:25], s[34:35], 64
Zp s26,5242880
Zp s27,0x20000
Zz v4,16,v2
v_lshl_add_u32 v4, v1, 2, v4
Zq s17,s31,8
Zq s19,s9,6
Zb s17,s17,s19
Zb s19,s17,0
Zf lgkmcnt(0)
Za v64,v4,s[24:27],s19 offen
Zb s19,s17,8192
Za v65,v4,s[24:27],s19 offen
Zb s19,s17,16384
Za v66,v4,s[24:27],s19 offen
Zb s19,s17,24576
Za v67,v4,s[24:27],s19 offen
Zb s19,s17,32768
Za v68,v4,s[24:27],s19 offen
Zb s19,s17,40960
Za v69,v4,s[24:27],s19 offen
Zb s19,s17,49152
Za v70,v4,s[24:27],s19 offen
Zb s19,s17,57344
Za v71,v4,s[24:27],s19 offen
Zb s19,s17,262144
Za v72,v4,s[24:27],s19 offen
Zb s19,s17,270336
Za v73,v4,s[24:27],s19 offen
Zb s19,s17,278528
Za v74,v4,s[24:27],s19 offen
Zb s19,s17,286720
Za v75,v4,s[24:27],s19 offen
Zb s19,s17,294912
Za v76,v4,s[24:27],s19 offen
Zb s19,s17,303104
Za v77,v4,s[24:27],s19 offen
Zb s19,s17,311296
Za v78,v4,s[24:27],s19 offen
Zb s19,s17,319488
Za v79,v4,s[24:27],s19 offen
Zb s19,s17,524288
Za v80,v4,s[24:27],s19 offen
Zb s19,s17,532480
Za v81,v4,s[24:27],s19 offen
Zb s19,s17,540672
Za v82,v4,s[24:27],s19 offen
Zb s19,s17,548864
Za v83,v4,s[24:27],s19 offen
Zb s19,s17,557056
Za v84,v4,s[24:27],s19 offen
Zb s19,s17,565248
Za v85,v4,s[24:27],s19 offen
Zb s19,s17,573440
Za v86,v4,s[24:27],s19 offen
Zb s19,s17,581632
Za v87,v4,s[24:27],s19 offen
Zb s19,s17,786432
Za v88,v4,s[24:27],s19 offen
Zb s19,s17,794624
Za v89,v4,s[24:27],s19 offen
Zb s19,s17,802816
Za v90,v4,s[24:27],s19 offen
Zb s19,s17,811008
Za v91,v4,s[24:27],s19 offen
Zb s19,s17,819200
Za v92,v4,s[24:27],s19 offen
Zb s19,s17,827392
Za v93,v4,s[24:27],s19 offen
Zb s19,s17,835584
Za v94,v4,s[24:27],s19 offen
Zb s19,s17,843776
Za v95,v4,s[24:27],s19 offen
Zb s19,s17,1048576
Za v96,v4,s[24:27],s19 offen
Zb s19,s17,1056768
Za v97,v4,s[24:27],s19 offen
Zb s19,s17,1064960
Za v98,v4,s[24:27],s19 offen
Zb s19,s17,1073152
Za v99,v4,s[24:27],s19 offen
Zb s19,s17,1081344
Za v100,v4,s[24:27],s19 offen
Zb s19,s17,1089536
Za v101,v4,s[24:27],s19 offen
Zb s19,s17,1097728
Za v102,v4,s[24:27],s19 offen
Zb s19,s17,1105920
Za v103,v4,s[24:27],s19 offen
Zb s19,s17,1310720
Za v104,v4,s[24:27],s19 offen
Zb s19,s17,1318912
Za v105,v4,s[24:27],s19 offen
Zb s19,s17,1327104
Za v106,v4,s[24:27],s19 offen
Zb s19,s17,1335296
Za v107,v4,s[24:27],s19 offen
Zb s19,s17,1343488
Za v108,v4,s[24:27],s19 offen
Zb s19,s17,1351680
Za v109,v4,s[24:27],s19 offen
Zb s19,s17,1359872
Za v110,v4,s[24:27],s19 offen
Zb s19,s17,1368064
Za v111,v4,s[24:27],s19 offen
Zf vmcnt(46)
Zc v56,v65,v64,s22
Zf vmcnt(44)
Zc v57,v67,v66,s22
Zf vmcnt(42)
Zc v58,v69,v68,s22
Zf vmcnt(40)
Zc v59,v71,v70,s22
Zc v60,v65,v64,s23
Zc v61,v67,v66,s23
Zc v62,v69,v68,s23
Zc v63,v71,v70,s23
Zd a0,v56
Zd a1,v57
Zd a2,v58
Zd a3,v59
Zd a4,v60
Zd a5,v61
Zd a6,v62
Zd a7,v63
Zb s19,s17,1572864
Za v64,v4,s[24:27],s19 offen
Zb s19,s17,1581056
Za v65,v4,s[24:27],s19 offen
Zb s19,s17,1589248
Za v66,v4,s[24:27],s19 offen
Zb s19,s17,1597440
Za v67,v4,s[24:27],s19 offen
Zb s19,s17,1605632
Za v68,v4,s[24:27],s19 offen
Zb s19,s17,1613824
Za v69,v4,s[24:27],s19 offen
Zb s19,s17,1622016
Za v70,v4,s[24:27],s19 offen
Zb s19,s17,1630208
Za v71,v4,s[24:27],s19 offen
Zf vmcnt(46)
Zc v56,v73,v72,s22
Zf vmcnt(44)
Zc v57,v75,v74,s22
Zf vmcnt(42)
Zc v58,v77,v76,s22
Zf vmcnt(40)
Zc v59,v79,v78,s22
Zc v60,v73,v72,s23
Zc v61,v75,v74,s23
Zc v62,v77,v76,s23
Zc v63,v79,v78,s23
Zd a8,v56
Zd a9,v57
Zd a10,v58
Zd a11,v59
Zd a12,v60
Zd a13,v61
Zd a14,v62
Zd a15,v63
Zb s19,s17,1835008
Za v72,v4,s[24:27],s19 offen
Zb s19,s17,1843200
Za v73,v4,s[24:27],s19 offen
Zb s19,s17,1851392
Za v74,v4,s[24:27],s19 offen
Zb s19,s17,1859584
Za v75,v4,s[24:27],s19 offen
Zb s19,s17,1867776
Za v76,v4,s[24:27],s19 offen
Zb s19,s17,1875968
Za v77,v4,s[24:27],s19 offen
Zb s19,s17,1884160
Za v78,v4,s[24:27],s19 offen
Zb s19,s17,1892352
Za v79,v4,s[24:27],s19 offen
Zf vmcnt(46)
Zc v56,v81,v80,s22
Zf vmcnt(44)
Zc v57,v83,v82,s22
Zf vmcnt(42)
Zc v58,v85,v84,s22
Zf vmcnt(40)
Zc v59,v87,v86,s22
Zc v60,v81,v80,s23
Zc v61,v83,v82,s23
Zc v62,v85,v84,s23
Zc v63,v87,v86,s23
Zd a16,v56
Zd a17,v57
Zd a18,v58
Zd a19,v59
Zd a20,v60
Zd a21,v61
Zd a22,v62
Zd a23,v63
Zb s19,s17,2097152
Za v80,v4,s[24:27],s19 offen
Zb s19,s17,2105344
Za v81,v4,s[24:27],s19 offen
Zb s19,s17,2113536
Za v82,v4,s[24:27],s19 offen
Zb s19,s17,2121728
Za v83,v4,s[24:27],s19 offen
Zb s19,s17,2129920
Za v84,v4,s[24:27],s19 offen
Zb s19,s17,2138112
Za v85,v4,s[24:27],s19 offen
Zb s19,s17,2146304
Za v86,v4,s[24:27],s19 offen
Zb s19,s17,2154496
Za v87,v4,s[24:27],s19 offen
Zf vmcnt(46)
Zc v56,v89,v88,s22
Zf vmcnt(44)
Zc v57,v91,v90,s22
Zf vmcnt(42)
Zc v58,v93,v92,s22
Zf vmcnt(40)
Zc v59,v95,v94,s22
Zc v60,v89,v88,s23
Zc v61,v91,v90,s23
Zc v62,v93,v92,s23
Zc v63,v95,v94,s23
Zd a24,v56
Zd a25,v57
Zd a26,v58
Zd a27,v59
Zd a28,v60
Zd a29,v61
Zd a30,v62
Zd a31,v63
Zb s19,s17,2359296
Za v88,v4,s[24:27],s19 offen
Zb s19,s17,2367488
Za v89,v4,s[24:27],s19 offen
Zb s19,s17,2375680
Za v90,v4,s[24:27],s19 offen
Zb s19,s17,2383872
Za v91,v4,s[24:27],s19 offen
Zb s19,s17,2392064
Za v92,v4,s[24:27],s19 offen
Zb s19,s17,2400256
Za v93,v4,s[24:27],s19 offen
Zb s19,s17,2408448
Za v94,v4,s[24:27],s19 offen
Zb s19,s17,2416640
Za v95,v4,s[24:27],s19 offen
Zf vmcnt(46)
Zc v56,v97,v96,s22
Zf vmcnt(44)
Zc v57,v99,v98,s22
Zf vmcnt(42)
Zc v58,v101,v100,s22
Zf vmcnt(40)
Zc v59,v103,v102,s22
Zc v60,v97,v96,s23
Zc v61,v99,v98,s23
Zc v62,v101,v100,s23
Zc v63,v103,v102,s23
Zd a32,v56
Zd a33,v57
Zd a34,v58
Zd a35,v59
Zd a36,v60
Zd a37,v61
Zd a38,v62
Zd a39,v63
Zb s19,s17,2621440
Za v96,v4,s[24:27],s19 offen
Zb s19,s17,2629632
Za v97,v4,s[24:27],s19 offen
Zb s19,s17,2637824
Za v98,v4,s[24:27],s19 offen
Zb s19,s17,2646016
Za v99,v4,s[24:27],s19 offen
Zb s19,s17,2654208
Za v100,v4,s[24:27],s19 offen
Zb s19,s17,2662400
Za v101,v4,s[24:27],s19 offen
Zb s19,s17,2670592
Za v102,v4,s[24:27],s19 offen
Zb s19,s17,2678784
Za v103,v4,s[24:27],s19 offen
Zf vmcnt(46)
Zc v56,v105,v104,s22
Zf vmcnt(44)
Zc v57,v107,v106,s22
Zf vmcnt(42)
Zc v58,v109,v108,s22
Zf vmcnt(40)
Zc v59,v111,v110,s22
Zc v60,v105,v104,s23
Zc v61,v107,v106,s23
Zc v62,v109,v108,s23
Zc v63,v111,v110,s23
Zd a40,v56
Zd a41,v57
Zd a42,v58
Zd a43,v59
Zd a44,v60
Zd a45,v61
Zd a46,v62
Zd a47,v63
Zb s19,s17,2883584
Za v104,v4,s[24:27],s19 offen
Zb s19,s17,2891776
Za v105,v4,s[24:27],s19 offen
Zb s19,s17,2899968
Za v106,v4,s[24:27],s19 offen
Zb s19,s17,2908160
Za v107,v4,s[24:27],s19 offen
Zb s19,s17,2916352
Za v108,v4,s[24:27],s19 offen
Zb s19,s17,2924544
Za v109,v4,s[24:27],s19 offen
Zb s19,s17,2932736
Za v110,v4,s[24:27],s19 offen
Zb s19,s17,2940928
Za v111,v4,s[24:27],s19 offen
Zf vmcnt(46)
Zc v56,v65,v64,s22
Zf vmcnt(44)
Zc v57,v67,v66,s22
Zf vmcnt(42)
Zc v58,v69,v68,s22
Zf vmcnt(40)
Zc v59,v71,v70,s22
Zc v60,v65,v64,s23
Zc v61,v67,v66,s23
Zc v62,v69,v68,s23
Zc v63,v71,v70,s23
Zd a48,v56
Zd a49,v57
Zd a50,v58
Zd a51,v59
Zd a52,v60
Zd a53,v61
Zd a54,v62
Zd a55,v63
Zb s19,s17,3145728
Za v64,v4,s[24:27],s19 offen
Zb s19,s17,3153920
Za v65,v4,s[24:27],s19 offen
Zb s19,s17,3162112
Za v66,v4,s[24:27],s19 offen
Zb s19,s17,3170304
Za v67,v4,s[24:27],s19 offen
Zb s19,s17,3178496
Za v68,v4,s[24:27],s19 offen
Zb s19,s17,3186688
Za v69,v4,s[24:27],s19 offen
Zb s19,s17,3194880
Za v70,v4,s[24:27],s19 offen
Zb s19,s17,3203072
Za v71,v4,s[24:27],s19 offen
Zf vmcnt(46)
Zc v56,v73,v72,s22
Zf vmcnt(44)
Zc v57,v75,v74,s22
Zf vmcnt(42)
Zc v58,v77,v76,s22
Zf vmcnt(40)
Zc v59,v79,v78,s22
Zc v60,v73,v72,s23
Zc v61,v75,v74,s23
Zc v62,v77,v76,s23
Zc v63,v79,v78,s23
Zd a56,v56
Zd a57,v57
Zd a58,v58
Zd a59,v59
Zd a60,v60
Zd a61,v61
Zd a62,v62
Zd a63,v63
Zb s19,s17,3407872
Za v72,v4,s[24:27],s19 offen
Zb s19,s17,3416064
Za v73,v4,s[24:27],s19 offen
Zb s19,s17,3424256
Za v74,v4,s[24:27],s19 offen
Zb s19,s17,3432448
Za v75,v4,s[24:27],s19 offen
Zb s19,s17,3440640
Za v76,v4,s[24:27],s19 offen
Zb s19,s17,3448832
Za v77,v4,s[24:27],s19 offen
Zb s19,s17,3457024
Za v78,v4,s[24:27],s19 offen
Zb s19,s17,3465216
Za v79,v4,s[24:27],s19 offen
Zf vmcnt(46)
Zc v56,v81,v80,s22
Zf vmcnt(44)
Zc v57,v83,v82,s22
Zf vmcnt(42)
Zc v58,v85,v84,s22
Zf vmcnt(40)
Zc v59,v87,v86,s22
Zc v60,v81,v80,s23
Zc v61,v83,v82,s23
Zc v62,v85,v84,s23
Zc v63,v87,v86,s23
Zd a64,v56
Zd a65,v57
Zd a66,v58
Zd a67,v59
Zd a68,v60
Zd a69,v61
Zd a70,v62
Zd a71,v63
Zb s19,s17,3670016
Za v80,v4,s[24:27],s19 offen
Zb s19,s17,3678208
Za v81,v4,s[24:27],s19 offen
Zb s19,s17,3686400
Za v82,v4,s[24:27],s19 offen
Zb s19,s17,3694592
Za v83,v4,s[24:27],s19 offen
Zb s19,s17,3702784
Za v84,v4,s[24:27],s19 offen
Zb s19,s17,3710976
Za v85,v4,s[24:27],s19 offen
Zb s19,s17,3719168
Za v86,v4,s[24:27],s19 offen
Zb s19,s17,3727360
Za v87,v4,s[24:27],s19 offen
Zf vmcnt(46)
Zc v56,v89,v88,s22
Zf vmcnt(44)
Zc v57,v91,v90,s22
Zf vmcnt(42)
Zc v58,v93,v92,s22
Zf vmcnt(40)
Zc v59,v95,v94,s22
Zc v60,v89,v88,s23
Zc v61,v91,v90,s23
Zc v62,v93,v92,s23
Zc v63,v95,v94,s23
Zd a72,v56
Zd a73,v57
Zd a74,v58
Zd a75,v59
Zd a76,v60
Zd a77,v61
Zd a78,v62
Zd a79,v63
Zb s19,s17,3932160
Za v88,v4,s[24:27],s19 offen
Zb s19,s17,3940352
Za v89,v4,s[24:27],s19 offen
Zb s19,s17,3948544
Za v90,v4,s[24:27],s19 offen
Zb s19,s17,3956736
Za v91,v4,s[24:27],s19 offen
Zb s19,s17,3964928
Za v92,v4,s[24:27],s19 offen
Zb s19,s17,3973120
Za v93,v4,s[24:27],s19 offen
Zb s19,s17,3981312
Za v94,v4,s[24:27],s19 offen
Zb s19,s17,3989504
Za v95,v4,s[24:27],s19 offen
Zf vmcnt(46)
Zc v56,v97,v96,s22
Zf vmcnt(44)
Zc v57,v99,v98,s22
Zf vmcnt(42)
Zc v58,v101,v100,s22
Zf vmcnt(40)
Zc v59,v103,v102,s22
Zc v60,v97,v96,s23
Zc v61,v99,v98,s23
Zc v62,v101,v100,s23
Zc v63,v103,v102,s23
Zd a80,v56
Zd a81,v57
Zd a82,v58
Zd a83,v59
Zd a84,v60
Zd a85,v61
Zd a86,v62
Zd a87,v63
Zb s19,s17,4194304
Za v96,v4,s[24:27],s19 offen
Zb s19,s17,4202496
Za v97,v4,s[24:27],s19 offen
Zb s19,s17,4210688
Za v98,v4,s[24:27],s19 offen
Zb s19,s17,4218880
Za v99,v4,s[24:27],s19 offen
Zb s19,s17,4227072
Za v100,v4,s[24:27],s19 offen
Zb s19,s17,4235264
Za v101,v4,s[24:27],s19 offen
Zb s19,s17,4243456
Za v102,v4,s[24:27],s19 offen
Zb s19,s17,4251648
Za v103,v4,s[24:27],s19 offen
Zf vmcnt(46)
Zc v56,v105,v104,s22
Zf vmcnt(44)
Zc v57,v107,v106,s22
Zf vmcnt(42)
Zc v58,v109,v108,s22
Zf vmcnt(40)
Zc v59,v111,v110,s22
Zc v60,v105,v104,s23
Zc v61,v107,v106,s23
Zc v62,v109,v108,s23
Zc v63,v111,v110,s23
Zd a88,v56
Zd a89,v57
Zd a90,v58
Zd a91,v59
Zd a92,v60
Zd a93,v61
Zd a94,v62
Zd a95,v63
Zb s19,s17,4456448
Za v104,v4,s[24:27],s19 offen
Zb s19,s17,4464640
Za v105,v4,s[24:27],s19 offen
Zb s19,s17,4472832
Za v106,v4,s[24:27],s19 offen
Zb s19,s17,4481024
Za v107,v4,s[24:27],s19 offen
Zb s19,s17,4489216
Za v108,v4,s[24:27],s19 offen
Zb s19,s17,4497408
Za v109,v4,s[24:27],s19 offen
Zb s19,s17,4505600
Za v110,v4,s[24:27],s19 offen
Zb s19,s17,4513792
Za v111,v4,s[24:27],s19 offen
Zf vmcnt(46)
Zc v56,v65,v64,s22
Zf vmcnt(44)
Zc v57,v67,v66,s22
Zf vmcnt(42)
Zc v58,v69,v68,s22
Zf vmcnt(40)
Zc v59,v71,v70,s22
Zc v60,v65,v64,s23
Zc v61,v67,v66,s23
Zc v62,v69,v68,s23
Zc v63,v71,v70,s23
Zd a96,v56
Zd a97,v57
Zd a98,v58
Zd a99,v59
Zd a100,v60
Zd a101,v61
Zd a102,v62
Zd a103,v63
Zb s19,s17,4718592
Za v64,v4,s[24:27],s19 offen
Zb s19,s17,4726784
Za v65,v4,s[24:27],s19 offen
Zb s19,s17,4734976
Za v66,v4,s[24:27],s19 offen
Zb s19,s17,4743168
Za v67,v4,s[24:27],s19 offen
Zb s19,s17,4751360
Za v68,v4,s[24:27],s19 offen
Zb s19,s17,4759552
Za v69,v4,s[24:27],s19 offen
Zb s19,s17,4767744
Za v70,v4,s[24:27],s19 offen
Zb s19,s17,4775936
Za v71,v4,s[24:27],s19 offen
Zf vmcnt(46)
Zc v56,v73,v72,s22
Zf vmcnt(44)
Zc v57,v75,v74,s22
Zf vmcnt(42)
Zc v58,v77,v76,s22
Zf vmcnt(40)
Zc v59,v79,v78,s22
Zc v60,v73,v72,s23
Zc v61,v75,v74,s23
Zc v62,v77,v76,s23
Zc v63,v79,v78,s23
Zd a104,v56
Zd a105,v57
Zd a106,v58
Zd a107,v59
Zd a108,v60
Zd a109,v61
Zd a110,v62
Zd a111,v63
Zb s19,s17,4980736
Za v72,v4,s[24:27],s19 offen
Zb s19,s17,4988928
Za v73,v4,s[24:27],s19 offen
Zb s19,s17,4997120
Za v74,v4,s[24:27],s19 offen
Zb s19,s17,5005312
Za v75,v4,s[24:27],s19 offen
Zb s19,s17,5013504
Za v76,v4,s[24:27],s19 offen
Zb s19,s17,5021696
Za v77,v4,s[24:27],s19 offen
Zb s19,s17,5029888
Za v78,v4,s[24:27],s19 offen
Zb s19,s17,5038080
Za v79,v4,s[24:27],s19 offen
Zf vmcnt(46)
Zc v56,v81,v80,s22
Zf vmcnt(44)
Zc v57,v83,v82,s22
Zf vmcnt(42)
Zc v58,v85,v84,s22
Zf vmcnt(40)
Zc v59,v87,v86,s22
Zc v60,v81,v80,s23
Zc v61,v83,v82,s23
Zc v62,v85,v84,s23
Zc v63,v87,v86,s23
Zd a112,v56
Zd a113,v57
Zd a114,v58
Zd a115,v59
Zd a116,v60
Zd a117,v61
Zd a118,v62
Zd a119,v63
Zf vmcnt(38)
Zc v56,v89,v88,s22
Zf vmcnt(36)
Zc v57,v91,v90,s22
Zf vmcnt(34)
Zc v58,v93,v92,s22
Zf vmcnt(32)
Zc v59,v95,v94,s22
Zc v60,v89,v88,s23
Zc v61,v91,v90,s23
Zc v62,v93,v92,s23
Zc v63,v95,v94,s23
Zd a120,v56
Zd a121,v57
Zd a122,v58
Zd a123,v59
Zd a124,v60
Zd a125,v61
Zd a126,v62
Zd a127,v63
Zf vmcnt(30)
Zc v56,v97,v96,s22
Zf vmcnt(28)
Zc v57,v99,v98,s22
Zf vmcnt(26)
Zc v58,v101,v100,s22
Zf vmcnt(24)
Zc v59,v103,v102,s22
Zc v60,v97,v96,s23
Zc v61,v99,v98,s23
Zc v62,v101,v100,s23
Zc v63,v103,v102,s23
Zd a128,v56
Zd a129,v57
Zd a130,v58
Zd a131,v59
Zd a132,v60
Zd a133,v61
Zd a134,v62
Zd a135,v63
Zf vmcnt(22)
Zc v56,v105,v104,s22
Zf vmcnt(20)
Zc v57,v107,v106,s22
Zf vmcnt(18)
Zc v58,v109,v108,s22
Zf vmcnt(16)
Zc v59,v111,v110,s22
Zc v60,v105,v104,s23
Zc v61,v107,v106,s23
Zc v62,v109,v108,s23
Zc v63,v111,v110,s23
Zd a136,v56
Zd a137,v57
Zd a138,v58
Zd a139,v59
Zd a140,v60
Zd a141,v61
Zd a142,v62
Zd a143,v63
Zf vmcnt(14)
Zc v56,v65,v64,s22
Zf vmcnt(12)
Zc v57,v67,v66,s22
Zf vmcnt(10)
Zc v58,v69,v68,s22
Zf vmcnt(8)
Zc v59,v71,v70,s22
Zc v60,v65,v64,s23
Zc v61,v67,v66,s23
Zc v62,v69,v68,s23
Zc v63,v71,v70,s23
Zd a144,v56
Zd a145,v57
Zd a146,v58
Zd a147,v59
Zd a148,v60
Zd a149,v61
Zd a150,v62
Zd a151,v63
Zf vmcnt(6)
Zc v56,v73,v72,s22
Zf vmcnt(4)
Zc v57,v75,v74,s22
Zf vmcnt(2)
Zc v58,v77,v76,s22
Zf vmcnt(0)
Zc v59,v79,v78,s22
Zc v60,v73,v72,s23
Zc v61,v75,v74,s23
Zc v62,v77,v76,s23
Zc v63,v79,v78,s23
Zd a152,v56
Zd a153,v57
Zd a154,v58
Zd a155,v59
Zd a156,v60
Zd a157,v61
Zd a158,v62
Zd a159,v63
s_load_dwordx2 s[24:25], s[0:1], 56
Zp s26,5242880
Zp s27,0x20000
Zq s29,s30,1
s_lshr_b32 s19, s9, 1
Zb s29,s29,s19
Zq s17,s31,8
Zq s19,s29,6
Zb s17,s17,s19
Zb s19,s17,0
Zf lgkmcnt(0)
Za v16,v4,s[24:27],s19 offen
Zb s19,s17,8192
Za v17,v4,s[24:27],s19 offen
Zb s19,s17,16384
Za v18,v4,s[24:27],s19 offen
Zb s19,s17,24576
Za v19,v4,s[24:27],s19 offen
Zb s19,s17,32768
Za v20,v4,s[24:27],s19 offen
Zb s19,s17,40960
Za v21,v4,s[24:27],s19 offen
Zb s19,s17,49152
Za v22,v4,s[24:27],s19 offen
Zb s19,s17,57344
Za v23,v4,s[24:27],s19 offen
Zb s19,s17,262144
Za v24,v4,s[24:27],s19 offen
Zb s19,s17,270336
Za v25,v4,s[24:27],s19 offen
Zb s19,s17,278528
Za v26,v4,s[24:27],s19 offen
Zb s19,s17,286720
Za v27,v4,s[24:27],s19 offen
Zb s19,s17,294912
Za v28,v4,s[24:27],s19 offen
Zb s19,s17,303104
Za v29,v4,s[24:27],s19 offen
Zb s19,s17,311296
Za v30,v4,s[24:27],s19 offen
Zb s19,s17,319488
Za v31,v4,s[24:27],s19 offen
Zb s19,s17,524288
Za v32,v4,s[24:27],s19 offen
Zb s19,s17,532480
Za v33,v4,s[24:27],s19 offen
Zb s19,s17,540672
Za v34,v4,s[24:27],s19 offen
Zb s19,s17,548864
Za v35,v4,s[24:27],s19 offen
Zb s19,s17,557056
Za v36,v4,s[24:27],s19 offen
Zb s19,s17,565248
Za v37,v4,s[24:27],s19 offen
Zb s19,s17,573440
Za v38,v4,s[24:27],s19 offen
Zb s19,s17,581632
Za v39,v4,s[24:27],s19 offen
Zb s19,s17,786432
Za v40,v4,s[24:27],s19 offen
Zb s19,s17,794624
Za v41,v4,s[24:27],s19 offen
Zb s19,s17,802816
Za v42,v4,s[24:27],s19 offen
Zb s19,s17,811008
Za v43,v4,s[24:27],s19 offen
Zb s19,s17,819200
Za v44,v4,s[24:27],s19 offen
Zb s19,s17,827392
Za v45,v4,s[24:27],s19 offen
Zb s19,s17,835584
Za v46,v4,s[24:27],s19 offen
Zb s19,s17,843776
Za v47,v4,s[24:27],s19 offen
Zb s19,s17,1048576
Za v48,v4,s[24:27],s19 offen
Zb s19,s17,1056768
Za v49,v4,s[24:27],s19 offen
Zb s19,s17,1064960
Za v50,v4,s[24:27],s19 offen
Zb s19,s17,1073152
Za v51,v4,s[24:27],s19 offen
Zb s19,s17,1081344
Za v52,v4,s[24:27],s19 offen
Zb s19,s17,1089536
Za v53,v4,s[24:27],s19 offen
Zb s19,s17,1097728
Za v54,v4,s[24:27],s19 offen
Zb s19,s17,1105920
Za v55,v4,s[24:27],s19 offen
Zb s19,s17,1310720
Za v56,v4,s[24:27],s19 offen
Zb s19,s17,1318912
Za v57,v4,s[24:27],s19 offen
Zb s19,s17,1327104
Za v58,v4,s[24:27],s19 offen
Zb s19,s17,1335296
Za v59,v4,s[24:27],s19 offen
Zb s19,s17,1343488
Za v60,v4,s[24:27],s19 offen
Zb s19,s17,1351680
Za v61,v4,s[24:27],s19 offen
Zb s19,s17,1359872
Za v62,v4,s[24:27],s19 offen
Zb s19,s17,1368064
Za v63,v4,s[24:27],s19 offen
Zf vmcnt(46)
Zc v96,v17,v16,s22
Zf vmcnt(44)
Zc v97,v19,v18,s22
Zf vmcnt(42)
Zc v98,v21,v20,s22
Zf vmcnt(40)
Zc v99,v23,v22,s22
Zc v100,v17,v16,s23
Zc v101,v19,v18,s23
Zc v102,v21,v20,s23
Zc v103,v23,v22,s23
Zb s19,s17,1572864
Za v16,v4,s[24:27],s19 offen
Zb s19,s17,1581056
Za v17,v4,s[24:27],s19 offen
Zb s19,s17,1589248
Za v18,v4,s[24:27],s19 offen
Zb s19,s17,1597440
Za v19,v4,s[24:27],s19 offen
Zb s19,s17,1605632
Za v20,v4,s[24:27],s19 offen
Zb s19,s17,1613824
Za v21,v4,s[24:27],s19 offen
Zb s19,s17,1622016
Za v22,v4,s[24:27],s19 offen
Zb s19,s17,1630208
Za v23,v4,s[24:27],s19 offen
Zf vmcnt(46)
Zc v104,v25,v24,s22
Zf vmcnt(44)
Zc v105,v27,v26,s22
Zf vmcnt(42)
Zc v106,v29,v28,s22
Zf vmcnt(40)
Zc v107,v31,v30,s22
Zc v108,v25,v24,s23
Zc v109,v27,v26,s23
Zc v110,v29,v28,s23
Zc v111,v31,v30,s23
Zb s19,s17,1835008
Za v24,v4,s[24:27],s19 offen
Zb s19,s17,1843200
Za v25,v4,s[24:27],s19 offen
Zb s19,s17,1851392
Za v26,v4,s[24:27],s19 offen
Zb s19,s17,1859584
Za v27,v4,s[24:27],s19 offen
Zb s19,s17,1867776
Za v28,v4,s[24:27],s19 offen
Zb s19,s17,1875968
Za v29,v4,s[24:27],s19 offen
Zb s19,s17,1884160
Za v30,v4,s[24:27],s19 offen
Zb s19,s17,1892352
Za v31,v4,s[24:27],s19 offen
Zf vmcnt(46)
Zc v112,v33,v32,s22
Zf vmcnt(44)
Zc v113,v35,v34,s22
Zf vmcnt(42)
Zc v114,v37,v36,s22
Zf vmcnt(40)
Zc v115,v39,v38,s22
Zc v116,v33,v32,s23
Zc v117,v35,v34,s23
Zc v118,v37,v36,s23
Zc v119,v39,v38,s23
Zb s19,s17,2097152
Za v32,v4,s[24:27],s19 offen
Zb s19,s17,2105344
Za v33,v4,s[24:27],s19 offen
Zb s19,s17,2113536
Za v34,v4,s[24:27],s19 offen
Zb s19,s17,2121728
Za v35,v4,s[24:27],s19 offen
Zb s19,s17,2129920
Za v36,v4,s[24:27],s19 offen
Zb s19,s17,2138112
Za v37,v4,s[24:27],s19 offen
Zb s19,s17,2146304
Za v38,v4,s[24:27],s19 offen
Zb s19,s17,2154496
Za v39,v4,s[24:27],s19 offen
Zf vmcnt(46)
Zc v120,v41,v40,s22
Zf vmcnt(44)
Zc v121,v43,v42,s22
Zf vmcnt(42)
Zc v122,v45,v44,s22
Zf vmcnt(40)
Zc v123,v47,v46,s22
Zc v124,v41,v40,s23
Zc v125,v43,v42,s23
Zc v126,v45,v44,s23
Zc v127,v47,v46,s23
Zb s19,s17,2359296
Za v40,v4,s[24:27],s19 offen
Zb s19,s17,2367488
Za v41,v4,s[24:27],s19 offen
Zb s19,s17,2375680
Za v42,v4,s[24:27],s19 offen
Zb s19,s17,2383872
Za v43,v4,s[24:27],s19 offen
Zb s19,s17,2392064
Za v44,v4,s[24:27],s19 offen
Zb s19,s17,2400256
Za v45,v4,s[24:27],s19 offen
Zb s19,s17,2408448
Za v46,v4,s[24:27],s19 offen
Zb s19,s17,2416640
Za v47,v4,s[24:27],s19 offen
Zf vmcnt(46)
Zc v128,v49,v48,s22
Zf vmcnt(44)
Zc v129,v51,v50,s22
Zf vmcnt(42)
Zc v130,v53,v52,s22
Zf vmcnt(40)
Zc v131,v55,v54,s22
Zc v132,v49,v48,s23
Zc v133,v51,v50,s23
Zc v134,v53,v52,s23
Zc v135,v55,v54,s23
Zb s19,s17,2621440
Za v48,v4,s[24:27],s19 offen
Zb s19,s17,2629632
Za v49,v4,s[24:27],s19 offen
Zb s19,s17,2637824
Za v50,v4,s[24:27],s19 offen
Zb s19,s17,2646016
Za v51,v4,s[24:27],s19 offen
Zb s19,s17,2654208
Za v52,v4,s[24:27],s19 offen
Zb s19,s17,2662400
Za v53,v4,s[24:27],s19 offen
Zb s19,s17,2670592
Za v54,v4,s[24:27],s19 offen
Zb s19,s17,2678784
Za v55,v4,s[24:27],s19 offen
Zf vmcnt(46)
Zc v136,v57,v56,s22
Zf vmcnt(44)
Zc v137,v59,v58,s22
Zf vmcnt(42)
Zc v138,v61,v60,s22
Zf vmcnt(40)
Zc v139,v63,v62,s22
Zc v140,v57,v56,s23
Zc v141,v59,v58,s23
Zc v142,v61,v60,s23
Zc v143,v63,v62,s23
Zb s19,s17,2883584
Za v56,v4,s[24:27],s19 offen
Zb s19,s17,2891776
Za v57,v4,s[24:27],s19 offen
Zb s19,s17,2899968
Za v58,v4,s[24:27],s19 offen
Zb s19,s17,2908160
Za v59,v4,s[24:27],s19 offen
Zb s19,s17,2916352
Za v60,v4,s[24:27],s19 offen
Zb s19,s17,2924544
Za v61,v4,s[24:27],s19 offen
Zb s19,s17,2932736
Za v62,v4,s[24:27],s19 offen
Zb s19,s17,2940928
Za v63,v4,s[24:27],s19 offen
Zf vmcnt(46)
Zc v144,v17,v16,s22
Zf vmcnt(44)
Zc v145,v19,v18,s22
Zf vmcnt(42)
Zc v146,v21,v20,s22
Zf vmcnt(40)
Zc v147,v23,v22,s22
Zc v148,v17,v16,s23
Zc v149,v19,v18,s23
Zc v150,v21,v20,s23
Zc v151,v23,v22,s23
Zb s19,s17,3145728
Za v16,v4,s[24:27],s19 offen
Zb s19,s17,3153920
Za v17,v4,s[24:27],s19 offen
Zb s19,s17,3162112
Za v18,v4,s[24:27],s19 offen
Zb s19,s17,3170304
Za v19,v4,s[24:27],s19 offen
Zb s19,s17,3178496
Za v20,v4,s[24:27],s19 offen
Zb s19,s17,3186688
Za v21,v4,s[24:27],s19 offen
Zb s19,s17,3194880
Za v22,v4,s[24:27],s19 offen
Zb s19,s17,3203072
Za v23,v4,s[24:27],s19 offen
Zf vmcnt(46)
Zc v152,v25,v24,s22
Zf vmcnt(44)
Zc v153,v27,v26,s22
Zf vmcnt(42)
Zc v154,v29,v28,s22
Zf vmcnt(40)
Zc v155,v31,v30,s22
Zc v156,v25,v24,s23
Zc v157,v27,v26,s23
Zc v158,v29,v28,s23
Zc v159,v31,v30,s23
Zb s19,s17,3407872
Za v24,v4,s[24:27],s19 offen
Zb s19,s17,3416064
Za v25,v4,s[24:27],s19 offen
Zb s19,s17,3424256
Za v26,v4,s[24:27],s19 offen
Zb s19,s17,3432448
Za v27,v4,s[24:27],s19 offen
Zb s19,s17,3440640
Za v28,v4,s[24:27],s19 offen
Zb s19,s17,3448832
Za v29,v4,s[24:27],s19 offen
Zb s19,s17,3457024
Za v30,v4,s[24:27],s19 offen
Zb s19,s17,3465216
Za v31,v4,s[24:27],s19 offen
Zf vmcnt(46)
Zc v160,v33,v32,s22
Zf vmcnt(44)
Zc v161,v35,v34,s22
Zf vmcnt(42)
Zc v162,v37,v36,s22
Zf vmcnt(40)
Zc v163,v39,v38,s22
Zc v164,v33,v32,s23
Zc v165,v35,v34,s23
Zc v166,v37,v36,s23
Zc v167,v39,v38,s23
Zb s19,s17,3670016
Za v32,v4,s[24:27],s19 offen
Zb s19,s17,3678208
Za v33,v4,s[24:27],s19 offen
Zb s19,s17,3686400
Za v34,v4,s[24:27],s19 offen
Zb s19,s17,3694592
Za v35,v4,s[24:27],s19 offen
Zb s19,s17,3702784
Za v36,v4,s[24:27],s19 offen
Zb s19,s17,3710976
Za v37,v4,s[24:27],s19 offen
Zb s19,s17,3719168
Za v38,v4,s[24:27],s19 offen
Zb s19,s17,3727360
Za v39,v4,s[24:27],s19 offen
Zf vmcnt(46)
Zc v168,v41,v40,s22
Zf vmcnt(44)
Zc v169,v43,v42,s22
Zf vmcnt(42)
Zc v170,v45,v44,s22
Zf vmcnt(40)
Zc v171,v47,v46,s22
Zc v172,v41,v40,s23
Zc v173,v43,v42,s23
Zc v174,v45,v44,s23
Zc v175,v47,v46,s23
Zb s19,s17,3932160
Za v40,v4,s[24:27],s19 offen
Zb s19,s17,3940352
Za v41,v4,s[24:27],s19 offen
Zb s19,s17,3948544
Za v42,v4,s[24:27],s19 offen
Zb s19,s17,3956736
Za v43,v4,s[24:27],s19 offen
Zb s19,s17,3964928
Za v44,v4,s[24:27],s19 offen
Zb s19,s17,3973120
Za v45,v4,s[24:27],s19 offen
Zb s19,s17,3981312
Za v46,v4,s[24:27],s19 offen
Zb s19,s17,3989504
Za v47,v4,s[24:27],s19 offen
Zf vmcnt(46)
Zc v176,v49,v48,s22
Zf vmcnt(44)
Zc v177,v51,v50,s22
Zf vmcnt(42)
Zc v178,v53,v52,s22
Zf vmcnt(40)
Zc v179,v55,v54,s22
Zc v180,v49,v48,s23
Zc v181,v51,v50,s23
Zc v182,v53,v52,s23
Zc v183,v55,v54,s23
Zb s19,s17,4194304
Za v48,v4,s[24:27],s19 offen
Zb s19,s17,4202496
Za v49,v4,s[24:27],s19 offen
Zb s19,s17,4210688
Za v50,v4,s[24:27],s19 offen
Zb s19,s17,4218880
Za v51,v4,s[24:27],s19 offen
Zb s19,s17,4227072
Za v52,v4,s[24:27],s19 offen
Zb s19,s17,4235264
Za v53,v4,s[24:27],s19 offen
Zb s19,s17,4243456
Za v54,v4,s[24:27],s19 offen
Zb s19,s17,4251648
Za v55,v4,s[24:27],s19 offen
Zf vmcnt(46)
Zc v184,v57,v56,s22
Zf vmcnt(44)
Zc v185,v59,v58,s22
Zf vmcnt(42)
Zc v186,v61,v60,s22
Zf vmcnt(40)
Zc v187,v63,v62,s22
Zc v188,v57,v56,s23
Zc v189,v59,v58,s23
Zc v190,v61,v60,s23
Zc v191,v63,v62,s23
Zb s19,s17,4456448
Za v56,v4,s[24:27],s19 offen
Zb s19,s17,4464640
Za v57,v4,s[24:27],s19 offen
Zb s19,s17,4472832
Za v58,v4,s[24:27],s19 offen
Zb s19,s17,4481024
Za v59,v4,s[24:27],s19 offen
Zb s19,s17,4489216
Za v60,v4,s[24:27],s19 offen
Zb s19,s17,4497408
Za v61,v4,s[24:27],s19 offen
Zb s19,s17,4505600
Za v62,v4,s[24:27],s19 offen
Zb s19,s17,4513792
Za v63,v4,s[24:27],s19 offen
Zf vmcnt(46)
Zc v192,v17,v16,s22
Zf vmcnt(44)
Zc v193,v19,v18,s22
Zf vmcnt(42)
Zc v194,v21,v20,s22
Zf vmcnt(40)
Zc v195,v23,v22,s22
Zc v196,v17,v16,s23
Zc v197,v19,v18,s23
Zc v198,v21,v20,s23
Zc v199,v23,v22,s23
Zb s19,s17,4718592
Za v16,v4,s[24:27],s19 offen
Zb s19,s17,4726784
Za v17,v4,s[24:27],s19 offen
Zb s19,s17,4734976
Za v18,v4,s[24:27],s19 offen
Zb s19,s17,4743168
Za v19,v4,s[24:27],s19 offen
Zb s19,s17,4751360
Za v20,v4,s[24:27],s19 offen
Zb s19,s17,4759552
Za v21,v4,s[24:27],s19 offen
Zb s19,s17,4767744
Za v22,v4,s[24:27],s19 offen
Zb s19,s17,4775936
Za v23,v4,s[24:27],s19 offen
Zf vmcnt(46)
Zc v200,v25,v24,s22
Zf vmcnt(44)
Zc v201,v27,v26,s22
Zf vmcnt(42)
Zc v202,v29,v28,s22
Zf vmcnt(40)
Zc v203,v31,v30,s22
Zc v204,v25,v24,s23
Zc v205,v27,v26,s23
Zc v206,v29,v28,s23
Zc v207,v31,v30,s23
Zb s19,s17,4980736
Za v24,v4,s[24:27],s19 offen
Zb s19,s17,4988928
Za v25,v4,s[24:27],s19 offen
Zb s19,s17,4997120
Za v26,v4,s[24:27],s19 offen
Zb s19,s17,5005312
Za v27,v4,s[24:27],s19 offen
Zb s19,s17,5013504
Za v28,v4,s[24:27],s19 offen
Zb s19,s17,5021696
Za v29,v4,s[24:27],s19 offen
Zb s19,s17,5029888
Za v30,v4,s[24:27],s19 offen
Zb s19,s17,5038080
Za v31,v4,s[24:27],s19 offen
Zf vmcnt(46)
Zc v208,v33,v32,s22
Zf vmcnt(44)
Zc v209,v35,v34,s22
Zf vmcnt(42)
Zc v210,v37,v36,s22
Zf vmcnt(40)
Zc v211,v39,v38,s22
Zc v212,v33,v32,s23
Zc v213,v35,v34,s23
Zc v214,v37,v36,s23
Zc v215,v39,v38,s23
Zf vmcnt(38)
Zc v216,v41,v40,s22
Zf vmcnt(36)
Zc v217,v43,v42,s22
Zf vmcnt(34)
Zc v218,v45,v44,s22
Zf vmcnt(32)
Zc v219,v47,v46,s22
Zc v220,v41,v40,s23
Zc v221,v43,v42,s23
Zc v222,v45,v44,s23
Zc v223,v47,v46,s23
Zf vmcnt(30)
Zc v224,v49,v48,s22
Zf vmcnt(28)
Zc v225,v51,v50,s22
Zf vmcnt(26)
Zc v226,v53,v52,s22
Zf vmcnt(24)
Zc v227,v55,v54,s22
Zc v228,v49,v48,s23
Zc v229,v51,v50,s23
Zc v230,v53,v52,s23
Zc v231,v55,v54,s23
Zf vmcnt(22)
Zc v232,v57,v56,s22
Zf vmcnt(20)
Zc v233,v59,v58,s22
Zf vmcnt(18)
Zc v234,v61,v60,s22
Zf vmcnt(16)
Zc v235,v63,v62,s22
Zc v236,v57,v56,s23
Zc v237,v59,v58,s23
Zc v238,v61,v60,s23
Zc v239,v63,v62,s23
Zf vmcnt(14)
Zc v240,v17,v16,s22
Zf vmcnt(12)
Zc v241,v19,v18,s22
Zf vmcnt(10)
Zc v242,v21,v20,s22
Zf vmcnt(8)
Zc v243,v23,v22,s22
Zc v244,v17,v16,s23
Zc v245,v19,v18,s23
Zc v246,v21,v20,s23
Zc v247,v23,v22,s23
Zf vmcnt(6)
Zc v248,v25,v24,s22
Zf vmcnt(4)
Zc v249,v27,v26,s22
Zf vmcnt(2)
Zc v250,v29,v28,s22
Zf vmcnt(0)
Zc v251,v31,v30,s22
Zc v252,v25,v24,s23
Zc v253,v27,v26,s23
Zc v254,v29,v28,s23
Zc v255,v31,v30,s23
s_and_b32 s19, s9, 1
Zq s38,s19,11
s_xor_b32 s39, s38, 2048
Zq s19,s19,12
Zq s29,s29,10
Zb s29,s29,s19
Zb s29,s29,134217728
Zp s12,9472
Zq s13,s31,7
Zq s19,s30,2
Zb s13,s13,s19
Zp s14,0
v_lshrrev_b32 v3, 2, v0
v_min_u32 v3, 12, v3
v_lshrrev_b32 v7, 7, v0
v_lshrrev_b32 v8, 4, v0
Zy v8,7,v8
v_xor_b32 v8, v8, v7
Zq s19,s9,3
v_add_u32 v7, s19, v7
v_mul_u32_u24 v4, 1280, v7
v_lshl_add_u32 v4, v8, 4, v4
Zy v7,7,v1
v_lshrrev_b32 v8, 3, v1
Zz v8,10,v8
v_lshl_add_u32 v8, v7, 7, v8
v_xor_b32 v7, v2, v7
v_lshl_add_u32 v5, v7, 4, v8
v_xor_b32 v6, 64, v5
Zp s10,0
s_and_b32 s35, s8, 31
s_mul_i32 s34, s35, 26
s_lshr_b32 s34, s34, 8
s_mul_i32 s34, s34, 10
s_sub_u32 s35, s35, s34
Zq s35,s35,7
Zq s11,s9,10
Zp s15,0
Zp s33,0
Zp s32,131072
v_lshrrev_b32 v11, 2, v0
v_add_u32 v11, 131072, v11
Zf vmcnt(0) lgkmcnt(0)
KV_L:
s_cmp_lg_u32 s15, 0
Zk KV_H
Zb s16,s10,1
s_and_b32 s21, s10, 1
Zq s21,s21,7
Zb s21,s21,9472
s_lshr_b32 s41, s10, 1
Zo s41,32
s_cselect_b32 s43, 124, 0
Zp s41,0
Zp s42,8704
s_cmp_ge_u32 s41, s43
Zk ND_58
NP_57:
Za v9,off,s[4:7],s42 sc1
Zf vmcnt(0)
v_readfirstlane_b32 s41, v9
s_cmp_ge_u32 s41, s43
Zk ND_58
s_sleep 32
s_sub_u32 s20, s20, 1
s_cmp_gt_i32 s20, 0
Zk NP_57
ND_58:
WF_55:
Za v9,v3,s[4:7],s21 offen sc1
Zf vmcnt(0)
v_cmp_gt_u32 vcc, s16, v9
s_cbranch_vccz WD_56
s_sleep 3
s_sub_u32 s20, s20, 1
s_cmp_gt_i32 s20, 0
Zk WF_55
WD_56:
s_mul_i32 s36, s10, 40960
Zb s36,s36,105906176
Zb s36,s36,s14
Zb s16,s10,1
s_and_b32 s21, s16, 1
Zq s21,s21,7
Zb s21,s21,9472
Zq s34,s35,5
Zb m0,s11,s34
Zb s37,s36,s35
Zh v4,s[4:7],s37 offen sc1 lds
Zb s35,s35,128
Zo s35,1280
s_cselect_b32 s35, 0, s35
Zq s34,s35,5
Zb m0,s11,s34
Zb s37,s36,s35
Zh v4,s[4:7],s37 offen sc1 lds
Zb s35,s35,128
Zo s35,1280
s_cselect_b32 s35, 0, s35
Zq s34,s35,5
Zb m0,s11,s34
Zb s37,s36,s35
Zh v4,s[4:7],s37 offen sc1 lds
Zb s35,s35,128
Zo s35,1280
s_cselect_b32 s35, 0, s35
Zq s34,s35,5
Zb m0,s11,s34
Zb s37,s36,s35
Zh v4,s[4:7],s37 offen sc1 lds
Zb s35,s35,128
Zo s35,1280
s_cselect_b32 s35, 0, s35
Zq s34,s35,5
Zb m0,s11,s34
Zb s37,s36,s35
Zh v4,s[4:7],s37 offen sc1 lds
Zb s35,s35,128
Zo s35,1280
s_cselect_b32 s35, 0, s35
Zq s34,s35,5
Zb m0,s11,s34
Zb s37,s36,s35
Zh v4,s[4:7],s37 offen sc1 lds
Zb s35,s35,128
Zo s35,1280
s_cselect_b32 s35, 0, s35
Zq s34,s35,5
Zb m0,s11,s34
Zb s37,s36,s35
Zh v4,s[4:7],s37 offen sc1 lds
Zb s35,s35,128
Zo s35,1280
s_cselect_b32 s35, 0, s35
Zq s34,s35,5
Zb m0,s11,s34
Zb s37,s36,s35
Zh v4,s[4:7],s37 offen sc1 lds
Zb s35,s35,128
Zo s35,1280
s_cselect_b32 s35, 0, s35
Zq s34,s35,5
Zb m0,s11,s34
Zb s37,s36,s35
Zh v4,s[4:7],s37 offen sc1 lds
Zb s35,s35,128
Zo s35,1280
s_cselect_b32 s35, 0, s35
Zq s34,s35,5
Zb m0,s11,s34
Zb s37,s36,s35
Zh v4,s[4:7],s37 offen sc1 lds
Zb s35,s35,128
Zo s35,1280
s_cselect_b32 s35, 0, s35
Zp m0,s32
s_nop 0
Za v3,s[4:7],s21 offen sc1 lds
s_xor_b32 s11, s11, 0x10000
s_xor_b32 s32, s32, 256
Zf vmcnt(0)
KV_H:
Zf vmcnt(3)
KV_I:
s_barrier
ds_read_b32 v9, v11
Zb s28,s10,1
Zb s16,s28,1
Zf lgkmcnt(0)
v_cmp_gt_u32 vcc, s16, v9
s_cmp_eq_u64 vcc, 0
s_cselect_b32 s15, 1, 0
s_mul_i32 s36, s28, 40960
Zb s36,s36,105906176
Zb s36,s36,s14
Zb s16,s28,1
s_and_b32 s21, s16, 1
Zq s21,s21,7
Zb s21,s21,9472
v_add_u32 v12, s38, v5
v_add_u32 v14, s39, v5
v_add_u32 v13, s38, v6
v_add_u32 v15, s39, v6
Zq s18,s10,5
Zb s18,s18,s31
Zq s17,s18,13
Zb s17,s17,s29
s_mul_i32 s18, s18, 20480
s_cmp_lg_u32 s30, 0
Zk KV_V
Zi v[32:35],v12 offset:0
Zi v[36:39],v14 offset:0
Zi v[40:43],v13 offset:0
Zi v[44:47],v15 offset:0
Zi v[48:51],v12 offset:4096
Zi v[52:55],v14 offset:4096
Zf lgkmcnt(5)
Ze v[16:19],a[0:3],v[32:35],0
Ze v[20:23],a[4:7],v[32:35],0
Ze v[56:59],v[96:99],v[32:35],0
Ze v[60:63],v[100:103],v[32:35],0
Zi v[32:35],v13 offset:4096
Zo s15,0
Zk ST_59
Zq s34,s35,5
Zb m0,s11,s34
Zb s37,s36,s35
Zh v4,s[4:7],s37 offen sc1 lds
Zb s35,s35,128
Zo s35,1280
s_cselect_b32 s35, 0, s35
ST_59:
Zf lgkmcnt(5)
Ze v[24:27],a[0:3],v[36:39],0
Ze v[28:31],a[4:7],v[36:39],0
Zi v[36:39],v15 offset:4096
Zf lgkmcnt(5)
Ze v[16:19],a[8:11],v[40:43],v[16:19]
Ze v[20:23],a[12:15],v[40:43],v[20:23]
Ze v[56:59],v[104:107],v[40:43],v[56:59]
Ze v[60:63],v[108:111],v[40:43],v[60:63]
Zi v[40:43],v12 offset:8192
Zo s15,0
Zk ST_60
Zq s34,s35,5
Zb m0,s11,s34
Zb s37,s36,s35
Zh v4,s[4:7],s37 offen sc1 lds
Zb s35,s35,128
Zo s35,1280
s_cselect_b32 s35, 0, s35
ST_60:
Zf lgkmcnt(5)
Ze v[24:27],a[8:11],v[44:47],v[24:27]
Ze v[28:31],a[12:15],v[44:47],v[28:31]
Zi v[44:47],v14 offset:8192
Zf lgkmcnt(5)
Ze v[16:19],a[16:19],v[48:51],v[16:19]
Ze v[20:23],a[20:23],v[48:51],v[20:23]
Ze v[56:59],v[112:115],v[48:51],v[56:59]
Ze v[60:63],v[116:119],v[48:51],v[60:63]
Zi v[48:51],v13 offset:8192
Zo s15,0
Zk ST_61
Zq s34,s35,5
Zb m0,s11,s34
Zb s37,s36,s35
Zh v4,s[4:7],s37 offen sc1 lds
Zb s35,s35,128
Zo s35,1280
s_cselect_b32 s35, 0, s35
ST_61:
Zf lgkmcnt(5)
Ze v[24:27],a[16:19],v[52:55],v[24:27]
Ze v[28:31],a[20:23],v[52:55],v[28:31]
Zi v[52:55],v15 offset:8192
Zf lgkmcnt(5)
Ze v[16:19],a[24:27],v[32:35],v[16:19]
Ze v[20:23],a[28:31],v[32:35],v[20:23]
Ze v[56:59],v[120:123],v[32:35],v[56:59]
Ze v[60:63],v[124:127],v[32:35],v[60:63]
Zi v[32:35],v12 offset:12288
Zo s15,0
Zk ST_62
Zq s34,s35,5
Zb m0,s11,s34
Zb s37,s36,s35
Zh v4,s[4:7],s37 offen sc1 lds
Zb s35,s35,128
Zo s35,1280
s_cselect_b32 s35, 0, s35
ST_62:
Zf lgkmcnt(5)
Ze v[24:27],a[24:27],v[36:39],v[24:27]
Ze v[28:31],a[28:31],v[36:39],v[28:31]
Zi v[36:39],v14 offset:12288
Zf lgkmcnt(5)
Ze v[16:19],a[32:35],v[40:43],v[16:19]
Ze v[20:23],a[36:39],v[40:43],v[20:23]
Ze v[56:59],v[128:131],v[40:43],v[56:59]
Ze v[60:63],v[132:135],v[40:43],v[60:63]
Zi v[40:43],v13 offset:12288
Zo s15,0
Zk ST_63
Zq s34,s35,5
Zb m0,s11,s34
Zb s37,s36,s35
Zh v4,s[4:7],s37 offen sc1 lds
Zb s35,s35,128
Zo s35,1280
s_cselect_b32 s35, 0, s35
ST_63:
Zf lgkmcnt(5)
Ze v[24:27],a[32:35],v[44:47],v[24:27]
Ze v[28:31],a[36:39],v[44:47],v[28:31]
Zi v[44:47],v15 offset:12288
Zf lgkmcnt(5)
Ze v[16:19],a[40:43],v[48:51],v[16:19]
Ze v[20:23],a[44:47],v[48:51],v[20:23]
Ze v[56:59],v[136:139],v[48:51],v[56:59]
Ze v[60:63],v[140:143],v[48:51],v[60:63]
Zi v[48:51],v12 offset:16384
Zo s15,0
Zk ST_64
Zq s34,s35,5
Zb m0,s11,s34
Zb s37,s36,s35
Zh v4,s[4:7],s37 offen sc1 lds
Zb s35,s35,128
Zo s35,1280
s_cselect_b32 s35, 0, s35
ST_64:
Zf lgkmcnt(5)
Ze v[24:27],a[40:43],v[52:55],v[24:27]
Ze v[28:31],a[44:47],v[52:55],v[28:31]
Zi v[52:55],v14 offset:16384
Zf lgkmcnt(5)
Ze v[16:19],a[48:51],v[32:35],v[16:19]
Ze v[20:23],a[52:55],v[32:35],v[20:23]
Ze v[56:59],v[144:147],v[32:35],v[56:59]
Ze v[60:63],v[148:151],v[32:35],v[60:63]
Zi v[32:35],v13 offset:16384
Zo s15,0
Zk ST_65
Zq s34,s35,5
Zb m0,s11,s34
Zb s37,s36,s35
Zh v4,s[4:7],s37 offen sc1 lds
Zb s35,s35,128
Zo s35,1280
s_cselect_b32 s35, 0, s35
ST_65:
Zf lgkmcnt(5)
Ze v[24:27],a[48:51],v[36:39],v[24:27]
Ze v[28:31],a[52:55],v[36:39],v[28:31]
Zi v[36:39],v15 offset:16384
Zf lgkmcnt(5)
Ze v[16:19],a[56:59],v[40:43],v[16:19]
Ze v[20:23],a[60:63],v[40:43],v[20:23]
Ze v[56:59],v[152:155],v[40:43],v[56:59]
Ze v[60:63],v[156:159],v[40:43],v[60:63]
Zi v[40:43],v12 offset:20480
Zo s15,0
Zk ST_66
Zq s34,s35,5
Zb m0,s11,s34
Zb s37,s36,s35
Zh v4,s[4:7],s37 offen sc1 lds
Zb s35,s35,128
Zo s35,1280
s_cselect_b32 s35, 0, s35
ST_66:
Zo s33,0
Zk MD_67
Zf vmcnt(8)
s_cmp_lg_u32 s15, 0
Zk ME_68
Zf vmcnt(0)
ME_68:
s_barrier
s_cmp_lg_u32 s9, 0
Zk SF_69
Zs v9,s33
Zu v9,off,s[4:7],s13 sc1
SF_69:
MD_67:
Zf lgkmcnt(5)
Ze v[24:27],a[56:59],v[44:47],v[24:27]
Ze v[28:31],a[60:63],v[44:47],v[28:31]
Zi v[44:47],v14 offset:20480
Zf lgkmcnt(5)
Ze v[16:19],a[64:67],v[48:51],v[16:19]
Ze v[20:23],a[68:71],v[48:51],v[20:23]
Ze v[56:59],v[160:163],v[48:51],v[56:59]
Ze v[60:63],v[164:167],v[48:51],v[60:63]
Zi v[48:51],v13 offset:20480
Zo s15,0
Zk ST_70
Zq s34,s35,5
Zb m0,s11,s34
Zb s37,s36,s35
Zh v4,s[4:7],s37 offen sc1 lds
Zb s35,s35,128
Zo s35,1280
s_cselect_b32 s35, 0, s35
ST_70:
Zf lgkmcnt(5)
Ze v[24:27],a[64:67],v[52:55],v[24:27]
Ze v[28:31],a[68:71],v[52:55],v[28:31]
Zi v[52:55],v15 offset:20480
Zf lgkmcnt(5)
Ze v[16:19],a[72:75],v[32:35],v[16:19]
Ze v[20:23],a[76:79],v[32:35],v[20:23]
Ze v[56:59],v[168:171],v[32:35],v[56:59]
Ze v[60:63],v[172:175],v[32:35],v[60:63]
Zi v[32:35],v12 offset:24576
Zo s15,0
Zk ST_71
Zq s34,s35,5
Zb m0,s11,s34
Zb s37,s36,s35
Zh v4,s[4:7],s37 offen sc1 lds
Zb s35,s35,128
Zo s35,1280
s_cselect_b32 s35, 0, s35
ST_71:
Zf lgkmcnt(5)
Ze v[24:27],a[72:75],v[36:39],v[24:27]
Ze v[28:31],a[76:79],v[36:39],v[28:31]
Zi v[36:39],v14 offset:24576
Zf lgkmcnt(5)
Ze v[16:19],a[80:83],v[40:43],v[16:19]
Ze v[20:23],a[84:87],v[40:43],v[20:23]
Ze v[56:59],v[176:179],v[40:43],v[56:59]
Ze v[60:63],v[180:183],v[40:43],v[60:63]
Zi v[40:43],v13 offset:24576
Zo s15,0
Zk ST_72
Zp m0,s32
s_nop 0
Za v3,s[4:7],s21 offen sc1 lds
s_xor_b32 s11, s11, 0x10000
s_xor_b32 s32, s32, 256
ST_72:
Zf lgkmcnt(5)
Ze v[24:27],a[80:83],v[44:47],v[24:27]
Ze v[28:31],a[84:87],v[44:47],v[28:31]
Zi v[44:47],v15 offset:24576
Zf lgkmcnt(5)
Ze v[16:19],a[88:91],v[48:51],v[16:19]
Ze v[20:23],a[92:95],v[48:51],v[20:23]
Ze v[56:59],v[184:187],v[48:51],v[56:59]
Ze v[60:63],v[188:191],v[48:51],v[60:63]
Zi v[48:51],v12 offset:28672
Zf lgkmcnt(5)
Ze v[24:27],a[88:91],v[52:55],v[24:27]
Ze v[28:31],a[92:95],v[52:55],v[28:31]
Zi v[52:55],v14 offset:28672
Zf lgkmcnt(5)
Ze v[16:19],a[96:99],v[32:35],v[16:19]
Ze v[20:23],a[100:103],v[32:35],v[20:23]
Ze v[56:59],v[192:195],v[32:35],v[56:59]
Ze v[60:63],v[196:199],v[32:35],v[60:63]
Zi v[32:35],v13 offset:28672
Zf lgkmcnt(5)
Ze v[24:27],a[96:99],v[36:39],v[24:27]
Ze v[28:31],a[100:103],v[36:39],v[28:31]
Zi v[36:39],v15 offset:28672
Zf lgkmcnt(5)
Ze v[16:19],a[104:107],v[40:43],v[16:19]
Ze v[20:23],a[108:111],v[40:43],v[20:23]
Ze v[56:59],v[200:203],v[40:43],v[56:59]
Ze v[60:63],v[204:207],v[40:43],v[60:63]
Zi v[40:43],v12 offset:32768
Zf lgkmcnt(5)
Ze v[24:27],a[104:107],v[44:47],v[24:27]
Ze v[28:31],a[108:111],v[44:47],v[28:31]
Zi v[44:47],v14 offset:32768
Zf lgkmcnt(5)
Ze v[16:19],a[112:115],v[48:51],v[16:19]
Ze v[20:23],a[116:119],v[48:51],v[20:23]
Ze v[56:59],v[208:211],v[48:51],v[56:59]
Ze v[60:63],v[212:215],v[48:51],v[60:63]
Zi v[48:51],v13 offset:32768
Zf lgkmcnt(5)
Ze v[24:27],a[112:115],v[52:55],v[24:27]
Ze v[28:31],a[116:119],v[52:55],v[28:31]
Zi v[52:55],v15 offset:32768
Zf lgkmcnt(5)
Ze v[16:19],a[120:123],v[32:35],v[16:19]
Ze v[20:23],a[124:127],v[32:35],v[20:23]
Ze v[56:59],v[216:219],v[32:35],v[56:59]
Ze v[60:63],v[220:223],v[32:35],v[60:63]
Zi v[32:35],v12 offset:36864
Zf lgkmcnt(5)
Ze v[24:27],a[120:123],v[36:39],v[24:27]
Ze v[28:31],a[124:127],v[36:39],v[28:31]
Zi v[36:39],v14 offset:36864
Zf lgkmcnt(5)
Ze v[16:19],a[128:131],v[40:43],v[16:19]
Ze v[20:23],a[132:135],v[40:43],v[20:23]
Ze v[56:59],v[224:227],v[40:43],v[56:59]
Ze v[60:63],v[228:231],v[40:43],v[60:63]
Zi v[40:43],v13 offset:36864
Zf lgkmcnt(5)
Ze v[24:27],a[128:131],v[44:47],v[24:27]
Ze v[28:31],a[132:135],v[44:47],v[28:31]
Zi v[44:47],v15 offset:36864
Zf lgkmcnt(5)
Ze v[16:19],a[136:139],v[48:51],v[16:19]
Ze v[20:23],a[140:143],v[48:51],v[20:23]
Ze v[56:59],v[232:235],v[48:51],v[56:59]
Ze v[60:63],v[236:239],v[48:51],v[60:63]
Zf lgkmcnt(4)
Ze v[24:27],a[136:139],v[52:55],v[24:27]
Ze v[28:31],a[140:143],v[52:55],v[28:31]
Zf lgkmcnt(3)
Ze v[16:19],a[144:147],v[32:35],v[16:19]
Ze v[20:23],a[148:151],v[32:35],v[20:23]
Ze v[56:59],v[240:243],v[32:35],v[56:59]
Ze v[60:63],v[244:247],v[32:35],v[60:63]
Zf lgkmcnt(2)
Ze v[24:27],a[144:147],v[36:39],v[24:27]
Ze v[28:31],a[148:151],v[36:39],v[28:31]
Zf lgkmcnt(1)
Ze v[16:19],a[152:155],v[40:43],v[16:19]
Ze v[20:23],a[156:159],v[40:43],v[20:23]
Ze v[56:59],v[248:251],v[40:43],v[56:59]
Ze v[60:63],v[252:255],v[40:43],v[60:63]
Zf lgkmcnt(0)
Ze v[24:27],a[152:155],v[44:47],v[24:27]
Ze v[28:31],a[156:159],v[44:47],v[28:31]
s_nop 15
s_bitcmp0_b32 s9, 0
Zk SW_73
v_swap_b32 v16, v24
v_swap_b32 v17, v25
v_swap_b32 v18, v26
v_swap_b32 v19, v27
v_swap_b32 v20, v28
v_swap_b32 v21, v29
v_swap_b32 v22, v30
v_swap_b32 v23, v31
SW_73:
Zj v32,v16,v20
Zj v33,v17,v21
Zj v34,v18,v22
Zj v35,v19,v23
Zj v36,v24,v28
Zj v37,v25,v29
Zj v38,v26,v30
Zj v39,v27,v31
Zq s19,s9,10
Zb s18,s18,s19
Zb s18,s18,16777216
Zb s19,s18,4096
Zr v[32:35],v0,s[4:7],s18 offen sc1
Zr v[36:39],v0,s[4:7],s19 offen sc1
s_branch KV_E
KV_V:
Zi v[32:35],v12 offset:0
Zi v[36:39],v14 offset:0
Zi v[40:43],v13 offset:0
Zi v[44:47],v15 offset:0
Zi v[48:51],v12 offset:4096
Zi v[52:55],v14 offset:4096
Zf lgkmcnt(5)
Ze v[16:19],v[32:35],a[0:3],0
Ze v[20:23],v[32:35],a[4:7],0
Ze v[56:59],v[96:99],v[32:35],0
Ze v[60:63],v[100:103],v[32:35],0
Zi v[32:35],v13 offset:4096
Zo s15,0
Zk ST_74
Zq s34,s35,5
Zb m0,s11,s34
Zb s37,s36,s35
Zh v4,s[4:7],s37 offen sc1 lds
Zb s35,s35,128
Zo s35,1280
s_cselect_b32 s35, 0, s35
ST_74:
Zf lgkmcnt(5)
Ze v[24:27],v[36:39],a[0:3],0
Ze v[28:31],v[36:39],a[4:7],0
Zi v[36:39],v15 offset:4096
Zf lgkmcnt(5)
Ze v[16:19],v[40:43],a[8:11],v[16:19]
Ze v[20:23],v[40:43],a[12:15],v[20:23]
Ze v[56:59],v[104:107],v[40:43],v[56:59]
Ze v[60:63],v[108:111],v[40:43],v[60:63]
Zi v[40:43],v12 offset:8192
Zo s15,0
Zk ST_75
Zq s34,s35,5
Zb m0,s11,s34
Zb s37,s36,s35
Zh v4,s[4:7],s37 offen sc1 lds
Zb s35,s35,128
Zo s35,1280
s_cselect_b32 s35, 0, s35
ST_75:
Zf lgkmcnt(5)
Ze v[24:27],v[44:47],a[8:11],v[24:27]
Ze v[28:31],v[44:47],a[12:15],v[28:31]
Zi v[44:47],v14 offset:8192
Zf lgkmcnt(5)
Ze v[16:19],v[48:51],a[16:19],v[16:19]
Ze v[20:23],v[48:51],a[20:23],v[20:23]
Ze v[56:59],v[112:115],v[48:51],v[56:59]
Ze v[60:63],v[116:119],v[48:51],v[60:63]
Zi v[48:51],v13 offset:8192
Zo s15,0
Zk ST_76
Zq s34,s35,5
Zb m0,s11,s34
Zb s37,s36,s35
Zh v4,s[4:7],s37 offen sc1 lds
Zb s35,s35,128
Zo s35,1280
s_cselect_b32 s35, 0, s35
ST_76:
Zf lgkmcnt(5)
Ze v[24:27],v[52:55],a[16:19],v[24:27]
Ze v[28:31],v[52:55],a[20:23],v[28:31]
Zi v[52:55],v15 offset:8192
Zf lgkmcnt(5)
Ze v[16:19],v[32:35],a[24:27],v[16:19]
Ze v[20:23],v[32:35],a[28:31],v[20:23]
Ze v[56:59],v[120:123],v[32:35],v[56:59]
Ze v[60:63],v[124:127],v[32:35],v[60:63]
Zi v[32:35],v12 offset:12288
Zo s15,0
Zk ST_77
Zq s34,s35,5
Zb m0,s11,s34
Zb s37,s36,s35
Zh v4,s[4:7],s37 offen sc1 lds
Zb s35,s35,128
Zo s35,1280
s_cselect_b32 s35, 0, s35
ST_77:
Zf lgkmcnt(5)
Ze v[24:27],v[36:39],a[24:27],v[24:27]
Ze v[28:31],v[36:39],a[28:31],v[28:31]
Zi v[36:39],v14 offset:12288
Zf lgkmcnt(5)
Ze v[16:19],v[40:43],a[32:35],v[16:19]
Ze v[20:23],v[40:43],a[36:39],v[20:23]
Ze v[56:59],v[128:131],v[40:43],v[56:59]
Ze v[60:63],v[132:135],v[40:43],v[60:63]
Zi v[40:43],v13 offset:12288
Zo s15,0
Zk ST_78
Zq s34,s35,5
Zb m0,s11,s34
Zb s37,s36,s35
Zh v4,s[4:7],s37 offen sc1 lds
Zb s35,s35,128
Zo s35,1280
s_cselect_b32 s35, 0, s35
ST_78:
Zf lgkmcnt(5)
Ze v[24:27],v[44:47],a[32:35],v[24:27]
Ze v[28:31],v[44:47],a[36:39],v[28:31]
Zi v[44:47],v15 offset:12288
Zf lgkmcnt(5)
Ze v[16:19],v[48:51],a[40:43],v[16:19]
Ze v[20:23],v[48:51],a[44:47],v[20:23]
Ze v[56:59],v[136:139],v[48:51],v[56:59]
Ze v[60:63],v[140:143],v[48:51],v[60:63]
Zi v[48:51],v12 offset:16384
Zo s15,0
Zk ST_79
Zq s34,s35,5
Zb m0,s11,s34
Zb s37,s36,s35
Zh v4,s[4:7],s37 offen sc1 lds
Zb s35,s35,128
Zo s35,1280
s_cselect_b32 s35, 0, s35
ST_79:
Zf lgkmcnt(5)
Ze v[24:27],v[52:55],a[40:43],v[24:27]
Ze v[28:31],v[52:55],a[44:47],v[28:31]
Zi v[52:55],v14 offset:16384
Zf lgkmcnt(5)
Ze v[16:19],v[32:35],a[48:51],v[16:19]
Ze v[20:23],v[32:35],a[52:55],v[20:23]
Ze v[56:59],v[144:147],v[32:35],v[56:59]
Ze v[60:63],v[148:151],v[32:35],v[60:63]
Zi v[32:35],v13 offset:16384
Zo s15,0
Zk ST_80
Zq s34,s35,5
Zb m0,s11,s34
Zb s37,s36,s35
Zh v4,s[4:7],s37 offen sc1 lds
Zb s35,s35,128
Zo s35,1280
s_cselect_b32 s35, 0, s35
ST_80:
Zf lgkmcnt(5)
Ze v[24:27],v[36:39],a[48:51],v[24:27]
Ze v[28:31],v[36:39],a[52:55],v[28:31]
Zi v[36:39],v15 offset:16384
Zf lgkmcnt(5)
Ze v[16:19],v[40:43],a[56:59],v[16:19]
Ze v[20:23],v[40:43],a[60:63],v[20:23]
Ze v[56:59],v[152:155],v[40:43],v[56:59]
Ze v[60:63],v[156:159],v[40:43],v[60:63]
Zi v[40:43],v12 offset:20480
Zo s15,0
Zk ST_81
Zq s34,s35,5
Zb m0,s11,s34
Zb s37,s36,s35
Zh v4,s[4:7],s37 offen sc1 lds
Zb s35,s35,128
Zo s35,1280
s_cselect_b32 s35, 0, s35
ST_81:
Zo s33,0
Zk MD_82
Zf vmcnt(8)
s_cmp_lg_u32 s15, 0
Zk ME_83
Zf vmcnt(0)
ME_83:
s_barrier
s_cmp_lg_u32 s9, 0
Zk SF_84
Zs v9,s33
Zu v9,off,s[4:7],s13 sc1
SF_84:
MD_82:
Zf lgkmcnt(5)
Ze v[24:27],v[44:47],a[56:59],v[24:27]
Ze v[28:31],v[44:47],a[60:63],v[28:31]
Zi v[44:47],v14 offset:20480
Zf lgkmcnt(5)
Ze v[16:19],v[48:51],a[64:67],v[16:19]
Ze v[20:23],v[48:51],a[68:71],v[20:23]
Ze v[56:59],v[160:163],v[48:51],v[56:59]
Ze v[60:63],v[164:167],v[48:51],v[60:63]
Zi v[48:51],v13 offset:20480
Zo s15,0
Zk ST_85
Zq s34,s35,5
Zb m0,s11,s34
Zb s37,s36,s35
Zh v4,s[4:7],s37 offen sc1 lds
Zb s35,s35,128
Zo s35,1280
s_cselect_b32 s35, 0, s35
ST_85:
Zf lgkmcnt(5)
Ze v[24:27],v[52:55],a[64:67],v[24:27]
Ze v[28:31],v[52:55],a[68:71],v[28:31]
Zi v[52:55],v15 offset:20480
Zf lgkmcnt(5)
Ze v[16:19],v[32:35],a[72:75],v[16:19]
Ze v[20:23],v[32:35],a[76:79],v[20:23]
Ze v[56:59],v[168:171],v[32:35],v[56:59]
Ze v[60:63],v[172:175],v[32:35],v[60:63]
Zi v[32:35],v12 offset:24576
Zo s15,0
Zk ST_86
Zq s34,s35,5
Zb m0,s11,s34
Zb s37,s36,s35
Zh v4,s[4:7],s37 offen sc1 lds
Zb s35,s35,128
Zo s35,1280
s_cselect_b32 s35, 0, s35
ST_86:
Zf lgkmcnt(5)
Ze v[24:27],v[36:39],a[72:75],v[24:27]
Ze v[28:31],v[36:39],a[76:79],v[28:31]
Zi v[36:39],v14 offset:24576
Zf lgkmcnt(5)
Ze v[16:19],v[40:43],a[80:83],v[16:19]
Ze v[20:23],v[40:43],a[84:87],v[20:23]
Ze v[56:59],v[176:179],v[40:43],v[56:59]
Ze v[60:63],v[180:183],v[40:43],v[60:63]
Zi v[40:43],v13 offset:24576
Zo s15,0
Zk ST_87
Zp m0,s32
s_nop 0
Za v3,s[4:7],s21 offen sc1 lds
s_xor_b32 s11, s11, 0x10000
s_xor_b32 s32, s32, 256
ST_87:
Zf lgkmcnt(5)
Ze v[24:27],v[44:47],a[80:83],v[24:27]
Ze v[28:31],v[44:47],a[84:87],v[28:31]
Zi v[44:47],v15 offset:24576
Zf lgkmcnt(5)
Ze v[16:19],v[48:51],a[88:91],v[16:19]
Ze v[20:23],v[48:51],a[92:95],v[20:23]
Ze v[56:59],v[184:187],v[48:51],v[56:59]
Ze v[60:63],v[188:191],v[48:51],v[60:63]
Zi v[48:51],v12 offset:28672
Zf lgkmcnt(5)
Ze v[24:27],v[52:55],a[88:91],v[24:27]
Ze v[28:31],v[52:55],a[92:95],v[28:31]
Zi v[52:55],v14 offset:28672
Zf lgkmcnt(5)
Ze v[16:19],v[32:35],a[96:99],v[16:19]
Ze v[20:23],v[32:35],a[100:103],v[20:23]
Ze v[56:59],v[192:195],v[32:35],v[56:59]
Ze v[60:63],v[196:199],v[32:35],v[60:63]
Zi v[32:35],v13 offset:28672
Zf lgkmcnt(5)
Ze v[24:27],v[36:39],a[96:99],v[24:27]
Ze v[28:31],v[36:39],a[100:103],v[28:31]
Zi v[36:39],v15 offset:28672
Zf lgkmcnt(5)
Ze v[16:19],v[40:43],a[104:107],v[16:19]
Ze v[20:23],v[40:43],a[108:111],v[20:23]
Ze v[56:59],v[200:203],v[40:43],v[56:59]
Ze v[60:63],v[204:207],v[40:43],v[60:63]
Zi v[40:43],v12 offset:32768
Zf lgkmcnt(5)
Ze v[24:27],v[44:47],a[104:107],v[24:27]
Ze v[28:31],v[44:47],a[108:111],v[28:31]
Zi v[44:47],v14 offset:32768
Zf lgkmcnt(5)
Ze v[16:19],v[48:51],a[112:115],v[16:19]
Ze v[20:23],v[48:51],a[116:119],v[20:23]
Ze v[56:59],v[208:211],v[48:51],v[56:59]
Ze v[60:63],v[212:215],v[48:51],v[60:63]
Zi v[48:51],v13 offset:32768
Zf lgkmcnt(5)
Ze v[24:27],v[52:55],a[112:115],v[24:27]
Ze v[28:31],v[52:55],a[116:119],v[28:31]
Zi v[52:55],v15 offset:32768
Zf lgkmcnt(5)
Ze v[16:19],v[32:35],a[120:123],v[16:19]
Ze v[20:23],v[32:35],a[124:127],v[20:23]
Ze v[56:59],v[216:219],v[32:35],v[56:59]
Ze v[60:63],v[220:223],v[32:35],v[60:63]
Zi v[32:35],v12 offset:36864
Zf lgkmcnt(5)
Ze v[24:27],v[36:39],a[120:123],v[24:27]
Ze v[28:31],v[36:39],a[124:127],v[28:31]
Zi v[36:39],v14 offset:36864
Zf lgkmcnt(5)
Ze v[16:19],v[40:43],a[128:131],v[16:19]
Ze v[20:23],v[40:43],a[132:135],v[20:23]
Ze v[56:59],v[224:227],v[40:43],v[56:59]
Ze v[60:63],v[228:231],v[40:43],v[60:63]
Zi v[40:43],v13 offset:36864
Zf lgkmcnt(5)
Ze v[24:27],v[44:47],a[128:131],v[24:27]
Ze v[28:31],v[44:47],a[132:135],v[28:31]
Zi v[44:47],v15 offset:36864
Zf lgkmcnt(5)
Ze v[16:19],v[48:51],a[136:139],v[16:19]
Ze v[20:23],v[48:51],a[140:143],v[20:23]
Ze v[56:59],v[232:235],v[48:51],v[56:59]
Ze v[60:63],v[236:239],v[48:51],v[60:63]
Zf lgkmcnt(4)
Ze v[24:27],v[52:55],a[136:139],v[24:27]
Ze v[28:31],v[52:55],a[140:143],v[28:31]
Zf lgkmcnt(3)
Ze v[16:19],v[32:35],a[144:147],v[16:19]
Ze v[20:23],v[32:35],a[148:151],v[20:23]
Ze v[56:59],v[240:243],v[32:35],v[56:59]
Ze v[60:63],v[244:247],v[32:35],v[60:63]
Zf lgkmcnt(2)
Ze v[24:27],v[36:39],a[144:147],v[24:27]
Ze v[28:31],v[36:39],a[148:151],v[28:31]
Zf lgkmcnt(1)
Ze v[16:19],v[40:43],a[152:155],v[16:19]
Ze v[20:23],v[40:43],a[156:159],v[20:23]
Ze v[56:59],v[248:251],v[40:43],v[56:59]
Ze v[60:63],v[252:255],v[40:43],v[60:63]
Zf lgkmcnt(0)
Ze v[24:27],v[44:47],a[152:155],v[24:27]
Ze v[28:31],v[44:47],a[156:159],v[28:31]
s_nop 15
s_bitcmp0_b32 s9, 0
Zk SW_88
v_swap_b32 v16, v24
v_swap_b32 v17, v25
v_swap_b32 v18, v26
v_swap_b32 v19, v27
v_swap_b32 v20, v28
v_swap_b32 v21, v29
v_swap_b32 v22, v30
v_swap_b32 v23, v31
SW_88:
Zj v32,v16,v17
Zj v33,v18,v19
Zj v34,v24,v25
Zj v35,v26,v27
Zj v36,v20,v21
Zj v37,v22,v23
Zj v38,v28,v29
Zj v39,v30,v31
Zq s19,s9,11
Zb s18,s18,s19
Zb s18,s18,16785408
Zr v[32:35],v0,s[4:7],s18 offen sc1
Zr v[36:39],v0,s[4:7],s18 offen offset:1024 sc1
KV_E:
Zj v40,v56,v60
Zj v41,v57,v61
Zj v42,v58,v62
Zj v43,v59,v63
Zr v[40:43],v0,s[4:7],s17 offen sc1
Zb s33,s10,1
s_and_b32 s16, s10, 63
s_cselect_b32 s16, s15, 0
s_cmp_lg_u32 s16, 0
Zk KV_N
Zo s15,0
Zk KV_R
s_xor_b32 m0, s32, 256
s_nop 0
Za v3,s[4:7],s21 offen sc1 lds
KV_R:
Zf vmcnt(0)
s_barrier
s_cmp_lg_u32 s9, 0
Zk SF_89
Zs v9,s33
Zu v9,off,s[4:7],s13 sc1
SF_89:
Zp s33,0
KV_N:
v_xor_b32 v5, 0x10000, v5
v_xor_b32 v11, 256, v11
v_xor_b32 v6, 0x10000, v6
Zp s10,s28
s_cmp_lt_u32 s10, 128
Zk KV_L
Zf vmcnt(0)
s_endpgm
R_AO:
Zy v0,63,v0
Zy v1,15,v0
v_lshrrev_b32 v2, 4, v0
Zz v0,4,v0
Zp s22,0x05040100
Zp s23,0x07060302
Zp s20,300000
s_load_dwordx2 s[24:25], s[0:1], 32
Zp s26,819200
Zp s27,0x20000
Zp s30,0
s_cmp_ge_u32 s8, 5
s_cselect_b32 s39, 1, 0
s_mul_i32 s19, s39, 5
s_sub_u32 s31, s8, s19
s_mul_i32 s19, s39, 27
Zb s8,s8,s19
v_mul_u32_u24 v4, 10240, v2
v_lshl_add_u32 v4, v1, 2, v4
Zs v5,v4
Zs v9,2130706432
v_cmp_le_u32 vcc, 3, v2
s_nop 1
v_cndmask_b32 v4, v4, v9, vcc
v_cmp_le_u32 vcc, 2, v2
s_nop 1
v_cndmask_b32 v5, v5, v9, vcc
s_mul_i32 s17, s30, 1310720
Zq s19,s31,8
Zb s17,s17,s19
Zq s19,s9,6
Zb s17,s17,s19
Zb s19,s17,0
Zf lgkmcnt(0)
Za v64,v4,s[24:27],s19 offen
Zb s19,s17,1280
Za v65,v4,s[24:27],s19 offen
Zb s19,s17,2560
Za v66,v4,s[24:27],s19 offen
Zb s19,s17,3840
Za v67,v4,s[24:27],s19 offen
Zb s19,s17,5120
Za v68,v5,s[24:27],s19 offen
Zb s19,s17,6400
Za v69,v5,s[24:27],s19 offen
Zb s19,s17,7680
Za v70,v5,s[24:27],s19 offen
Zb s19,s17,8960
Za v71,v5,s[24:27],s19 offen
Zb s19,s17,25600
Za v72,v4,s[24:27],s19 offen
Zb s19,s17,26880
Za v73,v4,s[24:27],s19 offen
Zb s19,s17,28160
Za v74,v4,s[24:27],s19 offen
Zb s19,s17,29440
Za v75,v4,s[24:27],s19 offen
Zb s19,s17,30720
Za v76,v5,s[24:27],s19 offen
Zb s19,s17,32000
Za v77,v5,s[24:27],s19 offen
Zb s19,s17,33280
Za v78,v5,s[24:27],s19 offen
Zb s19,s17,34560
Za v79,v5,s[24:27],s19 offen
Zb s19,s17,51200
Za v80,v4,s[24:27],s19 offen
Zb s19,s17,52480
Za v81,v4,s[24:27],s19 offen
Zb s19,s17,53760
Za v82,v4,s[24:27],s19 offen
Zb s19,s17,55040
Za v83,v4,s[24:27],s19 offen
Zb s19,s17,56320
Za v84,v5,s[24:27],s19 offen
Zb s19,s17,57600
Za v85,v5,s[24:27],s19 offen
Zb s19,s17,58880
Za v86,v5,s[24:27],s19 offen
Zb s19,s17,60160
Za v87,v5,s[24:27],s19 offen
Zb s19,s17,76800
Za v88,v4,s[24:27],s19 offen
Zb s19,s17,78080
Za v89,v4,s[24:27],s19 offen
Zb s19,s17,79360
Za v90,v4,s[24:27],s19 offen
Zb s19,s17,80640
Za v91,v4,s[24:27],s19 offen
Zb s19,s17,81920
Za v92,v5,s[24:27],s19 offen
Zb s19,s17,83200
Za v93,v5,s[24:27],s19 offen
Zb s19,s17,84480
Za v94,v5,s[24:27],s19 offen
Zb s19,s17,85760
Za v95,v5,s[24:27],s19 offen
Zb s19,s17,102400
Za v96,v4,s[24:27],s19 offen
Zb s19,s17,103680
Za v97,v4,s[24:27],s19 offen
Zb s19,s17,104960
Za v98,v4,s[24:27],s19 offen
Zb s19,s17,106240
Za v99,v4,s[24:27],s19 offen
Zb s19,s17,107520
Za v100,v5,s[24:27],s19 offen
Zb s19,s17,108800
Za v101,v5,s[24:27],s19 offen
Zb s19,s17,110080
Za v102,v5,s[24:27],s19 offen
Zb s19,s17,111360
Za v103,v5,s[24:27],s19 offen
Zb s19,s17,128000
Za v104,v4,s[24:27],s19 offen
Zb s19,s17,129280
Za v105,v4,s[24:27],s19 offen
Zb s19,s17,130560
Za v106,v4,s[24:27],s19 offen
Zb s19,s17,131840
Za v107,v4,s[24:27],s19 offen
Zb s19,s17,133120
Za v108,v5,s[24:27],s19 offen
Zb s19,s17,134400
Za v109,v5,s[24:27],s19 offen
Zb s19,s17,135680
Za v110,v5,s[24:27],s19 offen
Zb s19,s17,136960
Za v111,v5,s[24:27],s19 offen
Zf vmcnt(46)
Zc v56,v65,v64,s22
Zf vmcnt(44)
Zc v57,v67,v66,s22
Zf vmcnt(42)
Zc v58,v69,v68,s22
Zf vmcnt(40)
Zc v59,v71,v70,s22
Zc v60,v65,v64,s23
Zc v61,v67,v66,s23
Zc v62,v69,v68,s23
Zc v63,v71,v70,s23
Zd a0,v56
Zd a1,v57
Zd a2,v58
Zd a3,v59
Zd a4,v60
Zd a5,v61
Zd a6,v62
Zd a7,v63
Zb s19,s17,153600
Za v64,v4,s[24:27],s19 offen
Zb s19,s17,154880
Za v65,v4,s[24:27],s19 offen
Zb s19,s17,156160
Za v66,v4,s[24:27],s19 offen
Zb s19,s17,157440
Za v67,v4,s[24:27],s19 offen
Zb s19,s17,158720
Za v68,v5,s[24:27],s19 offen
Zb s19,s17,160000
Za v69,v5,s[24:27],s19 offen
Zb s19,s17,161280
Za v70,v5,s[24:27],s19 offen
Zb s19,s17,162560
Za v71,v5,s[24:27],s19 offen
Zf vmcnt(46)
Zc v56,v73,v72,s22
Zf vmcnt(44)
Zc v57,v75,v74,s22
Zf vmcnt(42)
Zc v58,v77,v76,s22
Zf vmcnt(40)
Zc v59,v79,v78,s22
Zc v60,v73,v72,s23
Zc v61,v75,v74,s23
Zc v62,v77,v76,s23
Zc v63,v79,v78,s23
Zd a8,v56
Zd a9,v57
Zd a10,v58
Zd a11,v59
Zd a12,v60
Zd a13,v61
Zd a14,v62
Zd a15,v63
Zb s19,s17,179200
Za v72,v4,s[24:27],s19 offen
Zb s19,s17,180480
Za v73,v4,s[24:27],s19 offen
Zb s19,s17,181760
Za v74,v4,s[24:27],s19 offen
Zb s19,s17,183040
Za v75,v4,s[24:27],s19 offen
Zb s19,s17,184320
Za v76,v5,s[24:27],s19 offen
Zb s19,s17,185600
Za v77,v5,s[24:27],s19 offen
Zb s19,s17,186880
Za v78,v5,s[24:27],s19 offen
Zb s19,s17,188160
Za v79,v5,s[24:27],s19 offen
Zf vmcnt(46)
Zc v56,v81,v80,s22
Zf vmcnt(44)
Zc v57,v83,v82,s22
Zf vmcnt(42)
Zc v58,v85,v84,s22
Zf vmcnt(40)
Zc v59,v87,v86,s22
Zc v60,v81,v80,s23
Zc v61,v83,v82,s23
Zc v62,v85,v84,s23
Zc v63,v87,v86,s23
Zd a16,v56
Zd a17,v57
Zd a18,v58
Zd a19,v59
Zd a20,v60
Zd a21,v61
Zd a22,v62
Zd a23,v63
Zb s19,s17,204800
Za v80,v4,s[24:27],s19 offen
Zb s19,s17,206080
Za v81,v4,s[24:27],s19 offen
Zb s19,s17,207360
Za v82,v4,s[24:27],s19 offen
Zb s19,s17,208640
Za v83,v4,s[24:27],s19 offen
Zb s19,s17,209920
Za v84,v5,s[24:27],s19 offen
Zb s19,s17,211200
Za v85,v5,s[24:27],s19 offen
Zb s19,s17,212480
Za v86,v5,s[24:27],s19 offen
Zb s19,s17,213760
Za v87,v5,s[24:27],s19 offen
Zf vmcnt(46)
Zc v56,v89,v88,s22
Zf vmcnt(44)
Zc v57,v91,v90,s22
Zf vmcnt(42)
Zc v58,v93,v92,s22
Zf vmcnt(40)
Zc v59,v95,v94,s22
Zc v60,v89,v88,s23
Zc v61,v91,v90,s23
Zc v62,v93,v92,s23
Zc v63,v95,v94,s23
Zd a24,v56
Zd a25,v57
Zd a26,v58
Zd a27,v59
Zd a28,v60
Zd a29,v61
Zd a30,v62
Zd a31,v63
Zb s19,s17,230400
Za v88,v4,s[24:27],s19 offen
Zb s19,s17,231680
Za v89,v4,s[24:27],s19 offen
Zb s19,s17,232960
Za v90,v4,s[24:27],s19 offen
Zb s19,s17,234240
Za v91,v4,s[24:27],s19 offen
Zb s19,s17,235520
Za v92,v5,s[24:27],s19 offen
Zb s19,s17,236800
Za v93,v5,s[24:27],s19 offen
Zb s19,s17,238080
Za v94,v5,s[24:27],s19 offen
Zb s19,s17,239360
Za v95,v5,s[24:27],s19 offen
Zf vmcnt(46)
Zc v56,v97,v96,s22
Zf vmcnt(44)
Zc v57,v99,v98,s22
Zf vmcnt(42)
Zc v58,v101,v100,s22
Zf vmcnt(40)
Zc v59,v103,v102,s22
Zc v60,v97,v96,s23
Zc v61,v99,v98,s23
Zc v62,v101,v100,s23
Zc v63,v103,v102,s23
Zd a32,v56
Zd a33,v57
Zd a34,v58
Zd a35,v59
Zd a36,v60
Zd a37,v61
Zd a38,v62
Zd a39,v63
Zb s19,s17,256000
Za v96,v4,s[24:27],s19 offen
Zb s19,s17,257280
Za v97,v4,s[24:27],s19 offen
Zb s19,s17,258560
Za v98,v4,s[24:27],s19 offen
Zb s19,s17,259840
Za v99,v4,s[24:27],s19 offen
Zb s19,s17,261120
Za v100,v5,s[24:27],s19 offen
Zb s19,s17,262400
Za v101,v5,s[24:27],s19 offen
Zb s19,s17,263680
Za v102,v5,s[24:27],s19 offen
Zb s19,s17,264960
Za v103,v5,s[24:27],s19 offen
Zf vmcnt(46)
Zc v56,v105,v104,s22
Zf vmcnt(44)
Zc v57,v107,v106,s22
Zf vmcnt(42)
Zc v58,v109,v108,s22
Zf vmcnt(40)
Zc v59,v111,v110,s22
Zc v60,v105,v104,s23
Zc v61,v107,v106,s23
Zc v62,v109,v108,s23
Zc v63,v111,v110,s23
Zd a40,v56
Zd a41,v57
Zd a42,v58
Zd a43,v59
Zd a44,v60
Zd a45,v61
Zd a46,v62
Zd a47,v63
Zb s19,s17,281600
Za v104,v4,s[24:27],s19 offen
Zb s19,s17,282880
Za v105,v4,s[24:27],s19 offen
Zb s19,s17,284160
Za v106,v4,s[24:27],s19 offen
Zb s19,s17,285440
Za v107,v4,s[24:27],s19 offen
Zb s19,s17,286720
Za v108,v5,s[24:27],s19 offen
Zb s19,s17,288000
Za v109,v5,s[24:27],s19 offen
Zb s19,s17,289280
Za v110,v5,s[24:27],s19 offen
Zb s19,s17,290560
Za v111,v5,s[24:27],s19 offen
Zf vmcnt(46)
Zc v56,v65,v64,s22
Zf vmcnt(44)
Zc v57,v67,v66,s22
Zf vmcnt(42)
Zc v58,v69,v68,s22
Zf vmcnt(40)
Zc v59,v71,v70,s22
Zc v60,v65,v64,s23
Zc v61,v67,v66,s23
Zc v62,v69,v68,s23
Zc v63,v71,v70,s23
Zd a48,v56
Zd a49,v57
Zd a50,v58
Zd a51,v59
Zd a52,v60
Zd a53,v61
Zd a54,v62
Zd a55,v63
Zb s19,s17,307200
Za v64,v4,s[24:27],s19 offen
Zb s19,s17,308480
Za v65,v4,s[24:27],s19 offen
Zb s19,s17,309760
Za v66,v4,s[24:27],s19 offen
Zb s19,s17,311040
Za v67,v4,s[24:27],s19 offen
Zb s19,s17,312320
Za v68,v5,s[24:27],s19 offen
Zb s19,s17,313600
Za v69,v5,s[24:27],s19 offen
Zb s19,s17,314880
Za v70,v5,s[24:27],s19 offen
Zb s19,s17,316160
Za v71,v5,s[24:27],s19 offen
Zf vmcnt(46)
Zc v56,v73,v72,s22
Zf vmcnt(44)
Zc v57,v75,v74,s22
Zf vmcnt(42)
Zc v58,v77,v76,s22
Zf vmcnt(40)
Zc v59,v79,v78,s22
Zc v60,v73,v72,s23
Zc v61,v75,v74,s23
Zc v62,v77,v76,s23
Zc v63,v79,v78,s23
Zd a56,v56
Zd a57,v57
Zd a58,v58
Zd a59,v59
Zd a60,v60
Zd a61,v61
Zd a62,v62
Zd a63,v63
Zb s19,s17,332800
Za v72,v4,s[24:27],s19 offen
Zb s19,s17,334080
Za v73,v4,s[24:27],s19 offen
Zb s19,s17,335360
Za v74,v4,s[24:27],s19 offen
Zb s19,s17,336640
Za v75,v4,s[24:27],s19 offen
Zb s19,s17,337920
Za v76,v5,s[24:27],s19 offen
Zb s19,s17,339200
Za v77,v5,s[24:27],s19 offen
Zb s19,s17,340480
Za v78,v5,s[24:27],s19 offen
Zb s19,s17,341760
Za v79,v5,s[24:27],s19 offen
Zf vmcnt(46)
Zc v56,v81,v80,s22
Zf vmcnt(44)
Zc v57,v83,v82,s22
Zf vmcnt(42)
Zc v58,v85,v84,s22
Zf vmcnt(40)
Zc v59,v87,v86,s22
Zc v60,v81,v80,s23
Zc v61,v83,v82,s23
Zc v62,v85,v84,s23
Zc v63,v87,v86,s23
Zd a64,v56
Zd a65,v57
Zd a66,v58
Zd a67,v59
Zd a68,v60
Zd a69,v61
Zd a70,v62
Zd a71,v63
Zb s19,s17,358400
Za v80,v4,s[24:27],s19 offen
Zb s19,s17,359680
Za v81,v4,s[24:27],s19 offen
Zb s19,s17,360960
Za v82,v4,s[24:27],s19 offen
Zb s19,s17,362240
Za v83,v4,s[24:27],s19 offen
Zb s19,s17,363520
Za v84,v5,s[24:27],s19 offen
Zb s19,s17,364800
Za v85,v5,s[24:27],s19 offen
Zb s19,s17,366080
Za v86,v5,s[24:27],s19 offen
Zb s19,s17,367360
Za v87,v5,s[24:27],s19 offen
Zf vmcnt(46)
Zc v56,v89,v88,s22
Zf vmcnt(44)
Zc v57,v91,v90,s22
Zf vmcnt(42)
Zc v58,v93,v92,s22
Zf vmcnt(40)
Zc v59,v95,v94,s22
Zc v60,v89,v88,s23
Zc v61,v91,v90,s23
Zc v62,v93,v92,s23
Zc v63,v95,v94,s23
Zd a72,v56
Zd a73,v57
Zd a74,v58
Zd a75,v59
Zd a76,v60
Zd a77,v61
Zd a78,v62
Zd a79,v63
Zb s19,s17,384000
Za v88,v4,s[24:27],s19 offen
Zb s19,s17,385280
Za v89,v4,s[24:27],s19 offen
Zb s19,s17,386560
Za v90,v4,s[24:27],s19 offen
Zb s19,s17,387840
Za v91,v4,s[24:27],s19 offen
Zb s19,s17,389120
Za v92,v5,s[24:27],s19 offen
Zb s19,s17,390400
Za v93,v5,s[24:27],s19 offen
Zb s19,s17,391680
Za v94,v5,s[24:27],s19 offen
Zb s19,s17,392960
Za v95,v5,s[24:27],s19 offen
Zf vmcnt(46)
Zc v56,v97,v96,s22
Zf vmcnt(44)
Zc v57,v99,v98,s22
Zf vmcnt(42)
Zc v58,v101,v100,s22
Zf vmcnt(40)
Zc v59,v103,v102,s22
Zc v60,v97,v96,s23
Zc v61,v99,v98,s23
Zc v62,v101,v100,s23
Zc v63,v103,v102,s23
Zd a80,v56
Zd a81,v57
Zd a82,v58
Zd a83,v59
Zd a84,v60
Zd a85,v61
Zd a86,v62
Zd a87,v63
Zb s19,s17,409600
Za v96,v4,s[24:27],s19 offen
Zb s19,s17,410880
Za v97,v4,s[24:27],s19 offen
Zb s19,s17,412160
Za v98,v4,s[24:27],s19 offen
Zb s19,s17,413440
Za v99,v4,s[24:27],s19 offen
Zb s19,s17,414720
Za v100,v5,s[24:27],s19 offen
Zb s19,s17,416000
Za v101,v5,s[24:27],s19 offen
Zb s19,s17,417280
Za v102,v5,s[24:27],s19 offen
Zb s19,s17,418560
Za v103,v5,s[24:27],s19 offen
Zf vmcnt(46)
Zc v56,v105,v104,s22
Zf vmcnt(44)
Zc v57,v107,v106,s22
Zf vmcnt(42)
Zc v58,v109,v108,s22
Zf vmcnt(40)
Zc v59,v111,v110,s22
Zc v60,v105,v104,s23
Zc v61,v107,v106,s23
Zc v62,v109,v108,s23
Zc v63,v111,v110,s23
Zd a88,v56
Zd a89,v57
Zd a90,v58
Zd a91,v59
Zd a92,v60
Zd a93,v61
Zd a94,v62
Zd a95,v63
Zb s19,s17,435200
Za v104,v4,s[24:27],s19 offen
Zb s19,s17,436480
Za v105,v4,s[24:27],s19 offen
Zb s19,s17,437760
Za v106,v4,s[24:27],s19 offen
Zb s19,s17,439040
Za v107,v4,s[24:27],s19 offen
Zb s19,s17,440320
Za v108,v5,s[24:27],s19 offen
Zb s19,s17,441600
Za v109,v5,s[24:27],s19 offen
Zb s19,s17,442880
Za v110,v5,s[24:27],s19 offen
Zb s19,s17,444160
Za v111,v5,s[24:27],s19 offen
Zf vmcnt(46)
Zc v56,v65,v64,s22
Zf vmcnt(44)
Zc v57,v67,v66,s22
Zf vmcnt(42)
Zc v58,v69,v68,s22
Zf vmcnt(40)
Zc v59,v71,v70,s22
Zc v60,v65,v64,s23
Zc v61,v67,v66,s23
Zc v62,v69,v68,s23
Zc v63,v71,v70,s23
Zd a96,v56
Zd a97,v57
Zd a98,v58
Zd a99,v59
Zd a100,v60
Zd a101,v61
Zd a102,v62
Zd a103,v63
Zb s19,s17,460800
Za v64,v4,s[24:27],s19 offen
Zb s19,s17,462080
Za v65,v4,s[24:27],s19 offen
Zb s19,s17,463360
Za v66,v4,s[24:27],s19 offen
Zb s19,s17,464640
Za v67,v4,s[24:27],s19 offen
Zb s19,s17,465920
Za v68,v5,s[24:27],s19 offen
Zb s19,s17,467200
Za v69,v5,s[24:27],s19 offen
Zb s19,s17,468480
Za v70,v5,s[24:27],s19 offen
Zb s19,s17,469760
Za v71,v5,s[24:27],s19 offen
Zf vmcnt(46)
Zc v56,v73,v72,s22
Zf vmcnt(44)
Zc v57,v75,v74,s22
Zf vmcnt(42)
Zc v58,v77,v76,s22
Zf vmcnt(40)
Zc v59,v79,v78,s22
Zc v60,v73,v72,s23
Zc v61,v75,v74,s23
Zc v62,v77,v76,s23
Zc v63,v79,v78,s23
Zd a104,v56
Zd a105,v57
Zd a106,v58
Zd a107,v59
Zd a108,v60
Zd a109,v61
Zd a110,v62
Zd a111,v63
Zb s19,s17,486400
Za v72,v4,s[24:27],s19 offen
Zb s19,s17,487680
Za v73,v4,s[24:27],s19 offen
Zb s19,s17,488960
Za v74,v4,s[24:27],s19 offen
Zb s19,s17,490240
Za v75,v4,s[24:27],s19 offen
Zb s19,s17,491520
Za v76,v5,s[24:27],s19 offen
Zb s19,s17,492800
Za v77,v5,s[24:27],s19 offen
Zb s19,s17,494080
Za v78,v5,s[24:27],s19 offen
Zb s19,s17,495360
Za v79,v5,s[24:27],s19 offen
Zf vmcnt(46)
Zc v56,v81,v80,s22
Zf vmcnt(44)
Zc v57,v83,v82,s22
Zf vmcnt(42)
Zc v58,v85,v84,s22
Zf vmcnt(40)
Zc v59,v87,v86,s22
Zc v60,v81,v80,s23
Zc v61,v83,v82,s23
Zc v62,v85,v84,s23
Zc v63,v87,v86,s23
Zd a112,v56
Zd a113,v57
Zd a114,v58
Zd a115,v59
Zd a116,v60
Zd a117,v61
Zd a118,v62
Zd a119,v63
Zb s19,s17,512000
Za v80,v4,s[24:27],s19 offen
Zb s19,s17,513280
Za v81,v4,s[24:27],s19 offen
Zb s19,s17,514560
Za v82,v4,s[24:27],s19 offen
Zb s19,s17,515840
Za v83,v4,s[24:27],s19 offen
Zb s19,s17,517120
Za v84,v5,s[24:27],s19 offen
Zb s19,s17,518400
Za v85,v5,s[24:27],s19 offen
Zb s19,s17,519680
Za v86,v5,s[24:27],s19 offen
Zb s19,s17,520960
Za v87,v5,s[24:27],s19 offen
Zf vmcnt(46)
Zc v56,v89,v88,s22
Zf vmcnt(44)
Zc v57,v91,v90,s22
Zf vmcnt(42)
Zc v58,v93,v92,s22
Zf vmcnt(40)
Zc v59,v95,v94,s22
Zc v60,v89,v88,s23
Zc v61,v91,v90,s23
Zc v62,v93,v92,s23
Zc v63,v95,v94,s23
Zd a120,v56
Zd a121,v57
Zd a122,v58
Zd a123,v59
Zd a124,v60
Zd a125,v61
Zd a126,v62
Zd a127,v63
Zb s19,s17,537600
Za v88,v4,s[24:27],s19 offen
Zb s19,s17,538880
Za v89,v4,s[24:27],s19 offen
Zb s19,s17,540160
Za v90,v4,s[24:27],s19 offen
Zb s19,s17,541440
Za v91,v4,s[24:27],s19 offen
Zb s19,s17,542720
Za v92,v5,s[24:27],s19 offen
Zb s19,s17,544000
Za v93,v5,s[24:27],s19 offen
Zb s19,s17,545280
Za v94,v5,s[24:27],s19 offen
Zb s19,s17,546560
Za v95,v5,s[24:27],s19 offen
Zf vmcnt(46)
Zc v56,v97,v96,s22
Zf vmcnt(44)
Zc v57,v99,v98,s22
Zf vmcnt(42)
Zc v58,v101,v100,s22
Zf vmcnt(40)
Zc v59,v103,v102,s22
Zc v60,v97,v96,s23
Zc v61,v99,v98,s23
Zc v62,v101,v100,s23
Zc v63,v103,v102,s23
Zd a128,v56
Zd a129,v57
Zd a130,v58
Zd a131,v59
Zd a132,v60
Zd a133,v61
Zd a134,v62
Zd a135,v63
Zb s19,s17,563200
Za v96,v4,s[24:27],s19 offen
Zb s19,s17,564480
Za v97,v4,s[24:27],s19 offen
Zb s19,s17,565760
Za v98,v4,s[24:27],s19 offen
Zb s19,s17,567040
Za v99,v4,s[24:27],s19 offen
Zb s19,s17,568320
Za v100,v5,s[24:27],s19 offen
Zb s19,s17,569600
Za v101,v5,s[24:27],s19 offen
Zb s19,s17,570880
Za v102,v5,s[24:27],s19 offen
Zb s19,s17,572160
Za v103,v5,s[24:27],s19 offen
Zf vmcnt(46)
Zc v56,v105,v104,s22
Zf vmcnt(44)
Zc v57,v107,v106,s22
Zf vmcnt(42)
Zc v58,v109,v108,s22
Zf vmcnt(40)
Zc v59,v111,v110,s22
Zc v60,v105,v104,s23
Zc v61,v107,v106,s23
Zc v62,v109,v108,s23
Zc v63,v111,v110,s23
Zd a136,v56
Zd a137,v57
Zd a138,v58
Zd a139,v59
Zd a140,v60
Zd a141,v61
Zd a142,v62
Zd a143,v63
Zb s19,s17,588800
Za v104,v4,s[24:27],s19 offen
Zb s19,s17,590080
Za v105,v4,s[24:27],s19 offen
Zb s19,s17,591360
Za v106,v4,s[24:27],s19 offen
Zb s19,s17,592640
Za v107,v4,s[24:27],s19 offen
Zb s19,s17,593920
Za v108,v5,s[24:27],s19 offen
Zb s19,s17,595200
Za v109,v5,s[24:27],s19 offen
Zb s19,s17,596480
Za v110,v5,s[24:27],s19 offen
Zb s19,s17,597760
Za v111,v5,s[24:27],s19 offen
Zf vmcnt(46)
Zc v56,v65,v64,s22
Zf vmcnt(44)
Zc v57,v67,v66,s22
Zf vmcnt(42)
Zc v58,v69,v68,s22
Zf vmcnt(40)
Zc v59,v71,v70,s22
Zc v60,v65,v64,s23
Zc v61,v67,v66,s23
Zc v62,v69,v68,s23
Zc v63,v71,v70,s23
Zd a144,v56
Zd a145,v57
Zd a146,v58
Zd a147,v59
Zd a148,v60
Zd a149,v61
Zd a150,v62
Zd a151,v63
Zb s19,s17,614400
Za v64,v4,s[24:27],s19 offen
Zb s19,s17,615680
Za v65,v4,s[24:27],s19 offen
Zb s19,s17,616960
Za v66,v4,s[24:27],s19 offen
Zb s19,s17,618240
Za v67,v4,s[24:27],s19 offen
Zb s19,s17,619520
Za v68,v5,s[24:27],s19 offen
Zb s19,s17,620800
Za v69,v5,s[24:27],s19 offen
Zb s19,s17,622080
Za v70,v5,s[24:27],s19 offen
Zb s19,s17,623360
Za v71,v5,s[24:27],s19 offen
Zf vmcnt(46)
Zc v56,v73,v72,s22
Zf vmcnt(44)
Zc v57,v75,v74,s22
Zf vmcnt(42)
Zc v58,v77,v76,s22
Zf vmcnt(40)
Zc v59,v79,v78,s22
Zc v60,v73,v72,s23
Zc v61,v75,v74,s23
Zc v62,v77,v76,s23
Zc v63,v79,v78,s23
Zd a152,v56
Zd a153,v57
Zd a154,v58
Zd a155,v59
Zd a156,v60
Zd a157,v61
Zd a158,v62
Zd a159,v63
Zb s19,s17,640000
Za v72,v4,s[24:27],s19 offen
Zb s19,s17,641280
Za v73,v4,s[24:27],s19 offen
Zb s19,s17,642560
Za v74,v4,s[24:27],s19 offen
Zb s19,s17,643840
Za v75,v4,s[24:27],s19 offen
Zb s19,s17,645120
Za v76,v5,s[24:27],s19 offen
Zb s19,s17,646400
Za v77,v5,s[24:27],s19 offen
Zb s19,s17,647680
Za v78,v5,s[24:27],s19 offen
Zb s19,s17,648960
Za v79,v5,s[24:27],s19 offen
Zf vmcnt(46)
Zc v56,v81,v80,s22
Zf vmcnt(44)
Zc v57,v83,v82,s22
Zf vmcnt(42)
Zc v58,v85,v84,s22
Zf vmcnt(40)
Zc v59,v87,v86,s22
Zc v60,v81,v80,s23
Zc v61,v83,v82,s23
Zc v62,v85,v84,s23
Zc v63,v87,v86,s23
Zd a160,v56
Zd a161,v57
Zd a162,v58
Zd a163,v59
Zd a164,v60
Zd a165,v61
Zd a166,v62
Zd a167,v63
Zb s19,s17,665600
Za v80,v4,s[24:27],s19 offen
Zb s19,s17,666880
Za v81,v4,s[24:27],s19 offen
Zb s19,s17,668160
Za v82,v4,s[24:27],s19 offen
Zb s19,s17,669440
Za v83,v4,s[24:27],s19 offen
Zb s19,s17,670720
Za v84,v5,s[24:27],s19 offen
Zb s19,s17,672000
Za v85,v5,s[24:27],s19 offen
Zb s19,s17,673280
Za v86,v5,s[24:27],s19 offen
Zb s19,s17,674560
Za v87,v5,s[24:27],s19 offen
Zf vmcnt(46)
Zc v56,v89,v88,s22
Zf vmcnt(44)
Zc v57,v91,v90,s22
Zf vmcnt(42)
Zc v58,v93,v92,s22
Zf vmcnt(40)
Zc v59,v95,v94,s22
Zc v60,v89,v88,s23
Zc v61,v91,v90,s23
Zc v62,v93,v92,s23
Zc v63,v95,v94,s23
Zd a168,v56
Zd a169,v57
Zd a170,v58
Zd a171,v59
Zd a172,v60
Zd a173,v61
Zd a174,v62
Zd a175,v63
Zb s19,s17,691200
Za v88,v4,s[24:27],s19 offen
Zb s19,s17,692480
Za v89,v4,s[24:27],s19 offen
Zb s19,s17,693760
Za v90,v4,s[24:27],s19 offen
Zb s19,s17,695040
Za v91,v4,s[24:27],s19 offen
Zb s19,s17,696320
Za v92,v5,s[24:27],s19 offen
Zb s19,s17,697600
Za v93,v5,s[24:27],s19 offen
Zb s19,s17,698880
Za v94,v5,s[24:27],s19 offen
Zb s19,s17,700160
Za v95,v5,s[24:27],s19 offen
Zf vmcnt(46)
Zc v56,v97,v96,s22
Zf vmcnt(44)
Zc v57,v99,v98,s22
Zf vmcnt(42)
Zc v58,v101,v100,s22
Zf vmcnt(40)
Zc v59,v103,v102,s22
Zc v60,v97,v96,s23
Zc v61,v99,v98,s23
Zc v62,v101,v100,s23
Zc v63,v103,v102,s23
Zd a176,v56
Zd a177,v57
Zd a178,v58
Zd a179,v59
Zd a180,v60
Zd a181,v61
Zd a182,v62
Zd a183,v63
Zb s19,s17,716800
Za v96,v4,s[24:27],s19 offen
Zb s19,s17,718080
Za v97,v4,s[24:27],s19 offen
Zb s19,s17,719360
Za v98,v4,s[24:27],s19 offen
Zb s19,s17,720640
Za v99,v4,s[24:27],s19 offen
Zb s19,s17,721920
Za v100,v5,s[24:27],s19 offen
Zb s19,s17,723200
Za v101,v5,s[24:27],s19 offen
Zb s19,s17,724480
Za v102,v5,s[24:27],s19 offen
Zb s19,s17,725760
Za v103,v5,s[24:27],s19 offen
Zf vmcnt(46)
Zc v56,v105,v104,s22
Zf vmcnt(44)
Zc v57,v107,v106,s22
Zf vmcnt(42)
Zc v58,v109,v108,s22
Zf vmcnt(40)
Zc v59,v111,v110,s22
Zc v60,v105,v104,s23
Zc v61,v107,v106,s23
Zc v62,v109,v108,s23
Zc v63,v111,v110,s23
Zd a184,v56
Zd a185,v57
Zd a186,v58
Zd a187,v59
Zd a188,v60
Zd a189,v61
Zd a190,v62
Zd a191,v63
Zb s19,s17,742400
Za v104,v4,s[24:27],s19 offen
Zb s19,s17,743680
Za v105,v4,s[24:27],s19 offen
Zb s19,s17,744960
Za v106,v4,s[24:27],s19 offen
Zb s19,s17,746240
Za v107,v4,s[24:27],s19 offen
Zb s19,s17,747520
Za v108,v5,s[24:27],s19 offen
Zb s19,s17,748800
Za v109,v5,s[24:27],s19 offen
Zb s19,s17,750080
Za v110,v5,s[24:27],s19 offen
Zb s19,s17,751360
Za v111,v5,s[24:27],s19 offen
Zf vmcnt(46)
Zc v56,v65,v64,s22
Zf vmcnt(44)
Zc v57,v67,v66,s22
Zf vmcnt(42)
Zc v58,v69,v68,s22
Zf vmcnt(40)
Zc v59,v71,v70,s22
Zc v60,v65,v64,s23
Zc v61,v67,v66,s23
Zc v62,v69,v68,s23
Zc v63,v71,v70,s23
Zd a192,v56
Zd a193,v57
Zd a194,v58
Zd a195,v59
Zd a196,v60
Zd a197,v61
Zd a198,v62
Zd a199,v63
Zb s19,s17,768000
Za v64,v4,s[24:27],s19 offen
Zb s19,s17,769280
Za v65,v4,s[24:27],s19 offen
Zb s19,s17,770560
Za v66,v4,s[24:27],s19 offen
Zb s19,s17,771840
Za v67,v4,s[24:27],s19 offen
Zb s19,s17,773120
Za v68,v5,s[24:27],s19 offen
Zb s19,s17,774400
Za v69,v5,s[24:27],s19 offen
Zb s19,s17,775680
Za v70,v5,s[24:27],s19 offen
Zb s19,s17,776960
Za v71,v5,s[24:27],s19 offen
Zf vmcnt(46)
Zc v56,v73,v72,s22
Zf vmcnt(44)
Zc v57,v75,v74,s22
Zf vmcnt(42)
Zc v58,v77,v76,s22
Zf vmcnt(40)
Zc v59,v79,v78,s22
Zc v60,v73,v72,s23
Zc v61,v75,v74,s23
Zc v62,v77,v76,s23
Zc v63,v79,v78,s23
Zd a200,v56
Zd a201,v57
Zd a202,v58
Zd a203,v59
Zd a204,v60
Zd a205,v61
Zd a206,v62
Zd a207,v63
Zb s19,s17,793600
Za v72,v4,s[24:27],s19 offen
Zb s19,s17,794880
Za v73,v4,s[24:27],s19 offen
Zb s19,s17,796160
Za v74,v4,s[24:27],s19 offen
Zb s19,s17,797440
Za v75,v4,s[24:27],s19 offen
Zb s19,s17,798720
Za v76,v5,s[24:27],s19 offen
Zb s19,s17,800000
Za v77,v5,s[24:27],s19 offen
Zb s19,s17,801280
Za v78,v5,s[24:27],s19 offen
Zb s19,s17,802560
Za v79,v5,s[24:27],s19 offen
Zf vmcnt(46)
Zc v56,v81,v80,s22
Zf vmcnt(44)
Zc v57,v83,v82,s22
Zf vmcnt(42)
Zc v58,v85,v84,s22
Zf vmcnt(40)
Zc v59,v87,v86,s22
Zc v60,v81,v80,s23
Zc v61,v83,v82,s23
Zc v62,v85,v84,s23
Zc v63,v87,v86,s23
Zd a208,v56
Zd a209,v57
Zd a210,v58
Zd a211,v59
Zd a212,v60
Zd a213,v61
Zd a214,v62
Zd a215,v63
Zf vmcnt(38)
Zc v56,v89,v88,s22
Zf vmcnt(36)
Zc v57,v91,v90,s22
Zf vmcnt(34)
Zc v58,v93,v92,s22
Zf vmcnt(32)
Zc v59,v95,v94,s22
Zc v60,v89,v88,s23
Zc v61,v91,v90,s23
Zc v62,v93,v92,s23
Zc v63,v95,v94,s23
Zd a216,v56
Zd a217,v57
Zd a218,v58
Zd a219,v59
Zd a220,v60
Zd a221,v61
Zd a222,v62
Zd a223,v63
Zf vmcnt(30)
Zc v56,v97,v96,s22
Zf vmcnt(28)
Zc v57,v99,v98,s22
Zf vmcnt(26)
Zc v58,v101,v100,s22
Zf vmcnt(24)
Zc v59,v103,v102,s22
Zc v60,v97,v96,s23
Zc v61,v99,v98,s23
Zc v62,v101,v100,s23
Zc v63,v103,v102,s23
Zd a224,v56
Zd a225,v57
Zd a226,v58
Zd a227,v59
Zd a228,v60
Zd a229,v61
Zd a230,v62
Zd a231,v63
Zf vmcnt(22)
Zc v56,v105,v104,s22
Zf vmcnt(20)
Zc v57,v107,v106,s22
Zf vmcnt(18)
Zc v58,v109,v108,s22
Zf vmcnt(16)
Zc v59,v111,v110,s22
Zc v60,v105,v104,s23
Zc v61,v107,v106,s23
Zc v62,v109,v108,s23
Zc v63,v111,v110,s23
Zd a232,v56
Zd a233,v57
Zd a234,v58
Zd a235,v59
Zd a236,v60
Zd a237,v61
Zd a238,v62
Zd a239,v63
Zf vmcnt(14)
Zc v56,v65,v64,s22
Zf vmcnt(12)
Zc v57,v67,v66,s22
Zf vmcnt(10)
Zc v58,v69,v68,s22
Zf vmcnt(8)
Zc v59,v71,v70,s22
Zc v60,v65,v64,s23
Zc v61,v67,v66,s23
Zc v62,v69,v68,s23
Zc v63,v71,v70,s23
Zd a240,v56
Zd a241,v57
Zd a242,v58
Zd a243,v59
Zd a244,v60
Zd a245,v61
Zd a246,v62
Zd a247,v63
Zf vmcnt(6)
Zc v56,v73,v72,s22
Zf vmcnt(4)
Zc v57,v75,v74,s22
Zf vmcnt(2)
Zc v58,v77,v76,s22
Zf vmcnt(0)
Zc v59,v79,v78,s22
Zc v60,v73,v72,s23
Zc v61,v75,v74,s23
Zc v62,v77,v76,s23
Zc v63,v79,v78,s23
Zd a248,v56
Zd a249,v57
Zd a250,v58
Zd a251,v59
Zd a252,v60
Zd a253,v61
Zd a254,v62
Zd a255,v63
v_mul_u32_u24 v10, 2560, v1
v_lshl_add_u32 v10, v2, 4, v10
Zq s29,s31,9
Zq s19,s9,7
Zb s29,s29,s19
s_mul_i32 s19, s30, 81920
Zb s29,s29,s19
Zb s29,s29,201326592
Zq s13,s8,2
Zb s13,s13,9216
Zq s14,s30,16
Zq s12,s30,5
Zb s12,s12,9728
v_lshrrev_b32 v3, 2, v0
v_min_u32 v3, 124, v3
Zs v5,v0
Zp s10,s39
s_mul_i32 s35, s31, 3072
s_and_b32 s35, s35, 0x1fff
Zq s11,s9,13
Zp s15,0
Zp s33,0
Zp s32,131072
v_lshrrev_b32 v11, 2, v0
v_add_u32 v11, 131072, v11
Zb s14,s14,s11
Zp s38,0
Zf vmcnt(0) lgkmcnt(0)
AO_L:
s_cmp_lg_u32 s15, 0
Zk AO_H
Zb s16,s10,1
s_and_b32 s21, s10, 1
Zq s21,s21,7
Zb s21,s21,8960
s_lshr_b32 s41, s10, 1
Zo s41,32
s_cselect_b32 s43, 124, 0
Zp s41,0
Zp s42,8704
s_cmp_ge_u32 s41, s43
Zk ND_93
NP_92:
Za v9,off,s[4:7],s42 sc1
Zf vmcnt(0)
v_readfirstlane_b32 s41, v9
s_cmp_ge_u32 s41, s43
Zk ND_93
s_sleep 32
s_sub_u32 s20, s20, 1
s_cmp_gt_i32 s20, 0
Zk NP_92
ND_93:
WF_90:
Za v9,v3,s[4:7],s21 offen sc1
Zf vmcnt(0)
v_cmp_gt_u32 vcc, s16, v9
s_cbranch_vccz WD_91
s_sleep 3
s_sub_u32 s20, s20, 1
s_cmp_gt_i32 s20, 0
Zk WF_90
WD_91:
s_mul_i32 s36, s10, 65536
Zb s36,s36,6291456
Zb s36,s36,s14
Zb s16,s10,2
s_and_b32 s21, s16, 1
Zq s21,s21,7
Zb s21,s21,8960
Zb m0,s11,s35
Zb s37,s36,s35
Zh v0,s[4:7],s37 offen sc1 lds
Zb s35,s35,1024
s_and_b32 s35, s35, 0x1fff
Zb m0,s11,s35
Zb s37,s36,s35
Zh v0,s[4:7],s37 offen sc1 lds
Zb s35,s35,1024
s_and_b32 s35, s35, 0x1fff
Zb m0,s11,s35
Zb s37,s36,s35
Zh v0,s[4:7],s37 offen sc1 lds
Zb s35,s35,1024
s_and_b32 s35, s35, 0x1fff
Zb m0,s11,s35
Zb s37,s36,s35
Zh v0,s[4:7],s37 offen sc1 lds
Zb s35,s35,1024
s_and_b32 s35, s35, 0x1fff
Zb m0,s11,s35
Zb s37,s36,s35
Zh v0,s[4:7],s37 offen sc1 lds
Zb s35,s35,1024
s_and_b32 s35, s35, 0x1fff
Zb m0,s11,s35
Zb s37,s36,s35
Zh v0,s[4:7],s37 offen sc1 lds
Zb s35,s35,1024
s_and_b32 s35, s35, 0x1fff
Zb m0,s11,s35
Zb s37,s36,s35
Zh v0,s[4:7],s37 offen sc1 lds
Zb s35,s35,1024
s_and_b32 s35, s35, 0x1fff
Zb m0,s11,s35
Zb s37,s36,s35
Zh v0,s[4:7],s37 offen sc1 lds
Zb s35,s35,1024
s_and_b32 s35, s35, 0x1fff
Zp m0,s32
s_nop 0
Za v3,s[4:7],s21 offen sc1 lds
s_or_b32 s34, s35, 0x8000
Zb m0,s11,s34
Zb s37,s36,s34
Zh v0,s[4:7],s37 offen sc1 lds
Zb s35,s35,1024
s_and_b32 s35, s35, 0x1fff
s_or_b32 s34, s35, 0x8000
Zb m0,s11,s34
Zb s37,s36,s34
Zh v0,s[4:7],s37 offen sc1 lds
Zb s35,s35,1024
s_and_b32 s35, s35, 0x1fff
s_or_b32 s34, s35, 0x8000
Zb m0,s11,s34
Zb s37,s36,s34
Zh v0,s[4:7],s37 offen sc1 lds
Zb s35,s35,1024
s_and_b32 s35, s35, 0x1fff
s_or_b32 s34, s35, 0x8000
Zb m0,s11,s34
Zb s37,s36,s34
Zh v0,s[4:7],s37 offen sc1 lds
Zb s35,s35,1024
s_and_b32 s35, s35, 0x1fff
s_or_b32 s34, s35, 0x8000
Zb m0,s11,s34
Zb s37,s36,s34
Zh v0,s[4:7],s37 offen sc1 lds
Zb s35,s35,1024
s_and_b32 s35, s35, 0x1fff
s_or_b32 s34, s35, 0x8000
Zb m0,s11,s34
Zb s37,s36,s34
Zh v0,s[4:7],s37 offen sc1 lds
Zb s35,s35,1024
s_and_b32 s35, s35, 0x1fff
s_or_b32 s34, s35, 0x8000
Zb m0,s11,s34
Zb s37,s36,s34
Zh v0,s[4:7],s37 offen sc1 lds
Zb s35,s35,1024
s_and_b32 s35, s35, 0x1fff
s_or_b32 s34, s35, 0x8000
Zb m0,s11,s34
Zb s37,s36,s34
Zh v0,s[4:7],s37 offen sc1 lds
Zb s35,s35,1024
s_and_b32 s35, s35, 0x1fff
s_xor_b32 s11, s11, 0x10000
s_xor_b32 s32, s32, 256
Zp s38,1
Zf vmcnt(8)
s_branch AO_I
AO_H:
Zf vmcnt(4)
AO_I:
s_barrier
ds_read_b32 v9, v11
Zb s28,s10,2
Zb s16,s28,1
Zf lgkmcnt(0)
v_cmp_gt_u32 vcc, s16, v9
s_cmp_eq_u64 vcc, 0
s_cselect_b32 s15, 1, 0
s_mul_i32 s36, s28, 65536
Zb s36,s36,6291456
Zb s36,s36,s14
Zb s16,s28,2
s_and_b32 s21, s16, 1
Zq s21,s21,7
Zb s21,s21,8960
Zi v[32:35],v5 offset:0
Zi v[36:39],v5 offset:1024
Zi v[40:43],v5 offset:2048
Zi v[44:47],v5 offset:3072
Zi v[48:51],v5 offset:4096
Zi v[52:55],v5 offset:5120
Zf lgkmcnt(5)
Ze v[16:19],a[0:3],v[32:35],0
Ze v[20:23],a[4:7],v[32:35],0
Zi v[32:35],v5 offset:6144
Zo s15,0
Zk ST_94
Zb m0,s11,s35
Zb s37,s36,s35
Zh v0,s[4:7],s37 offen sc1 lds
Zb s35,s35,1024
s_and_b32 s35, s35, 0x1fff
ST_94:
Zf lgkmcnt(5)
Ze v[24:27],a[0:3],v[36:39],0
Ze v[28:31],a[4:7],v[36:39],0
Zi v[36:39],v5 offset:7168
Zf lgkmcnt(5)
Ze v[16:19],a[8:11],v[40:43],v[16:19]
Ze v[20:23],a[12:15],v[40:43],v[20:23]
Zi v[40:43],v5 offset:8192
Zf lgkmcnt(5)
Ze v[24:27],a[8:11],v[44:47],v[24:27]
Ze v[28:31],a[12:15],v[44:47],v[28:31]
Zi v[44:47],v5 offset:9216
Zo s15,0
Zk ST_95
Zb m0,s11,s35
Zb s37,s36,s35
Zh v0,s[4:7],s37 offen sc1 lds
Zb s35,s35,1024
s_and_b32 s35, s35, 0x1fff
ST_95:
Zf lgkmcnt(5)
Ze v[16:19],a[16:19],v[48:51],v[16:19]
Ze v[20:23],a[20:23],v[48:51],v[20:23]
Zi v[48:51],v5 offset:10240
Zf lgkmcnt(5)
Ze v[24:27],a[16:19],v[52:55],v[24:27]
Ze v[28:31],a[20:23],v[52:55],v[28:31]
Zi v[52:55],v5 offset:11264
Zf lgkmcnt(5)
Ze v[16:19],a[24:27],v[32:35],v[16:19]
Ze v[20:23],a[28:31],v[32:35],v[20:23]
Zi v[32:35],v5 offset:12288
Zo s15,0
Zk ST_96
Zb m0,s11,s35
Zb s37,s36,s35
Zh v0,s[4:7],s37 offen sc1 lds
Zb s35,s35,1024
s_and_b32 s35, s35, 0x1fff
ST_96:
Zf lgkmcnt(5)
Ze v[24:27],a[24:27],v[36:39],v[24:27]
Ze v[28:31],a[28:31],v[36:39],v[28:31]
Zi v[36:39],v5 offset:13312
Zf lgkmcnt(5)
Ze v[16:19],a[32:35],v[40:43],v[16:19]
Ze v[20:23],a[36:39],v[40:43],v[20:23]
Zi v[40:43],v5 offset:14336
Zf lgkmcnt(5)
Ze v[24:27],a[32:35],v[44:47],v[24:27]
Ze v[28:31],a[36:39],v[44:47],v[28:31]
Zi v[44:47],v5 offset:15360
Zo s15,0
Zk ST_97
Zb m0,s11,s35
Zb s37,s36,s35
Zh v0,s[4:7],s37 offen sc1 lds
Zb s35,s35,1024
s_and_b32 s35, s35, 0x1fff
ST_97:
Zf lgkmcnt(5)
Ze v[16:19],a[40:43],v[48:51],v[16:19]
Ze v[20:23],a[44:47],v[48:51],v[20:23]
Zi v[48:51],v5 offset:16384
Zf lgkmcnt(5)
Ze v[24:27],a[40:43],v[52:55],v[24:27]
Ze v[28:31],a[44:47],v[52:55],v[28:31]
Zi v[52:55],v5 offset:17408
Zf lgkmcnt(5)
Ze v[16:19],a[48:51],v[32:35],v[16:19]
Ze v[20:23],a[52:55],v[32:35],v[20:23]
Zi v[32:35],v5 offset:18432
Zo s15,0
Zk ST_98
Zb m0,s11,s35
Zb s37,s36,s35
Zh v0,s[4:7],s37 offen sc1 lds
Zb s35,s35,1024
s_and_b32 s35, s35, 0x1fff
ST_98:
Zf lgkmcnt(5)
Ze v[24:27],a[48:51],v[36:39],v[24:27]
Ze v[28:31],a[52:55],v[36:39],v[28:31]
Zi v[36:39],v5 offset:19456
Zf lgkmcnt(5)
Ze v[16:19],a[56:59],v[40:43],v[16:19]
Ze v[20:23],a[60:63],v[40:43],v[20:23]
Zi v[40:43],v5 offset:20480
Zf lgkmcnt(5)
Ze v[24:27],a[56:59],v[44:47],v[24:27]
Ze v[28:31],a[60:63],v[44:47],v[28:31]
Zi v[44:47],v5 offset:21504
Zo s15,0
Zk ST_99
Zb m0,s11,s35
Zb s37,s36,s35
Zh v0,s[4:7],s37 offen sc1 lds
Zb s35,s35,1024
s_and_b32 s35, s35, 0x1fff
ST_99:
Zf lgkmcnt(5)
Ze v[16:19],a[64:67],v[48:51],v[16:19]
Ze v[20:23],a[68:71],v[48:51],v[20:23]
Zi v[48:51],v5 offset:22528
Zf lgkmcnt(5)
Ze v[24:27],a[64:67],v[52:55],v[24:27]
Ze v[28:31],a[68:71],v[52:55],v[28:31]
Zi v[52:55],v5 offset:23552
Zf lgkmcnt(5)
Ze v[16:19],a[72:75],v[32:35],v[16:19]
Ze v[20:23],a[76:79],v[32:35],v[20:23]
Zi v[32:35],v5 offset:24576
Zo s15,0
Zk ST_100
Zb m0,s11,s35
Zb s37,s36,s35
Zh v0,s[4:7],s37 offen sc1 lds
Zb s35,s35,1024
s_and_b32 s35, s35, 0x1fff
ST_100:
Zf lgkmcnt(5)
Ze v[24:27],a[72:75],v[36:39],v[24:27]
Ze v[28:31],a[76:79],v[36:39],v[28:31]
Zi v[36:39],v5 offset:25600
Zf lgkmcnt(5)
Ze v[16:19],a[80:83],v[40:43],v[16:19]
Ze v[20:23],a[84:87],v[40:43],v[20:23]
Zi v[40:43],v5 offset:26624
Zf lgkmcnt(5)
Ze v[24:27],a[80:83],v[44:47],v[24:27]
Ze v[28:31],a[84:87],v[44:47],v[28:31]
Zi v[44:47],v5 offset:27648
Zo s15,0
Zk ST_101
Zb m0,s11,s35
Zb s37,s36,s35
Zh v0,s[4:7],s37 offen sc1 lds
Zb s35,s35,1024
s_and_b32 s35, s35, 0x1fff
ST_101:
Zf lgkmcnt(5)
Ze v[16:19],a[88:91],v[48:51],v[16:19]
Ze v[20:23],a[92:95],v[48:51],v[20:23]
Zi v[48:51],v5 offset:28672
Zf lgkmcnt(5)
Ze v[24:27],a[88:91],v[52:55],v[24:27]
Ze v[28:31],a[92:95],v[52:55],v[28:31]
Zi v[52:55],v5 offset:29696
Zf lgkmcnt(5)
Ze v[16:19],a[96:99],v[32:35],v[16:19]
Ze v[20:23],a[100:103],v[32:35],v[20:23]
Zi v[32:35],v5 offset:30720
Zo s15,0
Zk ST_102
s_or_b32 s34, s35, 0x8000
Zb m0,s11,s34
Zb s37,s36,s34
Zh v0,s[4:7],s37 offen sc1 lds
Zb s35,s35,1024
s_and_b32 s35, s35, 0x1fff
ST_102:
s_or_b32 s38, s38, s33
s_cbranch_scc0 MD_103
Zp s38,0
Zf vmcnt(9)
s_cmp_lg_u32 s15, 0
Zk ME_104
Zf vmcnt(0)
ME_104:
s_barrier
Zo s33,0
Zk MD_103
s_cmp_lg_u32 s9, 0
Zk SF_105
Zs v9,s33
Zu v9,off,s[4:7],s13 sc1
SF_105:
MD_103:
Zf lgkmcnt(5)
Ze v[24:27],a[96:99],v[36:39],v[24:27]
Ze v[28:31],a[100:103],v[36:39],v[28:31]
Zi v[36:39],v5 offset:31744
Zf lgkmcnt(5)
Ze v[16:19],a[104:107],v[40:43],v[16:19]
Ze v[20:23],a[108:111],v[40:43],v[20:23]
Zi v[40:43],v5 offset:32768
Zf lgkmcnt(5)
Ze v[24:27],a[104:107],v[44:47],v[24:27]
Ze v[28:31],a[108:111],v[44:47],v[28:31]
Zi v[44:47],v5 offset:33792
Zo s15,0
Zk ST_106
s_or_b32 s34, s35, 0x8000
Zb m0,s11,s34
Zb s37,s36,s34
Zh v0,s[4:7],s37 offen sc1 lds
Zb s35,s35,1024
s_and_b32 s35, s35, 0x1fff
ST_106:
Zf lgkmcnt(5)
Ze v[16:19],a[112:115],v[48:51],v[16:19]
Ze v[20:23],a[116:119],v[48:51],v[20:23]
Zi v[48:51],v5 offset:34816
Zf lgkmcnt(5)
Ze v[24:27],a[112:115],v[52:55],v[24:27]
Ze v[28:31],a[116:119],v[52:55],v[28:31]
Zi v[52:55],v5 offset:35840
Zf lgkmcnt(5)
Ze v[16:19],a[120:123],v[32:35],v[16:19]
Ze v[20:23],a[124:127],v[32:35],v[20:23]
Zi v[32:35],v5 offset:36864
Zo s15,0
Zk ST_107
s_or_b32 s34, s35, 0x8000
Zb m0,s11,s34
Zb s37,s36,s34
Zh v0,s[4:7],s37 offen sc1 lds
Zb s35,s35,1024
s_and_b32 s35, s35, 0x1fff
ST_107:
Zf lgkmcnt(5)
Ze v[24:27],a[120:123],v[36:39],v[24:27]
Ze v[28:31],a[124:127],v[36:39],v[28:31]
Zi v[36:39],v5 offset:37888
Zf lgkmcnt(5)
Ze v[16:19],a[128:131],v[40:43],v[16:19]
Ze v[20:23],a[132:135],v[40:43],v[20:23]
Zi v[40:43],v5 offset:38912
Zf lgkmcnt(5)
Ze v[24:27],a[128:131],v[44:47],v[24:27]
Ze v[28:31],a[132:135],v[44:47],v[28:31]
Zi v[44:47],v5 offset:39936
Zo s15,0
Zk ST_108
s_or_b32 s34, s35, 0x8000
Zb m0,s11,s34
Zb s37,s36,s34
Zh v0,s[4:7],s37 offen sc1 lds
Zb s35,s35,1024
s_and_b32 s35, s35, 0x1fff
ST_108:
Zf lgkmcnt(5)
Ze v[16:19],a[136:139],v[48:51],v[16:19]
Ze v[20:23],a[140:143],v[48:51],v[20:23]
Zi v[48:51],v5 offset:40960
Zf lgkmcnt(5)
Ze v[24:27],a[136:139],v[52:55],v[24:27]
Ze v[28:31],a[140:143],v[52:55],v[28:31]
Zi v[52:55],v5 offset:41984
Zf lgkmcnt(5)
Ze v[16:19],a[144:147],v[32:35],v[16:19]
Ze v[20:23],a[148:151],v[32:35],v[20:23]
Zi v[32:35],v5 offset:43008
Zo s15,0
Zk ST_109
s_or_b32 s34, s35, 0x8000
Zb m0,s11,s34
Zb s37,s36,s34
Zh v0,s[4:7],s37 offen sc1 lds
Zb s35,s35,1024
s_and_b32 s35, s35, 0x1fff
ST_109:
Zf lgkmcnt(5)
Ze v[24:27],a[144:147],v[36:39],v[24:27]
Ze v[28:31],a[148:151],v[36:39],v[28:31]
Zi v[36:39],v5 offset:44032
Zf lgkmcnt(5)
Ze v[16:19],a[152:155],v[40:43],v[16:19]
Ze v[20:23],a[156:159],v[40:43],v[20:23]
Zi v[40:43],v5 offset:45056
Zf lgkmcnt(5)
Ze v[24:27],a[152:155],v[44:47],v[24:27]
Ze v[28:31],a[156:159],v[44:47],v[28:31]
Zi v[44:47],v5 offset:46080
Zo s15,0
Zk ST_110
s_or_b32 s34, s35, 0x8000
Zb m0,s11,s34
Zb s37,s36,s34
Zh v0,s[4:7],s37 offen sc1 lds
Zb s35,s35,1024
s_and_b32 s35, s35, 0x1fff
ST_110:
Zf lgkmcnt(5)
Ze v[16:19],a[160:163],v[48:51],v[16:19]
Ze v[20:23],a[164:167],v[48:51],v[20:23]
Zi v[48:51],v5 offset:47104
Zf lgkmcnt(5)
Ze v[24:27],a[160:163],v[52:55],v[24:27]
Ze v[28:31],a[164:167],v[52:55],v[28:31]
Zi v[52:55],v5 offset:48128
Zf lgkmcnt(5)
Ze v[16:19],a[168:171],v[32:35],v[16:19]
Ze v[20:23],a[172:175],v[32:35],v[20:23]
Zi v[32:35],v5 offset:49152
Zo s15,0
Zk ST_111
s_or_b32 s34, s35, 0x8000
Zb m0,s11,s34
Zb s37,s36,s34
Zh v0,s[4:7],s37 offen sc1 lds
Zb s35,s35,1024
s_and_b32 s35, s35, 0x1fff
ST_111:
Zf lgkmcnt(5)
Ze v[24:27],a[168:171],v[36:39],v[24:27]
Ze v[28:31],a[172:175],v[36:39],v[28:31]
Zi v[36:39],v5 offset:50176
Zf lgkmcnt(5)
Ze v[16:19],a[176:179],v[40:43],v[16:19]
Ze v[20:23],a[180:183],v[40:43],v[20:23]
Zi v[40:43],v5 offset:51200
Zf lgkmcnt(5)
Ze v[24:27],a[176:179],v[44:47],v[24:27]
Ze v[28:31],a[180:183],v[44:47],v[28:31]
Zi v[44:47],v5 offset:52224
Zo s15,0
Zk ST_112
s_or_b32 s34, s35, 0x8000
Zb m0,s11,s34
Zb s37,s36,s34
Zh v0,s[4:7],s37 offen sc1 lds
Zb s35,s35,1024
s_and_b32 s35, s35, 0x1fff
ST_112:
Zf lgkmcnt(5)
Ze v[16:19],a[184:187],v[48:51],v[16:19]
Ze v[20:23],a[188:191],v[48:51],v[20:23]
Zi v[48:51],v5 offset:53248
Zf lgkmcnt(5)
Ze v[24:27],a[184:187],v[52:55],v[24:27]
Ze v[28:31],a[188:191],v[52:55],v[28:31]
Zi v[52:55],v5 offset:54272
Zf lgkmcnt(5)
Ze v[16:19],a[192:195],v[32:35],v[16:19]
Ze v[20:23],a[196:199],v[32:35],v[20:23]
Zi v[32:35],v5 offset:55296
Zo s15,0
Zk ST_113
Zp m0,s32
s_nop 0
Za v3,s[4:7],s21 offen sc1 lds
s_xor_b32 s11, s11, 0x10000
s_xor_b32 s32, s32, 256
ST_113:
Zf lgkmcnt(5)
Ze v[24:27],a[192:195],v[36:39],v[24:27]
Ze v[28:31],a[196:199],v[36:39],v[28:31]
Zi v[36:39],v5 offset:56320
Zf lgkmcnt(5)
Ze v[16:19],a[200:203],v[40:43],v[16:19]
Ze v[20:23],a[204:207],v[40:43],v[20:23]
Zi v[40:43],v5 offset:57344
Zf lgkmcnt(5)
Ze v[24:27],a[200:203],v[44:47],v[24:27]
Ze v[28:31],a[204:207],v[44:47],v[28:31]
Zi v[44:47],v5 offset:58368
Zf lgkmcnt(5)
Ze v[16:19],a[208:211],v[48:51],v[16:19]
Ze v[20:23],a[212:215],v[48:51],v[20:23]
Zi v[48:51],v5 offset:59392
Zf lgkmcnt(5)
Ze v[24:27],a[208:211],v[52:55],v[24:27]
Ze v[28:31],a[212:215],v[52:55],v[28:31]
Zi v[52:55],v5 offset:60416
Zf lgkmcnt(5)
Ze v[16:19],a[216:219],v[32:35],v[16:19]
Ze v[20:23],a[220:223],v[32:35],v[20:23]
Zi v[32:35],v5 offset:61440
Zf lgkmcnt(5)
Ze v[24:27],a[216:219],v[36:39],v[24:27]
Ze v[28:31],a[220:223],v[36:39],v[28:31]
Zi v[36:39],v5 offset:62464
Zf lgkmcnt(5)
Ze v[16:19],a[224:227],v[40:43],v[16:19]
Ze v[20:23],a[228:231],v[40:43],v[20:23]
Zi v[40:43],v5 offset:63488
Zf lgkmcnt(5)
Ze v[24:27],a[224:227],v[44:47],v[24:27]
Ze v[28:31],a[228:231],v[44:47],v[28:31]
Zi v[44:47],v5 offset:64512
Zf lgkmcnt(5)
Ze v[16:19],a[232:235],v[48:51],v[16:19]
Ze v[20:23],a[236:239],v[48:51],v[20:23]
Zf lgkmcnt(4)
Ze v[24:27],a[232:235],v[52:55],v[24:27]
Ze v[28:31],a[236:239],v[52:55],v[28:31]
Zf lgkmcnt(3)
Ze v[16:19],a[240:243],v[32:35],v[16:19]
Ze v[20:23],a[244:247],v[32:35],v[20:23]
Zf lgkmcnt(2)
Ze v[24:27],a[240:243],v[36:39],v[24:27]
Ze v[28:31],a[244:247],v[36:39],v[28:31]
Zf lgkmcnt(1)
Ze v[16:19],a[248:251],v[40:43],v[16:19]
Ze v[20:23],a[252:255],v[40:43],v[20:23]
Zf lgkmcnt(0)
Ze v[24:27],a[248:251],v[44:47],v[24:27]
Ze v[28:31],a[252:255],v[44:47],v[28:31]
s_mul_i32 s18, s10, 81920
Zb s18,s18,s29
Zb s19,s18,40960
Zs v32,v16
Zs v33,v20
Zs v34,v17
Zs v35,v21
Zs v36,v18
Zs v37,v22
Zs v38,v19
Zs v39,v23
Zr v[32:35],v10,s[4:7],s18 offen offset:0 sc1
Zr v[36:39],v10,s[4:7],s18 offen offset:64 sc1
Zs v40,v24
Zs v41,v28
Zs v42,v25
Zs v43,v29
Zs v44,v26
Zs v45,v30
Zs v46,v27
Zs v47,v31
Zr v[40:43],v10,s[4:7],s19 offen offset:0 sc1
Zr v[44:47],v10,s[4:7],s19 offen offset:64 sc1
Zb s33,s10,1
s_and_b32 s16, s10, 63
s_cselect_b32 s16, s15, 0
s_cmp_lg_u32 s16, 0
Zk AO_N
Zf vmcnt(0)
s_barrier
s_cmp_lg_u32 s9, 0
Zk SF_114
Zs v9,s33
Zu v9,off,s[4:7],s13 sc1
SF_114:
Zp s33,0
AO_N:
v_xor_b32 v5, 0x10000, v5
v_xor_b32 v11, 256, v11
Zp s10,s28
s_cmp_lt_u32 s10, 128
Zk AO_L
Zf vmcnt(0)
s_endpgm
R_RA:
Zy v0,63,v0
Zy v1,15,v0
v_lshrrev_b32 v2, 4, v0
Zz v0,4,v0
Zp s22,0x05040100
Zp s23,0x07060302
Zp s20,300000
v_lshrrev_b32 v3, 2, v0
v_min_u32 v3, 16, v3
v_lshrrev_b32 v4, 1, v0
v_lshrrev_b32 v6, 1, v1
Zy v6,3,v6
Zz v5,4,v6
v_lshrrev_b32 v6, 3, v1
v_lshl_add_u32 v5, v6, 3, v5
Zy v6,1,v1
v_lshl_add_u32 v5, v6, 2, v5
v_lshl_add_u32 v5, v2, 6, v5
s_lshr_b32 s30, s8, 1
s_and_b32 s10, s8, 1
Zq s31,s30,2
Zb s31,s31,s9
Zq s31,s31,1
s_load_dwordx2 s[24:25], s[0:1], 0
Zp s26,2621440
Zp s27,0x20000
Zq s13,s30,2
Zq s19,s10,7
Zb s13,s13,s19
Zb s13,s13,9472
Zp s12,9216
Zb s12,s12,s19
Zf lgkmcnt(0)
RA_L:
s_and_b32 s14, s10, 63
Zq s14,s14,5
Zb s14,s14,s31
s_mul_i32 s14, s14, 1280
s_lshr_b32 s15, s10, 6
s_mul_i32 s15, s15, 5242880
Zb s15,s15,s14
Zb s15,s15,111149056
Zb s16,s10,1
s_lshr_b32 s41, s10, 1
Zo s41,32
s_cselect_b32 s43, 124, 0
Zp s41,0
Zp s42,8704
s_cmp_ge_u32 s41, s43
Zk ND_118
NP_117:
Za v9,off,s[4:7],s42 sc1
Zf vmcnt(0)
v_readfirstlane_b32 s41, v9
s_cmp_ge_u32 s41, s43
Zk ND_118
s_sleep 32
s_sub_u32 s20, s20, 1
s_cmp_gt_i32 s20, 0
Zk NP_117
ND_118:
WF_115:
Za v9,v3,s[4:7],s12 offen sc1
Zf vmcnt(0)
v_cmp_gt_u32 vcc, s16, v9
s_cbranch_vccz WD_116
s_sleep 3
s_sub_u32 s20, s20, 1
s_cmp_gt_i32 s20, 0
Zk WF_115
WD_116:
s_mul_i32 s18, s10, 81920
s_mul_i32 s19, s31, 2560
Zb s18,s18,s19
Zb s18,s18,201326592
buffer_load_dwordx2 v[64:65], v4, s[4:7], s18 offen offset:0 sc1
buffer_load_dwordx2 v[66:67], v4, s[4:7], s18 offen offset:512 sc1
buffer_load_dwordx2 v[68:69], v4, s[4:7], s18 offen offset:1024 sc1
buffer_load_dwordx2 v[70:71], v4, s[4:7], s18 offen offset:1536 sc1
buffer_load_dwordx2 v[72:73], v4, s[4:7], s18 offen offset:2048 sc1
Zb s18,s18,2560
buffer_load_dwordx2 v[74:75], v4, s[4:7], s18 offen offset:0 sc1
buffer_load_dwordx2 v[76:77], v4, s[4:7], s18 offen offset:512 sc1
buffer_load_dwordx2 v[78:79], v4, s[4:7], s18 offen offset:1024 sc1
buffer_load_dwordx2 v[80:81], v4, s[4:7], s18 offen offset:1536 sc1
buffer_load_dwordx2 v[82:83], v4, s[4:7], s18 offen offset:2048 sc1
s_cmp_ge_u32 s10, 64
Zk RA_X
Za v16,v5,s[24:27],s14 offen offset:0
Za v17,v5,s[24:27],s14 offen offset:256
Za v18,v5,s[24:27],s14 offen offset:512
Za v19,v5,s[24:27],s14 offen offset:768
Za v20,v5,s[24:27],s14 offen offset:1024
Za v21,v5,s[24:27],s14 offen offset:1280
Za v22,v5,s[24:27],s14 offen offset:1536
Za v23,v5,s[24:27],s14 offen offset:1792
Za v24,v5,s[24:27],s14 offen offset:2048
Za v25,v5,s[24:27],s14 offen offset:2304
s_branch RA_Y
RA_X:
Za v16,v5,s[4:7],s15 offen offset:0 sc1
Za v17,v5,s[4:7],s15 offen offset:256 sc1
Za v18,v5,s[4:7],s15 offen offset:512 sc1
Za v19,v5,s[4:7],s15 offen offset:768 sc1
Za v20,v5,s[4:7],s15 offen offset:1024 sc1
Za v21,v5,s[4:7],s15 offen offset:1280 sc1
Za v22,v5,s[4:7],s15 offen offset:1536 sc1
Za v23,v5,s[4:7],s15 offen offset:1792 sc1
Za v24,v5,s[4:7],s15 offen offset:2048 sc1
Za v25,v5,s[4:7],s15 offen offset:2304 sc1
RA_Y:
Zf vmcnt(19)
Zj v112,v64,v65
Zy v65,0xffff0000,v112
Zz v64,16,v112
Zf vmcnt(9)
Zy v129,0xffff0000,v16
Zz v128,16,v16
Zj v113,v66,v67
Zy v67,0xffff0000,v113
Zz v66,16,v113
Zf vmcnt(8)
Zy v131,0xffff0000,v17
Zz v130,16,v17
Zj v114,v68,v69
Zy v69,0xffff0000,v114
Zz v68,16,v114
Zf vmcnt(7)
Zy v133,0xffff0000,v18
Zz v132,16,v18
Zj v115,v70,v71
Zy v71,0xffff0000,v115
Zz v70,16,v115
Zf vmcnt(6)
Zy v135,0xffff0000,v19
Zz v134,16,v19
Zj v116,v72,v73
Zy v73,0xffff0000,v116
Zz v72,16,v116
Zf vmcnt(5)
Zy v137,0xffff0000,v20
Zz v136,16,v20
Zl v128,v128,v64
Zl v129,v129,v65
Zl v130,v130,v66
Zl v131,v131,v67
Zl v132,v132,v68
Zl v133,v133,v69
Zl v134,v134,v70
Zl v135,v135,v71
Zl v136,v136,v72
Zl v137,v137,v73
Zj v112,v128,v129
Zj v113,v130,v131
Zj v114,v132,v133
Zj v115,v134,v135
Zj v116,v136,v137
Zj v117,v74,v75
Zy v75,0xffff0000,v117
Zz v74,16,v117
Zf vmcnt(4)
Zy v149,0xffff0000,v21
Zz v148,16,v21
Zj v118,v76,v77
Zy v77,0xffff0000,v118
Zz v76,16,v118
Zf vmcnt(3)
Zy v151,0xffff0000,v22
Zz v150,16,v22
Zj v119,v78,v79
Zy v79,0xffff0000,v119
Zz v78,16,v119
Zf vmcnt(2)
Zy v153,0xffff0000,v23
Zz v152,16,v23
Zj v120,v80,v81
Zy v81,0xffff0000,v120
Zz v80,16,v120
Zf vmcnt(1)
Zy v155,0xffff0000,v24
Zz v154,16,v24
Zj v121,v82,v83
Zy v83,0xffff0000,v121
Zz v82,16,v121
Zf vmcnt(0)
Zy v157,0xffff0000,v25
Zz v156,16,v25
Zl v148,v148,v74
Zl v149,v149,v75
Zl v150,v150,v76
Zl v151,v151,v77
Zl v152,v152,v78
Zl v153,v153,v79
Zl v154,v154,v80
Zl v155,v155,v81
Zl v156,v156,v82
Zl v157,v157,v83
Zj v117,v148,v149
Zj v118,v150,v151
Zj v119,v152,v153
Zj v120,v154,v155
Zj v121,v156,v157
Zb s15,s15,2621440
s_mul_i32 s18, s10, 40960
s_mul_i32 s19, s31, 1280
Zb s18,s18,s19
Zb s18,s18,105906176
Zy v129,0xffff0000,v112
Zz v128,16,v112
Zy v131,0xffff0000,v113
Zz v130,16,v113
Zy v133,0xffff0000,v114
Zz v132,16,v114
Zy v135,0xffff0000,v115
Zz v134,16,v115
Zy v137,0xffff0000,v116
Zz v136,16,v116
Zl v143,v128,v129
Zl v143,v143,v130
Zl v143,v143,v131
Zl v143,v143,v132
Zl v143,v143,v133
Zl v143,v143,v134
Zl v143,v143,v135
Zl v143,v143,v136
Zl v143,v143,v137
s_nop 1
v_add_f32_dpp v143, v143, v143 row_ror:8 row_mask:0xf bank_mask:0xf
s_nop 1
v_add_f32_dpp v143, v143, v143 row_ror:4 row_mask:0xf bank_mask:0xf
s_nop 1
v_add_f32_dpp v143, v143, v143 row_ror:2 row_mask:0xf bank_mask:0xf
s_nop 1
v_add_f32_dpp v143, v143, v143 row_ror:1 row_mask:0xf bank_mask:0xf
Zs v144,v143
s_nop 1
v_permlane32_swap_b32 v143, v144
Zl v143,v143,v144
Zs v144,v143
s_nop 1
v_permlane16_swap_b32 v143, v144
Zl v143,v143,v144
Zw v143,986500301,v143
Zx v128,v128,v143
Zx v129,v129,v143
Zx v130,v130,v143
Zx v131,v131,v143
Zx v132,v132,v143
Zx v133,v133,v143
Zx v134,v134,v143
Zx v135,v135,v143
Zx v136,v136,v143
Zx v137,v137,v143
Zw v143,v128,v128
v_fmac_f32 v143, v129, v129
v_fmac_f32 v143, v130, v130
v_fmac_f32 v143, v131, v131
v_fmac_f32 v143, v132, v132
v_fmac_f32 v143, v133, v133
v_fmac_f32 v143, v134, v134
v_fmac_f32 v143, v135, v135
v_fmac_f32 v143, v136, v136
v_fmac_f32 v143, v137, v137
s_nop 1
v_add_f32_dpp v143, v143, v143 row_ror:8 row_mask:0xf bank_mask:0xf
s_nop 1
v_add_f32_dpp v143, v143, v143 row_ror:4 row_mask:0xf bank_mask:0xf
s_nop 1
v_add_f32_dpp v143, v143, v143 row_ror:2 row_mask:0xf bank_mask:0xf
s_nop 1
v_add_f32_dpp v143, v143, v143 row_ror:1 row_mask:0xf bank_mask:0xf
Zs v144,v143
s_nop 1
v_permlane32_swap_b32 v143, v144
Zl v143,v143,v144
Zs v144,v143
s_nop 1
v_permlane16_swap_b32 v143, v144
Zl v143,v143,v144
Zs v144,925353388
v_fmac_f32 v144, 986500301, v143
v_rsq_f32 v144, v144
s_nop 0
Zw v128,v128,v144
Zw v129,v129,v144
Zw v130,v130,v144
Zw v131,v131,v144
Zw v132,v132,v144
Zw v133,v133,v144
Zw v134,v134,v144
Zw v135,v135,v144
Zw v136,v136,v144
Zw v137,v137,v144
Zj v138,v128,v129
Zj v139,v130,v131
Zj v140,v132,v133
Zj v141,v134,v135
Zj v142,v136,v137
Zu v138,v5,s[4:7],s18 offen offset:0 sc1
Zu v139,v5,s[4:7],s18 offen offset:256 sc1
Zu v140,v5,s[4:7],s18 offen offset:512 sc1
Zu v141,v5,s[4:7],s18 offen offset:768 sc1
Zu v142,v5,s[4:7],s18 offen offset:1024 sc1
Zy v149,0xffff0000,v117
Zz v148,16,v117
Zy v151,0xffff0000,v118
Zz v150,16,v118
Zy v153,0xffff0000,v119
Zz v152,16,v119
Zy v155,0xffff0000,v120
Zz v154,16,v120
Zy v157,0xffff0000,v121
Zz v156,16,v121
Zl v163,v148,v149
Zl v163,v163,v150
Zl v163,v163,v151
Zl v163,v163,v152
Zl v163,v163,v153
Zl v163,v163,v154
Zl v163,v163,v155
Zl v163,v163,v156
Zl v163,v163,v157
s_nop 1
v_add_f32_dpp v163, v163, v163 row_ror:8 row_mask:0xf bank_mask:0xf
s_nop 1
v_add_f32_dpp v163, v163, v163 row_ror:4 row_mask:0xf bank_mask:0xf
s_nop 1
v_add_f32_dpp v163, v163, v163 row_ror:2 row_mask:0xf bank_mask:0xf
s_nop 1
v_add_f32_dpp v163, v163, v163 row_ror:1 row_mask:0xf bank_mask:0xf
Zs v164,v163
s_nop 1
v_permlane32_swap_b32 v163, v164
Zl v163,v163,v164
Zs v164,v163
s_nop 1
v_permlane16_swap_b32 v163, v164
Zl v163,v163,v164
Zw v163,986500301,v163
Zx v148,v148,v163
Zx v149,v149,v163
Zx v150,v150,v163
Zx v151,v151,v163
Zx v152,v152,v163
Zx v153,v153,v163
Zx v154,v154,v163
Zx v155,v155,v163
Zx v156,v156,v163
Zx v157,v157,v163
Zw v163,v148,v148
v_fmac_f32 v163, v149, v149
v_fmac_f32 v163, v150, v150
v_fmac_f32 v163, v151, v151
v_fmac_f32 v163, v152, v152
v_fmac_f32 v163, v153, v153
v_fmac_f32 v163, v154, v154
v_fmac_f32 v163, v155, v155
v_fmac_f32 v163, v156, v156
v_fmac_f32 v163, v157, v157
s_nop 1
v_add_f32_dpp v163, v163, v163 row_ror:8 row_mask:0xf bank_mask:0xf
s_nop 1
v_add_f32_dpp v163, v163, v163 row_ror:4 row_mask:0xf bank_mask:0xf
s_nop 1
v_add_f32_dpp v163, v163, v163 row_ror:2 row_mask:0xf bank_mask:0xf
s_nop 1
v_add_f32_dpp v163, v163, v163 row_ror:1 row_mask:0xf bank_mask:0xf
Zs v164,v163
s_nop 1
v_permlane32_swap_b32 v163, v164
Zl v163,v163,v164
Zs v164,v163
s_nop 1
v_permlane16_swap_b32 v163, v164
Zl v163,v163,v164
Zs v164,925353388
v_fmac_f32 v164, 986500301, v163
v_rsq_f32 v164, v164
s_nop 0
Zw v148,v148,v164
Zw v149,v149,v164
Zw v150,v150,v164
Zw v151,v151,v164
Zw v152,v152,v164
Zw v153,v153,v164
Zw v154,v154,v164
Zw v155,v155,v164
Zw v156,v156,v164
Zw v157,v157,v164
Zj v158,v148,v149
Zj v159,v150,v151
Zj v160,v152,v153
Zj v161,v154,v155
Zj v162,v156,v157
Zu v158,v5,s[4:7],s18 offen offset:1280 sc1
Zu v159,v5,s[4:7],s18 offen offset:1536 sc1
Zu v160,v5,s[4:7],s18 offen offset:1792 sc1
Zu v161,v5,s[4:7],s18 offen offset:2048 sc1
Zu v162,v5,s[4:7],s18 offen offset:2304 sc1
Zu v112,v5,s[4:7],s15 offen offset:0 sc1
Zu v113,v5,s[4:7],s15 offen offset:256 sc1
Zu v114,v5,s[4:7],s15 offen offset:512 sc1
Zu v115,v5,s[4:7],s15 offen offset:768 sc1
Zu v116,v5,s[4:7],s15 offen offset:1024 sc1
Zu v117,v5,s[4:7],s15 offen offset:1280 sc1
Zu v118,v5,s[4:7],s15 offen offset:1536 sc1
Zu v119,v5,s[4:7],s15 offen offset:1792 sc1
Zu v120,v5,s[4:7],s15 offen offset:2048 sc1
Zu v121,v5,s[4:7],s15 offen offset:2304 sc1
Zf vmcnt(0)
s_barrier
Zb s16,s10,1
s_cmp_lg_u32 s9, 0
Zk SF_119
Zs v9,s16
Zu v9,off,s[4:7],s13 sc1
SF_119:
Zb s10,s10,2
s_cmp_lt_u32 s10, 128
Zk RA_L
Zf vmcnt(0)
s_endpgm
R_BA:
Zy v0,63,v0
Zy v1,15,v0
v_lshrrev_b32 v2, 4, v0
Zz v0,4,v0
Zp s22,0x05040100
Zp s23,0x07060302
Zp s20,300000
Zq s12,s8,7
Zb s14,s12,4096
Zb s12,s12,0
Zq s13,s8,2
Zb s13,s13,9728
Zp s25,0
Zp s26,0
s_lshr_b32 s30, s9, 1
s_and_b32 s31, s9, 1
Zq s19,s30,12
v_add_u32 v8, s19, v0
v_lshrrev_b32 v10, 2, v1
Zz v10,8,v10
v_lshl_add_u32 v10, v2, 6, v10
Zy v11,1,v1
v_lshl_add_u32 v10, v11, 2, v10
v_add_u32 v10, 139264, v10
Zq s19,s31,11
Zb s19,s19,139272
v_add_u32 v11, s19, v0
Zs v12,v0
Zq s19,s31,12
v_add_u32 v13, s19, v0
Zq s19,s30,4
v_add_u32 v14, s19, v1
Zz v15,2,v2
v_sub_u32 v14, v14, v15
v_cmp_gt_i32 s[40:41], 0, v14
v_cmp_gt_i32 s[42:43], 1, v14
v_cmp_gt_i32 s[44:45], 2, v14
v_cmp_gt_i32 s[46:47], 3, v14
v_cmp_gt_i32 s[48:49], 16, v14
v_cmp_gt_i32 s[50:51], 17, v14
v_cmp_gt_i32 s[52:53], 18, v14
v_cmp_gt_i32 s[54:55], 19, v14
Zp s21,1040356334
Zq s11,s9,10
Zp s10,0
BA_LAY:
Zb s16,s10,1
s_cmp_ge_u32 s25, s16
Zk ND_121
NP_120:
buffer_load_dwordx2 v[14:15], off, s[4:7], s12 sc1
Zf vmcnt(0)
v_min_u32 v14, v14, v15
s_nop 0
v_readfirstlane_b32 s25, v14
s_cmp_ge_u32 s25, s16
Zk ND_121
s_sleep 2
s_sub_u32 s20, s20, 1
s_cmp_gt_i32 s20, 0
Zk NP_120
ND_121:
Zq s18,s10,5
Zb s18,s18,s8
Zq s36,s18,13
s_mul_i32 s18, s18, 20480
Zq s19,s9,10
Zb s18,s18,s19
Zb s36,s36,s19
Zb m0,s11,32768
Zb s19,s36,134217728
Zh v0,s[4:7],s19 offen sc1 lds
Zb m0,s11,36864
Zb s19,s36,134221824
Zh v0,s[4:7],s19 offen sc1 lds
Zb m0,s11,40960
Zb s19,s18,16777216
Zh v0,s[4:7],s19 offen sc1 lds
Zb m0,s11,45056
Zb s19,s18,16781312
Zh v0,s[4:7],s19 offen sc1 lds
Zb m0,s11,49152
Zb s19,s18,16785408
Zh v0,s[4:7],s19 offen sc1 lds
Zb m0,s11,53248
Zb s19,s18,16789504
Zh v0,s[4:7],s19 offen sc1 lds
s_xor_b32 s11, s11, 0x10000
Za v116,off,s[4:7],s14 sc1
Zf vmcnt(0)
BA_L:
Zf vmcnt(2) lgkmcnt(0)
s_barrier
Zi v[64:67],v8 offset:32768
Zi v[80:83],v12 offset:40960
Zi v[96:99],v12 offset:45056
Zi v[68:71],v8 offset:33792
Zi v[84:87],v12 offset:41984
Zi v[100:103],v12 offset:46080
Zi v[72:75],v8 offset:34816
Zi v[88:91],v12 offset:43008
Zi v[104:107],v12 offset:47104
Zi v[76:79],v8 offset:35840
Zi v[92:95],v12 offset:44032
Zi v[108:111],v12 offset:48128
v_readfirstlane_b32 s16, v116
s_max_u32 s26, s26, s16
Zb s28,s10,1
s_and_b32 s29, s28, 63
Zq s38,s10,5
Zb s38,s38,s8
s_cmp_ge_u32 s26, s28
s_cselect_b32 s27, 1, 0
s_cbranch_scc0 BA_P
s_mul_i32 s19, s38, 20480
Zq s16,s9,10
Zb s19,s19,s16
Zb s19,s19,16793600
Zb m0,s16,139264
s_nop 0
Zh v0,s[4:7],s19 offen sc1 lds
BA_P:
Zf lgkmcnt(10)
Ze v[16:19],v[80:83],v[64:67],0
Zf lgkmcnt(9)
Ze v[20:23],v[96:99],v[64:67],0
Zf lgkmcnt(7)
Ze v[16:19],v[84:87],v[68:71],v[16:19]
Zf lgkmcnt(6)
Ze v[20:23],v[100:103],v[68:71],v[20:23]
Zf lgkmcnt(4)
Ze v[16:19],v[88:91],v[72:75],v[16:19]
Zf lgkmcnt(3)
Ze v[20:23],v[104:107],v[72:75],v[20:23]
Zf lgkmcnt(1)
Ze v[16:19],v[92:95],v[76:79],v[16:19]
Zf lgkmcnt(0)
Ze v[20:23],v[108:111],v[76:79],v[20:23]
Zi v[80:83],v13 offset:49152
Zi v[84:87],v13 offset:50176
Zi v[88:91],v13 offset:51200
Zi v[92:95],v13 offset:52224
Zs v15,0xff800000
v_cndmask_b32 v16, v16, v15, s[40:41]
v_cndmask_b32 v17, v17, v15, s[42:43]
v_cndmask_b32 v18, v18, v15, s[44:45]
v_cndmask_b32 v19, v19, v15, s[46:47]
v_cndmask_b32 v20, v20, v15, s[48:49]
v_cndmask_b32 v21, v21, v15, s[50:51]
v_cndmask_b32 v22, v22, v15, s[52:53]
v_cndmask_b32 v23, v23, v15, s[54:55]
Zs v28,0x3f803f80
Zs v29,0x3f803f80
Zs v30,0x3f803f80
Zs v31,0x3f803f80
Zf vmcnt(0) lgkmcnt(0)
s_barrier
s_cmp_lg_u32 s9, 0
Zk SF_122
Zs v9,s10
Zu v9,off,s[4:7],s13 sc1
SF_122:
Zo s29,0
Zk BA_Q
Zb s16,s28,1
s_cmp_ge_u32 s25, s16
Zk ND_124
NP_123:
buffer_load_dwordx2 v[14:15], off, s[4:7], s12 sc1
Zf vmcnt(0)
v_min_u32 v14, v14, v15
s_nop 0
v_readfirstlane_b32 s25, v14
s_cmp_ge_u32 s25, s16
Zk ND_124
s_sleep 2
s_sub_u32 s20, s20, 1
s_cmp_gt_i32 s20, 0
Zk NP_123
ND_124:
Zq s18,s28,5
Zb s18,s18,s8
Zq s36,s18,13
s_mul_i32 s18, s18, 20480
Zq s19,s9,10
Zb s18,s18,s19
Zb s36,s36,s19
Zb m0,s11,32768
Zb s19,s36,134217728
Zh v0,s[4:7],s19 offen sc1 lds
Zb m0,s11,36864
Zb s19,s36,134221824
Zh v0,s[4:7],s19 offen sc1 lds
Zb m0,s11,40960
Zb s19,s18,16777216
Zh v0,s[4:7],s19 offen sc1 lds
Zb m0,s11,45056
Zb s19,s18,16781312
Zh v0,s[4:7],s19 offen sc1 lds
Zb m0,s11,49152
Zb s19,s18,16785408
Zh v0,s[4:7],s19 offen sc1 lds
Zb m0,s11,53248
Zb s19,s18,16789504
Zh v0,s[4:7],s19 offen sc1 lds
s_xor_b32 s11, s11, 0x10000
Za v116,off,s[4:7],s14 sc1
BA_Q:
s_cmp_lg_u32 s27, 0
Zk BA_J
s_cmp_ge_u32 s26, s28
Zk ND_126
NP_125:
Za v14,off,s[4:7],s14 sc1
Zf vmcnt(0)
v_readfirstlane_b32 s26, v14
s_cmp_ge_u32 s26, s28
Zk ND_126
s_sleep 2
s_sub_u32 s20, s20, 1
s_cmp_gt_i32 s20, 0
Zk NP_125
ND_126:
s_mul_i32 s19, s38, 20480
Zq s16,s9,10
Zb s19,s19,s16
Zb s19,s19,16793600
Zb m0,s16,139264
s_nop 0
Zh v0,s[4:7],s19 offen sc1 lds
Zf vmcnt(0)
BA_J:
s_barrier
v_add_u32 v14, 0, v10
ds_read2_b32 v[96:97], v14 offset0:0 offset1:4
ds_read2_b32 v[98:99], v14 offset0:8 offset1:12
v_add_u32 v14, 1024, v10
ds_read2_b32 v[100:101], v14 offset0:0 offset1:4
ds_read2_b32 v[102:103], v14 offset0:8 offset1:12
v_add_u32 v14, 2048, v10
ds_read2_b32 v[104:105], v14 offset0:0 offset1:4
ds_read2_b32 v[106:107], v14 offset0:8 offset1:12
v_add_u32 v14, 3072, v10
ds_read2_b32 v[108:109], v14 offset0:0 offset1:4
ds_read2_b32 v[110:111], v14 offset0:8 offset1:12
ds_read_b64 v[112:113], v11
ds_read_b64 v[114:115], v11 offset:1024
Zf lgkmcnt(8)
Ze v[24:27],v[96:99],v[64:67],0
Zf lgkmcnt(6)
Ze v[24:27],v[100:103],v[68:71],v[24:27]
Zf lgkmcnt(4)
Ze v[24:27],v[104:107],v[72:75],v[24:27]
Zf lgkmcnt(2)
Ze v[24:27],v[108:111],v[76:79],v[24:27]
v_max3_f32 v14, v16, v17, v18
v_max3_f32 v14, v14, v19, v20
v_max3_f32 v14, v14, v21, v22
s_nop 4
v_max3_f32 v14, v14, v23, v24
v_max_f32 v14, v14, v25
Zs v15,v14
s_nop 1
v_permlane32_swap_b32 v14, v15
v_max_f32 v14, v14, v15
Zs v15,v14
s_nop 1
v_permlane16_swap_b32 v14, v15
v_max_f32 v14, v14, v15
Zw v14,s21,v14
v_fma_f32 v16, v16, s21, -v14
v_fma_f32 v17, v17, s21, -v14
v_fma_f32 v18, v18, s21, -v14
v_fma_f32 v19, v19, s21, -v14
v_fma_f32 v20, v20, s21, -v14
v_fma_f32 v21, v21, s21, -v14
v_fma_f32 v22, v22, s21, -v14
v_fma_f32 v23, v23, s21, -v14
v_fma_f32 v24, v24, s21, -v14
v_fma_f32 v25, v25, s21, -v14
Zn v16,v16
Zn v17,v17
Zn v18,v18
Zn v19,v19
Zn v20,v20
Zn v21,v21
Zn v22,v22
Zn v23,v23
Zn v24,v24
Zn v25,v25
Zj v32,v16,v17
Zj v33,v18,v19
Zj v34,v20,v21
Zj v35,v22,v23
Zj v36,v24,v25
Zs v37,0
Zs v38,0
Zs v39,v36
Ze v[16:19],v[28:31],v[32:35],0
Ze v[40:43],v[80:83],v[32:35],0
Ze v[44:47],v[84:87],v[32:35],0
Ze v[48:51],v[88:91],v[32:35],0
Ze v[52:55],v[92:95],v[32:35],0
v_mfma_f32_16x16x16_bf16 v[16:19], v[28:29], v[36:37], v[16:19]
Zf lgkmcnt(1)
v_mfma_f32_16x16x16_bf16 v[40:43], v[112:113], v[36:37], v[40:43]
v_mfma_f32_16x16x16_bf16 v[44:47], v[112:113], v[38:39], v[44:47]
Zf lgkmcnt(0)
v_mfma_f32_16x16x16_bf16 v[48:51], v[114:115], v[36:37], v[48:51]
v_mfma_f32_16x16x16_bf16 v[52:55], v[114:115], v[38:39], v[52:55]
v_rcp_f32 v14, v16
Zq s18,s38,13
Zq s19,s31,12
Zb s18,s18,s19
Zq s19,s30,10
Zb s18,s18,s19
Zb s18,s18,167772160
Zw v40,v40,v14
Zw v41,v41,v14
Zw v42,v42,v14
Zw v43,v43,v14
Zw v44,v44,v14
Zw v45,v45,v14
Zw v46,v46,v14
Zw v47,v47,v14
Zj v56,v40,v44
Zj v57,v41,v45
Zj v58,v42,v46
Zj v59,v43,v47
Zr v[56:59],v0,s[4:7],s18 offen offset:0 sc1
Zw v48,v48,v14
Zw v49,v49,v14
Zw v50,v50,v14
Zw v51,v51,v14
Zw v52,v52,v14
Zw v53,v53,v14
Zw v54,v54,v14
Zw v55,v55,v14
Zj v60,v48,v52
Zj v61,v49,v53
Zj v62,v50,v54
Zj v63,v51,v55
Zr v[60:63],v0,s[4:7],s18 offen offset:2048 sc1
v_xor_b32 v8, 0x10000, v8
v_xor_b32 v12, 0x10000, v12
v_xor_b32 v13, 0x10000, v13
Zp s10,s28
s_cmp_lg_u32 s29, 0
Zk BA_L
Zf vmcnt(0) lgkmcnt(0)
s_barrier
s_cmp_lg_u32 s9, 0
Zk SF_127
Zs v9,s10
Zu v9,off,s[4:7],s13 sc1
SF_127:
s_cmp_lt_u32 s10, 128
Zk BA_LAY
Zf vmcnt(0)
s_endpgm
R_BO:
Zy v0,63,v0
Zy v1,15,v0
v_lshrrev_b32 v2, 4, v0
Zz v0,4,v0
Zp s22,0x05040100
Zp s23,0x07060302
Zp s20,300000
s_load_dwordx2 s[24:25], s[0:1], 80
Zp s26,5242880
Zp s27,0x20000
s_mul_i32 s30, s8, 52
s_lshr_b32 s30, s30, 8
s_mul_i32 s19, s30, 5
s_sub_u32 s31, s8, s19
v_mul_u32_u24 v4, 10240, v2
v_lshl_add_u32 v4, v1, 2, v4
Zs v5,v4
s_mul_i32 s17, s30, 1310720
Zq s19,s31,8
Zb s17,s17,s19
Zq s19,s9,6
Zb s17,s17,s19
Zb s19,s17,0
Zf lgkmcnt(0)
Za v64,v4,s[24:27],s19 offen
Zb s19,s17,1280
Za v65,v4,s[24:27],s19 offen
Zb s19,s17,2560
Za v66,v4,s[24:27],s19 offen
Zb s19,s17,3840
Za v67,v4,s[24:27],s19 offen
Zb s19,s17,5120
Za v68,v5,s[24:27],s19 offen
Zb s19,s17,6400
Za v69,v5,s[24:27],s19 offen
Zb s19,s17,7680
Za v70,v5,s[24:27],s19 offen
Zb s19,s17,8960
Za v71,v5,s[24:27],s19 offen
Zb s19,s17,40960
Za v72,v4,s[24:27],s19 offen
Zb s19,s17,42240
Za v73,v4,s[24:27],s19 offen
Zb s19,s17,43520
Za v74,v4,s[24:27],s19 offen
Zb s19,s17,44800
Za v75,v4,s[24:27],s19 offen
Zb s19,s17,46080
Za v76,v5,s[24:27],s19 offen
Zb s19,s17,47360
Za v77,v5,s[24:27],s19 offen
Zb s19,s17,48640
Za v78,v5,s[24:27],s19 offen
Zb s19,s17,49920
Za v79,v5,s[24:27],s19 offen
Zb s19,s17,81920
Za v80,v4,s[24:27],s19 offen
Zb s19,s17,83200
Za v81,v4,s[24:27],s19 offen
Zb s19,s17,84480
Za v82,v4,s[24:27],s19 offen
Zb s19,s17,85760
Za v83,v4,s[24:27],s19 offen
Zb s19,s17,87040
Za v84,v5,s[24:27],s19 offen
Zb s19,s17,88320
Za v85,v5,s[24:27],s19 offen
Zb s19,s17,89600
Za v86,v5,s[24:27],s19 offen
Zb s19,s17,90880
Za v87,v5,s[24:27],s19 offen
Zb s19,s17,122880
Za v88,v4,s[24:27],s19 offen
Zb s19,s17,124160
Za v89,v4,s[24:27],s19 offen
Zb s19,s17,125440
Za v90,v4,s[24:27],s19 offen
Zb s19,s17,126720
Za v91,v4,s[24:27],s19 offen
Zb s19,s17,128000
Za v92,v5,s[24:27],s19 offen
Zb s19,s17,129280
Za v93,v5,s[24:27],s19 offen
Zb s19,s17,130560
Za v94,v5,s[24:27],s19 offen
Zb s19,s17,131840
Za v95,v5,s[24:27],s19 offen
Zb s19,s17,163840
Za v96,v4,s[24:27],s19 offen
Zb s19,s17,165120
Za v97,v4,s[24:27],s19 offen
Zb s19,s17,166400
Za v98,v4,s[24:27],s19 offen
Zb s19,s17,167680
Za v99,v4,s[24:27],s19 offen
Zb s19,s17,168960
Za v100,v5,s[24:27],s19 offen
Zb s19,s17,170240
Za v101,v5,s[24:27],s19 offen
Zb s19,s17,171520
Za v102,v5,s[24:27],s19 offen
Zb s19,s17,172800
Za v103,v5,s[24:27],s19 offen
Zb s19,s17,204800
Za v104,v4,s[24:27],s19 offen
Zb s19,s17,206080
Za v105,v4,s[24:27],s19 offen
Zb s19,s17,207360
Za v106,v4,s[24:27],s19 offen
Zb s19,s17,208640
Za v107,v4,s[24:27],s19 offen
Zb s19,s17,209920
Za v108,v5,s[24:27],s19 offen
Zb s19,s17,211200
Za v109,v5,s[24:27],s19 offen
Zb s19,s17,212480
Za v110,v5,s[24:27],s19 offen
Zb s19,s17,213760
Za v111,v5,s[24:27],s19 offen
Zf vmcnt(46)
Zc v56,v65,v64,s22
Zf vmcnt(44)
Zc v57,v67,v66,s22
Zf vmcnt(42)
Zc v58,v69,v68,s22
Zf vmcnt(40)
Zc v59,v71,v70,s22
Zc v60,v65,v64,s23
Zc v61,v67,v66,s23
Zc v62,v69,v68,s23
Zc v63,v71,v70,s23
Zd a0,v56
Zd a1,v57
Zd a2,v58
Zd a3,v59
Zd a4,v60
Zd a5,v61
Zd a6,v62
Zd a7,v63
Zb s19,s17,245760
Za v64,v4,s[24:27],s19 offen
Zb s19,s17,247040
Za v65,v4,s[24:27],s19 offen
Zb s19,s17,248320
Za v66,v4,s[24:27],s19 offen
Zb s19,s17,249600
Za v67,v4,s[24:27],s19 offen
Zb s19,s17,250880
Za v68,v5,s[24:27],s19 offen
Zb s19,s17,252160
Za v69,v5,s[24:27],s19 offen
Zb s19,s17,253440
Za v70,v5,s[24:27],s19 offen
Zb s19,s17,254720
Za v71,v5,s[24:27],s19 offen
Zf vmcnt(46)
Zc v56,v73,v72,s22
Zf vmcnt(44)
Zc v57,v75,v74,s22
Zf vmcnt(42)
Zc v58,v77,v76,s22
Zf vmcnt(40)
Zc v59,v79,v78,s22
Zc v60,v73,v72,s23
Zc v61,v75,v74,s23
Zc v62,v77,v76,s23
Zc v63,v79,v78,s23
Zd a8,v56
Zd a9,v57
Zd a10,v58
Zd a11,v59
Zd a12,v60
Zd a13,v61
Zd a14,v62
Zd a15,v63
Zb s19,s17,286720
Za v72,v4,s[24:27],s19 offen
Zb s19,s17,288000
Za v73,v4,s[24:27],s19 offen
Zb s19,s17,289280
Za v74,v4,s[24:27],s19 offen
Zb s19,s17,290560
Za v75,v4,s[24:27],s19 offen
Zb s19,s17,291840
Za v76,v5,s[24:27],s19 offen
Zb s19,s17,293120
Za v77,v5,s[24:27],s19 offen
Zb s19,s17,294400
Za v78,v5,s[24:27],s19 offen
Zb s19,s17,295680
Za v79,v5,s[24:27],s19 offen
Zf vmcnt(46)
Zc v56,v81,v80,s22
Zf vmcnt(44)
Zc v57,v83,v82,s22
Zf vmcnt(42)
Zc v58,v85,v84,s22
Zf vmcnt(40)
Zc v59,v87,v86,s22
Zc v60,v81,v80,s23
Zc v61,v83,v82,s23
Zc v62,v85,v84,s23
Zc v63,v87,v86,s23
Zd a16,v56
Zd a17,v57
Zd a18,v58
Zd a19,v59
Zd a20,v60
Zd a21,v61
Zd a22,v62
Zd a23,v63
Zb s19,s17,327680
Za v80,v4,s[24:27],s19 offen
Zb s19,s17,328960
Za v81,v4,s[24:27],s19 offen
Zb s19,s17,330240
Za v82,v4,s[24:27],s19 offen
Zb s19,s17,331520
Za v83,v4,s[24:27],s19 offen
Zb s19,s17,332800
Za v84,v5,s[24:27],s19 offen
Zb s19,s17,334080
Za v85,v5,s[24:27],s19 offen
Zb s19,s17,335360
Za v86,v5,s[24:27],s19 offen
Zb s19,s17,336640
Za v87,v5,s[24:27],s19 offen
Zf vmcnt(46)
Zc v56,v89,v88,s22
Zf vmcnt(44)
Zc v57,v91,v90,s22
Zf vmcnt(42)
Zc v58,v93,v92,s22
Zf vmcnt(40)
Zc v59,v95,v94,s22
Zc v60,v89,v88,s23
Zc v61,v91,v90,s23
Zc v62,v93,v92,s23
Zc v63,v95,v94,s23
Zd a24,v56
Zd a25,v57
Zd a26,v58
Zd a27,v59
Zd a28,v60
Zd a29,v61
Zd a30,v62
Zd a31,v63
Zb s19,s17,368640
Za v88,v4,s[24:27],s19 offen
Zb s19,s17,369920
Za v89,v4,s[24:27],s19 offen
Zb s19,s17,371200
Za v90,v4,s[24:27],s19 offen
Zb s19,s17,372480
Za v91,v4,s[24:27],s19 offen
Zb s19,s17,373760
Za v92,v5,s[24:27],s19 offen
Zb s19,s17,375040
Za v93,v5,s[24:27],s19 offen
Zb s19,s17,376320
Za v94,v5,s[24:27],s19 offen
Zb s19,s17,377600
Za v95,v5,s[24:27],s19 offen
Zf vmcnt(46)
Zc v56,v97,v96,s22
Zf vmcnt(44)
Zc v57,v99,v98,s22
Zf vmcnt(42)
Zc v58,v101,v100,s22
Zf vmcnt(40)
Zc v59,v103,v102,s22
Zc v60,v97,v96,s23
Zc v61,v99,v98,s23
Zc v62,v101,v100,s23
Zc v63,v103,v102,s23
Zd a32,v56
Zd a33,v57
Zd a34,v58
Zd a35,v59
Zd a36,v60
Zd a37,v61
Zd a38,v62
Zd a39,v63
Zb s19,s17,409600
Za v96,v4,s[24:27],s19 offen
Zb s19,s17,410880
Za v97,v4,s[24:27],s19 offen
Zb s19,s17,412160
Za v98,v4,s[24:27],s19 offen
Zb s19,s17,413440
Za v99,v4,s[24:27],s19 offen
Zb s19,s17,414720
Za v100,v5,s[24:27],s19 offen
Zb s19,s17,416000
Za v101,v5,s[24:27],s19 offen
Zb s19,s17,417280
Za v102,v5,s[24:27],s19 offen
Zb s19,s17,418560
Za v103,v5,s[24:27],s19 offen
Zf vmcnt(46)
Zc v56,v105,v104,s22
Zf vmcnt(44)
Zc v57,v107,v106,s22
Zf vmcnt(42)
Zc v58,v109,v108,s22
Zf vmcnt(40)
Zc v59,v111,v110,s22
Zc v60,v105,v104,s23
Zc v61,v107,v106,s23
Zc v62,v109,v108,s23
Zc v63,v111,v110,s23
Zd a40,v56
Zd a41,v57
Zd a42,v58
Zd a43,v59
Zd a44,v60
Zd a45,v61
Zd a46,v62
Zd a47,v63
Zb s19,s17,450560
Za v104,v4,s[24:27],s19 offen
Zb s19,s17,451840
Za v105,v4,s[24:27],s19 offen
Zb s19,s17,453120
Za v106,v4,s[24:27],s19 offen
Zb s19,s17,454400
Za v107,v4,s[24:27],s19 offen
Zb s19,s17,455680
Za v108,v5,s[24:27],s19 offen
Zb s19,s17,456960
Za v109,v5,s[24:27],s19 offen
Zb s19,s17,458240
Za v110,v5,s[24:27],s19 offen
Zb s19,s17,459520
Za v111,v5,s[24:27],s19 offen
Zf vmcnt(46)
Zc v56,v65,v64,s22
Zf vmcnt(44)
Zc v57,v67,v66,s22
Zf vmcnt(42)
Zc v58,v69,v68,s22
Zf vmcnt(40)
Zc v59,v71,v70,s22
Zc v60,v65,v64,s23
Zc v61,v67,v66,s23
Zc v62,v69,v68,s23
Zc v63,v71,v70,s23
Zd a48,v56
Zd a49,v57
Zd a50,v58
Zd a51,v59
Zd a52,v60
Zd a53,v61
Zd a54,v62
Zd a55,v63
Zb s19,s17,491520
Za v64,v4,s[24:27],s19 offen
Zb s19,s17,492800
Za v65,v4,s[24:27],s19 offen
Zb s19,s17,494080
Za v66,v4,s[24:27],s19 offen
Zb s19,s17,495360
Za v67,v4,s[24:27],s19 offen
Zb s19,s17,496640
Za v68,v5,s[24:27],s19 offen
Zb s19,s17,497920
Za v69,v5,s[24:27],s19 offen
Zb s19,s17,499200
Za v70,v5,s[24:27],s19 offen
Zb s19,s17,500480
Za v71,v5,s[24:27],s19 offen
Zf vmcnt(46)
Zc v56,v73,v72,s22
Zf vmcnt(44)
Zc v57,v75,v74,s22
Zf vmcnt(42)
Zc v58,v77,v76,s22
Zf vmcnt(40)
Zc v59,v79,v78,s22
Zc v60,v73,v72,s23
Zc v61,v75,v74,s23
Zc v62,v77,v76,s23
Zc v63,v79,v78,s23
Zd a56,v56
Zd a57,v57
Zd a58,v58
Zd a59,v59
Zd a60,v60
Zd a61,v61
Zd a62,v62
Zd a63,v63
Zb s19,s17,532480
Za v72,v4,s[24:27],s19 offen
Zb s19,s17,533760
Za v73,v4,s[24:27],s19 offen
Zb s19,s17,535040
Za v74,v4,s[24:27],s19 offen
Zb s19,s17,536320
Za v75,v4,s[24:27],s19 offen
Zb s19,s17,537600
Za v76,v5,s[24:27],s19 offen
Zb s19,s17,538880
Za v77,v5,s[24:27],s19 offen
Zb s19,s17,540160
Za v78,v5,s[24:27],s19 offen
Zb s19,s17,541440
Za v79,v5,s[24:27],s19 offen
Zf vmcnt(46)
Zc v56,v81,v80,s22
Zf vmcnt(44)
Zc v57,v83,v82,s22
Zf vmcnt(42)
Zc v58,v85,v84,s22
Zf vmcnt(40)
Zc v59,v87,v86,s22
Zc v60,v81,v80,s23
Zc v61,v83,v82,s23
Zc v62,v85,v84,s23
Zc v63,v87,v86,s23
Zd a64,v56
Zd a65,v57
Zd a66,v58
Zd a67,v59
Zd a68,v60
Zd a69,v61
Zd a70,v62
Zd a71,v63
Zb s19,s17,573440
Za v80,v4,s[24:27],s19 offen
Zb s19,s17,574720
Za v81,v4,s[24:27],s19 offen
Zb s19,s17,576000
Za v82,v4,s[24:27],s19 offen
Zb s19,s17,577280
Za v83,v4,s[24:27],s19 offen
Zb s19,s17,578560
Za v84,v5,s[24:27],s19 offen
Zb s19,s17,579840
Za v85,v5,s[24:27],s19 offen
Zb s19,s17,581120
Za v86,v5,s[24:27],s19 offen
Zb s19,s17,582400
Za v87,v5,s[24:27],s19 offen
Zf vmcnt(46)
Zc v56,v89,v88,s22
Zf vmcnt(44)
Zc v57,v91,v90,s22
Zf vmcnt(42)
Zc v58,v93,v92,s22
Zf vmcnt(40)
Zc v59,v95,v94,s22
Zc v60,v89,v88,s23
Zc v61,v91,v90,s23
Zc v62,v93,v92,s23
Zc v63,v95,v94,s23
Zd a72,v56
Zd a73,v57
Zd a74,v58
Zd a75,v59
Zd a76,v60
Zd a77,v61
Zd a78,v62
Zd a79,v63
Zb s19,s17,614400
Za v88,v4,s[24:27],s19 offen
Zb s19,s17,615680
Za v89,v4,s[24:27],s19 offen
Zb s19,s17,616960
Za v90,v4,s[24:27],s19 offen
Zb s19,s17,618240
Za v91,v4,s[24:27],s19 offen
Zb s19,s17,619520
Za v92,v5,s[24:27],s19 offen
Zb s19,s17,620800
Za v93,v5,s[24:27],s19 offen
Zb s19,s17,622080
Za v94,v5,s[24:27],s19 offen
Zb s19,s17,623360
Za v95,v5,s[24:27],s19 offen
Zf vmcnt(46)
Zc v56,v97,v96,s22
Zf vmcnt(44)
Zc v57,v99,v98,s22
Zf vmcnt(42)
Zc v58,v101,v100,s22
Zf vmcnt(40)
Zc v59,v103,v102,s22
Zc v60,v97,v96,s23
Zc v61,v99,v98,s23
Zc v62,v101,v100,s23
Zc v63,v103,v102,s23
Zd a80,v56
Zd a81,v57
Zd a82,v58
Zd a83,v59
Zd a84,v60
Zd a85,v61
Zd a86,v62
Zd a87,v63
Zb s19,s17,655360
Za v96,v4,s[24:27],s19 offen
Zb s19,s17,656640
Za v97,v4,s[24:27],s19 offen
Zb s19,s17,657920
Za v98,v4,s[24:27],s19 offen
Zb s19,s17,659200
Za v99,v4,s[24:27],s19 offen
Zb s19,s17,660480
Za v100,v5,s[24:27],s19 offen
Zb s19,s17,661760
Za v101,v5,s[24:27],s19 offen
Zb s19,s17,663040
Za v102,v5,s[24:27],s19 offen
Zb s19,s17,664320
Za v103,v5,s[24:27],s19 offen
Zf vmcnt(46)
Zc v56,v105,v104,s22
Zf vmcnt(44)
Zc v57,v107,v106,s22
Zf vmcnt(42)
Zc v58,v109,v108,s22
Zf vmcnt(40)
Zc v59,v111,v110,s22
Zc v60,v105,v104,s23
Zc v61,v107,v106,s23
Zc v62,v109,v108,s23
Zc v63,v111,v110,s23
Zd a88,v56
Zd a89,v57
Zd a90,v58
Zd a91,v59
Zd a92,v60
Zd a93,v61
Zd a94,v62
Zd a95,v63
Zb s19,s17,696320
Za v104,v4,s[24:27],s19 offen
Zb s19,s17,697600
Za v105,v4,s[24:27],s19 offen
Zb s19,s17,698880
Za v106,v4,s[24:27],s19 offen
Zb s19,s17,700160
Za v107,v4,s[24:27],s19 offen
Zb s19,s17,701440
Za v108,v5,s[24:27],s19 offen
Zb s19,s17,702720
Za v109,v5,s[24:27],s19 offen
Zb s19,s17,704000
Za v110,v5,s[24:27],s19 offen
Zb s19,s17,705280
Za v111,v5,s[24:27],s19 offen
Zf vmcnt(46)
Zc v56,v65,v64,s22
Zf vmcnt(44)
Zc v57,v67,v66,s22
Zf vmcnt(42)
Zc v58,v69,v68,s22
Zf vmcnt(40)
Zc v59,v71,v70,s22
Zc v60,v65,v64,s23
Zc v61,v67,v66,s23
Zc v62,v69,v68,s23
Zc v63,v71,v70,s23
Zd a96,v56
Zd a97,v57
Zd a98,v58
Zd a99,v59
Zd a100,v60
Zd a101,v61
Zd a102,v62
Zd a103,v63
Zb s19,s17,737280
Za v64,v4,s[24:27],s19 offen
Zb s19,s17,738560
Za v65,v4,s[24:27],s19 offen
Zb s19,s17,739840
Za v66,v4,s[24:27],s19 offen
Zb s19,s17,741120
Za v67,v4,s[24:27],s19 offen
Zb s19,s17,742400
Za v68,v5,s[24:27],s19 offen
Zb s19,s17,743680
Za v69,v5,s[24:27],s19 offen
Zb s19,s17,744960
Za v70,v5,s[24:27],s19 offen
Zb s19,s17,746240
Za v71,v5,s[24:27],s19 offen
Zf vmcnt(46)
Zc v56,v73,v72,s22
Zf vmcnt(44)
Zc v57,v75,v74,s22
Zf vmcnt(42)
Zc v58,v77,v76,s22
Zf vmcnt(40)
Zc v59,v79,v78,s22
Zc v60,v73,v72,s23
Zc v61,v75,v74,s23
Zc v62,v77,v76,s23
Zc v63,v79,v78,s23
Zd a104,v56
Zd a105,v57
Zd a106,v58
Zd a107,v59
Zd a108,v60
Zd a109,v61
Zd a110,v62
Zd a111,v63
Zb s19,s17,778240
Za v72,v4,s[24:27],s19 offen
Zb s19,s17,779520
Za v73,v4,s[24:27],s19 offen
Zb s19,s17,780800
Za v74,v4,s[24:27],s19 offen
Zb s19,s17,782080
Za v75,v4,s[24:27],s19 offen
Zb s19,s17,783360
Za v76,v5,s[24:27],s19 offen
Zb s19,s17,784640
Za v77,v5,s[24:27],s19 offen
Zb s19,s17,785920
Za v78,v5,s[24:27],s19 offen
Zb s19,s17,787200
Za v79,v5,s[24:27],s19 offen
Zf vmcnt(46)
Zc v56,v81,v80,s22
Zf vmcnt(44)
Zc v57,v83,v82,s22
Zf vmcnt(42)
Zc v58,v85,v84,s22
Zf vmcnt(40)
Zc v59,v87,v86,s22
Zc v60,v81,v80,s23
Zc v61,v83,v82,s23
Zc v62,v85,v84,s23
Zc v63,v87,v86,s23
Zd a112,v56
Zd a113,v57
Zd a114,v58
Zd a115,v59
Zd a116,v60
Zd a117,v61
Zd a118,v62
Zd a119,v63
Zb s19,s17,819200
Za v80,v4,s[24:27],s19 offen
Zb s19,s17,820480
Za v81,v4,s[24:27],s19 offen
Zb s19,s17,821760
Za v82,v4,s[24:27],s19 offen
Zb s19,s17,823040
Za v83,v4,s[24:27],s19 offen
Zb s19,s17,824320
Za v84,v5,s[24:27],s19 offen
Zb s19,s17,825600
Za v85,v5,s[24:27],s19 offen
Zb s19,s17,826880
Za v86,v5,s[24:27],s19 offen
Zb s19,s17,828160
Za v87,v5,s[24:27],s19 offen
Zf vmcnt(46)
Zc v56,v89,v88,s22
Zf vmcnt(44)
Zc v57,v91,v90,s22
Zf vmcnt(42)
Zc v58,v93,v92,s22
Zf vmcnt(40)
Zc v59,v95,v94,s22
Zc v60,v89,v88,s23
Zc v61,v91,v90,s23
Zc v62,v93,v92,s23
Zc v63,v95,v94,s23
Zd a120,v56
Zd a121,v57
Zd a122,v58
Zd a123,v59
Zd a124,v60
Zd a125,v61
Zd a126,v62
Zd a127,v63
Zb s19,s17,860160
Za v88,v4,s[24:27],s19 offen
Zb s19,s17,861440
Za v89,v4,s[24:27],s19 offen
Zb s19,s17,862720
Za v90,v4,s[24:27],s19 offen
Zb s19,s17,864000
Za v91,v4,s[24:27],s19 offen
Zb s19,s17,865280
Za v92,v5,s[24:27],s19 offen
Zb s19,s17,866560
Za v93,v5,s[24:27],s19 offen
Zb s19,s17,867840
Za v94,v5,s[24:27],s19 offen
Zb s19,s17,869120
Za v95,v5,s[24:27],s19 offen
Zf vmcnt(46)
Zc v56,v97,v96,s22
Zf vmcnt(44)
Zc v57,v99,v98,s22
Zf vmcnt(42)
Zc v58,v101,v100,s22
Zf vmcnt(40)
Zc v59,v103,v102,s22
Zc v60,v97,v96,s23
Zc v61,v99,v98,s23
Zc v62,v101,v100,s23
Zc v63,v103,v102,s23
Zd a128,v56
Zd a129,v57
Zd a130,v58
Zd a131,v59
Zd a132,v60
Zd a133,v61
Zd a134,v62
Zd a135,v63
Zb s19,s17,901120
Za v96,v4,s[24:27],s19 offen
Zb s19,s17,902400
Za v97,v4,s[24:27],s19 offen
Zb s19,s17,903680
Za v98,v4,s[24:27],s19 offen
Zb s19,s17,904960
Za v99,v4,s[24:27],s19 offen
Zb s19,s17,906240
Za v100,v5,s[24:27],s19 offen
Zb s19,s17,907520
Za v101,v5,s[24:27],s19 offen
Zb s19,s17,908800
Za v102,v5,s[24:27],s19 offen
Zb s19,s17,910080
Za v103,v5,s[24:27],s19 offen
Zf vmcnt(46)
Zc v56,v105,v104,s22
Zf vmcnt(44)
Zc v57,v107,v106,s22
Zf vmcnt(42)
Zc v58,v109,v108,s22
Zf vmcnt(40)
Zc v59,v111,v110,s22
Zc v60,v105,v104,s23
Zc v61,v107,v106,s23
Zc v62,v109,v108,s23
Zc v63,v111,v110,s23
Zd a136,v56
Zd a137,v57
Zd a138,v58
Zd a139,v59
Zd a140,v60
Zd a141,v61
Zd a142,v62
Zd a143,v63
Zb s19,s17,942080
Za v104,v4,s[24:27],s19 offen
Zb s19,s17,943360
Za v105,v4,s[24:27],s19 offen
Zb s19,s17,944640
Za v106,v4,s[24:27],s19 offen
Zb s19,s17,945920
Za v107,v4,s[24:27],s19 offen
Zb s19,s17,947200
Za v108,v5,s[24:27],s19 offen
Zb s19,s17,948480
Za v109,v5,s[24:27],s19 offen
Zb s19,s17,949760
Za v110,v5,s[24:27],s19 offen
Zb s19,s17,951040
Za v111,v5,s[24:27],s19 offen
Zf vmcnt(46)
Zc v56,v65,v64,s22
Zf vmcnt(44)
Zc v57,v67,v66,s22
Zf vmcnt(42)
Zc v58,v69,v68,s22
Zf vmcnt(40)
Zc v59,v71,v70,s22
Zc v60,v65,v64,s23
Zc v61,v67,v66,s23
Zc v62,v69,v68,s23
Zc v63,v71,v70,s23
Zd a144,v56
Zd a145,v57
Zd a146,v58
Zd a147,v59
Zd a148,v60
Zd a149,v61
Zd a150,v62
Zd a151,v63
Zb s19,s17,983040
Za v64,v4,s[24:27],s19 offen
Zb s19,s17,984320
Za v65,v4,s[24:27],s19 offen
Zb s19,s17,985600
Za v66,v4,s[24:27],s19 offen
Zb s19,s17,986880
Za v67,v4,s[24:27],s19 offen
Zb s19,s17,988160
Za v68,v5,s[24:27],s19 offen
Zb s19,s17,989440
Za v69,v5,s[24:27],s19 offen
Zb s19,s17,990720
Za v70,v5,s[24:27],s19 offen
Zb s19,s17,992000
Za v71,v5,s[24:27],s19 offen
Zf vmcnt(46)
Zc v56,v73,v72,s22
Zf vmcnt(44)
Zc v57,v75,v74,s22
Zf vmcnt(42)
Zc v58,v77,v76,s22
Zf vmcnt(40)
Zc v59,v79,v78,s22
Zc v60,v73,v72,s23
Zc v61,v75,v74,s23
Zc v62,v77,v76,s23
Zc v63,v79,v78,s23
Zd a152,v56
Zd a153,v57
Zd a154,v58
Zd a155,v59
Zd a156,v60
Zd a157,v61
Zd a158,v62
Zd a159,v63
Zb s19,s17,1024000
Za v72,v4,s[24:27],s19 offen
Zb s19,s17,1025280
Za v73,v4,s[24:27],s19 offen
Zb s19,s17,1026560
Za v74,v4,s[24:27],s19 offen
Zb s19,s17,1027840
Za v75,v4,s[24:27],s19 offen
Zb s19,s17,1029120
Za v76,v5,s[24:27],s19 offen
Zb s19,s17,1030400
Za v77,v5,s[24:27],s19 offen
Zb s19,s17,1031680
Za v78,v5,s[24:27],s19 offen
Zb s19,s17,1032960
Za v79,v5,s[24:27],s19 offen
Zf vmcnt(46)
Zc v56,v81,v80,s22
Zf vmcnt(44)
Zc v57,v83,v82,s22
Zf vmcnt(42)
Zc v58,v85,v84,s22
Zf vmcnt(40)
Zc v59,v87,v86,s22
Zc v60,v81,v80,s23
Zc v61,v83,v82,s23
Zc v62,v85,v84,s23
Zc v63,v87,v86,s23
Zd a160,v56
Zd a161,v57
Zd a162,v58
Zd a163,v59
Zd a164,v60
Zd a165,v61
Zd a166,v62
Zd a167,v63
Zb s19,s17,1064960
Za v80,v4,s[24:27],s19 offen
Zb s19,s17,1066240
Za v81,v4,s[24:27],s19 offen
Zb s19,s17,1067520
Za v82,v4,s[24:27],s19 offen
Zb s19,s17,1068800
Za v83,v4,s[24:27],s19 offen
Zb s19,s17,1070080
Za v84,v5,s[24:27],s19 offen
Zb s19,s17,1071360
Za v85,v5,s[24:27],s19 offen
Zb s19,s17,1072640
Za v86,v5,s[24:27],s19 offen
Zb s19,s17,1073920
Za v87,v5,s[24:27],s19 offen
Zf vmcnt(46)
Zc v56,v89,v88,s22
Zf vmcnt(44)
Zc v57,v91,v90,s22
Zf vmcnt(42)
Zc v58,v93,v92,s22
Zf vmcnt(40)
Zc v59,v95,v94,s22
Zc v60,v89,v88,s23
Zc v61,v91,v90,s23
Zc v62,v93,v92,s23
Zc v63,v95,v94,s23
Zd a168,v56
Zd a169,v57
Zd a170,v58
Zd a171,v59
Zd a172,v60
Zd a173,v61
Zd a174,v62
Zd a175,v63
Zb s19,s17,1105920
Za v88,v4,s[24:27],s19 offen
Zb s19,s17,1107200
Za v89,v4,s[24:27],s19 offen
Zb s19,s17,1108480
Za v90,v4,s[24:27],s19 offen
Zb s19,s17,1109760
Za v91,v4,s[24:27],s19 offen
Zb s19,s17,1111040
Za v92,v5,s[24:27],s19 offen
Zb s19,s17,1112320
Za v93,v5,s[24:27],s19 offen
Zb s19,s17,1113600
Za v94,v5,s[24:27],s19 offen
Zb s19,s17,1114880
Za v95,v5,s[24:27],s19 offen
Zf vmcnt(46)
Zc v56,v97,v96,s22
Zf vmcnt(44)
Zc v57,v99,v98,s22
Zf vmcnt(42)
Zc v58,v101,v100,s22
Zf vmcnt(40)
Zc v59,v103,v102,s22
Zc v60,v97,v96,s23
Zc v61,v99,v98,s23
Zc v62,v101,v100,s23
Zc v63,v103,v102,s23
Zd a176,v56
Zd a177,v57
Zd a178,v58
Zd a179,v59
Zd a180,v60
Zd a181,v61
Zd a182,v62
Zd a183,v63
Zb s19,s17,1146880
Za v96,v4,s[24:27],s19 offen
Zb s19,s17,1148160
Za v97,v4,s[24:27],s19 offen
Zb s19,s17,1149440
Za v98,v4,s[24:27],s19 offen
Zb s19,s17,1150720
Za v99,v4,s[24:27],s19 offen
Zb s19,s17,1152000
Za v100,v5,s[24:27],s19 offen
Zb s19,s17,1153280
Za v101,v5,s[24:27],s19 offen
Zb s19,s17,1154560
Za v102,v5,s[24:27],s19 offen
Zb s19,s17,1155840
Za v103,v5,s[24:27],s19 offen
Zf vmcnt(46)
Zc v56,v105,v104,s22
Zf vmcnt(44)
Zc v57,v107,v106,s22
Zf vmcnt(42)
Zc v58,v109,v108,s22
Zf vmcnt(40)
Zc v59,v111,v110,s22
Zc v60,v105,v104,s23
Zc v61,v107,v106,s23
Zc v62,v109,v108,s23
Zc v63,v111,v110,s23
Zd a184,v56
Zd a185,v57
Zd a186,v58
Zd a187,v59
Zd a188,v60
Zd a189,v61
Zd a190,v62
Zd a191,v63
Zb s19,s17,1187840
Za v104,v4,s[24:27],s19 offen
Zb s19,s17,1189120
Za v105,v4,s[24:27],s19 offen
Zb s19,s17,1190400
Za v106,v4,s[24:27],s19 offen
Zb s19,s17,1191680
Za v107,v4,s[24:27],s19 offen
Zb s19,s17,1192960
Za v108,v5,s[24:27],s19 offen
Zb s19,s17,1194240
Za v109,v5,s[24:27],s19 offen
Zb s19,s17,1195520
Za v110,v5,s[24:27],s19 offen
Zb s19,s17,1196800
Za v111,v5,s[24:27],s19 offen
Zf vmcnt(46)
Zc v56,v65,v64,s22
Zf vmcnt(44)
Zc v57,v67,v66,s22
Zf vmcnt(42)
Zc v58,v69,v68,s22
Zf vmcnt(40)
Zc v59,v71,v70,s22
Zc v60,v65,v64,s23
Zc v61,v67,v66,s23
Zc v62,v69,v68,s23
Zc v63,v71,v70,s23
Zd a192,v56
Zd a193,v57
Zd a194,v58
Zd a195,v59
Zd a196,v60
Zd a197,v61
Zd a198,v62
Zd a199,v63
Zb s19,s17,1228800
Za v64,v4,s[24:27],s19 offen
Zb s19,s17,1230080
Za v65,v4,s[24:27],s19 offen
Zb s19,s17,1231360
Za v66,v4,s[24:27],s19 offen
Zb s19,s17,1232640
Za v67,v4,s[24:27],s19 offen
Zb s19,s17,1233920
Za v68,v5,s[24:27],s19 offen
Zb s19,s17,1235200
Za v69,v5,s[24:27],s19 offen
Zb s19,s17,1236480
Za v70,v5,s[24:27],s19 offen
Zb s19,s17,1237760
Za v71,v5,s[24:27],s19 offen
Zf vmcnt(46)
Zc v56,v73,v72,s22
Zf vmcnt(44)
Zc v57,v75,v74,s22
Zf vmcnt(42)
Zc v58,v77,v76,s22
Zf vmcnt(40)
Zc v59,v79,v78,s22
Zc v60,v73,v72,s23
Zc v61,v75,v74,s23
Zc v62,v77,v76,s23
Zc v63,v79,v78,s23
Zd a200,v56
Zd a201,v57
Zd a202,v58
Zd a203,v59
Zd a204,v60
Zd a205,v61
Zd a206,v62
Zd a207,v63
Zb s19,s17,1269760
Za v72,v4,s[24:27],s19 offen
Zb s19,s17,1271040
Za v73,v4,s[24:27],s19 offen
Zb s19,s17,1272320
Za v74,v4,s[24:27],s19 offen
Zb s19,s17,1273600
Za v75,v4,s[24:27],s19 offen
Zb s19,s17,1274880
Za v76,v5,s[24:27],s19 offen
Zb s19,s17,1276160
Za v77,v5,s[24:27],s19 offen
Zb s19,s17,1277440
Za v78,v5,s[24:27],s19 offen
Zb s19,s17,1278720
Za v79,v5,s[24:27],s19 offen
Zf vmcnt(46)
Zc v56,v81,v80,s22
Zf vmcnt(44)
Zc v57,v83,v82,s22
Zf vmcnt(42)
Zc v58,v85,v84,s22
Zf vmcnt(40)
Zc v59,v87,v86,s22
Zc v60,v81,v80,s23
Zc v61,v83,v82,s23
Zc v62,v85,v84,s23
Zc v63,v87,v86,s23
Zd a208,v56
Zd a209,v57
Zd a210,v58
Zd a211,v59
Zd a212,v60
Zd a213,v61
Zd a214,v62
Zd a215,v63
Zf vmcnt(38)
Zc v56,v89,v88,s22
Zf vmcnt(36)
Zc v57,v91,v90,s22
Zf vmcnt(34)
Zc v58,v93,v92,s22
Zf vmcnt(32)
Zc v59,v95,v94,s22
Zc v60,v89,v88,s23
Zc v61,v91,v90,s23
Zc v62,v93,v92,s23
Zc v63,v95,v94,s23
Zd a216,v56
Zd a217,v57
Zd a218,v58
Zd a219,v59
Zd a220,v60
Zd a221,v61
Zd a222,v62
Zd a223,v63
Zf vmcnt(30)
Zc v56,v97,v96,s22
Zf vmcnt(28)
Zc v57,v99,v98,s22
Zf vmcnt(26)
Zc v58,v101,v100,s22
Zf vmcnt(24)
Zc v59,v103,v102,s22
Zc v60,v97,v96,s23
Zc v61,v99,v98,s23
Zc v62,v101,v100,s23
Zc v63,v103,v102,s23
Zd a224,v56
Zd a225,v57
Zd a226,v58
Zd a227,v59
Zd a228,v60
Zd a229,v61
Zd a230,v62
Zd a231,v63
Zf vmcnt(22)
Zc v56,v105,v104,s22
Zf vmcnt(20)
Zc v57,v107,v106,s22
Zf vmcnt(18)
Zc v58,v109,v108,s22
Zf vmcnt(16)
Zc v59,v111,v110,s22
Zc v60,v105,v104,s23
Zc v61,v107,v106,s23
Zc v62,v109,v108,s23
Zc v63,v111,v110,s23
Zd a232,v56
Zd a233,v57
Zd a234,v58
Zd a235,v59
Zd a236,v60
Zd a237,v61
Zd a238,v62
Zd a239,v63
Zf vmcnt(14)
Zc v56,v65,v64,s22
Zf vmcnt(12)
Zc v57,v67,v66,s22
Zf vmcnt(10)
Zc v58,v69,v68,s22
Zf vmcnt(8)
Zc v59,v71,v70,s22
Zc v60,v65,v64,s23
Zc v61,v67,v66,s23
Zc v62,v69,v68,s23
Zc v63,v71,v70,s23
Zd a240,v56
Zd a241,v57
Zd a242,v58
Zd a243,v59
Zd a244,v60
Zd a245,v61
Zd a246,v62
Zd a247,v63
Zf vmcnt(6)
Zc v56,v73,v72,s22
Zf vmcnt(4)
Zc v57,v75,v74,s22
Zf vmcnt(2)
Zc v58,v77,v76,s22
Zf vmcnt(0)
Zc v59,v79,v78,s22
Zc v60,v73,v72,s23
Zc v61,v75,v74,s23
Zc v62,v77,v76,s23
Zc v63,v79,v78,s23
Zd a248,v56
Zd a249,v57
Zd a250,v58
Zd a251,v59
Zd a252,v60
Zd a253,v61
Zd a254,v62
Zd a255,v63
v_mul_u32_u24 v10, 2560, v1
v_lshl_add_u32 v10, v2, 4, v10
Zq s29,s31,9
Zq s19,s9,7
Zb s29,s29,s19
s_mul_i32 s19, s30, 81920
Zb s29,s29,s19
Zb s29,s29,218103808
Zq s13,s8,2
Zb s13,s13,9984
Zq s14,s30,16
Zq s12,s30,5
Zb s12,s12,9728
v_lshrrev_b32 v3, 2, v0
v_min_u32 v3, 28, v3
Zs v5,v0
Zp s10,0
s_mul_i32 s35, s31, 3072
s_and_b32 s35, s35, 0x1fff
Zq s11,s9,13
Zp s15,0
Zp s33,0
Zp s32,131072
v_lshrrev_b32 v11, 2, v0
v_add_u32 v11, 131072, v11
Zb s14,s14,s11
Zp s38,0
Zf vmcnt(0) lgkmcnt(0)
BO_L:
s_cmp_lg_u32 s15, 0
Zk BO_H
Zb s16,s10,1
Zp s21,s12
WF_128:
Za v9,v3,s[4:7],s21 offen sc1
Zf vmcnt(0)
v_cmp_gt_u32 vcc, s16, v9
s_cbranch_vccz WD_129
s_sleep 3
s_sub_u32 s20, s20, 1
s_cmp_gt_i32 s20, 0
Zk WF_128
WD_129:
s_mul_i32 s36, s10, 262144
Zb s36,s36,167772160
Zb s36,s36,s14
Zb s16,s10,1
Zp s21,s12
Zb m0,s11,s35
Zb s37,s36,s35
Zh v0,s[4:7],s37 offen sc1 lds
Zb s35,s35,1024
s_and_b32 s35, s35, 0x1fff
Zb m0,s11,s35
Zb s37,s36,s35
Zh v0,s[4:7],s37 offen sc1 lds
Zb s35,s35,1024
s_and_b32 s35, s35, 0x1fff
Zb m0,s11,s35
Zb s37,s36,s35
Zh v0,s[4:7],s37 offen sc1 lds
Zb s35,s35,1024
s_and_b32 s35, s35, 0x1fff
Zb m0,s11,s35
Zb s37,s36,s35
Zh v0,s[4:7],s37 offen sc1 lds
Zb s35,s35,1024
s_and_b32 s35, s35, 0x1fff
Zb m0,s11,s35
Zb s37,s36,s35
Zh v0,s[4:7],s37 offen sc1 lds
Zb s35,s35,1024
s_and_b32 s35, s35, 0x1fff
Zb m0,s11,s35
Zb s37,s36,s35
Zh v0,s[4:7],s37 offen sc1 lds
Zb s35,s35,1024
s_and_b32 s35, s35, 0x1fff
Zb m0,s11,s35
Zb s37,s36,s35
Zh v0,s[4:7],s37 offen sc1 lds
Zb s35,s35,1024
s_and_b32 s35, s35, 0x1fff
Zb m0,s11,s35
Zb s37,s36,s35
Zh v0,s[4:7],s37 offen sc1 lds
Zb s35,s35,1024
s_and_b32 s35, s35, 0x1fff
Zp m0,s32
s_nop 0
Za v3,s[4:7],s21 offen sc1 lds
s_or_b32 s34, s35, 0x8000
Zb m0,s11,s34
Zb s37,s36,s34
Zh v0,s[4:7],s37 offen sc1 lds
Zb s35,s35,1024
s_and_b32 s35, s35, 0x1fff
s_or_b32 s34, s35, 0x8000
Zb m0,s11,s34
Zb s37,s36,s34
Zh v0,s[4:7],s37 offen sc1 lds
Zb s35,s35,1024
s_and_b32 s35, s35, 0x1fff
s_or_b32 s34, s35, 0x8000
Zb m0,s11,s34
Zb s37,s36,s34
Zh v0,s[4:7],s37 offen sc1 lds
Zb s35,s35,1024
s_and_b32 s35, s35, 0x1fff
s_or_b32 s34, s35, 0x8000
Zb m0,s11,s34
Zb s37,s36,s34
Zh v0,s[4:7],s37 offen sc1 lds
Zb s35,s35,1024
s_and_b32 s35, s35, 0x1fff
s_or_b32 s34, s35, 0x8000
Zb m0,s11,s34
Zb s37,s36,s34
Zh v0,s[4:7],s37 offen sc1 lds
Zb s35,s35,1024
s_and_b32 s35, s35, 0x1fff
s_or_b32 s34, s35, 0x8000
Zb m0,s11,s34
Zb s37,s36,s34
Zh v0,s[4:7],s37 offen sc1 lds
Zb s35,s35,1024
s_and_b32 s35, s35, 0x1fff
s_or_b32 s34, s35, 0x8000
Zb m0,s11,s34
Zb s37,s36,s34
Zh v0,s[4:7],s37 offen sc1 lds
Zb s35,s35,1024
s_and_b32 s35, s35, 0x1fff
s_or_b32 s34, s35, 0x8000
Zb m0,s11,s34
Zb s37,s36,s34
Zh v0,s[4:7],s37 offen sc1 lds
Zb s35,s35,1024
s_and_b32 s35, s35, 0x1fff
s_xor_b32 s11, s11, 0x10000
s_xor_b32 s32, s32, 256
Zp s38,1
Zf vmcnt(8)
s_branch BO_I
BO_H:
Zf vmcnt(4)
BO_I:
s_barrier
ds_read_b32 v9, v11
Zb s28,s10,1
Zb s16,s28,1
Zf lgkmcnt(0)
v_cmp_gt_u32 vcc, s16, v9
s_cmp_eq_u64 vcc, 0
s_cselect_b32 s15, 1, 0
s_mul_i32 s36, s28, 262144
Zb s36,s36,167772160
Zb s36,s36,s14
Zb s16,s28,1
Zp s21,s12
Zi v[32:35],v5 offset:0
Zi v[36:39],v5 offset:1024
Zi v[40:43],v5 offset:2048
Zi v[44:47],v5 offset:3072
Zi v[48:51],v5 offset:4096
Zi v[52:55],v5 offset:5120
Zf lgkmcnt(5)
Ze v[16:19],a[0:3],v[32:35],0
Ze v[20:23],a[4:7],v[32:35],0
Zi v[32:35],v5 offset:6144
Zo s15,0
Zk ST_130
Zb m0,s11,s35
Zb s37,s36,s35
Zh v0,s[4:7],s37 offen sc1 lds
Zb s35,s35,1024
s_and_b32 s35, s35, 0x1fff
ST_130:
Zf lgkmcnt(5)
Ze v[24:27],a[0:3],v[36:39],0
Ze v[28:31],a[4:7],v[36:39],0
Zi v[36:39],v5 offset:7168
Zf lgkmcnt(5)
Ze v[16:19],a[8:11],v[40:43],v[16:19]
Ze v[20:23],a[12:15],v[40:43],v[20:23]
Zi v[40:43],v5 offset:8192
Zf lgkmcnt(5)
Ze v[24:27],a[8:11],v[44:47],v[24:27]
Ze v[28:31],a[12:15],v[44:47],v[28:31]
Zi v[44:47],v5 offset:9216
Zo s15,0
Zk ST_131
Zb m0,s11,s35
Zb s37,s36,s35
Zh v0,s[4:7],s37 offen sc1 lds
Zb s35,s35,1024
s_and_b32 s35, s35, 0x1fff
ST_131:
Zf lgkmcnt(5)
Ze v[16:19],a[16:19],v[48:51],v[16:19]
Ze v[20:23],a[20:23],v[48:51],v[20:23]
Zi v[48:51],v5 offset:10240
Zf lgkmcnt(5)
Ze v[24:27],a[16:19],v[52:55],v[24:27]
Ze v[28:31],a[20:23],v[52:55],v[28:31]
Zi v[52:55],v5 offset:11264
Zf lgkmcnt(5)
Ze v[16:19],a[24:27],v[32:35],v[16:19]
Ze v[20:23],a[28:31],v[32:35],v[20:23]
Zi v[32:35],v5 offset:12288
Zo s15,0
Zk ST_132
Zb m0,s11,s35
Zb s37,s36,s35
Zh v0,s[4:7],s37 offen sc1 lds
Zb s35,s35,1024
s_and_b32 s35, s35, 0x1fff
ST_132:
Zf lgkmcnt(5)
Ze v[24:27],a[24:27],v[36:39],v[24:27]
Ze v[28:31],a[28:31],v[36:39],v[28:31]
Zi v[36:39],v5 offset:13312
Zf lgkmcnt(5)
Ze v[16:19],a[32:35],v[40:43],v[16:19]
Ze v[20:23],a[36:39],v[40:43],v[20:23]
Zi v[40:43],v5 offset:14336
Zf lgkmcnt(5)
Ze v[24:27],a[32:35],v[44:47],v[24:27]
Ze v[28:31],a[36:39],v[44:47],v[28:31]
Zi v[44:47],v5 offset:15360
Zo s15,0
Zk ST_133
Zb m0,s11,s35
Zb s37,s36,s35
Zh v0,s[4:7],s37 offen sc1 lds
Zb s35,s35,1024
s_and_b32 s35, s35, 0x1fff
ST_133:
Zf lgkmcnt(5)
Ze v[16:19],a[40:43],v[48:51],v[16:19]
Ze v[20:23],a[44:47],v[48:51],v[20:23]
Zi v[48:51],v5 offset:16384
Zf lgkmcnt(5)
Ze v[24:27],a[40:43],v[52:55],v[24:27]
Ze v[28:31],a[44:47],v[52:55],v[28:31]
Zi v[52:55],v5 offset:17408
Zf lgkmcnt(5)
Ze v[16:19],a[48:51],v[32:35],v[16:19]
Ze v[20:23],a[52:55],v[32:35],v[20:23]
Zi v[32:35],v5 offset:18432
Zo s15,0
Zk ST_134
Zb m0,s11,s35
Zb s37,s36,s35
Zh v0,s[4:7],s37 offen sc1 lds
Zb s35,s35,1024
s_and_b32 s35, s35, 0x1fff
ST_134:
Zf lgkmcnt(5)
Ze v[24:27],a[48:51],v[36:39],v[24:27]
Ze v[28:31],a[52:55],v[36:39],v[28:31]
Zi v[36:39],v5 offset:19456
Zf lgkmcnt(5)
Ze v[16:19],a[56:59],v[40:43],v[16:19]
Ze v[20:23],a[60:63],v[40:43],v[20:23]
Zi v[40:43],v5 offset:20480
Zf lgkmcnt(5)
Ze v[24:27],a[56:59],v[44:47],v[24:27]
Ze v[28:31],a[60:63],v[44:47],v[28:31]
Zi v[44:47],v5 offset:21504
Zo s15,0
Zk ST_135
Zb m0,s11,s35
Zb s37,s36,s35
Zh v0,s[4:7],s37 offen sc1 lds
Zb s35,s35,1024
s_and_b32 s35, s35, 0x1fff
ST_135:
Zf lgkmcnt(5)
Ze v[16:19],a[64:67],v[48:51],v[16:19]
Ze v[20:23],a[68:71],v[48:51],v[20:23]
Zi v[48:51],v5 offset:22528
Zf lgkmcnt(5)
Ze v[24:27],a[64:67],v[52:55],v[24:27]
Ze v[28:31],a[68:71],v[52:55],v[28:31]
Zi v[52:55],v5 offset:23552
Zf lgkmcnt(5)
Ze v[16:19],a[72:75],v[32:35],v[16:19]
Ze v[20:23],a[76:79],v[32:35],v[20:23]
Zi v[32:35],v5 offset:24576
Zo s15,0
Zk ST_136
Zb m0,s11,s35
Zb s37,s36,s35
Zh v0,s[4:7],s37 offen sc1 lds
Zb s35,s35,1024
s_and_b32 s35, s35, 0x1fff
ST_136:
Zf lgkmcnt(5)
Ze v[24:27],a[72:75],v[36:39],v[24:27]
Ze v[28:31],a[76:79],v[36:39],v[28:31]
Zi v[36:39],v5 offset:25600
Zf lgkmcnt(5)
Ze v[16:19],a[80:83],v[40:43],v[16:19]
Ze v[20:23],a[84:87],v[40:43],v[20:23]
Zi v[40:43],v5 offset:26624
Zf lgkmcnt(5)
Ze v[24:27],a[80:83],v[44:47],v[24:27]
Ze v[28:31],a[84:87],v[44:47],v[28:31]
Zi v[44:47],v5 offset:27648
Zo s15,0
Zk ST_137
Zb m0,s11,s35
Zb s37,s36,s35
Zh v0,s[4:7],s37 offen sc1 lds
Zb s35,s35,1024
s_and_b32 s35, s35, 0x1fff
ST_137:
Zf lgkmcnt(5)
Ze v[16:19],a[88:91],v[48:51],v[16:19]
Ze v[20:23],a[92:95],v[48:51],v[20:23]
Zi v[48:51],v5 offset:28672
Zf lgkmcnt(5)
Ze v[24:27],a[88:91],v[52:55],v[24:27]
Ze v[28:31],a[92:95],v[52:55],v[28:31]
Zi v[52:55],v5 offset:29696
Zf lgkmcnt(5)
Ze v[16:19],a[96:99],v[32:35],v[16:19]
Ze v[20:23],a[100:103],v[32:35],v[20:23]
Zi v[32:35],v5 offset:30720
Zo s15,0
Zk ST_138
s_or_b32 s34, s35, 0x8000
Zb m0,s11,s34
Zb s37,s36,s34
Zh v0,s[4:7],s37 offen sc1 lds
Zb s35,s35,1024
s_and_b32 s35, s35, 0x1fff
ST_138:
s_or_b32 s38, s38, s33
s_cbranch_scc0 MD_139
Zp s38,0
Zf vmcnt(9)
s_cmp_lg_u32 s15, 0
Zk ME_140
Zf vmcnt(0)
ME_140:
s_barrier
Zo s33,0
Zk MD_139
s_cmp_lg_u32 s9, 0
Zk SF_141
Zs v9,s33
Zu v9,off,s[4:7],s13 sc1
SF_141:
MD_139:
Zf lgkmcnt(5)
Ze v[24:27],a[96:99],v[36:39],v[24:27]
Ze v[28:31],a[100:103],v[36:39],v[28:31]
Zi v[36:39],v5 offset:31744
Zf lgkmcnt(5)
Ze v[16:19],a[104:107],v[40:43],v[16:19]
Ze v[20:23],a[108:111],v[40:43],v[20:23]
Zi v[40:43],v5 offset:32768
Zf lgkmcnt(5)
Ze v[24:27],a[104:107],v[44:47],v[24:27]
Ze v[28:31],a[108:111],v[44:47],v[28:31]
Zi v[44:47],v5 offset:33792
Zo s15,0
Zk ST_142
s_or_b32 s34, s35, 0x8000
Zb m0,s11,s34
Zb s37,s36,s34
Zh v0,s[4:7],s37 offen sc1 lds
Zb s35,s35,1024
s_and_b32 s35, s35, 0x1fff
ST_142:
Zf lgkmcnt(5)
Ze v[16:19],a[112:115],v[48:51],v[16:19]
Ze v[20:23],a[116:119],v[48:51],v[20:23]
Zi v[48:51],v5 offset:34816
Zf lgkmcnt(5)
Ze v[24:27],a[112:115],v[52:55],v[24:27]
Ze v[28:31],a[116:119],v[52:55],v[28:31]
Zi v[52:55],v5 offset:35840
Zf lgkmcnt(5)
Ze v[16:19],a[120:123],v[32:35],v[16:19]
Ze v[20:23],a[124:127],v[32:35],v[20:23]
Zi v[32:35],v5 offset:36864
Zo s15,0
Zk ST_143
s_or_b32 s34, s35, 0x8000
Zb m0,s11,s34
Zb s37,s36,s34
Zh v0,s[4:7],s37 offen sc1 lds
Zb s35,s35,1024
s_and_b32 s35, s35, 0x1fff
ST_143:
Zf lgkmcnt(5)
Ze v[24:27],a[120:123],v[36:39],v[24:27]
Ze v[28:31],a[124:127],v[36:39],v[28:31]
Zi v[36:39],v5 offset:37888
Zf lgkmcnt(5)
Ze v[16:19],a[128:131],v[40:43],v[16:19]
Ze v[20:23],a[132:135],v[40:43],v[20:23]
Zi v[40:43],v5 offset:38912
Zf lgkmcnt(5)
Ze v[24:27],a[128:131],v[44:47],v[24:27]
Ze v[28:31],a[132:135],v[44:47],v[28:31]
Zi v[44:47],v5 offset:39936
Zo s15,0
Zk ST_144
s_or_b32 s34, s35, 0x8000
Zb m0,s11,s34
Zb s37,s36,s34
Zh v0,s[4:7],s37 offen sc1 lds
Zb s35,s35,1024
s_and_b32 s35, s35, 0x1fff
ST_144:
Zf lgkmcnt(5)
Ze v[16:19],a[136:139],v[48:51],v[16:19]
Ze v[20:23],a[140:143],v[48:51],v[20:23]
Zi v[48:51],v5 offset:40960
Zf lgkmcnt(5)
Ze v[24:27],a[136:139],v[52:55],v[24:27]
Ze v[28:31],a[140:143],v[52:55],v[28:31]
Zi v[52:55],v5 offset:41984
Zf lgkmcnt(5)
Ze v[16:19],a[144:147],v[32:35],v[16:19]
Ze v[20:23],a[148:151],v[32:35],v[20:23]
Zi v[32:35],v5 offset:43008
Zo s15,0
Zk ST_145
s_or_b32 s34, s35, 0x8000
Zb m0,s11,s34
Zb s37,s36,s34
Zh v0,s[4:7],s37 offen sc1 lds
Zb s35,s35,1024
s_and_b32 s35, s35, 0x1fff
ST_145:
Zf lgkmcnt(5)
Ze v[24:27],a[144:147],v[36:39],v[24:27]
Ze v[28:31],a[148:151],v[36:39],v[28:31]
Zi v[36:39],v5 offset:44032
Zf lgkmcnt(5)
Ze v[16:19],a[152:155],v[40:43],v[16:19]
Ze v[20:23],a[156:159],v[40:43],v[20:23]
Zi v[40:43],v5 offset:45056
Zf lgkmcnt(5)
Ze v[24:27],a[152:155],v[44:47],v[24:27]
Ze v[28:31],a[156:159],v[44:47],v[28:31]
Zi v[44:47],v5 offset:46080
Zo s15,0
Zk ST_146
s_or_b32 s34, s35, 0x8000
Zb m0,s11,s34
Zb s37,s36,s34
Zh v0,s[4:7],s37 offen sc1 lds
Zb s35,s35,1024
s_and_b32 s35, s35, 0x1fff
ST_146:
Zf lgkmcnt(5)
Ze v[16:19],a[160:163],v[48:51],v[16:19]
Ze v[20:23],a[164:167],v[48:51],v[20:23]
Zi v[48:51],v5 offset:47104
Zf lgkmcnt(5)
Ze v[24:27],a[160:163],v[52:55],v[24:27]
Ze v[28:31],a[164:167],v[52:55],v[28:31]
Zi v[52:55],v5 offset:48128
Zf lgkmcnt(5)
Ze v[16:19],a[168:171],v[32:35],v[16:19]
Ze v[20:23],a[172:175],v[32:35],v[20:23]
Zi v[32:35],v5 offset:49152
Zo s15,0
Zk ST_147
s_or_b32 s34, s35, 0x8000
Zb m0,s11,s34
Zb s37,s36,s34
Zh v0,s[4:7],s37 offen sc1 lds
Zb s35,s35,1024
s_and_b32 s35, s35, 0x1fff
ST_147:
Zf lgkmcnt(5)
Ze v[24:27],a[168:171],v[36:39],v[24:27]
Ze v[28:31],a[172:175],v[36:39],v[28:31]
Zi v[36:39],v5 offset:50176
Zf lgkmcnt(5)
Ze v[16:19],a[176:179],v[40:43],v[16:19]
Ze v[20:23],a[180:183],v[40:43],v[20:23]
Zi v[40:43],v5 offset:51200
Zf lgkmcnt(5)
Ze v[24:27],a[176:179],v[44:47],v[24:27]
Ze v[28:31],a[180:183],v[44:47],v[28:31]
Zi v[44:47],v5 offset:52224
Zo s15,0
Zk ST_148
s_or_b32 s34, s35, 0x8000
Zb m0,s11,s34
Zb s37,s36,s34
Zh v0,s[4:7],s37 offen sc1 lds
Zb s35,s35,1024
s_and_b32 s35, s35, 0x1fff
ST_148:
Zf lgkmcnt(5)
Ze v[16:19],a[184:187],v[48:51],v[16:19]
Ze v[20:23],a[188:191],v[48:51],v[20:23]
Zi v[48:51],v5 offset:53248
Zf lgkmcnt(5)
Ze v[24:27],a[184:187],v[52:55],v[24:27]
Ze v[28:31],a[188:191],v[52:55],v[28:31]
Zi v[52:55],v5 offset:54272
Zf lgkmcnt(5)
Ze v[16:19],a[192:195],v[32:35],v[16:19]
Ze v[20:23],a[196:199],v[32:35],v[20:23]
Zi v[32:35],v5 offset:55296
Zo s15,0
Zk ST_149
Zp m0,s32
s_nop 0
Za v3,s[4:7],s21 offen sc1 lds
s_xor_b32 s11, s11, 0x10000
s_xor_b32 s32, s32, 256
ST_149:
Zf lgkmcnt(5)
Ze v[24:27],a[192:195],v[36:39],v[24:27]
Ze v[28:31],a[196:199],v[36:39],v[28:31]
Zi v[36:39],v5 offset:56320
Zf lgkmcnt(5)
Ze v[16:19],a[200:203],v[40:43],v[16:19]
Ze v[20:23],a[204:207],v[40:43],v[20:23]
Zi v[40:43],v5 offset:57344
Zf lgkmcnt(5)
Ze v[24:27],a[200:203],v[44:47],v[24:27]
Ze v[28:31],a[204:207],v[44:47],v[28:31]
Zi v[44:47],v5 offset:58368
Zf lgkmcnt(5)
Ze v[16:19],a[208:211],v[48:51],v[16:19]
Ze v[20:23],a[212:215],v[48:51],v[20:23]
Zi v[48:51],v5 offset:59392
Zf lgkmcnt(5)
Ze v[24:27],a[208:211],v[52:55],v[24:27]
Ze v[28:31],a[212:215],v[52:55],v[28:31]
Zi v[52:55],v5 offset:60416
Zf lgkmcnt(5)
Ze v[16:19],a[216:219],v[32:35],v[16:19]
Ze v[20:23],a[220:223],v[32:35],v[20:23]
Zi v[32:35],v5 offset:61440
Zf lgkmcnt(5)
Ze v[24:27],a[216:219],v[36:39],v[24:27]
Ze v[28:31],a[220:223],v[36:39],v[28:31]
Zi v[36:39],v5 offset:62464
Zf lgkmcnt(5)
Ze v[16:19],a[224:227],v[40:43],v[16:19]
Ze v[20:23],a[228:231],v[40:43],v[20:23]
Zi v[40:43],v5 offset:63488
Zf lgkmcnt(5)
Ze v[24:27],a[224:227],v[44:47],v[24:27]
Ze v[28:31],a[228:231],v[44:47],v[28:31]
Zi v[44:47],v5 offset:64512
Zf lgkmcnt(5)
Ze v[16:19],a[232:235],v[48:51],v[16:19]
Ze v[20:23],a[236:239],v[48:51],v[20:23]
Zf lgkmcnt(4)
Ze v[24:27],a[232:235],v[52:55],v[24:27]
Ze v[28:31],a[236:239],v[52:55],v[28:31]
Zf lgkmcnt(3)
Ze v[16:19],a[240:243],v[32:35],v[16:19]
Ze v[20:23],a[244:247],v[32:35],v[20:23]
Zf lgkmcnt(2)
Ze v[24:27],a[240:243],v[36:39],v[24:27]
Ze v[28:31],a[244:247],v[36:39],v[28:31]
Zf lgkmcnt(1)
Ze v[16:19],a[248:251],v[40:43],v[16:19]
Ze v[20:23],a[252:255],v[40:43],v[20:23]
Zf lgkmcnt(0)
Ze v[24:27],a[248:251],v[44:47],v[24:27]
Ze v[28:31],a[252:255],v[44:47],v[28:31]
s_mul_i32 s18, s10, 327680
Zb s18,s18,s29
Zb s19,s18,40960
Zs v32,v16
Zs v33,v20
Zs v34,v17
Zs v35,v21
Zs v36,v18
Zs v37,v22
Zs v38,v19
Zs v39,v23
Zr v[32:35],v10,s[4:7],s18 offen offset:0 sc1
Zr v[36:39],v10,s[4:7],s18 offen offset:64 sc1
Zs v40,v24
Zs v41,v28
Zs v42,v25
Zs v43,v29
Zs v44,v26
Zs v45,v30
Zs v46,v27
Zs v47,v31
Zr v[40:43],v10,s[4:7],s19 offen offset:0 sc1
Zr v[44:47],v10,s[4:7],s19 offen offset:64 sc1
Zb s33,s10,1
s_and_b32 s16, s10, 63
s_cselect_b32 s16, s15, 0
s_cmp_lg_u32 s16, 0
Zk BO_N
Zf vmcnt(0)
s_barrier
s_cmp_lg_u32 s9, 0
Zk SF_150
Zs v9,s33
Zu v9,off,s[4:7],s13 sc1
SF_150:
Zp s33,0
BO_N:
v_xor_b32 v5, 0x10000, v5
v_xor_b32 v11, 256, v11
Zp s10,s28
s_cmp_lt_u32 s10, 128
Zk BO_L
Zf vmcnt(0)
s_endpgm
R_RB:
Zy v0,63,v0
Zy v1,15,v0
v_lshrrev_b32 v2, 4, v0
Zz v0,4,v0
Zp s22,0x05040100
Zp s23,0x07060302
Zp s20,300000
v_lshrrev_b32 v3, 2, v0
v_min_u32 v3, 76, v3
v_lshrrev_b32 v4, 1, v0
v_lshrrev_b32 v6, 1, v1
Zy v6,3,v6
Zz v5,4,v6
v_lshrrev_b32 v6, 3, v1
v_lshl_add_u32 v5, v6, 3, v5
Zy v6,1,v1
v_lshl_add_u32 v5, v6, 2, v5
v_lshl_add_u32 v5, v2, 6, v5
s_lshr_b32 s30, s8, 1
s_and_b32 s10, s8, 1
Zq s31,s30,2
Zb s31,s31,s9
s_load_dwordx2 s[24:25], s[0:1], 96
Zp s26,2621440
Zp s27,0x20000
Zq s13,s30,2
Zq s19,s10,7
Zb s13,s13,s19
Zb s13,s13,8192
Zp s12,9984
Zf lgkmcnt(0)
RB_L:
s_and_b32 s14, s10, 63
Zq s14,s14,5
Zb s14,s14,s31
s_mul_i32 s14, s14, 1280
s_lshr_b32 s15, s10, 6
s_mul_i32 s15, s15, 5242880
Zb s15,s15,s14
Zb s15,s15,113770496
Zb s16,s10,1
WF_151:
Za v9,v3,s[4:7],s12 offen sc1
Zf vmcnt(0)
v_cmp_gt_u32 vcc, s16, v9
s_cbranch_vccz WD_152
s_sleep 3
s_sub_u32 s20, s20, 1
s_cmp_gt_i32 s20, 0
Zk WF_151
WD_152:
s_mul_i32 s18, s10, 327680
s_mul_i32 s19, s31, 2560
Zb s18,s18,s19
Zb s18,s18,218103808
buffer_load_dwordx2 v[64:65], v4, s[4:7], s18 offen offset:0 sc1
buffer_load_dwordx2 v[66:67], v4, s[4:7], s18 offen offset:512 sc1
buffer_load_dwordx2 v[68:69], v4, s[4:7], s18 offen offset:1024 sc1
buffer_load_dwordx2 v[70:71], v4, s[4:7], s18 offen offset:1536 sc1
buffer_load_dwordx2 v[72:73], v4, s[4:7], s18 offen offset:2048 sc1
Zb s18,s18,81920
buffer_load_dwordx2 v[74:75], v4, s[4:7], s18 offen offset:0 sc1
buffer_load_dwordx2 v[76:77], v4, s[4:7], s18 offen offset:512 sc1
buffer_load_dwordx2 v[78:79], v4, s[4:7], s18 offen offset:1024 sc1
buffer_load_dwordx2 v[80:81], v4, s[4:7], s18 offen offset:1536 sc1
buffer_load_dwordx2 v[82:83], v4, s[4:7], s18 offen offset:2048 sc1
Zb s18,s18,81920
buffer_load_dwordx2 v[84:85], v4, s[4:7], s18 offen offset:0 sc1
buffer_load_dwordx2 v[86:87], v4, s[4:7], s18 offen offset:512 sc1
buffer_load_dwordx2 v[88:89], v4, s[4:7], s18 offen offset:1024 sc1
buffer_load_dwordx2 v[90:91], v4, s[4:7], s18 offen offset:1536 sc1
buffer_load_dwordx2 v[92:93], v4, s[4:7], s18 offen offset:2048 sc1
Zb s18,s18,81920
buffer_load_dwordx2 v[94:95], v4, s[4:7], s18 offen offset:0 sc1
buffer_load_dwordx2 v[96:97], v4, s[4:7], s18 offen offset:512 sc1
buffer_load_dwordx2 v[98:99], v4, s[4:7], s18 offen offset:1024 sc1
buffer_load_dwordx2 v[100:101], v4, s[4:7], s18 offen offset:1536 sc1
buffer_load_dwordx2 v[102:103], v4, s[4:7], s18 offen offset:2048 sc1
Za v16,v5,s[4:7],s15 offen offset:0 sc1
Za v17,v5,s[4:7],s15 offen offset:256 sc1
Za v18,v5,s[4:7],s15 offen offset:512 sc1
Za v19,v5,s[4:7],s15 offen offset:768 sc1
Za v20,v5,s[4:7],s15 offen offset:1024 sc1
Zf vmcnt(19)
Zl v64,v64,v74
Zl v65,v65,v75
Zf vmcnt(18)
Zl v66,v66,v76
Zl v67,v67,v77
Zf vmcnt(17)
Zl v68,v68,v78
Zl v69,v69,v79
Zf vmcnt(16)
Zl v70,v70,v80
Zl v71,v71,v81
Zf vmcnt(15)
Zl v72,v72,v82
Zl v73,v73,v83
Zf vmcnt(14)
Zl v64,v64,v84
Zl v65,v65,v85
Zf vmcnt(13)
Zl v66,v66,v86
Zl v67,v67,v87
Zf vmcnt(12)
Zl v68,v68,v88
Zl v69,v69,v89
Zf vmcnt(11)
Zl v70,v70,v90
Zl v71,v71,v91
Zf vmcnt(10)
Zl v72,v72,v92
Zl v73,v73,v93
Zf vmcnt(9)
Zl v64,v64,v94
Zl v65,v65,v95
Zf vmcnt(8)
Zl v66,v66,v96
Zl v67,v67,v97
Zf vmcnt(7)
Zl v68,v68,v98
Zl v69,v69,v99
Zf vmcnt(6)
Zl v70,v70,v100
Zl v71,v71,v101
Zf vmcnt(5)
Zl v72,v72,v102
Zl v73,v73,v103
Zj v112,v64,v65
Zy v65,0xffff0000,v112
Zz v64,16,v112
Zf vmcnt(4)
Zy v129,0xffff0000,v16
Zz v128,16,v16
Zj v113,v66,v67
Zy v67,0xffff0000,v113
Zz v66,16,v113
Zf vmcnt(3)
Zy v131,0xffff0000,v17
Zz v130,16,v17
Zj v114,v68,v69
Zy v69,0xffff0000,v114
Zz v68,16,v114
Zf vmcnt(2)
Zy v133,0xffff0000,v18
Zz v132,16,v18
Zj v115,v70,v71
Zy v71,0xffff0000,v115
Zz v70,16,v115
Zf vmcnt(1)
Zy v135,0xffff0000,v19
Zz v134,16,v19
Zj v116,v72,v73
Zy v73,0xffff0000,v116
Zz v72,16,v116
Zf vmcnt(0)
Zy v137,0xffff0000,v20
Zz v136,16,v20
Zl v128,v128,v64
Zl v129,v129,v65
Zl v130,v130,v66
Zl v131,v131,v67
Zl v132,v132,v68
Zl v133,v133,v69
Zl v134,v134,v70
Zl v135,v135,v71
Zl v136,v136,v72
Zl v137,v137,v73
Zj v112,v128,v129
Zj v113,v130,v131
Zj v114,v132,v133
Zj v115,v134,v135
Zj v116,v136,v137
Zb s15,s15,2621440
s_cmp_lt_u32 s10, 64
Zk RB_X
Zu v112,v5,s[24:27],s14 offen offset:0
Zu v113,v5,s[24:27],s14 offen offset:256
Zu v114,v5,s[24:27],s14 offen offset:512
Zu v115,v5,s[24:27],s14 offen offset:768
Zu v116,v5,s[24:27],s14 offen offset:1024
s_branch RB_N
RB_X:
s_mul_i32 s18, s10, 40960
s_mul_i32 s19, s31, 1280
Zb s18,s18,s19
Zb s18,s18,103284736
Zy v129,0xffff0000,v112
Zz v128,16,v112
Zy v131,0xffff0000,v113
Zz v130,16,v113
Zy v133,0xffff0000,v114
Zz v132,16,v114
Zy v135,0xffff0000,v115
Zz v134,16,v115
Zy v137,0xffff0000,v116
Zz v136,16,v116
Zl v143,v128,v129
Zl v143,v143,v130
Zl v143,v143,v131
Zl v143,v143,v132
Zl v143,v143,v133
Zl v143,v143,v134
Zl v143,v143,v135
Zl v143,v143,v136
Zl v143,v143,v137
s_nop 1
v_add_f32_dpp v143, v143, v143 row_ror:8 row_mask:0xf bank_mask:0xf
s_nop 1
v_add_f32_dpp v143, v143, v143 row_ror:4 row_mask:0xf bank_mask:0xf
s_nop 1
v_add_f32_dpp v143, v143, v143 row_ror:2 row_mask:0xf bank_mask:0xf
s_nop 1
v_add_f32_dpp v143, v143, v143 row_ror:1 row_mask:0xf bank_mask:0xf
Zs v144,v143
s_nop 1
v_permlane32_swap_b32 v143, v144
Zl v143,v143,v144
Zs v144,v143
s_nop 1
v_permlane16_swap_b32 v143, v144
Zl v143,v143,v144
Zw v143,986500301,v143
Zx v128,v128,v143
Zx v129,v129,v143
Zx v130,v130,v143
Zx v131,v131,v143
Zx v132,v132,v143
Zx v133,v133,v143
Zx v134,v134,v143
Zx v135,v135,v143
Zx v136,v136,v143
Zx v137,v137,v143
Zw v143,v128,v128
v_fmac_f32 v143, v129, v129
v_fmac_f32 v143, v130, v130
v_fmac_f32 v143, v131, v131
v_fmac_f32 v143, v132, v132
v_fmac_f32 v143, v133, v133
v_fmac_f32 v143, v134, v134
v_fmac_f32 v143, v135, v135
v_fmac_f32 v143, v136, v136
v_fmac_f32 v143, v137, v137
s_nop 1
v_add_f32_dpp v143, v143, v143 row_ror:8 row_mask:0xf bank_mask:0xf
s_nop 1
v_add_f32_dpp v143, v143, v143 row_ror:4 row_mask:0xf bank_mask:0xf
s_nop 1
v_add_f32_dpp v143, v143, v143 row_ror:2 row_mask:0xf bank_mask:0xf
s_nop 1
v_add_f32_dpp v143, v143, v143 row_ror:1 row_mask:0xf bank_mask:0xf
Zs v144,v143
s_nop 1
v_permlane32_swap_b32 v143, v144
Zl v143,v143,v144
Zs v144,v143
s_nop 1
v_permlane16_swap_b32 v143, v144
Zl v143,v143,v144
Zs v144,925353388
v_fmac_f32 v144, 986500301, v143
v_rsq_f32 v144, v144
s_nop 0
Zw v128,v128,v144
Zw v129,v129,v144
Zw v130,v130,v144
Zw v131,v131,v144
Zw v132,v132,v144
Zw v133,v133,v144
Zw v134,v134,v144
Zw v135,v135,v144
Zw v136,v136,v144
Zw v137,v137,v144
Zj v138,v128,v129
Zj v139,v130,v131
Zj v140,v132,v133
Zj v141,v134,v135
Zj v142,v136,v137
Zu v138,v5,s[4:7],s18 offen offset:0 sc1
Zu v139,v5,s[4:7],s18 offen offset:256 sc1
Zu v140,v5,s[4:7],s18 offen offset:512 sc1
Zu v141,v5,s[4:7],s18 offen offset:768 sc1
Zu v142,v5,s[4:7],s18 offen offset:1024 sc1
Zu v112,v5,s[4:7],s15 offen offset:0 sc1
Zu v113,v5,s[4:7],s15 offen offset:256 sc1
Zu v114,v5,s[4:7],s15 offen offset:512 sc1
Zu v115,v5,s[4:7],s15 offen offset:768 sc1
Zu v116,v5,s[4:7],s15 offen offset:1024 sc1
Zf vmcnt(0)
s_barrier
Zb s16,s10,65
s_cmp_lg_u32 s9, 0
Zk SF_153
Zs v9,s16
Zu v9,off,s[4:7],s13 sc1
SF_153:
RB_N:
Zb s10,s10,2
s_cmp_lt_u32 s10, 128
Zk RB_L
Zf vmcnt(0)
s_endpgm
R_AK:
Zy v0,63,v0
Zy v1,15,v0
v_lshrrev_b32 v2, 4, v0
Zz v0,4,v0
Zp s22,0x05040100
Zp s23,0x07060302
Zp s20,300000
Zs v9,2130706432
s_and_b32 s19, s9, 1
Zq s19,s19,3
Zb s34,s0,s19
s_addc_u32 s35, s1, 0
s_load_dwordx2 s[24:25], s[34:35], 16
Zp s26,25600
Zp s27,0x20000
Zp s17,0
v_mul_u32_u24 v4, 320, v2
v_lshl_add_u32 v4, v1, 2, v4
v_cmp_le_u32 vcc, 10, v1
s_nop 1
v_cndmask_b32 v4, v4, v9, vcc
Zb s19,s17,0
Zf lgkmcnt(0)
Za v64,v4,s[24:27],s19 offen
Zb s19,s17,40
Za v65,v4,s[24:27],s19 offen
Zb s19,s17,80
Za v66,v4,s[24:27],s19 offen
Zb s19,s17,120
Za v67,v4,s[24:27],s19 offen
Zb s19,s17,160
Za v68,v4,s[24:27],s19 offen
Zb s19,s17,200
Za v69,v4,s[24:27],s19 offen
Zb s19,s17,240
Za v70,v4,s[24:27],s19 offen
Zb s19,s17,280
Za v71,v4,s[24:27],s19 offen
Zb s19,s17,1280
Za v72,v4,s[24:27],s19 offen
Zb s19,s17,1320
Za v73,v4,s[24:27],s19 offen
Zb s19,s17,1360
Za v74,v4,s[24:27],s19 offen
Zb s19,s17,1400
Za v75,v4,s[24:27],s19 offen
Zb s19,s17,1440
Za v76,v4,s[24:27],s19 offen
Zb s19,s17,1480
Za v77,v4,s[24:27],s19 offen
Zb s19,s17,1520
Za v78,v4,s[24:27],s19 offen
Zb s19,s17,1560
Za v79,v4,s[24:27],s19 offen
Zb s19,s17,2560
Za v80,v4,s[24:27],s19 offen
Zb s19,s17,2600
Za v81,v4,s[24:27],s19 offen
Zb s19,s17,2640
Za v82,v4,s[24:27],s19 offen
Zb s19,s17,2680
Za v83,v4,s[24:27],s19 offen
Zb s19,s17,2720
Za v84,v4,s[24:27],s19 offen
Zb s19,s17,2760
Za v85,v4,s[24:27],s19 offen
Zb s19,s17,2800
Za v86,v4,s[24:27],s19 offen
Zb s19,s17,2840
Za v87,v4,s[24:27],s19 offen
Zb s19,s17,3840
Za v88,v4,s[24:27],s19 offen
Zb s19,s17,3880
Za v89,v4,s[24:27],s19 offen
Zb s19,s17,3920
Za v90,v4,s[24:27],s19 offen
Zb s19,s17,3960
Za v91,v4,s[24:27],s19 offen
Zb s19,s17,4000
Za v92,v4,s[24:27],s19 offen
Zb s19,s17,4040
Za v93,v4,s[24:27],s19 offen
Zb s19,s17,4080
Za v94,v4,s[24:27],s19 offen
Zb s19,s17,4120
Za v95,v4,s[24:27],s19 offen
Zb s19,s17,5120
Za v96,v4,s[24:27],s19 offen
Zb s19,s17,5160
Za v97,v4,s[24:27],s19 offen
Zb s19,s17,5200
Za v98,v4,s[24:27],s19 offen
Zb s19,s17,5240
Za v99,v4,s[24:27],s19 offen
Zb s19,s17,5280
Za v100,v4,s[24:27],s19 offen
Zb s19,s17,5320
Za v101,v4,s[24:27],s19 offen
Zb s19,s17,5360
Za v102,v4,s[24:27],s19 offen
Zb s19,s17,5400
Za v103,v4,s[24:27],s19 offen
Zb s19,s17,6400
Za v104,v4,s[24:27],s19 offen
Zb s19,s17,6440
Za v105,v4,s[24:27],s19 offen
Zb s19,s17,6480
Za v106,v4,s[24:27],s19 offen
Zb s19,s17,6520
Za v107,v4,s[24:27],s19 offen
Zb s19,s17,6560
Za v108,v4,s[24:27],s19 offen
Zb s19,s17,6600
Za v109,v4,s[24:27],s19 offen
Zb s19,s17,6640
Za v110,v4,s[24:27],s19 offen
Zb s19,s17,6680
Za v111,v4,s[24:27],s19 offen
Zf vmcnt(46)
Zc v56,v65,v64,s22
Zf vmcnt(44)
Zc v57,v67,v66,s22
Zf vmcnt(42)
Zc v58,v69,v68,s22
Zf vmcnt(40)
Zc v59,v71,v70,s22
Zc v60,v65,v64,s23
Zc v61,v67,v66,s23
Zc v62,v69,v68,s23
Zc v63,v71,v70,s23
Zd a0,v56
Zd a1,v57
Zd a2,v58
Zd a3,v59
Zd a4,v60
Zd a5,v61
Zd a6,v62
Zd a7,v63
Zb s19,s17,7680
Za v64,v4,s[24:27],s19 offen
Zb s19,s17,7720
Za v65,v4,s[24:27],s19 offen
Zb s19,s17,7760
Za v66,v4,s[24:27],s19 offen
Zb s19,s17,7800
Za v67,v4,s[24:27],s19 offen
Zb s19,s17,7840
Za v68,v4,s[24:27],s19 offen
Zb s19,s17,7880
Za v69,v4,s[24:27],s19 offen
Zb s19,s17,7920
Za v70,v4,s[24:27],s19 offen
Zb s19,s17,7960
Za v71,v4,s[24:27],s19 offen
Zf vmcnt(46)
Zc v56,v73,v72,s22
Zf vmcnt(44)
Zc v57,v75,v74,s22
Zf vmcnt(42)
Zc v58,v77,v76,s22
Zf vmcnt(40)
Zc v59,v79,v78,s22
Zc v60,v73,v72,s23
Zc v61,v75,v74,s23
Zc v62,v77,v76,s23
Zc v63,v79,v78,s23
Zd a8,v56
Zd a9,v57
Zd a10,v58
Zd a11,v59
Zd a12,v60
Zd a13,v61
Zd a14,v62
Zd a15,v63
Zb s19,s17,8960
Za v72,v4,s[24:27],s19 offen
Zb s19,s17,9000
Za v73,v4,s[24:27],s19 offen
Zb s19,s17,9040
Za v74,v4,s[24:27],s19 offen
Zb s19,s17,9080
Za v75,v4,s[24:27],s19 offen
Zb s19,s17,9120
Za v76,v4,s[24:27],s19 offen
Zb s19,s17,9160
Za v77,v4,s[24:27],s19 offen
Zb s19,s17,9200
Za v78,v4,s[24:27],s19 offen
Zb s19,s17,9240
Za v79,v4,s[24:27],s19 offen
Zf vmcnt(46)
Zc v56,v81,v80,s22
Zf vmcnt(44)
Zc v57,v83,v82,s22
Zf vmcnt(42)
Zc v58,v85,v84,s22
Zf vmcnt(40)
Zc v59,v87,v86,s22
Zc v60,v81,v80,s23
Zc v61,v83,v82,s23
Zc v62,v85,v84,s23
Zc v63,v87,v86,s23
Zd a16,v56
Zd a17,v57
Zd a18,v58
Zd a19,v59
Zd a20,v60
Zd a21,v61
Zd a22,v62
Zd a23,v63
Zb s19,s17,10240
Za v80,v4,s[24:27],s19 offen
Zb s19,s17,10280
Za v81,v4,s[24:27],s19 offen
Zb s19,s17,10320
Za v82,v4,s[24:27],s19 offen
Zb s19,s17,10360
Za v83,v4,s[24:27],s19 offen
Zb s19,s17,10400
Za v84,v4,s[24:27],s19 offen
Zb s19,s17,10440
Za v85,v4,s[24:27],s19 offen
Zb s19,s17,10480
Za v86,v4,s[24:27],s19 offen
Zb s19,s17,10520
Za v87,v4,s[24:27],s19 offen
Zf vmcnt(46)
Zc v56,v89,v88,s22
Zf vmcnt(44)
Zc v57,v91,v90,s22
Zf vmcnt(42)
Zc v58,v93,v92,s22
Zf vmcnt(40)
Zc v59,v95,v94,s22
Zc v60,v89,v88,s23
Zc v61,v91,v90,s23
Zc v62,v93,v92,s23
Zc v63,v95,v94,s23
Zd a24,v56
Zd a25,v57
Zd a26,v58
Zd a27,v59
Zd a28,v60
Zd a29,v61
Zd a30,v62
Zd a31,v63
Zb s19,s17,11520
Za v88,v4,s[24:27],s19 offen
Zb s19,s17,11560
Za v89,v4,s[24:27],s19 offen
Zb s19,s17,11600
Za v90,v4,s[24:27],s19 offen
Zb s19,s17,11640
Za v91,v4,s[24:27],s19 offen
Zb s19,s17,11680
Za v92,v4,s[24:27],s19 offen
Zb s19,s17,11720
Za v93,v4,s[24:27],s19 offen
Zb s19,s17,11760
Za v94,v4,s[24:27],s19 offen
Zb s19,s17,11800
Za v95,v4,s[24:27],s19 offen
Zf vmcnt(46)
Zc v56,v97,v96,s22
Zf vmcnt(44)
Zc v57,v99,v98,s22
Zf vmcnt(42)
Zc v58,v101,v100,s22
Zf vmcnt(40)
Zc v59,v103,v102,s22
Zc v60,v97,v96,s23
Zc v61,v99,v98,s23
Zc v62,v101,v100,s23
Zc v63,v103,v102,s23
Zd a32,v56
Zd a33,v57
Zd a34,v58
Zd a35,v59
Zd a36,v60
Zd a37,v61
Zd a38,v62
Zd a39,v63
Zb s19,s17,12800
Za v96,v4,s[24:27],s19 offen
Zb s19,s17,12840
Za v97,v4,s[24:27],s19 offen
Zb s19,s17,12880
Za v98,v4,s[24:27],s19 offen
Zb s19,s17,12920
Za v99,v4,s[24:27],s19 offen
Zb s19,s17,12960
Za v100,v4,s[24:27],s19 offen
Zb s19,s17,13000
Za v101,v4,s[24:27],s19 offen
Zb s19,s17,13040
Za v102,v4,s[24:27],s19 offen
Zb s19,s17,13080
Za v103,v4,s[24:27],s19 offen
Zf vmcnt(46)
Zc v56,v105,v104,s22
Zf vmcnt(44)
Zc v57,v107,v106,s22
Zf vmcnt(42)
Zc v58,v109,v108,s22
Zf vmcnt(40)
Zc v59,v111,v110,s22
Zc v60,v105,v104,s23
Zc v61,v107,v106,s23
Zc v62,v109,v108,s23
Zc v63,v111,v110,s23
Zd a40,v56
Zd a41,v57
Zd a42,v58
Zd a43,v59
Zd a44,v60
Zd a45,v61
Zd a46,v62
Zd a47,v63
Zb s19,s17,14080
Za v104,v4,s[24:27],s19 offen
Zb s19,s17,14120
Za v105,v4,s[24:27],s19 offen
Zb s19,s17,14160
Za v106,v4,s[24:27],s19 offen
Zb s19,s17,14200
Za v107,v4,s[24:27],s19 offen
Zb s19,s17,14240
Za v108,v4,s[24:27],s19 offen
Zb s19,s17,14280
Za v109,v4,s[24:27],s19 offen
Zb s19,s17,14320
Za v110,v4,s[24:27],s19 offen
Zb s19,s17,14360
Za v111,v4,s[24:27],s19 offen
Zf vmcnt(46)
Zc v56,v65,v64,s22
Zf vmcnt(44)
Zc v57,v67,v66,s22
Zf vmcnt(42)
Zc v58,v69,v68,s22
Zf vmcnt(40)
Zc v59,v71,v70,s22
Zc v60,v65,v64,s23
Zc v61,v67,v66,s23
Zc v62,v69,v68,s23
Zc v63,v71,v70,s23
Zd a48,v56
Zd a49,v57
Zd a50,v58
Zd a51,v59
Zd a52,v60
Zd a53,v61
Zd a54,v62
Zd a55,v63
Zb s19,s17,15360
Za v64,v4,s[24:27],s19 offen
Zb s19,s17,15400
Za v65,v4,s[24:27],s19 offen
Zb s19,s17,15440
Za v66,v4,s[24:27],s19 offen
Zb s19,s17,15480
Za v67,v4,s[24:27],s19 offen
Zb s19,s17,15520
Za v68,v4,s[24:27],s19 offen
Zb s19,s17,15560
Za v69,v4,s[24:27],s19 offen
Zb s19,s17,15600
Za v70,v4,s[24:27],s19 offen
Zb s19,s17,15640
Za v71,v4,s[24:27],s19 offen
Zf vmcnt(46)
Zc v56,v73,v72,s22
Zf vmcnt(44)
Zc v57,v75,v74,s22
Zf vmcnt(42)
Zc v58,v77,v76,s22
Zf vmcnt(40)
Zc v59,v79,v78,s22
Zc v60,v73,v72,s23
Zc v61,v75,v74,s23
Zc v62,v77,v76,s23
Zc v63,v79,v78,s23
Zd a56,v56
Zd a57,v57
Zd a58,v58
Zd a59,v59
Zd a60,v60
Zd a61,v61
Zd a62,v62
Zd a63,v63
Zb s19,s17,16640
Za v72,v4,s[24:27],s19 offen
Zb s19,s17,16680
Za v73,v4,s[24:27],s19 offen
Zb s19,s17,16720
Za v74,v4,s[24:27],s19 offen
Zb s19,s17,16760
Za v75,v4,s[24:27],s19 offen
Zb s19,s17,16800
Za v76,v4,s[24:27],s19 offen
Zb s19,s17,16840
Za v77,v4,s[24:27],s19 offen
Zb s19,s17,16880
Za v78,v4,s[24:27],s19 offen
Zb s19,s17,16920
Za v79,v4,s[24:27],s19 offen
Zf vmcnt(46)
Zc v56,v81,v80,s22
Zf vmcnt(44)
Zc v57,v83,v82,s22
Zf vmcnt(42)
Zc v58,v85,v84,s22
Zf vmcnt(40)
Zc v59,v87,v86,s22
Zc v60,v81,v80,s23
Zc v61,v83,v82,s23
Zc v62,v85,v84,s23
Zc v63,v87,v86,s23
Zd a64,v56
Zd a65,v57
Zd a66,v58
Zd a67,v59
Zd a68,v60
Zd a69,v61
Zd a70,v62
Zd a71,v63
Zb s19,s17,17920
Za v80,v4,s[24:27],s19 offen
Zb s19,s17,17960
Za v81,v4,s[24:27],s19 offen
Zb s19,s17,18000
Za v82,v4,s[24:27],s19 offen
Zb s19,s17,18040
Za v83,v4,s[24:27],s19 offen
Zb s19,s17,18080
Za v84,v4,s[24:27],s19 offen
Zb s19,s17,18120
Za v85,v4,s[24:27],s19 offen
Zb s19,s17,18160
Za v86,v4,s[24:27],s19 offen
Zb s19,s17,18200
Za v87,v4,s[24:27],s19 offen
Zf vmcnt(46)
Zc v56,v89,v88,s22
Zf vmcnt(44)
Zc v57,v91,v90,s22
Zf vmcnt(42)
Zc v58,v93,v92,s22
Zf vmcnt(40)
Zc v59,v95,v94,s22
Zc v60,v89,v88,s23
Zc v61,v91,v90,s23
Zc v62,v93,v92,s23
Zc v63,v95,v94,s23
Zd a72,v56
Zd a73,v57
Zd a74,v58
Zd a75,v59
Zd a76,v60
Zd a77,v61
Zd a78,v62
Zd a79,v63
Zb s19,s17,19200
Za v88,v4,s[24:27],s19 offen
Zb s19,s17,19240
Za v89,v4,s[24:27],s19 offen
Zb s19,s17,19280
Za v90,v4,s[24:27],s19 offen
Zb s19,s17,19320
Za v91,v4,s[24:27],s19 offen
Zb s19,s17,19360
Za v92,v4,s[24:27],s19 offen
Zb s19,s17,19400
Za v93,v4,s[24:27],s19 offen
Zb s19,s17,19440
Za v94,v4,s[24:27],s19 offen
Zb s19,s17,19480
Za v95,v4,s[24:27],s19 offen
Zf vmcnt(46)
Zc v56,v97,v96,s22
Zf vmcnt(44)
Zc v57,v99,v98,s22
Zf vmcnt(42)
Zc v58,v101,v100,s22
Zf vmcnt(40)
Zc v59,v103,v102,s22
Zc v60,v97,v96,s23
Zc v61,v99,v98,s23
Zc v62,v101,v100,s23
Zc v63,v103,v102,s23
Zd a80,v56
Zd a81,v57
Zd a82,v58
Zd a83,v59
Zd a84,v60
Zd a85,v61
Zd a86,v62
Zd a87,v63
Zb s19,s17,20480
Za v96,v4,s[24:27],s19 offen
Zb s19,s17,20520
Za v97,v4,s[24:27],s19 offen
Zb s19,s17,20560
Za v98,v4,s[24:27],s19 offen
Zb s19,s17,20600
Za v99,v4,s[24:27],s19 offen
Zb s19,s17,20640
Za v100,v4,s[24:27],s19 offen
Zb s19,s17,20680
Za v101,v4,s[24:27],s19 offen
Zb s19,s17,20720
Za v102,v4,s[24:27],s19 offen
Zb s19,s17,20760
Za v103,v4,s[24:27],s19 offen
Zf vmcnt(46)
Zc v56,v105,v104,s22
Zf vmcnt(44)
Zc v57,v107,v106,s22
Zf vmcnt(42)
Zc v58,v109,v108,s22
Zf vmcnt(40)
Zc v59,v111,v110,s22
Zc v60,v105,v104,s23
Zc v61,v107,v106,s23
Zc v62,v109,v108,s23
Zc v63,v111,v110,s23
Zd a88,v56
Zd a89,v57
Zd a90,v58
Zd a91,v59
Zd a92,v60
Zd a93,v61
Zd a94,v62
Zd a95,v63
Zb s19,s17,21760
Za v104,v4,s[24:27],s19 offen
Zb s19,s17,21800
Za v105,v4,s[24:27],s19 offen
Zb s19,s17,21840
Za v106,v4,s[24:27],s19 offen
Zb s19,s17,21880
Za v107,v4,s[24:27],s19 offen
Zb s19,s17,21920
Za v108,v4,s[24:27],s19 offen
Zb s19,s17,21960
Za v109,v4,s[24:27],s19 offen
Zb s19,s17,22000
Za v110,v4,s[24:27],s19 offen
Zb s19,s17,22040
Za v111,v4,s[24:27],s19 offen
Zf vmcnt(46)
Zc v56,v65,v64,s22
Zf vmcnt(44)
Zc v57,v67,v66,s22
Zf vmcnt(42)
Zc v58,v69,v68,s22
Zf vmcnt(40)
Zc v59,v71,v70,s22
Zc v60,v65,v64,s23
Zc v61,v67,v66,s23
Zc v62,v69,v68,s23
Zc v63,v71,v70,s23
Zd a96,v56
Zd a97,v57
Zd a98,v58
Zd a99,v59
Zd a100,v60
Zd a101,v61
Zd a102,v62
Zd a103,v63
Zb s19,s17,23040
Za v64,v4,s[24:27],s19 offen
Zb s19,s17,23080
Za v65,v4,s[24:27],s19 offen
Zb s19,s17,23120
Za v66,v4,s[24:27],s19 offen
Zb s19,s17,23160
Za v67,v4,s[24:27],s19 offen
Zb s19,s17,23200
Za v68,v4,s[24:27],s19 offen
Zb s19,s17,23240
Za v69,v4,s[24:27],s19 offen
Zb s19,s17,23280
Za v70,v4,s[24:27],s19 offen
Zb s19,s17,23320
Za v71,v4,s[24:27],s19 offen
Zf vmcnt(46)
Zc v56,v73,v72,s22
Zf vmcnt(44)
Zc v57,v75,v74,s22
Zf vmcnt(42)
Zc v58,v77,v76,s22
Zf vmcnt(40)
Zc v59,v79,v78,s22
Zc v60,v73,v72,s23
Zc v61,v75,v74,s23
Zc v62,v77,v76,s23
Zc v63,v79,v78,s23
Zd a104,v56
Zd a105,v57
Zd a106,v58
Zd a107,v59
Zd a108,v60
Zd a109,v61
Zd a110,v62
Zd a111,v63
Zb s19,s17,24320
Za v72,v4,s[24:27],s19 offen
Zb s19,s17,24360
Za v73,v4,s[24:27],s19 offen
Zb s19,s17,24400
Za v74,v4,s[24:27],s19 offen
Zb s19,s17,24440
Za v75,v4,s[24:27],s19 offen
Zb s19,s17,24480
Za v76,v4,s[24:27],s19 offen
Zb s19,s17,24520
Za v77,v4,s[24:27],s19 offen
Zb s19,s17,24560
Za v78,v4,s[24:27],s19 offen
Zb s19,s17,24600
Za v79,v4,s[24:27],s19 offen
Zf vmcnt(46)
Zc v56,v81,v80,s22
Zf vmcnt(44)
Zc v57,v83,v82,s22
Zf vmcnt(42)
Zc v58,v85,v84,s22
Zf vmcnt(40)
Zc v59,v87,v86,s22
Zc v60,v81,v80,s23
Zc v61,v83,v82,s23
Zc v62,v85,v84,s23
Zc v63,v87,v86,s23
Zd a112,v56
Zd a113,v57
Zd a114,v58
Zd a115,v59
Zd a116,v60
Zd a117,v61
Zd a118,v62
Zd a119,v63
Zf vmcnt(38)
Zc v56,v89,v88,s22
Zf vmcnt(36)
Zc v57,v91,v90,s22
Zf vmcnt(34)
Zc v58,v93,v92,s22
Zf vmcnt(32)
Zc v59,v95,v94,s22
Zc v60,v89,v88,s23
Zc v61,v91,v90,s23
Zc v62,v93,v92,s23
Zc v63,v95,v94,s23
Zd a120,v56
Zd a121,v57
Zd a122,v58
Zd a123,v59
Zd a124,v60
Zd a125,v61
Zd a126,v62
Zd a127,v63
Zf vmcnt(30)
Zc v56,v97,v96,s22
Zf vmcnt(28)
Zc v57,v99,v98,s22
Zf vmcnt(26)
Zc v58,v101,v100,s22
Zf vmcnt(24)
Zc v59,v103,v102,s22
Zc v60,v97,v96,s23
Zc v61,v99,v98,s23
Zc v62,v101,v100,s23
Zc v63,v103,v102,s23
Zd a128,v56
Zd a129,v57
Zd a130,v58
Zd a131,v59
Zd a132,v60
Zd a133,v61
Zd a134,v62
Zd a135,v63
Zf vmcnt(22)
Zc v56,v105,v104,s22
Zf vmcnt(20)
Zc v57,v107,v106,s22
Zf vmcnt(18)
Zc v58,v109,v108,s22
Zf vmcnt(16)
Zc v59,v111,v110,s22
Zc v60,v105,v104,s23
Zc v61,v107,v106,s23
Zc v62,v109,v108,s23
Zc v63,v111,v110,s23
Zd a136,v56
Zd a137,v57
Zd a138,v58
Zd a139,v59
Zd a140,v60
Zd a141,v61
Zd a142,v62
Zd a143,v63
Zf vmcnt(14)
Zc v56,v65,v64,s22
Zf vmcnt(12)
Zc v57,v67,v66,s22
Zf vmcnt(10)
Zc v58,v69,v68,s22
Zf vmcnt(8)
Zc v59,v71,v70,s22
Zc v60,v65,v64,s23
Zc v61,v67,v66,s23
Zc v62,v69,v68,s23
Zc v63,v71,v70,s23
Zd a144,v56
Zd a145,v57
Zd a146,v58
Zd a147,v59
Zd a148,v60
Zd a149,v61
Zd a150,v62
Zd a151,v63
Zf vmcnt(6)
Zc v56,v73,v72,s22
Zf vmcnt(4)
Zc v57,v75,v74,s22
Zf vmcnt(2)
Zc v58,v77,v76,s22
Zf vmcnt(0)
Zc v59,v79,v78,s22
Zc v60,v73,v72,s23
Zc v61,v75,v74,s23
Zc v62,v77,v76,s23
Zc v63,v79,v78,s23
Zd a152,v56
Zd a153,v57
Zd a154,v58
Zd a155,v59
Zd a156,v60
Zd a157,v61
Zd a158,v62
Zd a159,v63
Zp s12,8192
Zp s13,8704
Zp s14,0
v_lshrrev_b32 v3, 2, v0
v_min_u32 v3, 28, v3
v_lshrrev_b32 v7, 7, v0
v_lshrrev_b32 v8, 4, v0
Zy v8,7,v8
v_xor_b32 v8, v8, v7
Zq s19,s9,3
v_add_u32 v7, s19, v7
v_mul_u32_u24 v4, 1280, v7
v_lshl_add_u32 v4, v8, 4, v4
Zy v7,7,v1
v_lshrrev_b32 v8, 3, v1
Zz v8,10,v8
v_lshl_add_u32 v8, v7, 7, v8
v_xor_b32 v7, v2, v7
v_lshl_add_u32 v5, v7, 4, v8
v_xor_b32 v6, 64, v5
Zp s10,64
s_and_b32 s35, s8, 31
s_mul_i32 s34, s35, 26
s_lshr_b32 s34, s34, 8
s_mul_i32 s34, s34, 10
s_sub_u32 s35, s35, s34
Zq s35,s35,7
Zq s11,s9,10
Zp s15,0
Zp s33,0
Zp s32,131072
v_lshrrev_b32 v11, 2, v0
v_add_u32 v11, 131072, v11
Zf vmcnt(0) lgkmcnt(0)
AK_L:
s_cmp_lg_u32 s15, 0
Zk AK_H
Zb s16,s10,1
s_and_b32 s21, s10, 1
Zq s21,s21,7
Zb s21,s21,8192
WF_154:
Za v9,v3,s[4:7],s21 offen sc1
Zf vmcnt(0)
v_cmp_gt_u32 vcc, s16, v9
s_cbranch_vccz WD_155
s_sleep 3
s_sub_u32 s20, s20, 1
s_cmp_gt_i32 s20, 0
Zk WF_154
WD_155:
s_mul_i32 s36, s10, 40960
Zb s36,s36,100663296
Zb s36,s36,s14
Zb s16,s10,1
s_and_b32 s21, s16, 1
Zq s21,s21,7
Zb s21,s21,8192
Zq s34,s35,5
Zb m0,s11,s34
Zb s37,s36,s35
Zh v4,s[4:7],s37 offen sc1 lds
Zb s35,s35,128
Zo s35,1280
s_cselect_b32 s35, 0, s35
Zq s34,s35,5
Zb m0,s11,s34
Zb s37,s36,s35
Zh v4,s[4:7],s37 offen sc1 lds
Zb s35,s35,128
Zo s35,1280
s_cselect_b32 s35, 0, s35
Zq s34,s35,5
Zb m0,s11,s34
Zb s37,s36,s35
Zh v4,s[4:7],s37 offen sc1 lds
Zb s35,s35,128
Zo s35,1280
s_cselect_b32 s35, 0, s35
Zq s34,s35,5
Zb m0,s11,s34
Zb s37,s36,s35
Zh v4,s[4:7],s37 offen sc1 lds
Zb s35,s35,128
Zo s35,1280
s_cselect_b32 s35, 0, s35
Zq s34,s35,5
Zb m0,s11,s34
Zb s37,s36,s35
Zh v4,s[4:7],s37 offen sc1 lds
Zb s35,s35,128
Zo s35,1280
s_cselect_b32 s35, 0, s35
Zq s34,s35,5
Zb m0,s11,s34
Zb s37,s36,s35
Zh v4,s[4:7],s37 offen sc1 lds
Zb s35,s35,128
Zo s35,1280
s_cselect_b32 s35, 0, s35
Zq s34,s35,5
Zb m0,s11,s34
Zb s37,s36,s35
Zh v4,s[4:7],s37 offen sc1 lds
Zb s35,s35,128
Zo s35,1280
s_cselect_b32 s35, 0, s35
Zq s34,s35,5
Zb m0,s11,s34
Zb s37,s36,s35
Zh v4,s[4:7],s37 offen sc1 lds
Zb s35,s35,128
Zo s35,1280
s_cselect_b32 s35, 0, s35
Zq s34,s35,5
Zb m0,s11,s34
Zb s37,s36,s35
Zh v4,s[4:7],s37 offen sc1 lds
Zb s35,s35,128
Zo s35,1280
s_cselect_b32 s35, 0, s35
Zq s34,s35,5
Zb m0,s11,s34
Zb s37,s36,s35
Zh v4,s[4:7],s37 offen sc1 lds
Zb s35,s35,128
Zo s35,1280
s_cselect_b32 s35, 0, s35
Zp m0,s32
s_nop 0
Za v3,s[4:7],s21 offen sc1 lds
s_xor_b32 s11, s11, 0x10000
s_xor_b32 s32, s32, 256
Zf vmcnt(0)
AK_H:
Zf vmcnt(0)
AK_I:
s_barrier
ds_read_b32 v9, v11
Zb s28,s10,1
Zb s16,s28,1
Zf lgkmcnt(0)
v_cmp_gt_u32 vcc, s16, v9
s_cmp_eq_u64 vcc, 0
s_cselect_b32 s15, 1, 0
s_mul_i32 s36, s28, 40960
Zb s36,s36,100663296
Zb s36,s36,s14
Zb s16,s28,1
s_and_b32 s21, s16, 1
Zq s21,s21,7
Zb s21,s21,8192
Zq s18,s10,12
Zb s18,s18,130023424
s_cmp_lt_u32 s9, 2
Zk AKB_W
Zo s15,0
Zk ST_156
Zq s34,s35,5
Zb m0,s11,s34
Zb s37,s36,s35
Zh v4,s[4:7],s37 offen sc1 lds
Zb s35,s35,128
Zo s35,1280
s_cselect_b32 s35, 0, s35
ST_156:
Zo s15,0
Zk ST_157
Zq s34,s35,5
Zb m0,s11,s34
Zb s37,s36,s35
Zh v4,s[4:7],s37 offen sc1 lds
Zb s35,s35,128
Zo s35,1280
s_cselect_b32 s35, 0, s35
ST_157:
Zo s15,0
Zk ST_158
Zq s34,s35,5
Zb m0,s11,s34
Zb s37,s36,s35
Zh v4,s[4:7],s37 offen sc1 lds
Zb s35,s35,128
Zo s35,1280
s_cselect_b32 s35, 0, s35
ST_158:
Zo s15,0
Zk ST_159
Zq s34,s35,5
Zb m0,s11,s34
Zb s37,s36,s35
Zh v4,s[4:7],s37 offen sc1 lds
Zb s35,s35,128
Zo s35,1280
s_cselect_b32 s35, 0, s35
ST_159:
Zo s15,0
Zk ST_160
Zq s34,s35,5
Zb m0,s11,s34
Zb s37,s36,s35
Zh v4,s[4:7],s37 offen sc1 lds
Zb s35,s35,128
Zo s35,1280
s_cselect_b32 s35, 0, s35
ST_160:
Zo s15,0
Zk ST_161
Zq s34,s35,5
Zb m0,s11,s34
Zb s37,s36,s35
Zh v4,s[4:7],s37 offen sc1 lds
Zb s35,s35,128
Zo s35,1280
s_cselect_b32 s35, 0, s35
ST_161:
Zo s15,0
Zk ST_162
Zq s34,s35,5
Zb m0,s11,s34
Zb s37,s36,s35
Zh v4,s[4:7],s37 offen sc1 lds
Zb s35,s35,128
Zo s35,1280
s_cselect_b32 s35, 0, s35
ST_162:
Zo s15,0
Zk ST_163
Zq s34,s35,5
Zb m0,s11,s34
Zb s37,s36,s35
Zh v4,s[4:7],s37 offen sc1 lds
Zb s35,s35,128
Zo s35,1280
s_cselect_b32 s35, 0, s35
ST_163:
Zo s33,0
Zk MD_164
Zf vmcnt(8)
s_cmp_lg_u32 s15, 0
Zk ME_165
Zf vmcnt(0)
ME_165:
s_barrier
s_cmp_lg_u32 s9, 0
Zk SF_166
Zs v9,s33
Zu v9,off,s[4:7],s13 sc1
SF_166:
MD_164:
Zo s15,0
Zk ST_167
Zq s34,s35,5
Zb m0,s11,s34
Zb s37,s36,s35
Zh v4,s[4:7],s37 offen sc1 lds
Zb s35,s35,128
Zo s35,1280
s_cselect_b32 s35, 0, s35
ST_167:
Zo s15,0
Zk ST_168
Zq s34,s35,5
Zb m0,s11,s34
Zb s37,s36,s35
Zh v4,s[4:7],s37 offen sc1 lds
Zb s35,s35,128
Zo s35,1280
s_cselect_b32 s35, 0, s35
ST_168:
Zo s15,0
Zk ST_169
Zp m0,s32
s_nop 0
Za v3,s[4:7],s21 offen sc1 lds
s_xor_b32 s11, s11, 0x10000
s_xor_b32 s32, s32, 256
ST_169:
s_branch AKB_E
AKB_W:
Zo s9,1
Zk AKB_V
Zi v[32:35],v5 offset:0
Zi v[36:39],v5 offset:2048
Zi v[40:43],v6 offset:0
Zi v[44:47],v6 offset:2048
Zi v[48:51],v5 offset:4096
Zi v[52:55],v5 offset:6144
Zf lgkmcnt(5)
Ze v[16:19],a[0:3],v[32:35],0
Ze v[20:23],a[4:7],v[32:35],0
Zi v[32:35],v6 offset:4096
Zo s15,0
Zk ST_170
Zq s34,s35,5
Zb m0,s11,s34
Zb s37,s36,s35
Zh v4,s[4:7],s37 offen sc1 lds
Zb s35,s35,128
Zo s35,1280
s_cselect_b32 s35, 0, s35
ST_170:
Zf lgkmcnt(5)
Ze v[24:27],a[0:3],v[36:39],0
Ze v[28:31],a[4:7],v[36:39],0
Zi v[36:39],v6 offset:6144
Zf lgkmcnt(5)
Ze v[16:19],a[8:11],v[40:43],v[16:19]
Ze v[20:23],a[12:15],v[40:43],v[20:23]
Zi v[40:43],v5 offset:8192
Zo s15,0
Zk ST_171
Zq s34,s35,5
Zb m0,s11,s34
Zb s37,s36,s35
Zh v4,s[4:7],s37 offen sc1 lds
Zb s35,s35,128
Zo s35,1280
s_cselect_b32 s35, 0, s35
ST_171:
Zf lgkmcnt(5)
Ze v[24:27],a[8:11],v[44:47],v[24:27]
Ze v[28:31],a[12:15],v[44:47],v[28:31]
Zi v[44:47],v5 offset:10240
Zf lgkmcnt(5)
Ze v[16:19],a[16:19],v[48:51],v[16:19]
Ze v[20:23],a[20:23],v[48:51],v[20:23]
Zi v[48:51],v6 offset:8192
Zo s15,0
Zk ST_172
Zq s34,s35,5
Zb m0,s11,s34
Zb s37,s36,s35
Zh v4,s[4:7],s37 offen sc1 lds
Zb s35,s35,128
Zo s35,1280
s_cselect_b32 s35, 0, s35
ST_172:
Zf lgkmcnt(5)
Ze v[24:27],a[16:19],v[52:55],v[24:27]
Ze v[28:31],a[20:23],v[52:55],v[28:31]
Zi v[52:55],v6 offset:10240
Zf lgkmcnt(5)
Ze v[16:19],a[24:27],v[32:35],v[16:19]
Ze v[20:23],a[28:31],v[32:35],v[20:23]
Zi v[32:35],v5 offset:12288
Zo s15,0
Zk ST_173
Zq s34,s35,5
Zb m0,s11,s34
Zb s37,s36,s35
Zh v4,s[4:7],s37 offen sc1 lds
Zb s35,s35,128
Zo s35,1280
s_cselect_b32 s35, 0, s35
ST_173:
Zf lgkmcnt(5)
Ze v[24:27],a[24:27],v[36:39],v[24:27]
Ze v[28:31],a[28:31],v[36:39],v[28:31]
Zi v[36:39],v5 offset:14336
Zf lgkmcnt(5)
Ze v[16:19],a[32:35],v[40:43],v[16:19]
Ze v[20:23],a[36:39],v[40:43],v[20:23]
Zi v[40:43],v6 offset:12288
Zo s15,0
Zk ST_174
Zq s34,s35,5
Zb m0,s11,s34
Zb s37,s36,s35
Zh v4,s[4:7],s37 offen sc1 lds
Zb s35,s35,128
Zo s35,1280
s_cselect_b32 s35, 0, s35
ST_174:
Zf lgkmcnt(5)
Ze v[24:27],a[32:35],v[44:47],v[24:27]
Ze v[28:31],a[36:39],v[44:47],v[28:31]
Zi v[44:47],v6 offset:14336
Zf lgkmcnt(5)
Ze v[16:19],a[40:43],v[48:51],v[16:19]
Ze v[20:23],a[44:47],v[48:51],v[20:23]
Zi v[48:51],v5 offset:16384
Zo s15,0
Zk ST_175
Zq s34,s35,5
Zb m0,s11,s34
Zb s37,s36,s35
Zh v4,s[4:7],s37 offen sc1 lds
Zb s35,s35,128
Zo s35,1280
s_cselect_b32 s35, 0, s35
ST_175:
Zf lgkmcnt(5)
Ze v[24:27],a[40:43],v[52:55],v[24:27]
Ze v[28:31],a[44:47],v[52:55],v[28:31]
Zi v[52:55],v5 offset:18432
Zf lgkmcnt(5)
Ze v[16:19],a[48:51],v[32:35],v[16:19]
Ze v[20:23],a[52:55],v[32:35],v[20:23]
Zi v[32:35],v6 offset:16384
Zo s15,0
Zk ST_176
Zq s34,s35,5
Zb m0,s11,s34
Zb s37,s36,s35
Zh v4,s[4:7],s37 offen sc1 lds
Zb s35,s35,128
Zo s35,1280
s_cselect_b32 s35, 0, s35
ST_176:
Zf lgkmcnt(5)
Ze v[24:27],a[48:51],v[36:39],v[24:27]
Ze v[28:31],a[52:55],v[36:39],v[28:31]
Zi v[36:39],v6 offset:18432
Zf lgkmcnt(5)
Ze v[16:19],a[56:59],v[40:43],v[16:19]
Ze v[20:23],a[60:63],v[40:43],v[20:23]
Zi v[40:43],v5 offset:20480
Zo s15,0
Zk ST_177
Zq s34,s35,5
Zb m0,s11,s34
Zb s37,s36,s35
Zh v4,s[4:7],s37 offen sc1 lds
Zb s35,s35,128
Zo s35,1280
s_cselect_b32 s35, 0, s35
ST_177:
Zo s33,0
Zk MD_178
Zf vmcnt(8)
s_cmp_lg_u32 s15, 0
Zk ME_179
Zf vmcnt(0)
ME_179:
s_barrier
s_cmp_lg_u32 s9, 0
Zk SF_180
Zs v9,s33
Zu v9,off,s[4:7],s13 sc1
SF_180:
MD_178:
Zf lgkmcnt(5)
Ze v[24:27],a[56:59],v[44:47],v[24:27]
Ze v[28:31],a[60:63],v[44:47],v[28:31]
Zi v[44:47],v5 offset:22528
Zf lgkmcnt(5)
Ze v[16:19],a[64:67],v[48:51],v[16:19]
Ze v[20:23],a[68:71],v[48:51],v[20:23]
Zi v[48:51],v6 offset:20480
Zo s15,0
Zk ST_181
Zq s34,s35,5
Zb m0,s11,s34
Zb s37,s36,s35
Zh v4,s[4:7],s37 offen sc1 lds
Zb s35,s35,128
Zo s35,1280
s_cselect_b32 s35, 0, s35
ST_181:
Zf lgkmcnt(5)
Ze v[24:27],a[64:67],v[52:55],v[24:27]
Ze v[28:31],a[68:71],v[52:55],v[28:31]
Zi v[52:55],v6 offset:22528
Zf lgkmcnt(5)
Ze v[16:19],a[72:75],v[32:35],v[16:19]
Ze v[20:23],a[76:79],v[32:35],v[20:23]
Zi v[32:35],v5 offset:24576
Zo s15,0
Zk ST_182
Zq s34,s35,5
Zb m0,s11,s34
Zb s37,s36,s35
Zh v4,s[4:7],s37 offen sc1 lds
Zb s35,s35,128
Zo s35,1280
s_cselect_b32 s35, 0, s35
ST_182:
Zf lgkmcnt(5)
Ze v[24:27],a[72:75],v[36:39],v[24:27]
Ze v[28:31],a[76:79],v[36:39],v[28:31]
Zi v[36:39],v5 offset:26624
Zf lgkmcnt(5)
Ze v[16:19],a[80:83],v[40:43],v[16:19]
Ze v[20:23],a[84:87],v[40:43],v[20:23]
Zi v[40:43],v6 offset:24576
Zo s15,0
Zk ST_183
Zp m0,s32
s_nop 0
Za v3,s[4:7],s21 offen sc1 lds
s_xor_b32 s11, s11, 0x10000
s_xor_b32 s32, s32, 256
ST_183:
Zf lgkmcnt(5)
Ze v[24:27],a[80:83],v[44:47],v[24:27]
Ze v[28:31],a[84:87],v[44:47],v[28:31]
Zi v[44:47],v6 offset:26624
Zf lgkmcnt(5)
Ze v[16:19],a[88:91],v[48:51],v[16:19]
Ze v[20:23],a[92:95],v[48:51],v[20:23]
Zi v[48:51],v5 offset:28672
Zf lgkmcnt(5)
Ze v[24:27],a[88:91],v[52:55],v[24:27]
Ze v[28:31],a[92:95],v[52:55],v[28:31]
Zi v[52:55],v5 offset:30720
Zf lgkmcnt(5)
Ze v[16:19],a[96:99],v[32:35],v[16:19]
Ze v[20:23],a[100:103],v[32:35],v[20:23]
Zi v[32:35],v6 offset:28672
Zf lgkmcnt(5)
Ze v[24:27],a[96:99],v[36:39],v[24:27]
Ze v[28:31],a[100:103],v[36:39],v[28:31]
Zi v[36:39],v6 offset:30720
Zf lgkmcnt(5)
Ze v[16:19],a[104:107],v[40:43],v[16:19]
Ze v[20:23],a[108:111],v[40:43],v[20:23]
Zi v[40:43],v5 offset:32768
Zf lgkmcnt(5)
Ze v[24:27],a[104:107],v[44:47],v[24:27]
Ze v[28:31],a[108:111],v[44:47],v[28:31]
Zi v[44:47],v5 offset:34816
Zf lgkmcnt(5)
Ze v[16:19],a[112:115],v[48:51],v[16:19]
Ze v[20:23],a[116:119],v[48:51],v[20:23]
Zi v[48:51],v6 offset:32768
Zf lgkmcnt(5)
Ze v[24:27],a[112:115],v[52:55],v[24:27]
Ze v[28:31],a[116:119],v[52:55],v[28:31]
Zi v[52:55],v6 offset:34816
Zf lgkmcnt(5)
Ze v[16:19],a[120:123],v[32:35],v[16:19]
Ze v[20:23],a[124:127],v[32:35],v[20:23]
Zi v[32:35],v5 offset:36864
Zf lgkmcnt(5)
Ze v[24:27],a[120:123],v[36:39],v[24:27]
Ze v[28:31],a[124:127],v[36:39],v[28:31]
Zi v[36:39],v5 offset:38912
Zf lgkmcnt(5)
Ze v[16:19],a[128:131],v[40:43],v[16:19]
Ze v[20:23],a[132:135],v[40:43],v[20:23]
Zi v[40:43],v6 offset:36864
Zf lgkmcnt(5)
Ze v[24:27],a[128:131],v[44:47],v[24:27]
Ze v[28:31],a[132:135],v[44:47],v[28:31]
Zi v[44:47],v6 offset:38912
Zf lgkmcnt(5)
Ze v[16:19],a[136:139],v[48:51],v[16:19]
Ze v[20:23],a[140:143],v[48:51],v[20:23]
Zf lgkmcnt(4)
Ze v[24:27],a[136:139],v[52:55],v[24:27]
Ze v[28:31],a[140:143],v[52:55],v[28:31]
Zf lgkmcnt(3)
Ze v[16:19],a[144:147],v[32:35],v[16:19]
Ze v[20:23],a[148:151],v[32:35],v[20:23]
Zf lgkmcnt(2)
Ze v[24:27],a[144:147],v[36:39],v[24:27]
Ze v[28:31],a[148:151],v[36:39],v[28:31]
Zf lgkmcnt(1)
Ze v[16:19],a[152:155],v[40:43],v[16:19]
Ze v[20:23],a[156:159],v[40:43],v[20:23]
Zf lgkmcnt(0)
Ze v[24:27],a[152:155],v[44:47],v[24:27]
Ze v[28:31],a[156:159],v[44:47],v[28:31]
Zj v32,v16,v20
Zj v33,v17,v21
Zj v34,v18,v22
Zj v35,v19,v23
s_nop 3
Zj v36,v24,v28
Zj v37,v25,v29
Zj v38,v26,v30
Zj v39,v27,v31
s_branch AKB_S
AKB_V:
Zi v[32:35],v5 offset:0
Zi v[36:39],v5 offset:2048
Zi v[40:43],v6 offset:0
Zi v[44:47],v6 offset:2048
Zi v[48:51],v5 offset:4096
Zi v[52:55],v5 offset:6144
Zf lgkmcnt(5)
Ze v[16:19],v[32:35],a[0:3],0
Ze v[20:23],v[32:35],a[4:7],0
Zi v[32:35],v6 offset:4096
Zo s15,0
Zk ST_184
Zq s34,s35,5
Zb m0,s11,s34
Zb s37,s36,s35
Zh v4,s[4:7],s37 offen sc1 lds
Zb s35,s35,128
Zo s35,1280
s_cselect_b32 s35, 0, s35
ST_184:
Zf lgkmcnt(5)
Ze v[24:27],v[36:39],a[0:3],0
Ze v[28:31],v[36:39],a[4:7],0
Zi v[36:39],v6 offset:6144
Zf lgkmcnt(5)
Ze v[16:19],v[40:43],a[8:11],v[16:19]
Ze v[20:23],v[40:43],a[12:15],v[20:23]
Zi v[40:43],v5 offset:8192
Zo s15,0
Zk ST_185
Zq s34,s35,5
Zb m0,s11,s34
Zb s37,s36,s35
Zh v4,s[4:7],s37 offen sc1 lds
Zb s35,s35,128
Zo s35,1280
s_cselect_b32 s35, 0, s35
ST_185:
Zf lgkmcnt(5)
Ze v[24:27],v[44:47],a[8:11],v[24:27]
Ze v[28:31],v[44:47],a[12:15],v[28:31]
Zi v[44:47],v5 offset:10240
Zf lgkmcnt(5)
Ze v[16:19],v[48:51],a[16:19],v[16:19]
Ze v[20:23],v[48:51],a[20:23],v[20:23]
Zi v[48:51],v6 offset:8192
Zo s15,0
Zk ST_186
Zq s34,s35,5
Zb m0,s11,s34
Zb s37,s36,s35
Zh v4,s[4:7],s37 offen sc1 lds
Zb s35,s35,128
Zo s35,1280
s_cselect_b32 s35, 0, s35
ST_186:
Zf lgkmcnt(5)
Ze v[24:27],v[52:55],a[16:19],v[24:27]
Ze v[28:31],v[52:55],a[20:23],v[28:31]
Zi v[52:55],v6 offset:10240
Zf lgkmcnt(5)
Ze v[16:19],v[32:35],a[24:27],v[16:19]
Ze v[20:23],v[32:35],a[28:31],v[20:23]
Zi v[32:35],v5 offset:12288
Zo s15,0
Zk ST_187
Zq s34,s35,5
Zb m0,s11,s34
Zb s37,s36,s35
Zh v4,s[4:7],s37 offen sc1 lds
Zb s35,s35,128
Zo s35,1280
s_cselect_b32 s35, 0, s35
ST_187:
Zf lgkmcnt(5)
Ze v[24:27],v[36:39],a[24:27],v[24:27]
Ze v[28:31],v[36:39],a[28:31],v[28:31]
Zi v[36:39],v5 offset:14336
Zf lgkmcnt(5)
Ze v[16:19],v[40:43],a[32:35],v[16:19]
Ze v[20:23],v[40:43],a[36:39],v[20:23]
Zi v[40:43],v6 offset:12288
Zo s15,0
Zk ST_188
Zq s34,s35,5
Zb m0,s11,s34
Zb s37,s36,s35
Zh v4,s[4:7],s37 offen sc1 lds
Zb s35,s35,128
Zo s35,1280
s_cselect_b32 s35, 0, s35
ST_188:
Zf lgkmcnt(5)
Ze v[24:27],v[44:47],a[32:35],v[24:27]
Ze v[28:31],v[44:47],a[36:39],v[28:31]
Zi v[44:47],v6 offset:14336
Zf lgkmcnt(5)
Ze v[16:19],v[48:51],a[40:43],v[16:19]
Ze v[20:23],v[48:51],a[44:47],v[20:23]
Zi v[48:51],v5 offset:16384
Zo s15,0
Zk ST_189
Zq s34,s35,5
Zb m0,s11,s34
Zb s37,s36,s35
Zh v4,s[4:7],s37 offen sc1 lds
Zb s35,s35,128
Zo s35,1280
s_cselect_b32 s35, 0, s35
ST_189:
Zf lgkmcnt(5)
Ze v[24:27],v[52:55],a[40:43],v[24:27]
Ze v[28:31],v[52:55],a[44:47],v[28:31]
Zi v[52:55],v5 offset:18432
Zf lgkmcnt(5)
Ze v[16:19],v[32:35],a[48:51],v[16:19]
Ze v[20:23],v[32:35],a[52:55],v[20:23]
Zi v[32:35],v6 offset:16384
Zo s15,0
Zk ST_190
Zq s34,s35,5
Zb m0,s11,s34
Zb s37,s36,s35
Zh v4,s[4:7],s37 offen sc1 lds
Zb s35,s35,128
Zo s35,1280
s_cselect_b32 s35, 0, s35
ST_190:
Zf lgkmcnt(5)
Ze v[24:27],v[36:39],a[48:51],v[24:27]
Ze v[28:31],v[36:39],a[52:55],v[28:31]
Zi v[36:39],v6 offset:18432
Zf lgkmcnt(5)
Ze v[16:19],v[40:43],a[56:59],v[16:19]
Ze v[20:23],v[40:43],a[60:63],v[20:23]
Zi v[40:43],v5 offset:20480
Zo s15,0
Zk ST_191
Zq s34,s35,5
Zb m0,s11,s34
Zb s37,s36,s35
Zh v4,s[4:7],s37 offen sc1 lds
Zb s35,s35,128
Zo s35,1280
s_cselect_b32 s35, 0, s35
ST_191:
Zo s33,0
Zk MD_192
Zf vmcnt(8)
s_cmp_lg_u32 s15, 0
Zk ME_193
Zf vmcnt(0)
ME_193:
s_barrier
s_cmp_lg_u32 s9, 0
Zk SF_194
Zs v9,s33
Zu v9,off,s[4:7],s13 sc1
SF_194:
MD_192:
Zf lgkmcnt(5)
Ze v[24:27],v[44:47],a[56:59],v[24:27]
Ze v[28:31],v[44:47],a[60:63],v[28:31]
Zi v[44:47],v5 offset:22528
Zf lgkmcnt(5)
Ze v[16:19],v[48:51],a[64:67],v[16:19]
Ze v[20:23],v[48:51],a[68:71],v[20:23]
Zi v[48:51],v6 offset:20480
Zo s15,0
Zk ST_195
Zq s34,s35,5
Zb m0,s11,s34
Zb s37,s36,s35
Zh v4,s[4:7],s37 offen sc1 lds
Zb s35,s35,128
Zo s35,1280
s_cselect_b32 s35, 0, s35
ST_195:
Zf lgkmcnt(5)
Ze v[24:27],v[52:55],a[64:67],v[24:27]
Ze v[28:31],v[52:55],a[68:71],v[28:31]
Zi v[52:55],v6 offset:22528
Zf lgkmcnt(5)
Ze v[16:19],v[32:35],a[72:75],v[16:19]
Ze v[20:23],v[32:35],a[76:79],v[20:23]
Zi v[32:35],v5 offset:24576
Zo s15,0
Zk ST_196
Zq s34,s35,5
Zb m0,s11,s34
Zb s37,s36,s35
Zh v4,s[4:7],s37 offen sc1 lds
Zb s35,s35,128
Zo s35,1280
s_cselect_b32 s35, 0, s35
ST_196:
Zf lgkmcnt(5)
Ze v[24:27],v[36:39],a[72:75],v[24:27]
Ze v[28:31],v[36:39],a[76:79],v[28:31]
Zi v[36:39],v5 offset:26624
Zf lgkmcnt(5)
Ze v[16:19],v[40:43],a[80:83],v[16:19]
Ze v[20:23],v[40:43],a[84:87],v[20:23]
Zi v[40:43],v6 offset:24576
Zo s15,0
Zk ST_197
Zp m0,s32
s_nop 0
Za v3,s[4:7],s21 offen sc1 lds
s_xor_b32 s11, s11, 0x10000
s_xor_b32 s32, s32, 256
ST_197:
Zf lgkmcnt(5)
Ze v[24:27],v[44:47],a[80:83],v[24:27]
Ze v[28:31],v[44:47],a[84:87],v[28:31]
Zi v[44:47],v6 offset:26624
Zf lgkmcnt(5)
Ze v[16:19],v[48:51],a[88:91],v[16:19]
Ze v[20:23],v[48:51],a[92:95],v[20:23]
Zi v[48:51],v5 offset:28672
Zf lgkmcnt(5)
Ze v[24:27],v[52:55],a[88:91],v[24:27]
Ze v[28:31],v[52:55],a[92:95],v[28:31]
Zi v[52:55],v5 offset:30720
Zf lgkmcnt(5)
Ze v[16:19],v[32:35],a[96:99],v[16:19]
Ze v[20:23],v[32:35],a[100:103],v[20:23]
Zi v[32:35],v6 offset:28672
Zf lgkmcnt(5)
Ze v[24:27],v[36:39],a[96:99],v[24:27]
Ze v[28:31],v[36:39],a[100:103],v[28:31]
Zi v[36:39],v6 offset:30720
Zf lgkmcnt(5)
Ze v[16:19],v[40:43],a[104:107],v[16:19]
Ze v[20:23],v[40:43],a[108:111],v[20:23]
Zi v[40:43],v5 offset:32768
Zf lgkmcnt(5)
Ze v[24:27],v[44:47],a[104:107],v[24:27]
Ze v[28:31],v[44:47],a[108:111],v[28:31]
Zi v[44:47],v5 offset:34816
Zf lgkmcnt(5)
Ze v[16:19],v[48:51],a[112:115],v[16:19]
Ze v[20:23],v[48:51],a[116:119],v[20:23]
Zi v[48:51],v6 offset:32768
Zf lgkmcnt(5)
Ze v[24:27],v[52:55],a[112:115],v[24:27]
Ze v[28:31],v[52:55],a[116:119],v[28:31]
Zi v[52:55],v6 offset:34816
Zf lgkmcnt(5)
Ze v[16:19],v[32:35],a[120:123],v[16:19]
Ze v[20:23],v[32:35],a[124:127],v[20:23]
Zi v[32:35],v5 offset:36864
Zf lgkmcnt(5)
Ze v[24:27],v[36:39],a[120:123],v[24:27]
Ze v[28:31],v[36:39],a[124:127],v[28:31]
Zi v[36:39],v5 offset:38912
Zf lgkmcnt(5)
Ze v[16:19],v[40:43],a[128:131],v[16:19]
Ze v[20:23],v[40:43],a[132:135],v[20:23]
Zi v[40:43],v6 offset:36864
Zf lgkmcnt(5)
Ze v[24:27],v[44:47],a[128:131],v[24:27]
Ze v[28:31],v[44:47],a[132:135],v[28:31]
Zi v[44:47],v6 offset:38912
Zf lgkmcnt(5)
Ze v[16:19],v[48:51],a[136:139],v[16:19]
Ze v[20:23],v[48:51],a[140:143],v[20:23]
Zf lgkmcnt(4)
Ze v[24:27],v[52:55],a[136:139],v[24:27]
Ze v[28:31],v[52:55],a[140:143],v[28:31]
Zf lgkmcnt(3)
Ze v[16:19],v[32:35],a[144:147],v[16:19]
Ze v[20:23],v[32:35],a[148:151],v[20:23]
Zf lgkmcnt(2)
Ze v[24:27],v[36:39],a[144:147],v[24:27]
Ze v[28:31],v[36:39],a[148:151],v[28:31]
Zf lgkmcnt(1)
Ze v[16:19],v[40:43],a[152:155],v[16:19]
Ze v[20:23],v[40:43],a[156:159],v[20:23]
Zf lgkmcnt(0)
Ze v[24:27],v[44:47],a[152:155],v[24:27]
Ze v[28:31],v[44:47],a[156:159],v[28:31]
Zj v32,v16,v17
Zj v33,v18,v19
s_nop 1
Zj v34,v24,v25
Zj v35,v26,v27
Zj v36,v20,v21
Zj v37,v22,v23
Zj v38,v28,v29
Zj v39,v30,v31
Zs v40,0x3f803f80
v_cmp_eq_u32 vcc, 10, v1
s_nop 1
v_cndmask_b32 v32, v32, v40, vcc
v_cndmask_b32 v33, v33, v40, vcc
v_cndmask_b32 v34, v34, v40, vcc
v_cndmask_b32 v35, v35, v40, vcc
Zb s18,s18,2048
AKB_S:
Zr v[32:35],v0,s[4:7],s18 offen sc1
Zr v[36:39],v0,s[4:7],s18 offen offset:1024 sc1
AKB_E:
Zb s33,s10,1
s_and_b32 s16, s10, 63
s_cselect_b32 s16, s15, 0
s_cmp_lg_u32 s16, 0
Zk AK_N
Zf vmcnt(0)
s_barrier
s_cmp_lg_u32 s9, 0
Zk SF_198
Zs v9,s33
Zu v9,off,s[4:7],s13 sc1
SF_198:
Zp s33,0
AK_N:
v_xor_b32 v5, 0x10000, v5
v_xor_b32 v11, 256, v11
v_xor_b32 v6, 0x10000, v6
Zp s10,s28
s_cmp_lt_u32 s10, 128
Zk AK_L
Zf vmcnt(0)
s_endpgm
R_CH:
s_cmp_lg_u32 s9, 1
Zk L_nw1
s_getpc_b64 s[34:35]
Zb s34,s34,L_w1-.
s_addc_u32 s35, s35, 0
s_setpc_b64 s[34:35]
L_nw1:
s_cmp_lg_u32 s9, 2
Zk L_nw2
s_getpc_b64 s[34:35]
Zb s34,s34,L_w2-.
s_addc_u32 s35, s35, 0
s_setpc_b64 s[34:35]
L_nw2:
s_cmp_lg_u32 s9, 3
Zk L_nw3
s_getpc_b64 s[34:35]
Zb s34,s34,L_w3-.
s_addc_u32 s35, s35, 0
s_setpc_b64 s[34:35]
L_nw3:
L_w0:
Zy v0,63,v0
Zy v12,15,v0
v_lshrrev_b32 v13, 4, v0
Zz v0,4,v0
Zp s22,0x05040100
Zp s23,0x07060302
v_add_u32 v5, 24576, v0
s_mul_i32 s18, s8, 73728
Zb s18,s18,3145728
v_lshrrev_b32 v14, 1, v13
Zz v14,4,v14
Zy v1,1,v13
v_lshl_add_u32 v14, v1, 2, v14
s_load_dwordx2 s[24:25], s[0:1], 80
Zp s26,5242880
Zp s27,0x20000
v_mul_u32_u24 v2, 1280, v14
v_lshl_add_u32 v3, v12, 2, v2
v_lshl_add_u32 v2, v12, 4, v2
v_add_u32 v2, 0, v2
v_add_u32 v3, 1024, v3
s_mul_i32 s17, s8, 163840
Zb s19,s17,0
Zf lgkmcnt(0)
Zh v[80:83],v2,s[24:27],s19 offen
Za v208,v3,s[24:27],s19 offen
Zb s19,s17,1280
Zh v[84:87],v2,s[24:27],s19 offen
Za v209,v3,s[24:27],s19 offen
Zb s19,s17,10240
Zh v[88:91],v2,s[24:27],s19 offen
Za v210,v3,s[24:27],s19 offen
Zb s19,s17,11520
Zh v[92:95],v2,s[24:27],s19 offen
Za v211,v3,s[24:27],s19 offen
Zb s19,s17,2560
Zh v[96:99],v2,s[24:27],s19 offen
Za v212,v3,s[24:27],s19 offen
Zb s19,s17,3840
Zh v[100:103],v2,s[24:27],s19 offen
Za v213,v3,s[24:27],s19 offen
Zb s19,s17,12800
Zh v[104:107],v2,s[24:27],s19 offen
Za v214,v3,s[24:27],s19 offen
Zb s19,s17,14080
Zh v[108:111],v2,s[24:27],s19 offen
Za v215,v3,s[24:27],s19 offen
Zb s19,s17,40960
Zh v[112:115],v2,s[24:27],s19 offen
Za v216,v3,s[24:27],s19 offen
Zb s19,s17,42240
Zh v[116:119],v2,s[24:27],s19 offen
Za v217,v3,s[24:27],s19 offen
Zb s19,s17,51200
Zh v[120:123],v2,s[24:27],s19 offen
Za v218,v3,s[24:27],s19 offen
Zb s19,s17,52480
Zh v[124:127],v2,s[24:27],s19 offen
Za v219,v3,s[24:27],s19 offen
Zb s19,s17,43520
Zh v[128:131],v2,s[24:27],s19 offen
Za v220,v3,s[24:27],s19 offen
Zb s19,s17,44800
Zh v[132:135],v2,s[24:27],s19 offen
Za v221,v3,s[24:27],s19 offen
Zb s19,s17,53760
Zh v[136:139],v2,s[24:27],s19 offen
Za v222,v3,s[24:27],s19 offen
Zb s19,s17,55040
Zh v[140:143],v2,s[24:27],s19 offen
Za v223,v3,s[24:27],s19 offen
Zb s19,s17,81920
Zh v[144:147],v2,s[24:27],s19 offen
Za v224,v3,s[24:27],s19 offen
Zb s19,s17,83200
Zh v[148:151],v2,s[24:27],s19 offen
Za v225,v3,s[24:27],s19 offen
Zb s19,s17,92160
Zh v[152:155],v2,s[24:27],s19 offen
Za v226,v3,s[24:27],s19 offen
Zb s19,s17,93440
Zh v[156:159],v2,s[24:27],s19 offen
Za v227,v3,s[24:27],s19 offen
Zb s19,s17,84480
Zh v[160:163],v2,s[24:27],s19 offen
Za v228,v3,s[24:27],s19 offen
Zb s19,s17,85760
Zh v[164:167],v2,s[24:27],s19 offen
Za v229,v3,s[24:27],s19 offen
Zb s19,s17,94720
Zh v[168:171],v2,s[24:27],s19 offen
Za v230,v3,s[24:27],s19 offen
Zb s19,s17,96000
Zh v[172:175],v2,s[24:27],s19 offen
Za v231,v3,s[24:27],s19 offen
Zb s19,s17,122880
Zh v[176:179],v2,s[24:27],s19 offen
Za v232,v3,s[24:27],s19 offen
Zb s19,s17,124160
Zh v[180:183],v2,s[24:27],s19 offen
Za v233,v3,s[24:27],s19 offen
Zb s19,s17,133120
Zh v[184:187],v2,s[24:27],s19 offen
Za v234,v3,s[24:27],s19 offen
Zb s19,s17,134400
Zh v[188:191],v2,s[24:27],s19 offen
Za v235,v3,s[24:27],s19 offen
Zb s19,s17,125440
Zh v[192:195],v2,s[24:27],s19 offen
Za v236,v3,s[24:27],s19 offen
Zb s19,s17,126720
Zh v[196:199],v2,s[24:27],s19 offen
Za v237,v3,s[24:27],s19 offen
Zb s19,s17,135680
Zh v[200:203],v2,s[24:27],s19 offen
Za v238,v3,s[24:27],s19 offen
Zb s19,s17,136960
Zh v[204:207],v2,s[24:27],s19 offen
Za v239,v3,s[24:27],s19 offen
Zf vmcnt(62)
Zf vmcnt(61)
Zc v72,v84,v80,s22
Zf vmcnt(57)
Zc v73,v92,v88,s22
Zf vmcnt(53)
Zc v74,v100,v96,s22
Zf vmcnt(49)
Zc v75,v108,v104,s22
Zf vmcnt(45)
Zc v76,v116,v112,s22
Zf vmcnt(41)
Zc v77,v124,v120,s22
Zf vmcnt(37)
Zc v78,v132,v128,s22
Zf vmcnt(33)
Zc v79,v140,v136,s22
Zt v5,v[72:75] offset:26624
Zt v5,v[76:79] offset:27648
Zc v64,v84,v80,s23
Zc v65,v92,v88,s23
Zc v66,v100,v96,s23
Zc v67,v108,v104,s23
Zc v68,v116,v112,s23
Zc v69,v124,v120,s23
Zc v70,v132,v128,s23
Zc v71,v140,v136,s23
Zd a0,v64
Zd a1,v65
Zd a2,v66
Zd a3,v67
Zd a4,v68
Zd a5,v69
Zd a6,v70
Zd a7,v71
Zc v72,v85,v81,s22
Zc v73,v93,v89,s22
Zc v74,v101,v97,s22
Zc v75,v109,v105,s22
Zc v76,v117,v113,s22
Zc v77,v125,v121,s22
Zc v78,v133,v129,s22
Zc v79,v141,v137,s22
Zd a16,v72
Zd a17,v73
Zd a18,v74
Zd a19,v75
Zd a20,v76
Zd a21,v77
Zd a22,v78
Zd a23,v79
Zc v64,v85,v81,s23
Zc v65,v93,v89,s23
Zc v66,v101,v97,s23
Zc v67,v109,v105,s23
Zc v68,v117,v113,s23
Zc v69,v125,v121,s23
Zc v70,v133,v129,s23
Zc v71,v141,v137,s23
Zd a32,v64
Zd a33,v65
Zd a34,v66
Zd a35,v67
Zd a36,v68
Zd a37,v69
Zd a38,v70
Zd a39,v71
Zc v72,v86,v82,s22
Zc v73,v94,v90,s22
Zc v74,v102,v98,s22
Zc v75,v110,v106,s22
Zc v76,v118,v114,s22
Zc v77,v126,v122,s22
Zc v78,v134,v130,s22
Zc v79,v142,v138,s22
Zt v5,v[72:75] offset:32768
Zt v5,v[76:79] offset:33792
Zc v64,v86,v82,s23
Zc v65,v94,v90,s23
Zc v66,v102,v98,s23
Zc v67,v110,v106,s23
Zc v68,v118,v114,s23
Zc v69,v126,v122,s23
Zc v70,v134,v130,s23
Zc v71,v142,v138,s23
Zd a48,v64
Zd a49,v65
Zd a50,v66
Zd a51,v67
Zd a52,v68
Zd a53,v69
Zd a54,v70
Zd a55,v71
Zc v72,v87,v83,s22
Zc v73,v95,v91,s22
Zc v74,v103,v99,s22
Zc v75,v111,v107,s22
Zc v76,v119,v115,s22
Zc v77,v127,v123,s22
Zc v78,v135,v131,s22
Zc v79,v143,v139,s22
Zd a64,v72
Zd a65,v73
Zd a66,v74
Zd a67,v75
Zd a68,v76
Zd a69,v77
Zd a70,v78
Zd a71,v79
Zc v64,v87,v83,s23
Zc v65,v95,v91,s23
Zc v66,v103,v99,s23
Zc v67,v111,v107,s23
Zc v68,v119,v115,s23
Zc v69,v127,v123,s23
Zc v70,v135,v131,s23
Zc v71,v143,v139,s23
Zd a80,v64
Zd a81,v65
Zd a82,v66
Zd a83,v67
Zd a84,v68
Zd a85,v69
Zd a86,v70
Zd a87,v71
Zc v72,v209,v208,s22
Zc v73,v211,v210,s22
Zc v74,v213,v212,s22
Zc v75,v215,v214,s22
Zc v76,v217,v216,s22
Zc v77,v219,v218,s22
Zc v78,v221,v220,s22
Zf vmcnt(32)
Zc v79,v223,v222,s22
Zd a96,v72
Zd a97,v73
Zd a98,v74
Zd a99,v75
Zd a100,v76
Zd a101,v77
Zd a102,v78
Zd a103,v79
Zc v64,v209,v208,s23
Zc v65,v211,v210,s23
Zc v66,v213,v212,s23
Zc v67,v215,v214,s23
Zc v68,v217,v216,s23
Zc v69,v219,v218,s23
Zc v70,v221,v220,s23
Zc v71,v223,v222,s23
Zd a112,v64
Zd a113,v65
Zd a114,v66
Zd a115,v67
Zd a116,v68
Zd a117,v69
Zd a118,v70
Zd a119,v71
Zf vmcnt(29)
Zc v72,v148,v144,s22
Zf vmcnt(25)
Zc v73,v156,v152,s22
Zf vmcnt(21)
Zc v74,v164,v160,s22
Zf vmcnt(17)
Zc v75,v172,v168,s22
Zf vmcnt(13)
Zc v76,v180,v176,s22
Zf vmcnt(9)
Zc v77,v188,v184,s22
Zf vmcnt(5)
Zc v78,v196,v192,s22
Zf vmcnt(1)
Zc v79,v204,v200,s22
Zt v5,v[72:75] offset:30720
Zt v5,v[76:79] offset:31744
Zc v64,v148,v144,s23
Zc v65,v156,v152,s23
Zc v66,v164,v160,s23
Zc v67,v172,v168,s23
Zc v68,v180,v176,s23
Zc v69,v188,v184,s23
Zc v70,v196,v192,s23
Zc v71,v204,v200,s23
Zd a8,v64
Zd a9,v65
Zd a10,v66
Zd a11,v67
Zd a12,v68
Zd a13,v69
Zd a14,v70
Zd a15,v71
Zc v72,v149,v145,s22
Zc v73,v157,v153,s22
Zc v74,v165,v161,s22
Zc v75,v173,v169,s22
Zc v76,v181,v177,s22
Zc v77,v189,v185,s22
Zc v78,v197,v193,s22
Zc v79,v205,v201,s22
Zd a24,v72
Zd a25,v73
Zd a26,v74
Zd a27,v75
Zd a28,v76
Zd a29,v77
Zd a30,v78
Zd a31,v79
Zc v64,v149,v145,s23
Zc v65,v157,v153,s23
Zc v66,v165,v161,s23
Zc v67,v173,v169,s23
Zc v68,v181,v177,s23
Zc v69,v189,v185,s23
Zc v70,v197,v193,s23
Zc v71,v205,v201,s23
Zt v5,v[64:67] offset:28672
Zt v5,v[68:71] offset:29696
Zc v72,v150,v146,s22
Zc v73,v158,v154,s22
Zc v74,v166,v162,s22
Zc v75,v174,v170,s22
Zc v76,v182,v178,s22
Zc v77,v190,v186,s22
Zc v78,v198,v194,s22
Zc v79,v206,v202,s22
Zd a40,v72
Zd a41,v73
Zd a42,v74
Zd a43,v75
Zd a44,v76
Zd a45,v77
Zd a46,v78
Zd a47,v79
Zc v64,v150,v146,s23
Zc v65,v158,v154,s23
Zc v66,v166,v162,s23
Zc v67,v174,v170,s23
Zc v68,v182,v178,s23
Zc v69,v190,v186,s23
Zc v70,v198,v194,s23
Zc v71,v206,v202,s23
Zd a56,v64
Zd a57,v65
Zd a58,v66
Zd a59,v67
Zd a60,v68
Zd a61,v69
Zd a62,v70
Zd a63,v71
Zc v72,v151,v147,s22
Zc v73,v159,v155,s22
Zc v74,v167,v163,s22
Zc v75,v175,v171,s22
Zc v76,v183,v179,s22
Zc v77,v191,v187,s22
Zc v78,v199,v195,s22
Zc v79,v207,v203,s22
Zd a72,v72
Zd a73,v73
Zd a74,v74
Zd a75,v75
Zd a76,v76
Zd a77,v77
Zd a78,v78
Zd a79,v79
Zc v64,v151,v147,s23
Zc v65,v159,v155,s23
Zc v66,v167,v163,s23
Zc v67,v175,v171,s23
Zc v68,v183,v179,s23
Zc v69,v191,v187,s23
Zc v70,v199,v195,s23
Zc v71,v207,v203,s23
Zd a88,v64
Zd a89,v65
Zd a90,v66
Zd a91,v67
Zd a92,v68
Zd a93,v69
Zd a94,v70
Zd a95,v71
Zc v72,v225,v224,s22
Zc v73,v227,v226,s22
Zc v74,v229,v228,s22
Zc v75,v231,v230,s22
Zc v76,v233,v232,s22
Zc v77,v235,v234,s22
Zc v78,v237,v236,s22
Zf vmcnt(0)
Zc v79,v239,v238,s22
Zd a104,v72
Zd a105,v73
Zd a106,v74
Zd a107,v75
Zd a108,v76
Zd a109,v77
Zd a110,v78
Zd a111,v79
Zc v64,v225,v224,s23
Zc v65,v227,v226,s23
Zc v66,v229,v228,s23
Zc v67,v231,v230,s23
Zc v68,v233,v232,s23
Zc v69,v235,v234,s23
Zc v70,v237,v236,s23
Zc v71,v239,v238,s23
Zd a120,v64
Zd a121,v65
Zd a122,v66
Zd a123,v67
Zd a124,v68
Zd a125,v69
Zd a126,v70
Zd a127,v71
s_load_dwordx2 s[24:25], s[0:1], 56
Zp s26,5242880
Zp s27,0x20000
s_load_dwordx2 s[28:29], s[0:1], 64
Zp s30,5242880
Zp s31,0x20000
s_load_dwordx2 s[32:33], s[0:1], 72
Zp s34,5242880
Zp s35,0x20000
Zz v2,13,v14
v_lshl_add_u32 v2, v12, 2, v2
v_add_u32 v2, 0, v2
Zq s17,s8,8
Zb s19,s17,0
Zf lgkmcnt(0)
Za v16,v2,s[24:27],s19 offen
Zb s19,s17,8192
Za v17,v2,s[24:27],s19 offen
Zb s19,s17,65536
Za v18,v2,s[24:27],s19 offen
Zb s19,s17,73728
Za v19,v2,s[24:27],s19 offen
Zb s19,s17,16384
Za v20,v2,s[24:27],s19 offen
Zb s19,s17,24576
Za v21,v2,s[24:27],s19 offen
Zb s19,s17,81920
Za v22,v2,s[24:27],s19 offen
Zb s19,s17,90112
Za v23,v2,s[24:27],s19 offen
Zb s19,s17,262144
Za v24,v2,s[24:27],s19 offen
Zb s19,s17,270336
Za v25,v2,s[24:27],s19 offen
Zb s19,s17,327680
Za v26,v2,s[24:27],s19 offen
Zb s19,s17,335872
Za v27,v2,s[24:27],s19 offen
Zb s19,s17,278528
Za v28,v2,s[24:27],s19 offen
Zb s19,s17,286720
Za v29,v2,s[24:27],s19 offen
Zb s19,s17,344064
Za v30,v2,s[24:27],s19 offen
Zb s19,s17,352256
Za v31,v2,s[24:27],s19 offen
Zb s19,s17,524288
Za v32,v2,s[24:27],s19 offen
Zb s19,s17,532480
Za v33,v2,s[24:27],s19 offen
Zb s19,s17,589824
Za v34,v2,s[24:27],s19 offen
Zb s19,s17,598016
Za v35,v2,s[24:27],s19 offen
Zb s19,s17,540672
Za v36,v2,s[24:27],s19 offen
Zb s19,s17,548864
Za v37,v2,s[24:27],s19 offen
Zb s19,s17,606208
Za v38,v2,s[24:27],s19 offen
Zb s19,s17,614400
Za v39,v2,s[24:27],s19 offen
Zb s19,s17,786432
Za v40,v2,s[24:27],s19 offen
Zb s19,s17,794624
Za v41,v2,s[24:27],s19 offen
Zb s19,s17,851968
Za v42,v2,s[24:27],s19 offen
Zb s19,s17,860160
Za v43,v2,s[24:27],s19 offen
Zb s19,s17,802816
Za v44,v2,s[24:27],s19 offen
Zb s19,s17,811008
Za v45,v2,s[24:27],s19 offen
Zb s19,s17,868352
Za v46,v2,s[24:27],s19 offen
Zb s19,s17,876544
Za v47,v2,s[24:27],s19 offen
Zb s19,s17,1048576
Za v48,v2,s[24:27],s19 offen
Zb s19,s17,1056768
Za v49,v2,s[24:27],s19 offen
Zb s19,s17,1114112
Za v50,v2,s[24:27],s19 offen
Zb s19,s17,1122304
Za v51,v2,s[24:27],s19 offen
Zb s19,s17,1064960
Za v52,v2,s[24:27],s19 offen
Zb s19,s17,1073152
Za v53,v2,s[24:27],s19 offen
Zb s19,s17,1130496
Za v54,v2,s[24:27],s19 offen
Zb s19,s17,1138688
Za v55,v2,s[24:27],s19 offen
Zb s19,s17,1310720
Za v56,v2,s[24:27],s19 offen
Zb s19,s17,1318912
Za v57,v2,s[24:27],s19 offen
Zb s19,s17,1376256
Za v58,v2,s[24:27],s19 offen
Zb s19,s17,1384448
Za v59,v2,s[24:27],s19 offen
Zb s19,s17,1327104
Za v60,v2,s[24:27],s19 offen
Zb s19,s17,1335296
Za v61,v2,s[24:27],s19 offen
Zb s19,s17,1392640
Za v62,v2,s[24:27],s19 offen
Zb s19,s17,1400832
Za v63,v2,s[24:27],s19 offen
Zf vmcnt(46)
Zc v72,v17,v16,s22
Zf vmcnt(44)
Zc v73,v19,v18,s22
Zf vmcnt(42)
Zc v74,v21,v20,s22
Zf vmcnt(40)
Zc v75,v23,v22,s22
Zf vmcnt(38)
Zc v76,v25,v24,s22
Zf vmcnt(36)
Zc v77,v27,v26,s22
Zf vmcnt(34)
Zc v78,v29,v28,s22
Zf vmcnt(32)
Zc v79,v31,v30,s22
Zb s19,s18,0
Zr v[72:75],v0,s[4:7],s19 offen
Zr v[76:79],v0,s[4:7],s19 offen offset:1024
Zc v64,v17,v16,s23
Zc v65,v19,v18,s23
Zc v66,v21,v20,s23
Zc v67,v23,v22,s23
Zc v68,v25,v24,s23
Zc v69,v27,v26,s23
Zc v70,v29,v28,s23
Zc v71,v31,v30,s23
Zb s19,s18,6144
Zr v[64:67],v0,s[4:7],s19 offen
Zr v[68:71],v0,s[4:7],s19 offen offset:1024
Zb s19,s17,1572864
Za v16,v2,s[24:27],s19 offen
Zb s19,s17,1581056
Za v17,v2,s[24:27],s19 offen
Zb s19,s17,1638400
Za v18,v2,s[24:27],s19 offen
Zb s19,s17,1646592
Za v19,v2,s[24:27],s19 offen
Zb s19,s17,1589248
Za v20,v2,s[24:27],s19 offen
Zb s19,s17,1597440
Za v21,v2,s[24:27],s19 offen
Zb s19,s17,1654784
Za v22,v2,s[24:27],s19 offen
Zb s19,s17,1662976
Za v23,v2,s[24:27],s19 offen
Zb s19,s17,1835008
Za v24,v2,s[24:27],s19 offen
Zb s19,s17,1843200
Za v25,v2,s[24:27],s19 offen
Zb s19,s17,1900544
Za v26,v2,s[24:27],s19 offen
Zb s19,s17,1908736
Za v27,v2,s[24:27],s19 offen
Zb s19,s17,1851392
Za v28,v2,s[24:27],s19 offen
Zb s19,s17,1859584
Za v29,v2,s[24:27],s19 offen
Zb s19,s17,1916928
Za v30,v2,s[24:27],s19 offen
Zb s19,s17,1925120
Za v31,v2,s[24:27],s19 offen
Zf vmcnt(50)
Zc v72,v33,v32,s22
Zf vmcnt(48)
Zc v73,v35,v34,s22
Zf vmcnt(46)
Zc v74,v37,v36,s22
Zf vmcnt(44)
Zc v75,v39,v38,s22
Zf vmcnt(42)
Zc v76,v41,v40,s22
Zf vmcnt(40)
Zc v77,v43,v42,s22
Zf vmcnt(38)
Zc v78,v45,v44,s22
Zf vmcnt(36)
Zc v79,v47,v46,s22
Zd a144,v72
Zd a145,v73
Zd a146,v74
Zd a147,v75
Zd a148,v76
Zd a149,v77
Zd a150,v78
Zd a151,v79
Zc v64,v33,v32,s23
Zc v65,v35,v34,s23
Zc v66,v37,v36,s23
Zc v67,v39,v38,s23
Zc v68,v41,v40,s23
Zc v69,v43,v42,s23
Zc v70,v45,v44,s23
Zc v71,v47,v46,s23
Zt v5,v[64:67] offset:2048
Zt v5,v[68:71] offset:3072
Zb s19,s17,2097152
Za v32,v2,s[24:27],s19 offen
Zb s19,s17,2105344
Za v33,v2,s[24:27],s19 offen
Zb s19,s17,2162688
Za v34,v2,s[24:27],s19 offen
Zb s19,s17,2170880
Za v35,v2,s[24:27],s19 offen
Zb s19,s17,2113536
Za v36,v2,s[24:27],s19 offen
Zb s19,s17,2121728
Za v37,v2,s[24:27],s19 offen
Zb s19,s17,2179072
Za v38,v2,s[24:27],s19 offen
Zb s19,s17,2187264
Za v39,v2,s[24:27],s19 offen
Zb s19,s17,2359296
Za v40,v2,s[24:27],s19 offen
Zb s19,s17,2367488
Za v41,v2,s[24:27],s19 offen
Zb s19,s17,2424832
Za v42,v2,s[24:27],s19 offen
Zb s19,s17,2433024
Za v43,v2,s[24:27],s19 offen
Zb s19,s17,2375680
Za v44,v2,s[24:27],s19 offen
Zb s19,s17,2383872
Za v45,v2,s[24:27],s19 offen
Zb s19,s17,2441216
Za v46,v2,s[24:27],s19 offen
Zb s19,s17,2449408
Za v47,v2,s[24:27],s19 offen
Zf vmcnt(50)
Zc v72,v49,v48,s22
Zf vmcnt(48)
Zc v73,v51,v50,s22
Zf vmcnt(46)
Zc v74,v53,v52,s22
Zf vmcnt(44)
Zc v75,v55,v54,s22
Zf vmcnt(42)
Zc v76,v57,v56,s22
Zf vmcnt(40)
Zc v77,v59,v58,s22
Zf vmcnt(38)
Zc v78,v61,v60,s22
Zf vmcnt(36)
Zc v79,v63,v62,s22
Zd a168,v72
Zd a169,v73
Zd a170,v74
Zd a171,v75
Zd a172,v76
Zd a173,v77
Zd a174,v78
Zd a175,v79
Zc v64,v49,v48,s23
Zc v65,v51,v50,s23
Zc v66,v53,v52,s23
Zc v67,v55,v54,s23
Zc v68,v57,v56,s23
Zc v69,v59,v58,s23
Zc v70,v61,v60,s23
Zc v71,v63,v62,s23
Zt v5,v[64:67] offset:12288
Zt v5,v[68:71] offset:13312
Zb s19,s17,2621440
Za v48,v2,s[24:27],s19 offen
Zb s19,s17,2629632
Za v49,v2,s[24:27],s19 offen
Zb s19,s17,2686976
Za v50,v2,s[24:27],s19 offen
Zb s19,s17,2695168
Za v51,v2,s[24:27],s19 offen
Zb s19,s17,2637824
Za v52,v2,s[24:27],s19 offen
Zb s19,s17,2646016
Za v53,v2,s[24:27],s19 offen
Zb s19,s17,2703360
Za v54,v2,s[24:27],s19 offen
Zb s19,s17,2711552
Za v55,v2,s[24:27],s19 offen
Zb s19,s17,2883584
Za v56,v2,s[24:27],s19 offen
Zb s19,s17,2891776
Za v57,v2,s[24:27],s19 offen
Zb s19,s17,2949120
Za v58,v2,s[24:27],s19 offen
Zb s19,s17,2957312
Za v59,v2,s[24:27],s19 offen
Zb s19,s17,2899968
Za v60,v2,s[24:27],s19 offen
Zb s19,s17,2908160
Za v61,v2,s[24:27],s19 offen
Zb s19,s17,2965504
Za v62,v2,s[24:27],s19 offen
Zb s19,s17,2973696
Za v63,v2,s[24:27],s19 offen
Zf vmcnt(46)
Zc v72,v17,v16,s22
Zf vmcnt(44)
Zc v73,v19,v18,s22
Zf vmcnt(42)
Zc v74,v21,v20,s22
Zf vmcnt(40)
Zc v75,v23,v22,s22
Zf vmcnt(38)
Zc v76,v25,v24,s22
Zf vmcnt(36)
Zc v77,v27,v26,s22
Zf vmcnt(34)
Zc v78,v29,v28,s22
Zf vmcnt(32)
Zc v79,v31,v30,s22
Zd a200,v72
Zd a201,v73
Zd a202,v74
Zd a203,v75
Zd a204,v76
Zd a205,v77
Zd a206,v78
Zd a207,v79
Zc v64,v17,v16,s23
Zc v65,v19,v18,s23
Zc v66,v21,v20,s23
Zc v67,v23,v22,s23
Zc v68,v25,v24,s23
Zc v69,v27,v26,s23
Zc v70,v29,v28,s23
Zc v71,v31,v30,s23
Zt v5,v[64:67] offset:14336
Zt v5,v[68:71] offset:15360
Zb s19,s17,3145728
Za v16,v2,s[24:27],s19 offen
Zb s19,s17,3153920
Za v17,v2,s[24:27],s19 offen
Zb s19,s17,3211264
Za v18,v2,s[24:27],s19 offen
Zb s19,s17,3219456
Za v19,v2,s[24:27],s19 offen
Zb s19,s17,3162112
Za v20,v2,s[24:27],s19 offen
Zb s19,s17,3170304
Za v21,v2,s[24:27],s19 offen
Zb s19,s17,3227648
Za v22,v2,s[24:27],s19 offen
Zb s19,s17,3235840
Za v23,v2,s[24:27],s19 offen
Zb s19,s17,3407872
Za v24,v2,s[24:27],s19 offen
Zb s19,s17,3416064
Za v25,v2,s[24:27],s19 offen
Zb s19,s17,3473408
Za v26,v2,s[24:27],s19 offen
Zb s19,s17,3481600
Za v27,v2,s[24:27],s19 offen
Zb s19,s17,3424256
Za v28,v2,s[24:27],s19 offen
Zb s19,s17,3432448
Za v29,v2,s[24:27],s19 offen
Zb s19,s17,3489792
Za v30,v2,s[24:27],s19 offen
Zb s19,s17,3497984
Za v31,v2,s[24:27],s19 offen
Zf vmcnt(46)
Zc v72,v33,v32,s22
Zf vmcnt(44)
Zc v73,v35,v34,s22
Zf vmcnt(42)
Zc v74,v37,v36,s22
Zf vmcnt(40)
Zc v75,v39,v38,s22
Zf vmcnt(38)
Zc v76,v41,v40,s22
Zf vmcnt(36)
Zc v77,v43,v42,s22
Zf vmcnt(34)
Zc v78,v45,v44,s22
Zf vmcnt(32)
Zc v79,v47,v46,s22
Zd a232,v72
Zd a233,v73
Zd a234,v74
Zd a235,v75
Zd a236,v76
Zd a237,v77
Zd a238,v78
Zd a239,v79
Zc v64,v33,v32,s23
Zc v65,v35,v34,s23
Zc v66,v37,v36,s23
Zc v67,v39,v38,s23
Zc v68,v41,v40,s23
Zc v69,v43,v42,s23
Zc v70,v45,v44,s23
Zc v71,v47,v46,s23
Zd a240,v64
Zd a241,v65
Zd a242,v66
Zd a243,v67
Zd a244,v68
Zd a245,v69
Zd a246,v70
Zd a247,v71
Zb s19,s17,3670016
Za v32,v2,s[24:27],s19 offen
Zb s19,s17,3678208
Za v33,v2,s[24:27],s19 offen
Zb s19,s17,3735552
Za v34,v2,s[24:27],s19 offen
Zb s19,s17,3743744
Za v35,v2,s[24:27],s19 offen
Zb s19,s17,3686400
Za v36,v2,s[24:27],s19 offen
Zb s19,s17,3694592
Za v37,v2,s[24:27],s19 offen
Zb s19,s17,3751936
Za v38,v2,s[24:27],s19 offen
Zb s19,s17,3760128
Za v39,v2,s[24:27],s19 offen
Zb s19,s17,3932160
Za v40,v2,s[24:27],s19 offen
Zb s19,s17,3940352
Za v41,v2,s[24:27],s19 offen
Zb s19,s17,3997696
Za v42,v2,s[24:27],s19 offen
Zb s19,s17,4005888
Za v43,v2,s[24:27],s19 offen
Zb s19,s17,3948544
Za v44,v2,s[24:27],s19 offen
Zb s19,s17,3956736
Za v45,v2,s[24:27],s19 offen
Zb s19,s17,4014080
Za v46,v2,s[24:27],s19 offen
Zb s19,s17,4022272
Za v47,v2,s[24:27],s19 offen
Zf vmcnt(46)
Zc v88,v49,v48,s22
Zf vmcnt(44)
Zc v89,v51,v50,s22
Zf vmcnt(42)
Zc v90,v53,v52,s22
Zf vmcnt(40)
Zc v91,v55,v54,s22
Zf vmcnt(38)
Zc v92,v57,v56,s22
Zf vmcnt(36)
Zc v93,v59,v58,s22
Zf vmcnt(34)
Zc v94,v61,v60,s22
Zf vmcnt(32)
Zc v95,v63,v62,s22
Zc v96,v49,v48,s23
Zc v97,v51,v50,s23
Zc v98,v53,v52,s23
Zc v99,v55,v54,s23
Zc v100,v57,v56,s23
Zc v101,v59,v58,s23
Zc v102,v61,v60,s23
Zc v103,v63,v62,s23
Zb s19,s17,4194304
Za v48,v2,s[24:27],s19 offen
Zb s19,s17,4202496
Za v49,v2,s[24:27],s19 offen
Zb s19,s17,4259840
Za v50,v2,s[24:27],s19 offen
Zb s19,s17,4268032
Za v51,v2,s[24:27],s19 offen
Zb s19,s17,4210688
Za v52,v2,s[24:27],s19 offen
Zb s19,s17,4218880
Za v53,v2,s[24:27],s19 offen
Zb s19,s17,4276224
Za v54,v2,s[24:27],s19 offen
Zb s19,s17,4284416
Za v55,v2,s[24:27],s19 offen
Zb s19,s17,4456448
Za v56,v2,s[24:27],s19 offen
Zb s19,s17,4464640
Za v57,v2,s[24:27],s19 offen
Zb s19,s17,4521984
Za v58,v2,s[24:27],s19 offen
Zb s19,s17,4530176
Za v59,v2,s[24:27],s19 offen
Zb s19,s17,4472832
Za v60,v2,s[24:27],s19 offen
Zb s19,s17,4481024
Za v61,v2,s[24:27],s19 offen
Zb s19,s17,4538368
Za v62,v2,s[24:27],s19 offen
Zb s19,s17,4546560
Za v63,v2,s[24:27],s19 offen
Zf vmcnt(46)
Zc v120,v17,v16,s22
Zf vmcnt(44)
Zc v121,v19,v18,s22
Zf vmcnt(42)
Zc v122,v21,v20,s22
Zf vmcnt(40)
Zc v123,v23,v22,s22
Zf vmcnt(38)
Zc v124,v25,v24,s22
Zf vmcnt(36)
Zc v125,v27,v26,s22
Zf vmcnt(34)
Zc v126,v29,v28,s22
Zf vmcnt(32)
Zc v127,v31,v30,s22
Zc v128,v17,v16,s23
Zc v129,v19,v18,s23
Zc v130,v21,v20,s23
Zc v131,v23,v22,s23
Zc v132,v25,v24,s23
Zc v133,v27,v26,s23
Zc v134,v29,v28,s23
Zc v135,v31,v30,s23
Zb s19,s17,4718592
Za v16,v2,s[24:27],s19 offen
Zb s19,s17,4726784
Za v17,v2,s[24:27],s19 offen
Zb s19,s17,4784128
Za v18,v2,s[24:27],s19 offen
Zb s19,s17,4792320
Za v19,v2,s[24:27],s19 offen
Zb s19,s17,4734976
Za v20,v2,s[24:27],s19 offen
Zb s19,s17,4743168
Za v21,v2,s[24:27],s19 offen
Zb s19,s17,4800512
Za v22,v2,s[24:27],s19 offen
Zb s19,s17,4808704
Za v23,v2,s[24:27],s19 offen
Zb s19,s17,4980736
Za v24,v2,s[24:27],s19 offen
Zb s19,s17,4988928
Za v25,v2,s[24:27],s19 offen
Zb s19,s17,5046272
Za v26,v2,s[24:27],s19 offen
Zb s19,s17,5054464
Za v27,v2,s[24:27],s19 offen
Zb s19,s17,4997120
Za v28,v2,s[24:27],s19 offen
Zb s19,s17,5005312
Za v29,v2,s[24:27],s19 offen
Zb s19,s17,5062656
Za v30,v2,s[24:27],s19 offen
Zb s19,s17,5070848
Za v31,v2,s[24:27],s19 offen
Zf vmcnt(46)
Zc v160,v33,v32,s22
Zf vmcnt(44)
Zc v161,v35,v34,s22
Zf vmcnt(42)
Zc v162,v37,v36,s22
Zf vmcnt(40)
Zc v163,v39,v38,s22
Zf vmcnt(38)
Zc v164,v41,v40,s22
Zf vmcnt(36)
Zc v165,v43,v42,s22
Zf vmcnt(34)
Zc v166,v45,v44,s22
Zf vmcnt(32)
Zc v167,v47,v46,s22
Zc v168,v33,v32,s23
Zc v169,v35,v34,s23
Zc v170,v37,v36,s23
Zc v171,v39,v38,s23
Zc v172,v41,v40,s23
Zc v173,v43,v42,s23
Zc v174,v45,v44,s23
Zc v175,v47,v46,s23
Zb s19,s17,0
Za v32,v2,s[28:31],s19 offen
Zb s19,s17,8192
Za v33,v2,s[28:31],s19 offen
Zb s19,s17,65536
Za v34,v2,s[28:31],s19 offen
Zb s19,s17,73728
Za v35,v2,s[28:31],s19 offen
Zb s19,s17,16384
Za v36,v2,s[28:31],s19 offen
Zb s19,s17,24576
Za v37,v2,s[28:31],s19 offen
Zb s19,s17,81920
Za v38,v2,s[28:31],s19 offen
Zb s19,s17,90112
Za v39,v2,s[28:31],s19 offen
Zb s19,s17,262144
Za v40,v2,s[28:31],s19 offen
Zb s19,s17,270336
Za v41,v2,s[28:31],s19 offen
Zb s19,s17,327680
Za v42,v2,s[28:31],s19 offen
Zb s19,s17,335872
Za v43,v2,s[28:31],s19 offen
Zb s19,s17,278528
Za v44,v2,s[28:31],s19 offen
Zb s19,s17,286720
Za v45,v2,s[28:31],s19 offen
Zb s19,s17,344064
Za v46,v2,s[28:31],s19 offen
Zb s19,s17,352256
Za v47,v2,s[28:31],s19 offen
Zf vmcnt(46)
Zc v184,v49,v48,s22
Zf vmcnt(44)
Zc v185,v51,v50,s22
Zf vmcnt(42)
Zc v186,v53,v52,s22
Zf vmcnt(40)
Zc v187,v55,v54,s22
Zf vmcnt(38)
Zc v188,v57,v56,s22
Zf vmcnt(36)
Zc v189,v59,v58,s22
Zf vmcnt(34)
Zc v190,v61,v60,s22
Zf vmcnt(32)
Zc v191,v63,v62,s22
Zc v64,v49,v48,s23
Zc v65,v51,v50,s23
Zc v66,v53,v52,s23
Zc v67,v55,v54,s23
Zc v68,v57,v56,s23
Zc v69,v59,v58,s23
Zc v70,v61,v60,s23
Zc v71,v63,v62,s23
Zt v5,v[64:67] offset:6144
Zt v5,v[68:71] offset:7168
Zb s19,s17,524288
Za v48,v2,s[28:31],s19 offen
Zb s19,s17,532480
Za v49,v2,s[28:31],s19 offen
Zb s19,s17,589824
Za v50,v2,s[28:31],s19 offen
Zb s19,s17,598016
Za v51,v2,s[28:31],s19 offen
Zb s19,s17,540672
Za v52,v2,s[28:31],s19 offen
Zb s19,s17,548864
Za v53,v2,s[28:31],s19 offen
Zb s19,s17,606208
Za v54,v2,s[28:31],s19 offen
Zb s19,s17,614400
Za v55,v2,s[28:31],s19 offen
Zb s19,s17,786432
Za v56,v2,s[28:31],s19 offen
Zb s19,s17,794624
Za v57,v2,s[28:31],s19 offen
Zb s19,s17,851968
Za v58,v2,s[28:31],s19 offen
Zb s19,s17,860160
Za v59,v2,s[28:31],s19 offen
Zb s19,s17,802816
Za v60,v2,s[28:31],s19 offen
Zb s19,s17,811008
Za v61,v2,s[28:31],s19 offen
Zb s19,s17,868352
Za v62,v2,s[28:31],s19 offen
Zb s19,s17,876544
Za v63,v2,s[28:31],s19 offen
Zf vmcnt(46)
Zc v192,v17,v16,s22
Zf vmcnt(44)
Zc v193,v19,v18,s22
Zf vmcnt(42)
Zc v194,v21,v20,s22
Zf vmcnt(40)
Zc v195,v23,v22,s22
Zf vmcnt(38)
Zc v196,v25,v24,s22
Zf vmcnt(36)
Zc v197,v27,v26,s22
Zf vmcnt(34)
Zc v198,v29,v28,s22
Zf vmcnt(32)
Zc v199,v31,v30,s22
Zc v200,v17,v16,s23
Zc v201,v19,v18,s23
Zc v202,v21,v20,s23
Zc v203,v23,v22,s23
Zc v204,v25,v24,s23
Zc v205,v27,v26,s23
Zc v206,v29,v28,s23
Zc v207,v31,v30,s23
Zb s19,s17,1048576
Za v16,v2,s[28:31],s19 offen
Zb s19,s17,1056768
Za v17,v2,s[28:31],s19 offen
Zb s19,s17,1114112
Za v18,v2,s[28:31],s19 offen
Zb s19,s17,1122304
Za v19,v2,s[28:31],s19 offen
Zb s19,s17,1064960
Za v20,v2,s[28:31],s19 offen
Zb s19,s17,1073152
Za v21,v2,s[28:31],s19 offen
Zb s19,s17,1130496
Za v22,v2,s[28:31],s19 offen
Zb s19,s17,1138688
Za v23,v2,s[28:31],s19 offen
Zb s19,s17,1310720
Za v24,v2,s[28:31],s19 offen
Zb s19,s17,1318912
Za v25,v2,s[28:31],s19 offen
Zb s19,s17,1376256
Za v26,v2,s[28:31],s19 offen
Zb s19,s17,1384448
Za v27,v2,s[28:31],s19 offen
Zb s19,s17,1327104
Za v28,v2,s[28:31],s19 offen
Zb s19,s17,1335296
Za v29,v2,s[28:31],s19 offen
Zb s19,s17,1392640
Za v30,v2,s[28:31],s19 offen
Zb s19,s17,1400832
Za v31,v2,s[28:31],s19 offen
Zf vmcnt(46)
Zc v72,v33,v32,s22
Zf vmcnt(44)
Zc v73,v35,v34,s22
Zf vmcnt(42)
Zc v74,v37,v36,s22
Zf vmcnt(40)
Zc v75,v39,v38,s22
Zf vmcnt(38)
Zc v76,v41,v40,s22
Zf vmcnt(36)
Zc v77,v43,v42,s22
Zf vmcnt(34)
Zc v78,v45,v44,s22
Zf vmcnt(32)
Zc v79,v47,v46,s22
Zb s19,s18,10240
Zr v[72:75],v0,s[4:7],s19 offen
Zr v[76:79],v0,s[4:7],s19 offen offset:1024
Zc v64,v33,v32,s23
Zc v65,v35,v34,s23
Zc v66,v37,v36,s23
Zc v67,v39,v38,s23
Zc v68,v41,v40,s23
Zc v69,v43,v42,s23
Zc v70,v45,v44,s23
Zc v71,v47,v46,s23
Zb s19,s18,14336
Zr v[64:67],v0,s[4:7],s19 offen
Zr v[68:71],v0,s[4:7],s19 offen offset:1024
Zb s19,s17,1572864
Za v32,v2,s[28:31],s19 offen
Zb s19,s17,1581056
Za v33,v2,s[28:31],s19 offen
Zb s19,s17,1638400
Za v34,v2,s[28:31],s19 offen
Zb s19,s17,1646592
Za v35,v2,s[28:31],s19 offen
Zb s19,s17,1589248
Za v36,v2,s[28:31],s19 offen
Zb s19,s17,1597440
Za v37,v2,s[28:31],s19 offen
Zb s19,s17,1654784
Za v38,v2,s[28:31],s19 offen
Zb s19,s17,1662976
Za v39,v2,s[28:31],s19 offen
Zb s19,s17,1835008
Za v40,v2,s[28:31],s19 offen
Zb s19,s17,1843200
Za v41,v2,s[28:31],s19 offen
Zb s19,s17,1900544
Za v42,v2,s[28:31],s19 offen
Zb s19,s17,1908736
Za v43,v2,s[28:31],s19 offen
Zb s19,s17,1851392
Za v44,v2,s[28:31],s19 offen
Zb s19,s17,1859584
Za v45,v2,s[28:31],s19 offen
Zb s19,s17,1916928
Za v46,v2,s[28:31],s19 offen
Zb s19,s17,1925120
Za v47,v2,s[28:31],s19 offen
Zf vmcnt(50)
Zc v72,v49,v48,s22
Zf vmcnt(48)
Zc v73,v51,v50,s22
Zf vmcnt(46)
Zc v74,v53,v52,s22
Zf vmcnt(44)
Zc v75,v55,v54,s22
Zf vmcnt(42)
Zc v76,v57,v56,s22
Zf vmcnt(40)
Zc v77,v59,v58,s22
Zf vmcnt(38)
Zc v78,v61,v60,s22
Zf vmcnt(36)
Zc v79,v63,v62,s22
Zt v5,v[72:75] offset:10240
Zt v5,v[76:79] offset:11264
Zc v64,v49,v48,s23
Zc v65,v51,v50,s23
Zc v66,v53,v52,s23
Zc v67,v55,v54,s23
Zc v68,v57,v56,s23
Zc v69,v59,v58,s23
Zc v70,v61,v60,s23
Zc v71,v63,v62,s23
Zt v5,v[64:67] offset:18432
Zt v5,v[68:71] offset:19456
Zb s19,s17,2097152
Za v48,v2,s[28:31],s19 offen
Zb s19,s17,2105344
Za v49,v2,s[28:31],s19 offen
Zb s19,s17,2162688
Za v50,v2,s[28:31],s19 offen
Zb s19,s17,2170880
Za v51,v2,s[28:31],s19 offen
Zb s19,s17,2113536
Za v52,v2,s[28:31],s19 offen
Zb s19,s17,2121728
Za v53,v2,s[28:31],s19 offen
Zb s19,s17,2179072
Za v54,v2,s[28:31],s19 offen
Zb s19,s17,2187264
Za v55,v2,s[28:31],s19 offen
Zb s19,s17,2359296
Za v56,v2,s[28:31],s19 offen
Zb s19,s17,2367488
Za v57,v2,s[28:31],s19 offen
Zb s19,s17,2424832
Za v58,v2,s[28:31],s19 offen
Zb s19,s17,2433024
Za v59,v2,s[28:31],s19 offen
Zb s19,s17,2375680
Za v60,v2,s[28:31],s19 offen
Zb s19,s17,2383872
Za v61,v2,s[28:31],s19 offen
Zb s19,s17,2441216
Za v62,v2,s[28:31],s19 offen
Zb s19,s17,2449408
Za v63,v2,s[28:31],s19 offen
Zf vmcnt(50)
Zc v72,v17,v16,s22
Zf vmcnt(48)
Zc v73,v19,v18,s22
Zf vmcnt(46)
Zc v74,v21,v20,s22
Zf vmcnt(44)
Zc v75,v23,v22,s22
Zf vmcnt(42)
Zc v76,v25,v24,s22
Zf vmcnt(40)
Zc v77,v27,v26,s22
Zf vmcnt(38)
Zc v78,v29,v28,s22
Zf vmcnt(36)
Zc v79,v31,v30,s22
Zd a176,v72
Zd a177,v73
Zd a178,v74
Zd a179,v75
Zd a180,v76
Zd a181,v77
Zd a182,v78
Zd a183,v79
Zc v64,v17,v16,s23
Zc v65,v19,v18,s23
Zc v66,v21,v20,s23
Zc v67,v23,v22,s23
Zc v68,v25,v24,s23
Zc v69,v27,v26,s23
Zc v70,v29,v28,s23
Zc v71,v31,v30,s23
Zt v5,v[64:67] offset:20480
Zt v5,v[68:71] offset:21504
Zb s19,s17,2621440
Za v16,v2,s[28:31],s19 offen
Zb s19,s17,2629632
Za v17,v2,s[28:31],s19 offen
Zb s19,s17,2686976
Za v18,v2,s[28:31],s19 offen
Zb s19,s17,2695168
Za v19,v2,s[28:31],s19 offen
Zb s19,s17,2637824
Za v20,v2,s[28:31],s19 offen
Zb s19,s17,2646016
Za v21,v2,s[28:31],s19 offen
Zb s19,s17,2703360
Za v22,v2,s[28:31],s19 offen
Zb s19,s17,2711552
Za v23,v2,s[28:31],s19 offen
Zb s19,s17,2883584
Za v24,v2,s[28:31],s19 offen
Zb s19,s17,2891776
Za v25,v2,s[28:31],s19 offen
Zb s19,s17,2949120
Za v26,v2,s[28:31],s19 offen
Zb s19,s17,2957312
Za v27,v2,s[28:31],s19 offen
Zb s19,s17,2899968
Za v28,v2,s[28:31],s19 offen
Zb s19,s17,2908160
Za v29,v2,s[28:31],s19 offen
Zb s19,s17,2965504
Za v30,v2,s[28:31],s19 offen
Zb s19,s17,2973696
Za v31,v2,s[28:31],s19 offen
Zf vmcnt(46)
Zc v72,v33,v32,s22
Zf vmcnt(44)
Zc v73,v35,v34,s22
Zf vmcnt(42)
Zc v74,v37,v36,s22
Zf vmcnt(40)
Zc v75,v39,v38,s22
Zf vmcnt(38)
Zc v76,v41,v40,s22
Zf vmcnt(36)
Zc v77,v43,v42,s22
Zf vmcnt(34)
Zc v78,v45,v44,s22
Zf vmcnt(32)
Zc v79,v47,v46,s22
Zd a208,v72
Zd a209,v73
Zd a210,v74
Zd a211,v75
Zd a212,v76
Zd a213,v77
Zd a214,v78
Zd a215,v79
Zc v64,v33,v32,s23
Zc v65,v35,v34,s23
Zc v66,v37,v36,s23
Zc v67,v39,v38,s23
Zc v68,v41,v40,s23
Zc v69,v43,v42,s23
Zc v70,v45,v44,s23
Zc v71,v47,v46,s23
Zt v5,v[64:67] offset:22528
Zt v5,v[68:71] offset:23552
Zb s19,s17,3145728
Za v32,v2,s[28:31],s19 offen
Zb s19,s17,3153920
Za v33,v2,s[28:31],s19 offen
Zb s19,s17,3211264
Za v34,v2,s[28:31],s19 offen
Zb s19,s17,3219456
Za v35,v2,s[28:31],s19 offen
Zb s19,s17,3162112
Za v36,v2,s[28:31],s19 offen
Zb s19,s17,3170304
Za v37,v2,s[28:31],s19 offen
Zb s19,s17,3227648
Za v38,v2,s[28:31],s19 offen
Zb s19,s17,3235840
Za v39,v2,s[28:31],s19 offen
Zb s19,s17,3407872
Za v40,v2,s[28:31],s19 offen
Zb s19,s17,3416064
Za v41,v2,s[28:31],s19 offen
Zb s19,s17,3473408
Za v42,v2,s[28:31],s19 offen
Zb s19,s17,3481600
Za v43,v2,s[28:31],s19 offen
Zb s19,s17,3424256
Za v44,v2,s[28:31],s19 offen
Zb s19,s17,3432448
Za v45,v2,s[28:31],s19 offen
Zb s19,s17,3489792
Za v46,v2,s[28:31],s19 offen
Zb s19,s17,3497984
Za v47,v2,s[28:31],s19 offen
Zf vmcnt(46)
Zc v72,v49,v48,s22
Zf vmcnt(44)
Zc v73,v51,v50,s22
Zf vmcnt(42)
Zc v74,v53,v52,s22
Zf vmcnt(40)
Zc v75,v55,v54,s22
Zf vmcnt(38)
Zc v76,v57,v56,s22
Zf vmcnt(36)
Zc v77,v59,v58,s22
Zf vmcnt(34)
Zc v78,v61,v60,s22
Zf vmcnt(32)
Zc v79,v63,v62,s22
Zb s19,s18,2048
Zr v[72:75],v0,s[4:7],s19 offen
Zr v[76:79],v0,s[4:7],s19 offen offset:1024
Zc v64,v49,v48,s23
Zc v65,v51,v50,s23
Zc v66,v53,v52,s23
Zc v67,v55,v54,s23
Zc v68,v57,v56,s23
Zc v69,v59,v58,s23
Zc v70,v61,v60,s23
Zc v71,v63,v62,s23
Zt v5,v[64:67] offset:24576
Zt v5,v[68:71] offset:25600
Zb s19,s17,3670016
Za v48,v2,s[28:31],s19 offen
Zb s19,s17,3678208
Za v49,v2,s[28:31],s19 offen
Zb s19,s17,3735552
Za v50,v2,s[28:31],s19 offen
Zb s19,s17,3743744
Za v51,v2,s[28:31],s19 offen
Zb s19,s17,3686400
Za v52,v2,s[28:31],s19 offen
Zb s19,s17,3694592
Za v53,v2,s[28:31],s19 offen
Zb s19,s17,3751936
Za v54,v2,s[28:31],s19 offen
Zb s19,s17,3760128
Za v55,v2,s[28:31],s19 offen
Zb s19,s17,3932160
Za v56,v2,s[28:31],s19 offen
Zb s19,s17,3940352
Za v57,v2,s[28:31],s19 offen
Zb s19,s17,3997696
Za v58,v2,s[28:31],s19 offen
Zb s19,s17,4005888
Za v59,v2,s[28:31],s19 offen
Zb s19,s17,3948544
Za v60,v2,s[28:31],s19 offen
Zb s19,s17,3956736
Za v61,v2,s[28:31],s19 offen
Zb s19,s17,4014080
Za v62,v2,s[28:31],s19 offen
Zb s19,s17,4022272
Za v63,v2,s[28:31],s19 offen
Zf vmcnt(48)
Zc v72,v17,v16,s22
Zf vmcnt(46)
Zc v73,v19,v18,s22
Zf vmcnt(44)
Zc v74,v21,v20,s22
Zf vmcnt(42)
Zc v75,v23,v22,s22
Zf vmcnt(40)
Zc v76,v25,v24,s22
Zf vmcnt(38)
Zc v77,v27,v26,s22
Zf vmcnt(36)
Zc v78,v29,v28,s22
Zf vmcnt(34)
Zc v79,v31,v30,s22
Zt v5,v[72:75] offset:0
Zt v5,v[76:79] offset:1024
Zc v104,v17,v16,s23
Zc v105,v19,v18,s23
Zc v106,v21,v20,s23
Zc v107,v23,v22,s23
Zc v108,v25,v24,s23
Zc v109,v27,v26,s23
Zc v110,v29,v28,s23
Zc v111,v31,v30,s23
Zb s19,s17,4194304
Za v16,v2,s[28:31],s19 offen
Zb s19,s17,4202496
Za v17,v2,s[28:31],s19 offen
Zb s19,s17,4259840
Za v18,v2,s[28:31],s19 offen
Zb s19,s17,4268032
Za v19,v2,s[28:31],s19 offen
Zb s19,s17,4210688
Za v20,v2,s[28:31],s19 offen
Zb s19,s17,4218880
Za v21,v2,s[28:31],s19 offen
Zb s19,s17,4276224
Za v22,v2,s[28:31],s19 offen
Zb s19,s17,4284416
Za v23,v2,s[28:31],s19 offen
Zb s19,s17,4456448
Za v24,v2,s[28:31],s19 offen
Zb s19,s17,4464640
Za v25,v2,s[28:31],s19 offen
Zb s19,s17,4521984
Za v26,v2,s[28:31],s19 offen
Zb s19,s17,4530176
Za v27,v2,s[28:31],s19 offen
Zb s19,s17,4472832
Za v28,v2,s[28:31],s19 offen
Zb s19,s17,4481024
Za v29,v2,s[28:31],s19 offen
Zb s19,s17,4538368
Za v30,v2,s[28:31],s19 offen
Zb s19,s17,4546560
Za v31,v2,s[28:31],s19 offen
Zf vmcnt(48)
Zc v136,v33,v32,s22
Zf vmcnt(46)
Zc v137,v35,v34,s22
Zf vmcnt(44)
Zc v138,v37,v36,s22
Zf vmcnt(42)
Zc v139,v39,v38,s22
Zf vmcnt(40)
Zc v140,v41,v40,s22
Zf vmcnt(38)
Zc v141,v43,v42,s22
Zf vmcnt(36)
Zc v142,v45,v44,s22
Zf vmcnt(34)
Zc v143,v47,v46,s22
Zc v144,v33,v32,s23
Zc v145,v35,v34,s23
Zc v146,v37,v36,s23
Zc v147,v39,v38,s23
Zc v148,v41,v40,s23
Zc v149,v43,v42,s23
Zc v150,v45,v44,s23
Zc v151,v47,v46,s23
Zb s19,s17,4718592
Za v32,v2,s[28:31],s19 offen
Zb s19,s17,4726784
Za v33,v2,s[28:31],s19 offen
Zb s19,s17,4784128
Za v34,v2,s[28:31],s19 offen
Zb s19,s17,4792320
Za v35,v2,s[28:31],s19 offen
Zb s19,s17,4734976
Za v36,v2,s[28:31],s19 offen
Zb s19,s17,4743168
Za v37,v2,s[28:31],s19 offen
Zb s19,s17,4800512
Za v38,v2,s[28:31],s19 offen
Zb s19,s17,4808704
Za v39,v2,s[28:31],s19 offen
Zb s19,s17,4980736
Za v40,v2,s[28:31],s19 offen
Zb s19,s17,4988928
Za v41,v2,s[28:31],s19 offen
Zb s19,s17,5046272
Za v42,v2,s[28:31],s19 offen
Zb s19,s17,5054464
Za v43,v2,s[28:31],s19 offen
Zb s19,s17,4997120
Za v44,v2,s[28:31],s19 offen
Zb s19,s17,5005312
Za v45,v2,s[28:31],s19 offen
Zb s19,s17,5062656
Za v46,v2,s[28:31],s19 offen
Zb s19,s17,5070848
Za v47,v2,s[28:31],s19 offen
Zf vmcnt(46)
Zc v176,v49,v48,s22
Zf vmcnt(44)
Zc v177,v51,v50,s22
Zf vmcnt(42)
Zc v178,v53,v52,s22
Zf vmcnt(40)
Zc v179,v55,v54,s22
Zf vmcnt(38)
Zc v180,v57,v56,s22
Zf vmcnt(36)
Zc v181,v59,v58,s22
Zf vmcnt(34)
Zc v182,v61,v60,s22
Zf vmcnt(32)
Zc v183,v63,v62,s22
Zc v64,v49,v48,s23
Zc v65,v51,v50,s23
Zc v66,v53,v52,s23
Zc v67,v55,v54,s23
Zc v68,v57,v56,s23
Zc v69,v59,v58,s23
Zc v70,v61,v60,s23
Zc v71,v63,v62,s23
Zb s19,s18,12288
Zr v[64:67],v0,s[4:7],s19 offen
Zr v[68:71],v0,s[4:7],s19 offen offset:1024
Zb s19,s17,0
Za v48,v2,s[32:35],s19 offen
Zb s19,s17,8192
Za v49,v2,s[32:35],s19 offen
Zb s19,s17,65536
Za v50,v2,s[32:35],s19 offen
Zb s19,s17,73728
Za v51,v2,s[32:35],s19 offen
Zb s19,s17,16384
Za v52,v2,s[32:35],s19 offen
Zb s19,s17,24576
Za v53,v2,s[32:35],s19 offen
Zb s19,s17,81920
Za v54,v2,s[32:35],s19 offen
Zb s19,s17,90112
Za v55,v2,s[32:35],s19 offen
Zb s19,s17,262144
Za v56,v2,s[32:35],s19 offen
Zb s19,s17,270336
Za v57,v2,s[32:35],s19 offen
Zb s19,s17,327680
Za v58,v2,s[32:35],s19 offen
Zb s19,s17,335872
Za v59,v2,s[32:35],s19 offen
Zb s19,s17,278528
Za v60,v2,s[32:35],s19 offen
Zb s19,s17,286720
Za v61,v2,s[32:35],s19 offen
Zb s19,s17,344064
Za v62,v2,s[32:35],s19 offen
Zb s19,s17,352256
Za v63,v2,s[32:35],s19 offen
Zf vmcnt(48)
Zc v208,v17,v16,s22
Zf vmcnt(46)
Zc v209,v19,v18,s22
Zf vmcnt(44)
Zc v210,v21,v20,s22
Zf vmcnt(42)
Zc v211,v23,v22,s22
Zf vmcnt(40)
Zc v212,v25,v24,s22
Zf vmcnt(38)
Zc v213,v27,v26,s22
Zf vmcnt(36)
Zc v214,v29,v28,s22
Zf vmcnt(34)
Zc v215,v31,v30,s22
Zc v64,v17,v16,s23
Zc v65,v19,v18,s23
Zc v66,v21,v20,s23
Zc v67,v23,v22,s23
Zc v68,v25,v24,s23
Zc v69,v27,v26,s23
Zc v70,v29,v28,s23
Zc v71,v31,v30,s23
Zt v5,v[64:67] offset:16384
Zt v5,v[68:71] offset:17408
Zb s19,s17,524288
Za v16,v2,s[32:35],s19 offen
Zb s19,s17,532480
Za v17,v2,s[32:35],s19 offen
Zb s19,s17,589824
Za v18,v2,s[32:35],s19 offen
Zb s19,s17,598016
Za v19,v2,s[32:35],s19 offen
Zb s19,s17,540672
Za v20,v2,s[32:35],s19 offen
Zb s19,s17,548864
Za v21,v2,s[32:35],s19 offen
Zb s19,s17,606208
Za v22,v2,s[32:35],s19 offen
Zb s19,s17,614400
Za v23,v2,s[32:35],s19 offen
Zb s19,s17,786432
Za v24,v2,s[32:35],s19 offen
Zb s19,s17,794624
Za v25,v2,s[32:35],s19 offen
Zb s19,s17,851968
Za v26,v2,s[32:35],s19 offen
Zb s19,s17,860160
Za v27,v2,s[32:35],s19 offen
Zb s19,s17,802816
Za v28,v2,s[32:35],s19 offen
Zb s19,s17,811008
Za v29,v2,s[32:35],s19 offen
Zb s19,s17,868352
Za v30,v2,s[32:35],s19 offen
Zb s19,s17,876544
Za v31,v2,s[32:35],s19 offen
Zf vmcnt(48)
Zc v72,v33,v32,s22
Zf vmcnt(46)
Zc v73,v35,v34,s22
Zf vmcnt(44)
Zc v74,v37,v36,s22
Zf vmcnt(42)
Zc v75,v39,v38,s22
Zf vmcnt(40)
Zc v76,v41,v40,s22
Zf vmcnt(38)
Zc v77,v43,v42,s22
Zf vmcnt(36)
Zc v78,v45,v44,s22
Zf vmcnt(34)
Zc v79,v47,v46,s22
Zb s19,s18,16384
Zr v[72:75],v0,s[4:7],s19 offen
Zr v[76:79],v0,s[4:7],s19 offen offset:1024
Zc v64,v33,v32,s23
Zc v65,v35,v34,s23
Zc v66,v37,v36,s23
Zc v67,v39,v38,s23
Zc v68,v41,v40,s23
Zc v69,v43,v42,s23
Zc v70,v45,v44,s23
Zc v71,v47,v46,s23
Zt v5,v[64:67] offset:8192
Zt v5,v[68:71] offset:9216
Zb s19,s17,1048576
Za v32,v2,s[32:35],s19 offen
Zb s19,s17,1056768
Za v33,v2,s[32:35],s19 offen
Zb s19,s17,1114112
Za v34,v2,s[32:35],s19 offen
Zb s19,s17,1122304
Za v35,v2,s[32:35],s19 offen
Zb s19,s17,1064960
Za v36,v2,s[32:35],s19 offen
Zb s19,s17,1073152
Za v37,v2,s[32:35],s19 offen
Zb s19,s17,1130496
Za v38,v2,s[32:35],s19 offen
Zb s19,s17,1138688
Za v39,v2,s[32:35],s19 offen
Zb s19,s17,1310720
Za v40,v2,s[32:35],s19 offen
Zb s19,s17,1318912
Za v41,v2,s[32:35],s19 offen
Zb s19,s17,1376256
Za v42,v2,s[32:35],s19 offen
Zb s19,s17,1384448
Za v43,v2,s[32:35],s19 offen
Zb s19,s17,1327104
Za v44,v2,s[32:35],s19 offen
Zb s19,s17,1335296
Za v45,v2,s[32:35],s19 offen
Zb s19,s17,1392640
Za v46,v2,s[32:35],s19 offen
Zb s19,s17,1400832
Za v47,v2,s[32:35],s19 offen
Zf vmcnt(48)
Zc v72,v49,v48,s22
Zf vmcnt(46)
Zc v73,v51,v50,s22
Zf vmcnt(44)
Zc v74,v53,v52,s22
Zf vmcnt(42)
Zc v75,v55,v54,s22
Zf vmcnt(40)
Zc v76,v57,v56,s22
Zf vmcnt(38)
Zc v77,v59,v58,s22
Zf vmcnt(36)
Zc v78,v61,v60,s22
Zf vmcnt(34)
Zc v79,v63,v62,s22
Zd a128,v72
Zd a129,v73
Zd a130,v74
Zd a131,v75
Zd a132,v76
Zd a133,v77
Zd a134,v78
Zd a135,v79
Zc v64,v49,v48,s23
Zc v65,v51,v50,s23
Zc v66,v53,v52,s23
Zc v67,v55,v54,s23
Zc v68,v57,v56,s23
Zc v69,v59,v58,s23
Zc v70,v61,v60,s23
Zc v71,v63,v62,s23
Zd a136,v64
Zd a137,v65
Zd a138,v66
Zd a139,v67
Zd a140,v68
Zd a141,v69
Zd a142,v70
Zd a143,v71
Zb s19,s17,1572864
Za v48,v2,s[32:35],s19 offen
Zb s19,s17,1581056
Za v49,v2,s[32:35],s19 offen
Zb s19,s17,1638400
Za v50,v2,s[32:35],s19 offen
Zb s19,s17,1646592
Za v51,v2,s[32:35],s19 offen
Zb s19,s17,1589248
Za v52,v2,s[32:35],s19 offen
Zb s19,s17,1597440
Za v53,v2,s[32:35],s19 offen
Zb s19,s17,1654784
Za v54,v2,s[32:35],s19 offen
Zb s19,s17,1662976
Za v55,v2,s[32:35],s19 offen
Zb s19,s17,1835008
Za v56,v2,s[32:35],s19 offen
Zb s19,s17,1843200
Za v57,v2,s[32:35],s19 offen
Zb s19,s17,1900544
Za v58,v2,s[32:35],s19 offen
Zb s19,s17,1908736
Za v59,v2,s[32:35],s19 offen
Zb s19,s17,1851392
Za v60,v2,s[32:35],s19 offen
Zb s19,s17,1859584
Za v61,v2,s[32:35],s19 offen
Zb s19,s17,1916928
Za v62,v2,s[32:35],s19 offen
Zb s19,s17,1925120
Za v63,v2,s[32:35],s19 offen
Zf vmcnt(48)
Zc v72,v17,v16,s22
Zf vmcnt(46)
Zc v73,v19,v18,s22
Zf vmcnt(44)
Zc v74,v21,v20,s22
Zf vmcnt(42)
Zc v75,v23,v22,s22
Zf vmcnt(40)
Zc v76,v25,v24,s22
Zf vmcnt(38)
Zc v77,v27,v26,s22
Zf vmcnt(36)
Zc v78,v29,v28,s22
Zf vmcnt(34)
Zc v79,v31,v30,s22
Zd a152,v72
Zd a153,v73
Zd a154,v74
Zd a155,v75
Zd a156,v76
Zd a157,v77
Zd a158,v78
Zd a159,v79
Zc v64,v17,v16,s23
Zc v65,v19,v18,s23
Zc v66,v21,v20,s23
Zc v67,v23,v22,s23
Zc v68,v25,v24,s23
Zc v69,v27,v26,s23
Zc v70,v29,v28,s23
Zc v71,v31,v30,s23
Zd a160,v64
Zd a161,v65
Zd a162,v66
Zd a163,v67
Zd a164,v68
Zd a165,v69
Zd a166,v70
Zd a167,v71
Zb s19,s17,2097152
Za v16,v2,s[32:35],s19 offen
Zb s19,s17,2105344
Za v17,v2,s[32:35],s19 offen
Zb s19,s17,2162688
Za v18,v2,s[32:35],s19 offen
Zb s19,s17,2170880
Za v19,v2,s[32:35],s19 offen
Zb s19,s17,2113536
Za v20,v2,s[32:35],s19 offen
Zb s19,s17,2121728
Za v21,v2,s[32:35],s19 offen
Zb s19,s17,2179072
Za v22,v2,s[32:35],s19 offen
Zb s19,s17,2187264
Za v23,v2,s[32:35],s19 offen
Zb s19,s17,2359296
Za v24,v2,s[32:35],s19 offen
Zb s19,s17,2367488
Za v25,v2,s[32:35],s19 offen
Zb s19,s17,2424832
Za v26,v2,s[32:35],s19 offen
Zb s19,s17,2433024
Za v27,v2,s[32:35],s19 offen
Zb s19,s17,2375680
Za v28,v2,s[32:35],s19 offen
Zb s19,s17,2383872
Za v29,v2,s[32:35],s19 offen
Zb s19,s17,2441216
Za v30,v2,s[32:35],s19 offen
Zb s19,s17,2449408
Za v31,v2,s[32:35],s19 offen
Zf vmcnt(46)
Zc v72,v33,v32,s22
Zf vmcnt(44)
Zc v73,v35,v34,s22
Zf vmcnt(42)
Zc v74,v37,v36,s22
Zf vmcnt(40)
Zc v75,v39,v38,s22
Zf vmcnt(38)
Zc v76,v41,v40,s22
Zf vmcnt(36)
Zc v77,v43,v42,s22
Zf vmcnt(34)
Zc v78,v45,v44,s22
Zf vmcnt(32)
Zc v79,v47,v46,s22
Zd a184,v72
Zd a185,v73
Zd a186,v74
Zd a187,v75
Zd a188,v76
Zd a189,v77
Zd a190,v78
Zd a191,v79
Zc v64,v33,v32,s23
Zc v65,v35,v34,s23
Zc v66,v37,v36,s23
Zc v67,v39,v38,s23
Zc v68,v41,v40,s23
Zc v69,v43,v42,s23
Zc v70,v45,v44,s23
Zc v71,v47,v46,s23
Zd a192,v64
Zd a193,v65
Zd a194,v66
Zd a195,v67
Zd a196,v68
Zd a197,v69
Zd a198,v70
Zd a199,v71
Zb s19,s17,2621440
Za v32,v2,s[32:35],s19 offen
Zb s19,s17,2629632
Za v33,v2,s[32:35],s19 offen
Zb s19,s17,2686976
Za v34,v2,s[32:35],s19 offen
Zb s19,s17,2695168
Za v35,v2,s[32:35],s19 offen
Zb s19,s17,2637824
Za v36,v2,s[32:35],s19 offen
Zb s19,s17,2646016
Za v37,v2,s[32:35],s19 offen
Zb s19,s17,2703360
Za v38,v2,s[32:35],s19 offen
Zb s19,s17,2711552
Za v39,v2,s[32:35],s19 offen
Zb s19,s17,2883584
Za v40,v2,s[32:35],s19 offen
Zb s19,s17,2891776
Za v41,v2,s[32:35],s19 offen
Zb s19,s17,2949120
Za v42,v2,s[32:35],s19 offen
Zb s19,s17,2957312
Za v43,v2,s[32:35],s19 offen
Zb s19,s17,2899968
Za v44,v2,s[32:35],s19 offen
Zb s19,s17,2908160
Za v45,v2,s[32:35],s19 offen
Zb s19,s17,2965504
Za v46,v2,s[32:35],s19 offen
Zb s19,s17,2973696
Za v47,v2,s[32:35],s19 offen
Zf vmcnt(46)
Zc v72,v49,v48,s22
Zf vmcnt(44)
Zc v73,v51,v50,s22
Zf vmcnt(42)
Zc v74,v53,v52,s22
Zf vmcnt(40)
Zc v75,v55,v54,s22
Zf vmcnt(38)
Zc v76,v57,v56,s22
Zf vmcnt(36)
Zc v77,v59,v58,s22
Zf vmcnt(34)
Zc v78,v61,v60,s22
Zf vmcnt(32)
Zc v79,v63,v62,s22
Zd a216,v72
Zd a217,v73
Zd a218,v74
Zd a219,v75
Zd a220,v76
Zd a221,v77
Zd a222,v78
Zd a223,v79
Zc v64,v49,v48,s23
Zc v65,v51,v50,s23
Zc v66,v53,v52,s23
Zc v67,v55,v54,s23
Zc v68,v57,v56,s23
Zc v69,v59,v58,s23
Zc v70,v61,v60,s23
Zc v71,v63,v62,s23
Zd a224,v64
Zd a225,v65
Zd a226,v66
Zd a227,v67
Zd a228,v68
Zd a229,v69
Zd a230,v70
Zd a231,v71
Zb s19,s17,3145728
Za v48,v2,s[32:35],s19 offen
Zb s19,s17,3153920
Za v49,v2,s[32:35],s19 offen
Zb s19,s17,3211264
Za v50,v2,s[32:35],s19 offen
Zb s19,s17,3219456
Za v51,v2,s[32:35],s19 offen
Zb s19,s17,3162112
Za v52,v2,s[32:35],s19 offen
Zb s19,s17,3170304
Za v53,v2,s[32:35],s19 offen
Zb s19,s17,3227648
Za v54,v2,s[32:35],s19 offen
Zb s19,s17,3235840
Za v55,v2,s[32:35],s19 offen
Zb s19,s17,3407872
Za v56,v2,s[32:35],s19 offen
Zb s19,s17,3416064
Za v57,v2,s[32:35],s19 offen
Zb s19,s17,3473408
Za v58,v2,s[32:35],s19 offen
Zb s19,s17,3481600
Za v59,v2,s[32:35],s19 offen
Zb s19,s17,3424256
Za v60,v2,s[32:35],s19 offen
Zb s19,s17,3432448
Za v61,v2,s[32:35],s19 offen
Zb s19,s17,3489792
Za v62,v2,s[32:35],s19 offen
Zb s19,s17,3497984
Za v63,v2,s[32:35],s19 offen
Zf vmcnt(46)
Zc v72,v17,v16,s22
Zf vmcnt(44)
Zc v73,v19,v18,s22
Zf vmcnt(42)
Zc v74,v21,v20,s22
Zf vmcnt(40)
Zc v75,v23,v22,s22
Zf vmcnt(38)
Zc v76,v25,v24,s22
Zf vmcnt(36)
Zc v77,v27,v26,s22
Zf vmcnt(34)
Zc v78,v29,v28,s22
Zf vmcnt(32)
Zc v79,v31,v30,s22
Zd a248,v72
Zd a249,v73
Zd a250,v74
Zd a251,v75
Zd a252,v76
Zd a253,v77
Zd a254,v78
Zd a255,v79
Zc v80,v17,v16,s23
Zc v81,v19,v18,s23
Zc v82,v21,v20,s23
Zc v83,v23,v22,s23
Zc v84,v25,v24,s23
Zc v85,v27,v26,s23
Zc v86,v29,v28,s23
Zc v87,v31,v30,s23
Zb s19,s17,3670016
Za v16,v2,s[32:35],s19 offen
Zb s19,s17,3678208
Za v17,v2,s[32:35],s19 offen
Zb s19,s17,3735552
Za v18,v2,s[32:35],s19 offen
Zb s19,s17,3743744
Za v19,v2,s[32:35],s19 offen
Zb s19,s17,3686400
Za v20,v2,s[32:35],s19 offen
Zb s19,s17,3694592
Za v21,v2,s[32:35],s19 offen
Zb s19,s17,3751936
Za v22,v2,s[32:35],s19 offen
Zb s19,s17,3760128
Za v23,v2,s[32:35],s19 offen
Zb s19,s17,3932160
Za v24,v2,s[32:35],s19 offen
Zb s19,s17,3940352
Za v25,v2,s[32:35],s19 offen
Zb s19,s17,3997696
Za v26,v2,s[32:35],s19 offen
Zb s19,s17,4005888
Za v27,v2,s[32:35],s19 offen
Zb s19,s17,3948544
Za v28,v2,s[32:35],s19 offen
Zb s19,s17,3956736
Za v29,v2,s[32:35],s19 offen
Zb s19,s17,4014080
Za v30,v2,s[32:35],s19 offen
Zb s19,s17,4022272
Za v31,v2,s[32:35],s19 offen
Zf vmcnt(46)
Zc v112,v33,v32,s22
Zf vmcnt(44)
Zc v113,v35,v34,s22
Zf vmcnt(42)
Zc v114,v37,v36,s22
Zf vmcnt(40)
Zc v115,v39,v38,s22
Zf vmcnt(38)
Zc v116,v41,v40,s22
Zf vmcnt(36)
Zc v117,v43,v42,s22
Zf vmcnt(34)
Zc v118,v45,v44,s22
Zf vmcnt(32)
Zc v119,v47,v46,s22
Zc v64,v33,v32,s23
Zc v65,v35,v34,s23
Zc v66,v37,v36,s23
Zc v67,v39,v38,s23
Zc v68,v41,v40,s23
Zc v69,v43,v42,s23
Zc v70,v45,v44,s23
Zc v71,v47,v46,s23
Zb s19,s18,8192
Zr v[64:67],v0,s[4:7],s19 offen
Zr v[68:71],v0,s[4:7],s19 offen offset:1024
Zb s19,s17,4194304
Za v32,v2,s[32:35],s19 offen
Zb s19,s17,4202496
Za v33,v2,s[32:35],s19 offen
Zb s19,s17,4259840
Za v34,v2,s[32:35],s19 offen
Zb s19,s17,4268032
Za v35,v2,s[32:35],s19 offen
Zb s19,s17,4210688
Za v36,v2,s[32:35],s19 offen
Zb s19,s17,4218880
Za v37,v2,s[32:35],s19 offen
Zb s19,s17,4276224
Za v38,v2,s[32:35],s19 offen
Zb s19,s17,4284416
Za v39,v2,s[32:35],s19 offen
Zb s19,s17,4456448
Za v40,v2,s[32:35],s19 offen
Zb s19,s17,4464640
Za v41,v2,s[32:35],s19 offen
Zb s19,s17,4521984
Za v42,v2,s[32:35],s19 offen
Zb s19,s17,4530176
Za v43,v2,s[32:35],s19 offen
Zb s19,s17,4472832
Za v44,v2,s[32:35],s19 offen
Zb s19,s17,4481024
Za v45,v2,s[32:35],s19 offen
Zb s19,s17,4538368
Za v46,v2,s[32:35],s19 offen
Zb s19,s17,4546560
Za v47,v2,s[32:35],s19 offen
Zf vmcnt(48)
Zc v152,v49,v48,s22
Zf vmcnt(46)
Zc v153,v51,v50,s22
Zf vmcnt(44)
Zc v154,v53,v52,s22
Zf vmcnt(42)
Zc v155,v55,v54,s22
Zf vmcnt(40)
Zc v156,v57,v56,s22
Zf vmcnt(38)
Zc v157,v59,v58,s22
Zf vmcnt(36)
Zc v158,v61,v60,s22
Zf vmcnt(34)
Zc v159,v63,v62,s22
Zc v64,v49,v48,s23
Zc v65,v51,v50,s23
Zc v66,v53,v52,s23
Zc v67,v55,v54,s23
Zc v68,v57,v56,s23
Zc v69,v59,v58,s23
Zc v70,v61,v60,s23
Zc v71,v63,v62,s23
Zt v5,v[64:67] offset:4096
Zt v5,v[68:71] offset:5120
Zb s19,s17,4718592
Za v48,v2,s[32:35],s19 offen
Zb s19,s17,4726784
Za v49,v2,s[32:35],s19 offen
Zb s19,s17,4784128
Za v50,v2,s[32:35],s19 offen
Zb s19,s17,4792320
Za v51,v2,s[32:35],s19 offen
Zb s19,s17,4734976
Za v52,v2,s[32:35],s19 offen
Zb s19,s17,4743168
Za v53,v2,s[32:35],s19 offen
Zb s19,s17,4800512
Za v54,v2,s[32:35],s19 offen
Zb s19,s17,4808704
Za v55,v2,s[32:35],s19 offen
Zb s19,s17,4980736
Za v56,v2,s[32:35],s19 offen
Zb s19,s17,4988928
Za v57,v2,s[32:35],s19 offen
Zb s19,s17,5046272
Za v58,v2,s[32:35],s19 offen
Zb s19,s17,5054464
Za v59,v2,s[32:35],s19 offen
Zb s19,s17,4997120
Za v60,v2,s[32:35],s19 offen
Zb s19,s17,5005312
Za v61,v2,s[32:35],s19 offen
Zb s19,s17,5062656
Za v62,v2,s[32:35],s19 offen
Zb s19,s17,5070848
Za v63,v2,s[32:35],s19 offen
Zf vmcnt(48)
Zc v248,v17,v16,s22
Zf vmcnt(46)
Zc v249,v19,v18,s22
Zf vmcnt(44)
Zc v250,v21,v20,s22
Zf vmcnt(42)
Zc v251,v23,v22,s22
Zf vmcnt(40)
Zc v252,v25,v24,s22
Zf vmcnt(38)
Zc v253,v27,v26,s22
Zf vmcnt(36)
Zc v254,v29,v28,s22
Zf vmcnt(34)
Zc v255,v31,v30,s22
Zc v64,v17,v16,s23
Zc v65,v19,v18,s23
Zc v66,v21,v20,s23
Zc v67,v23,v22,s23
Zc v68,v25,v24,s23
Zc v69,v27,v26,s23
Zc v70,v29,v28,s23
Zc v71,v31,v30,s23
Zb s19,s18,4096
Zr v[64:67],v0,s[4:7],s19 offen
Zr v[68:71],v0,s[4:7],s19 offen offset:1024
Zf vmcnt(32)
Zc v232,v33,v32,s22
Zf vmcnt(30)
Zc v233,v35,v34,s22
Zf vmcnt(28)
Zc v234,v37,v36,s22
Zf vmcnt(26)
Zc v235,v39,v38,s22
Zf vmcnt(24)
Zc v236,v41,v40,s22
Zf vmcnt(22)
Zc v237,v43,v42,s22
Zf vmcnt(20)
Zc v238,v45,v44,s22
Zf vmcnt(18)
Zc v239,v47,v46,s22
Zc v240,v33,v32,s23
Zc v241,v35,v34,s23
Zc v242,v37,v36,s23
Zc v243,v39,v38,s23
Zc v244,v41,v40,s23
Zc v245,v43,v42,s23
Zc v246,v45,v44,s23
Zc v247,v47,v46,s23
Zf vmcnt(16)
Zc v216,v49,v48,s22
Zf vmcnt(14)
Zc v217,v51,v50,s22
Zf vmcnt(12)
Zc v218,v53,v52,s22
Zf vmcnt(10)
Zc v219,v55,v54,s22
Zf vmcnt(8)
Zc v220,v57,v56,s22
Zf vmcnt(6)
Zc v221,v59,v58,s22
Zf vmcnt(4)
Zc v222,v61,v60,s22
Zf vmcnt(2)
Zc v223,v63,v62,s22
Zc v224,v49,v48,s23
Zc v225,v51,v50,s23
Zc v226,v53,v52,s23
Zc v227,v55,v54,s23
Zc v228,v57,v56,s23
Zc v229,v59,v58,s23
Zc v230,v61,v60,s23
Zc v231,v63,v62,s23
v_lshrrev_b32 v14, 1, v12
Zy v14,1,v14
Zs v1,0x4444
Zs v15,0xeeee
v_cmp_eq_u32 vcc, 1, v14
s_nop 1
v_cndmask_b32 v1, v1, v15, vcc
v_lshrrev_b32 v15, 2, v12
Zz v15,1,v15
Zy v16,1,v12
v_add_u32 v15, v15, v16
v_mul_u32_u24 v7, 1280, v15
v_lshl_add_u32 v7, v13, 5, v7
v_lshl_add_u32 v7, v14, 4, v7
v_mul_u32_u24 v10, 288, v15
v_lshl_add_u32 v10, v13, 4, v10
v_add_u32 v10, 20736, v10
Zy v16,7,v12
v_mul_u32_u24 v9, 288, v16
v_lshl_add_u32 v9, v13, 4, v9
v_add_u32 v9, 18432, v9
v_mul_u32_u24 v8, 576, v13
v_lshl_add_u32 v8, v12, 2, v8
v_add_u32 v8, 18432, v8
v_lshrrev_b32 v17, 1, v16
Zz v17,2,v17
Zy v18,1,v16
v_add_u32 v17, v17, v18
Zy v18,1,v13
v_lshl_add_u32 v17, v18, 1, v17
v_lshrrev_b32 v18, 1, v13
v_lshl_add_u32 v17, v18, 4, v17
Zz v11,4,v17
v_add_u32 v11, 0, v11
s_mul_i32 s19, s8, 10368
v_mul_u32_u24 v2, 2560, v13
v_add_u32 v2, s19, v2
v_lshl_add_u32 v3, v12, 2, v2
v_add_u32 v3, 1024, v3
v_lshl_add_u32 v2, v12, 4, v2
v_add_u32 v2, 0, v2
v_lshrrev_b32 v16, 3, v12
v_lshl_add_u32 v16, v13, 1, v16
Zy v17,7,v12
Zq s19,s8,7
Zb s19,s19,0
v_mul_u32_u24 v4, 10368, v16
v_lshl_add_u32 v4, v17, 4, v4
v_add_u32 v4, s19, v4
Zy v16,1,v12
Zs v17,0x3f80
Zs v18,0x3f800000
v_cmp_eq_u32 vcc, 1, v16
s_nop 1
v_cndmask_b32 v17, v17, v18, vcc
v_lshrrev_b32 v16, 1, v12
v_cmp_eq_u32 vcc, 0, v16
s_nop 1
v_cndmask_b32 v20, 0, v17, vcc
v_cmp_eq_u32 vcc, 1, v16
s_nop 1
v_cndmask_b32 v21, 0, v17, vcc
v_cmp_eq_u32 vcc, 2, v16
s_nop 1
v_cndmask_b32 v22, 0, v17, vcc
v_cmp_eq_u32 vcc, 3, v16
s_nop 1
v_cndmask_b32 v23, 0, v17, vcc
Zt v0,v[20:23] offset:23040
Zp s21,1040356334
Zp s20,400000
Zp s12,1048576
Zp s15,2097152
Zf vmcnt(0) lgkmcnt(0)
v_lshrrev_b32 v12, 2, v0
Zy v12,60,v12
L_md0:
global_load_dword v13, v12, s[36:37] sc1
Zf vmcnt(0)
v_readlane_b32 s40, v13, 0
v_readlane_b32 s41, v13, 1
v_readlane_b32 s42, v13, 2
v_readlane_b32 s43, v13, 3
v_readlane_b32 s44, v13, 4
v_readlane_b32 s45, v13, 5
v_readlane_b32 s46, v13, 6
v_readlane_b32 s47, v13, 7
v_readlane_b32 s48, v13, 8
s_cmp_ge_u32 s40, 32
Zk L_fa0
Zb s40,s40,s41
Zb s40,s40,s42
Zb s40,s40,s43
Zb s40,s40,s44
Zb s40,s40,s45
Zb s40,s40,s46
Zb s40,s40,s47
Zb s40,s40,s48
s_cmp_ge_u32 s40, 256
Zk L_sl0
s_sleep 2
s_sub_u32 s20, s20, 1
s_cmp_gt_i32 s20, 0
Zk L_md0
L_sl0:
Zq s24,s8,7
Zb s26,s24,4096
Zb s24,s24,0
Zp s11,0
s_mul_i32 s17, s8, 20480
Zb s17,s17,16777216
Zb s27,s17,16384
s_load_dwordx2 s[28:29], s[0:1], 48
Zp s30,10240
Zp s31,0x20000
Zp s39,0
Zb s90,s18,0
Zb s91,s18,4096
Zb s92,s18,8192
Zb s93,s18,12288
Zb s94,s18,16384
Zb s36,s8,0
s_mul_i32 s22, s36, 205
s_lshr_b32 s22, s22, 11
s_mul_i32 s23, s22, 10
s_sub_u32 s36, s36, s23
Zq s38,s36,10
s_lshr_b32 s23, s22, 1
Zq s23,s23,6
Zb s38,s38,s23
s_and_b32 s23, s22, 1
Zq s23,s23,4
Zb s38,s38,s23
s_cmp_ge_u32 s36, 8
s_cselect_b32 s36, 1, 0
Zb s13,s12,82944
Zb s14,s12,165888
Zb s59,s12,248832
Zp s32,394264576
Zp s33,1342177280
Zf lgkmcnt(0)
CL_w0x:
Zp s10,0
s_barrier
Zp s37,8192
Zs v6,v0
Zb m0,s37,2048
Zb s19,s17,0
Zh v0,s[4:7],s19 offen sc1 nt lds
Zb m0,s37,3072
Zb s19,s17,1024
Zh v0,s[4:7],s19 offen sc1 nt lds
Zh v[12:15],v7,s[28:31],0 offen offset:0
Zh v[40:43],v7,s[28:31],0 offen offset:128
Zh v[44:47],v7,s[28:31],0 offen offset:256
Zb s19,s18,0
Zh v[48:51],v0,s[4:7],s19 offen offset:0
Zh v[52:55],v0,s[4:7],s19 offen offset:1024
Zb s19,s18,6144
Zh v[56:59],v0,s[4:7],s19 offen offset:0
Zh v[60:63],v0,s[4:7],s19 offen offset:1024
Zb s19,s18,10240
Zh v[64:67],v0,s[4:7],s19 offen offset:0
Zh v[68:71],v0,s[4:7],s19 offen offset:1024
Zb s19,s18,14336
Zh v[72:75],v0,s[4:7],s19 offen offset:0
Zh v[76:79],v0,s[4:7],s19 offen offset:1024
Zm v[16:17],0
Zm v[18:19],0
Zm v[20:21],0
Zm v[22:23],0
Zm v[24:25],0
Zm v[26:27],0
Zm v[28:29],0
Zm v[30:31],0
Zm v[32:33],0
Zm v[34:35],0
Zm v[36:37],0
Zm v[38:39],0
Zf vmcnt(0) lgkmcnt(0)
CS_w0x:
Zt v0,v[12:15] offset:0
Zt v0,v[40:43] offset:1024
Zt v6,v[44:47] offset:2048
Zg v[16:19],v[12:15],v[48:55],v1
Zb s19,s18,2048
Zh v[48:51],v0,s[4:7],s19 offen offset:0
Zh v[52:55],v0,s[4:7],s19 offen offset:1024
Zg v[20:23],v[12:15],v[56:63],v1
Zi v[56:59],v5 offset:2048
Zi v[60:63],v5 offset:3072
Zg v[24:27],v[12:15],v[64:71],v1
Zi v[64:67],v5 offset:10240
Zi v[68:71],v5 offset:11264
Zf vmcnt(2)
Zg v[28:31],v[12:15],v[72:79],v1
Zi v[72:75],v5 offset:18432
Zi v[76:79],v5 offset:19456
Zg v[32:35],v[12:15],a[128:135],v1
Zg v[36:39],v[12:15],a[136:143],v1
Zf lgkmcnt(6)
s_barrier
Zi v[12:15],v6 offset:3072
Zg v[16:19],v[40:43],a[144:151],v1
Zf lgkmcnt(5)
Zg v[20:23],v[40:43],v[56:63],v1
Zb s19,s18,8192
Zh v[56:59],v0,s[4:7],s19 offen offset:0
Zh v[60:63],v0,s[4:7],s19 offen offset:1024
Zf lgkmcnt(3)
Zg v[24:27],v[40:43],v[64:71],v1
Zi v[64:67],v5 offset:12288
Zi v[68:71],v5 offset:13312
Zf lgkmcnt(3)
Zg v[28:31],v[40:43],v[72:79],v1
Zi v[72:75],v5 offset:20480
Zi v[76:79],v5 offset:21504
Zg v[32:35],v[40:43],a[152:159],v1
Zg v[36:39],v[40:43],a[160:167],v1
Zg v[16:19],v[44:47],a[168:175],v1
Zi v[40:43],v6 offset:4096
Zf lgkmcnt(3)
Zg v[20:23],v[44:47],v[64:71],v1
Zi v[64:67],v5 offset:14336
Zi v[68:71],v5 offset:15360
Zg v[24:27],v[44:47],a[176:183],v1
Zf lgkmcnt(3)
Zg v[28:31],v[44:47],v[72:79],v1
Zi v[72:75],v5 offset:22528
Zi v[76:79],v5 offset:23552
Zg v[32:35],v[44:47],a[184:191],v1
Zg v[36:39],v[44:47],a[192:199],v1
Zg v[16:19],v[12:15],a[200:207],v1
Zi v[44:47],v6 offset:5120
Zf lgkmcnt(3)
Zg v[20:23],v[12:15],v[64:71],v1
Zb s19,s18,12288
Zh v[64:67],v0,s[4:7],s19 offen offset:0
Zh v[68:71],v0,s[4:7],s19 offen offset:1024
Zg v[24:27],v[12:15],a[208:215],v1
Zf lgkmcnt(1)
Zg v[28:31],v[12:15],v[72:79],v1
Zi v[72:75],v5 offset:24576
Zi v[76:79],v5 offset:25600
Zg v[32:35],v[12:15],a[216:223],v1
Zg v[36:39],v[12:15],a[224:231],v1
Zg v[16:19],v[40:43],a[232:239],v1
Zi v[12:15],v6 offset:6144
Zg v[20:23],v[40:43],a[240:247],v1
Zf vmcnt(4)
Zg v[24:27],v[40:43],v[48:55],v1
Zi v[48:51],v5 offset:0
Zi v[52:55],v5 offset:1024
Zf lgkmcnt(3)
Zg v[28:31],v[40:43],v[72:79],v1
Zb s19,s18,16384
Zh v[72:75],v0,s[4:7],s19 offen offset:0
Zh v[76:79],v0,s[4:7],s19 offen offset:1024
Zg v[32:35],v[40:43],a[248:255],v1
Zg v[36:39],v[40:43],v[80:87],v1
Zg v[16:19],v[44:47],v[88:95],v1
Zi v[40:43],v6 offset:7168
Zg v[20:23],v[44:47],v[96:103],v1
Zf lgkmcnt(1)
Zg v[24:27],v[44:47],v[48:55],v1
Zb s19,s18,4096
Zh v[48:51],v0,s[4:7],s19 offen offset:0
Zh v[52:55],v0,s[4:7],s19 offen offset:1024
Zg v[28:31],v[44:47],v[104:111],v1
Zg v[32:35],v[44:47],v[112:119],v1
Zf vmcnt(6)
Zg v[36:39],v[44:47],v[56:63],v1
Zb s34,s17,655360
Zi v[56:59],v5 offset:4096
Zi v[60:63],v5 offset:5120
Zg v[16:19],v[12:15],v[120:127],v1
Zi v[44:47],v6 offset:8192
Zo s10,63
s_cselect_b32 s34, s17, s34
Zg v[20:23],v[12:15],v[128:135],v1
s_xor_b32 s37, s37, 8192
Zg v[24:27],v[12:15],v[136:143],v1
Zg v[28:31],v[12:15],v[144:151],v1
Zg v[32:35],v[12:15],v[152:159],v1
Zf lgkmcnt(1)
Zg v[36:39],v[12:15],v[56:63],v1
Zi v[56:59],v5 offset:6144
Zi v[60:63],v5 offset:7168
Zg v[16:19],v[40:43],v[160:167],v1
Zi v[12:15],v6 offset:9216
Zg v[20:23],v[40:43],v[168:175],v1
Zg v[24:27],v[40:43],v[176:183],v1
Zf vmcnt(4)
Zg v[28:31],v[40:43],v[64:71],v1
Zi v[64:67],v5 offset:16384
Zi v[68:71],v5 offset:17408
Zf lgkmcnt(5)
Zg v[16:19],v[44:47],v[184:191],v1
Zf lgkmcnt(3)
Zg v[20:23],v[44:47],v[56:63],v1
Zi v[56:59],v5 offset:8192
Zi v[60:63],v5 offset:9216
Zf lgkmcnt(4)
Zg v[16:19],v[12:15],v[192:199],v1
Zg v[20:23],v[12:15],v[200:207],v1
Zg v[24:27],v[44:47],v[208:215],v1
v_xor_b32 v6, 8192, v6
Zf lgkmcnt(2)
Zg v[28:31],v[44:47],v[64:71],v1
Zl v16,v16,v18
Zb s19,s17,8192
Zh v[64:67],v0,s[4:7],s19 offen sc1 nt
Zh v[68:71],v0,s[4:7],s19 offen offset:1024 sc1 nt
Zf vmcnt(4)
Zg v[24:27],v[12:15],v[72:79],v1
Zl v17,v17,v19
Zf lgkmcnt(0)
Zg v[28:31],v[12:15],v[56:63],v1
Zl v20,v20,v22
Zg v[32:35],v[12:15],v[216:223],v1
Zl v21,v21,v23
Zw v16,s21,v16
Zi v[72:75],v6 offset:2048
Zi v[76:79],v6 offset:6144
Zg v[36:39],v[12:15],v[224:231],v1
Zw v17,s21,v17
Zw v20,s21,v20
Zw v21,s21,v21
Zj v18,v16,v20
Zj v19,v17,v21
ds_write2_b32 v8, v18, v19 offset0:0 offset1:72
Zi v[56:59],v6 offset:3072
Zi v[60:63],v6 offset:7168
Zl v24,v24,v26
Zl v25,v25,v27
Zl v28,v28,v30
Zl v29,v29,v31
Zj v12,v24,v28
Zj v13,v25,v29
ds_write_b32 v8, v12 offset:2304
ds_write_b32 v8, v13 offset:2592
Zg v[32:35],v[44:47],v[232:239],v1
Zg v[36:39],v[44:47],v[240:247],v1
Zf lgkmcnt(0)
s_barrier
Zi v[16:19],v9 offset:0
Zi v[20:23],v10 offset:0
Zi v[24:27],v9 offset:64
Zi v[28:31],v10 offset:64
Zg v[32:35],v[40:43],v[248:255],v1
Zf vmcnt(2)
Zg v[36:39],v[40:43],v[48:55],v1
Zi v[48:51],v6 offset:4096
Zi v[52:55],v6 offset:8192
s_nop 1
Zl v32,v32,v34
Zl v33,v33,v35
s_nop 1
Zl v36,v36,v38
Zl v37,v37,v39
Zj v14,v32,v33
Zj v15,v36,v37
Zr v[12:15],v0,s[4:7],s27 offen sc1 nt
Zf lgkmcnt(5)
Ze v[44:47],v[76:79],v[16:19],0
Zf lgkmcnt(4)
Ze v[32:35],v[20:23],v[16:19],0
Ze v[40:43],v[72:75],v[16:19],0
Zi v[16:19],v9 offset:128
Zi v[20:23],v10 offset:128
Zi v[72:75],v6 offset:5120
Zi v[76:79],v6 offset:9216
Zb m0,s37,2048
Zb s19,s34,0
Zh v0,s[4:7],s19 offen sc1 nt lds
Zf lgkmcnt(7)
Ze v[44:47],v[60:63],v[24:27],v[44:47]
Zs v36,0x3f803f80
Zs v37,0x3f803f80
Zf lgkmcnt(6)
Ze v[32:35],v[28:31],v[24:27],v[32:35]
Zs v38,0x3f803f80
Zs v39,0x3f803f80
Ze v[40:43],v[56:59],v[24:27],v[40:43]
Zi v[24:27],v9 offset:192
Zi v[28:31],v10 offset:192
Zi v[56:59],v5 offset:30720
Zi v[60:63],v5 offset:31744
Zb m0,s37,3072
Zb s19,s34,1024
Zh v0,s[4:7],s19 offen sc1 nt lds
Zf lgkmcnt(7)
Ze v[44:47],v[52:55],v[16:19],v[44:47]
Zf lgkmcnt(6)
Ze v[32:35],v[20:23],v[16:19],v[32:35]
Ze v[40:43],v[48:51],v[16:19],v[40:43]
Zi v[48:51],v5 offset:26624
Zi v[52:55],v5 offset:27648
Zf lgkmcnt(5)
Ze v[44:47],v[76:79],v[24:27],v[44:47]
Zs v21,0
Zs v22,0
Zf lgkmcnt(4)
Ze v[32:35],v[28:31],v[24:27],v[32:35]
Ze v[40:43],v[72:75],v[24:27],v[40:43]
Zp s23,0
SX_w0x:
Zn v76,v44
Zn v77,v45
Zn v78,v46
Zn v79,v47
Zn v24,v32
Zn v25,v33
s_nop 0
Zn v72,v40
Zn v73,v41
Zn v74,v42
Zn v75,v43
Zj v18,v76,v77
Zj v19,v78,v79
Zj v16,v72,v73
Zj v17,v74,v75
Zj v20,v24,v25
Zj v23,v24,v25
Ze v[72:75],v[36:39],v[16:19],0
Zf vmcnt(4)
Ze v[24:27],v[64:67],v[16:19],0
Zf vmcnt(3)
Ze v[28:31],v[68:71],v[16:19],0
v_mfma_f32_16x16x16_bf16 v[72:75], v[36:37], v[20:21], v[72:75]
v_mfma_f32_16x16x16_bf16 v[24:27], v[14:15], v[20:21], v[24:27]
Zm v[76:77],0
Zm v[78:79],0
v_mfma_f32_16x16x16_bf16 v[28:31], v[14:15], v[22:23], v[28:31]
s_nop 2
v_subrev_u32 v73, s32, v72
v_rcp_f32 v74, v72
v_cmp_le_u32 vcc, s33, v73
Zs v75,v74
s_cbranch_vccnz FB_w0x
SO_w0x:
v_pk_mul_f32 v[24:25], v[24:25], v[74:75]
v_pk_mul_f32 v[26:27], v[26:27], v[74:75]
v_pk_mul_f32 v[28:29], v[28:29], v[74:75]
v_pk_mul_f32 v[30:31], v[30:31], v[74:75]
Zj v24,v24,v28
Zj v25,v25,v29
Zj v26,v26,v30
Zj v27,v27,v31
Zt v11,v[24:27]
Zm v[72:73],0
Zm v[74:75],0
Zm v[16:17],0
Zm v[18:19],0
Zm v[20:21],0
Zm v[22:23],0
Zm v[64:65],0
Zm v[66:67],0
Zm v[68:69],0
Zm v[70:71],0
Zf lgkmcnt(0)
s_barrier
Zi v[40:43],v0 offset:0
Zi v[44:47],v0 offset:1024
Zo s10,63
Zk CE_w0x
Zm v[24:25],0
Zm v[26:27],0
Zm v[28:29],0
Zm v[30:31],0
Zb s17,s17,655360
Zf lgkmcnt(1)
Zg v[72:75],v[40:43],v[48:55],v1
Zm v[32:33],0
Zi v[48:51],v5 offset:28672
Zi v[52:55],v5 offset:29696
Zf lgkmcnt(2)
Zg v[72:75],v[44:47],v[56:63],v1
Zm v[34:35],0
Zi v[56:59],v5 offset:32768
Zi v[60:63],v5 offset:33792
Zg v[76:79],v[40:43],a[0:7],v1
Zm v[36:37],0
Zg v[76:79],v[44:47],a[8:15],v1
Zm v[38:39],0
Zg v[16:19],v[40:43],a[16:23],v1
Zl v72,v72,v74
Zg v[16:19],v[44:47],a[24:31],v1
Zl v73,v73,v75
Zg v[20:23],v[40:43],a[32:39],v1
Zl v76,v76,v78
Zf lgkmcnt(2)
Zg v[20:23],v[44:47],v[48:55],v1
Zl v77,v77,v79
Zf lgkmcnt(0)
Zg v[64:67],v[40:43],v[56:63],v1
Zl v16,v16,v18
Zg v[64:67],v[44:47],a[40:47],v1
Zl v17,v17,v19
Zg v[68:71],v[40:43],a[48:55],v1
Zl v20,v20,v22
Zj v12,v72,v76
Zg v[68:71],v[44:47],a[56:63],v1
Zl v21,v21,v23
Zj v48,v73,v77
Zg v[24:27],v[40:43],a[64:71],v1
Zl v64,v64,v66
Zj v13,v16,v20
Zg v[24:27],v[44:47],a[72:79],v1
Zl v65,v65,v67
Zj v49,v17,v21
Zg v[28:31],v[40:43],a[80:87],v1
Zl v68,v68,v70
v_bfi_b32 v12, 1, s39, v12
Zg v[28:31],v[44:47],a[88:95],v1
Zl v69,v69,v71
v_bfi_b32 v48, 1, s39, v48
Zg v[32:35],v[40:43],a[96:103],v1
Zl v24,v24,v26
Zj v14,v64,v68
Zg v[32:35],v[44:47],a[104:111],v1
Zl v25,v25,v27
Zj v50,v65,v69
Zg v[36:39],v[40:43],a[112:119],v1
Zl v28,v28,v30
Zj v15,v24,v28
Zr v[12:15],v2,s[4:7],s12 offen sc1
Zg v[36:39],v[44:47],a[120:127],v1
Zl v29,v29,v31
Zj v51,v25,v29
Zr v[48:51],v2,s[4:7],s12 offen offset:1280 sc1
Zl v32,v32,v34
Zl v33,v33,v35
s_nop 2
Zl v36,v36,v38
Zj v56,v32,v36
v_bfi_b32 v56, 1, s39, v56
Zu v56,v3,s[4:7],s12 offen offset:0 sc1
Zl v37,v37,v39
Zj v57,v33,v37
v_bfi_b32 v57, 1, s39, v57
Zu v57,v3,s[4:7],s12 offen offset:1280 sc1
s_xor_b32 s16, s15, 0x4000
Zb s10,s10,1
Zb s11,s11,1
Zb s27,s27,655360
Zi v[12:15],v0 offset:23040
Zm v[38:39],-1
Zy v40,0x60,v0
v_lshl_add_u32 v40, v40, 3, s38
Zy v41,0x10,v0
v_lshl_add_u32 v40, v41, 1, v40
v_lshrrev_b32 v41, 5, v0
Zy v41,8,v41
v_add_u32 v40, v40, v41
Zy v41,0x280,v0
Zs v42,2130706432
v_cmp_ne_u32 vcc, 0, v41
s_nop 1
v_cndmask_b32 v40, v40, v42, vcc
Zf vmcnt(0)
Zf lgkmcnt(0)
Zh v[16:19],v4,s[4:7],s12 offen sc1
Zh v[20:23],v4,s[4:7],s13 offen sc1
Zh v[24:27],v4,s[4:7],s14 offen sc1
Zh v[28:31],v4,s[4:7],s59 offen sc1
Zb s19,s18,0
Zh v[48:51],v0,s[4:7],s19 offen offset:0
Zh v[52:55],v0,s[4:7],s19 offen offset:1024
Zb s19,s18,6144
Zh v[56:59],v0,s[4:7],s19 offen offset:0
Zh v[60:63],v0,s[4:7],s19 offen offset:1024
Zf vmcnt(7)
Ze v[32:35],v[12:15],v[16:19],0
v_xor_b32 v36, s39, v16
v_xor_b32 v37, v17, v16
Zv v37,v37,v18,v16 bitop3:0xf6
Zv v37,v37,v19,v16 bitop3:0xf6
Zf vmcnt(6)
Ze v[32:35],v[12:15],v[20:23],v[32:35]
Zv v36,v36,v20,s39 bitop3:0xf6
Zv v37,v37,v21,v20 bitop3:0xf6
Zv v37,v37,v22,v20 bitop3:0xf6
Zv v37,v37,v23,v20 bitop3:0xf6
Zf vmcnt(5)
Ze v[32:35],v[12:15],v[24:27],v[32:35]
Zv v36,v36,v24,s39 bitop3:0xf6
Zv v37,v37,v25,v24 bitop3:0xf6
Zv v37,v37,v26,v24 bitop3:0xf6
Zv v37,v37,v27,v24 bitop3:0xf6
Zf vmcnt(4)
Ze v[32:35],v[12:15],v[28:31],v[32:35]
Zv v36,v36,v28,s39 bitop3:0xf6
Zv v37,v37,v29,v28 bitop3:0xf6
Zv v37,v37,v30,v28 bitop3:0xf6
Zv v37,v37,v31,v28 bitop3:0xf6
v_and_or_b32 v36, v37, s36, v36
Zy v36,1,v36
v_cmp_ne_u32 vcc, 0, v36
s_cbranch_vccz P1D_w0x
P1_w0x:
Zh v[16:19],v4,s[4:7],s12 offen sc1
Zh v[20:23],v4,s[4:7],s13 offen sc1
Zh v[24:27],v4,s[4:7],s14 offen sc1
Zh v[28:31],v4,s[4:7],s59 offen sc1
Zf vmcnt(3)
Ze v[32:35],v[12:15],v[16:19],0
v_xor_b32 v36, s39, v16
v_xor_b32 v37, v17, v16
Zv v37,v37,v18,v16 bitop3:0xf6
Zv v37,v37,v19,v16 bitop3:0xf6
Zf vmcnt(2)
Ze v[32:35],v[12:15],v[20:23],v[32:35]
Zv v36,v36,v20,s39 bitop3:0xf6
Zv v37,v37,v21,v20 bitop3:0xf6
Zv v37,v37,v22,v20 bitop3:0xf6
Zv v37,v37,v23,v20 bitop3:0xf6
Zf vmcnt(1)
Ze v[32:35],v[12:15],v[24:27],v[32:35]
Zv v36,v36,v24,s39 bitop3:0xf6
Zv v37,v37,v25,v24 bitop3:0xf6
Zv v37,v37,v26,v24 bitop3:0xf6
Zv v37,v37,v27,v24 bitop3:0xf6
Zf vmcnt(0)
Ze v[32:35],v[12:15],v[28:31],v[32:35]
Zv v36,v36,v28,s39 bitop3:0xf6
Zv v37,v37,v29,v28 bitop3:0xf6
Zv v37,v37,v30,v28 bitop3:0xf6
Zv v37,v37,v31,v28 bitop3:0xf6
v_and_or_b32 v36, v37, s36, v36
Zy v36,1,v36
v_cmp_ne_u32 vcc, 0, v36
s_cbranch_vccz P1D_w0x
s_sub_u32 s20, s20, 1
s_cmp_gt_i32 s20, 0
Zk P1_w0x
P1D_w0x:
v_add_f32_dpp v16, v32, v32 row_shl:8 row_mask:0xf bank_mask:0xf bound_ctrl:1
v_add_f32_dpp v17, v33, v33 row_shl:8 row_mask:0xf bank_mask:0xf bound_ctrl:1
v_add_f32_dpp v18, v34, v34 row_shl:8 row_mask:0xf bank_mask:0xf bound_ctrl:1
v_add_f32_dpp v19, v35, v35 row_shl:8 row_mask:0xf bank_mask:0xf bound_ctrl:1
Zj v36,v16,v17
Zj v37,v18,v19
buffer_store_dwordx2 v[36:37], v40, s[4:7], s15 offen sc1
buffer_store_dwordx2 v[38:39], v40, s[4:7], s16 offen sc1
s_barrier
Zb s19,s18,10240
Zh v[64:67],v0,s[4:7],s19 offen offset:0
Zh v[68:71],v0,s[4:7],s19 offen offset:1024
Zm v[18:19],0
Zm v[20:21],0
Zm v[22:23],0
Zm v[24:25],0
Zm v[26:27],0
Zm v[28:29],0
Zm v[30:31],0
Zm v[32:33],0
Zm v[34:35],0
Zm v[36:37],0
Zm v[38:39],0
s_xor_b32 s39, s39, 1
Zb s22,s15,0
Zf lgkmcnt(0)
Zh v[12:15],v0,s[4:7],s22 offen offset:0 sc1
Zh v[40:43],v0,s[4:7],s22 offen offset:1024 sc1
Zh v[44:47],v0,s[4:7],s22 offen offset:2048 sc1
Zf vmcnt(2)
Zb s19,s18,14336
Zh v[72:75],v0,s[4:7],s19 offen offset:0
Zh v[76:79],v0,s[4:7],s19 offen offset:1024
v_max3_u32 v16, v12, v13, v14
Zf vmcnt(3)
v_max3_u32 v16, v16, v15, v40
v_max3_u32 v16, v16, v41, v42
Zf vmcnt(2)
v_max3_u32 v16, v16, v43, v44
v_max3_u32 v16, v16, v45, v46
v_max_u32 v16, v16, v47
v_cmp_eq_u32 vcc, -1, v16
Zm v[16:17],0
s_cbranch_vccz P2D_w0x
P2_w0x:
Zh v[12:15],v0,s[4:7],s22 offen offset:0 sc1
Zh v[40:43],v0,s[4:7],s22 offen offset:1024 sc1
Zh v[44:47],v0,s[4:7],s22 offen offset:2048 sc1
Zf vmcnt(2)
v_max3_u32 v16, v12, v13, v14
Zf vmcnt(1)
v_max3_u32 v16, v16, v15, v40
v_max3_u32 v16, v16, v41, v42
Zf vmcnt(0)
v_max3_u32 v16, v16, v43, v44
v_max3_u32 v16, v16, v45, v46
v_max_u32 v16, v16, v47
v_cmp_eq_u32 vcc, -1, v16
Zm v[16:17],0
s_cbranch_vccz P2D_w0x
s_sub_u32 s20, s20, 1
s_cmp_gt_i32 s20, 0
Zk P2_w0x
P2D_w0x:
Zp s15,s16
s_branch CS_w0x
FB_w0x:
s_cmp_lg_u32 s23, 0
Zk SO_w0x
Zp s23,1
s_nop 11
v_max3_f32 v24, v40, v41, v42
v_max3_f32 v24, v24, v43, v44
v_max3_f32 v24, v24, v45, v46
v_max3_f32 v24, v24, v47, v32
v_max_f32 v24, v24, v33
Zs v25,v24
s_nop 1
v_permlane32_swap_b32 v24, v25
v_max_f32 v24, v24, v25
Zs v25,v24
s_nop 1
v_permlane16_swap_b32 v24, v25
v_max_f32 v24, v24, v25
Zx v40,v40,v24
Zx v41,v41,v24
Zx v42,v42,v24
Zx v43,v43,v24
Zx v44,v44,v24
Zx v45,v45,v24
Zx v46,v46,v24
Zx v47,v47,v24
Zx v32,v32,v24
Zx v33,v33,v24
Zf lgkmcnt(0)
s_branch SX_w0x
CE_w0x:
Zf vmcnt(0) lgkmcnt(0)
s_barrier
Zb s11,s11,1
Zb s27,s27,655360
Zb s17,s17,655360
Zp s15,2129920
Zf vmcnt(0)
s_cmp_lt_u32 s11, 128
Zk CL_w0x
s_endpgm
.p2align 6
L_fa0:
Zq s24,s8,7
Zb s26,s24,4096
Zb s24,s24,0
Zp s11,0
s_mul_i32 s17, s8, 20480
Zb s17,s17,16777216
Zb s27,s17,16384
s_load_dwordx2 s[28:29], s[0:1], 48
Zp s30,10240
Zp s31,0x20000
Zp s39,0
Zb s90,s18,0
Zb s91,s18,4096
Zb s92,s18,8192
Zb s93,s18,12288
Zb s94,s18,16384
Zb s36,s8,0
s_mul_i32 s22, s36, 205
s_lshr_b32 s22, s22, 11
s_mul_i32 s23, s22, 10
s_sub_u32 s36, s36, s23
Zq s38,s36,10
s_lshr_b32 s23, s22, 1
Zq s23,s23,6
Zb s38,s38,s23
s_and_b32 s23, s22, 1
Zq s23,s23,4
Zb s38,s38,s23
s_cmp_ge_u32 s36, 8
s_cselect_b32 s36, 1, 0
Zb s13,s12,82944
Zb s14,s12,165888
Zb s59,s12,248832
Zp s32,394264576
Zp s33,1342177280
Zf lgkmcnt(0)
CL_w0:
Zp s10,0
s_barrier
Zp s37,8192
Zs v6,v0
Zb m0,s37,2048
Zb s19,s17,0
Zh v0,s[4:7],s19 offen sc1 nt lds
Zb m0,s37,3072
Zb s19,s17,1024
Zh v0,s[4:7],s19 offen sc1 nt lds
Zh v[12:15],v7,s[28:31],0 offen offset:0
Zh v[40:43],v7,s[28:31],0 offen offset:128
Zh v[44:47],v7,s[28:31],0 offen offset:256
Zb s19,s18,0
Zh v[48:51],v0,s[4:7],s19 offen offset:0
Zh v[52:55],v0,s[4:7],s19 offen offset:1024
Zb s19,s18,6144
Zh v[56:59],v0,s[4:7],s19 offen offset:0
Zh v[60:63],v0,s[4:7],s19 offen offset:1024
Zb s19,s18,10240
Zh v[64:67],v0,s[4:7],s19 offen offset:0
Zh v[68:71],v0,s[4:7],s19 offen offset:1024
Zb s19,s18,14336
Zh v[72:75],v0,s[4:7],s19 offen offset:0
Zh v[76:79],v0,s[4:7],s19 offen offset:1024
Zm v[16:17],0
Zm v[18:19],0
Zm v[20:21],0
Zm v[22:23],0
Zm v[24:25],0
Zm v[26:27],0
Zm v[28:29],0
Zm v[30:31],0
Zm v[32:33],0
Zm v[34:35],0
Zm v[36:37],0
Zm v[38:39],0
Zf vmcnt(0) lgkmcnt(0)
CS_w0:
Zt v0,v[12:15] offset:0
Zt v0,v[40:43] offset:1024
Zt v6,v[44:47] offset:2048
Zg v[16:19],v[12:15],v[48:55],v1
Zb s19,s18,2048
Zh v[48:51],v0,s[4:7],s19 offen offset:0
Zh v[52:55],v0,s[4:7],s19 offen offset:1024
Zg v[20:23],v[12:15],v[56:63],v1
Zi v[56:59],v5 offset:2048
Zi v[60:63],v5 offset:3072
Zg v[24:27],v[12:15],v[64:71],v1
Zi v[64:67],v5 offset:10240
Zi v[68:71],v5 offset:11264
Zf vmcnt(2)
Zg v[28:31],v[12:15],v[72:79],v1
Zi v[72:75],v5 offset:18432
Zi v[76:79],v5 offset:19456
Zg v[32:35],v[12:15],a[128:135],v1
Zg v[36:39],v[12:15],a[136:143],v1
Zf lgkmcnt(6)
s_barrier
Zi v[12:15],v6 offset:3072
Zg v[16:19],v[40:43],a[144:151],v1
Zf lgkmcnt(5)
Zg v[20:23],v[40:43],v[56:63],v1
Zb s19,s18,8192
Zh v[56:59],v0,s[4:7],s19 offen offset:0
Zh v[60:63],v0,s[4:7],s19 offen offset:1024
Zf lgkmcnt(3)
Zg v[24:27],v[40:43],v[64:71],v1
Zi v[64:67],v5 offset:12288
Zi v[68:71],v5 offset:13312
Zf lgkmcnt(3)
Zg v[28:31],v[40:43],v[72:79],v1
Zi v[72:75],v5 offset:20480
Zi v[76:79],v5 offset:21504
Zg v[32:35],v[40:43],a[152:159],v1
Zg v[36:39],v[40:43],a[160:167],v1
Zg v[16:19],v[44:47],a[168:175],v1
Zi v[40:43],v6 offset:4096
Zf lgkmcnt(3)
Zg v[20:23],v[44:47],v[64:71],v1
Zi v[64:67],v5 offset:14336
Zi v[68:71],v5 offset:15360
Zg v[24:27],v[44:47],a[176:183],v1
Zf lgkmcnt(3)
Zg v[28:31],v[44:47],v[72:79],v1
Zi v[72:75],v5 offset:22528
Zi v[76:79],v5 offset:23552
Zg v[32:35],v[44:47],a[184:191],v1
Zg v[36:39],v[44:47],a[192:199],v1
Zg v[16:19],v[12:15],a[200:207],v1
Zi v[44:47],v6 offset:5120
Zf lgkmcnt(3)
Zg v[20:23],v[12:15],v[64:71],v1
Zb s19,s18,12288
Zh v[64:67],v0,s[4:7],s19 offen offset:0
Zh v[68:71],v0,s[4:7],s19 offen offset:1024
Zg v[24:27],v[12:15],a[208:215],v1
Zf lgkmcnt(1)
Zg v[28:31],v[12:15],v[72:79],v1
Zi v[72:75],v5 offset:24576
Zi v[76:79],v5 offset:25600
Zg v[32:35],v[12:15],a[216:223],v1
Zg v[36:39],v[12:15],a[224:231],v1
Zg v[16:19],v[40:43],a[232:239],v1
Zi v[12:15],v6 offset:6144
Zg v[20:23],v[40:43],a[240:247],v1
Zf vmcnt(4)
Zg v[24:27],v[40:43],v[48:55],v1
Zi v[48:51],v5 offset:0
Zi v[52:55],v5 offset:1024
Zf lgkmcnt(3)
Zg v[28:31],v[40:43],v[72:79],v1
Zb s19,s18,16384
Zh v[72:75],v0,s[4:7],s19 offen offset:0
Zh v[76:79],v0,s[4:7],s19 offen offset:1024
Zg v[32:35],v[40:43],a[248:255],v1
Zg v[36:39],v[40:43],v[80:87],v1
Zg v[16:19],v[44:47],v[88:95],v1
Zi v[40:43],v6 offset:7168
Zg v[20:23],v[44:47],v[96:103],v1
Zf lgkmcnt(1)
Zg v[24:27],v[44:47],v[48:55],v1
Zb s19,s18,4096
Zh v[48:51],v0,s[4:7],s19 offen offset:0
Zh v[52:55],v0,s[4:7],s19 offen offset:1024
Zg v[28:31],v[44:47],v[104:111],v1
Zg v[32:35],v[44:47],v[112:119],v1
Zf vmcnt(6)
Zg v[36:39],v[44:47],v[56:63],v1
Zb s34,s17,655360
Zi v[56:59],v5 offset:4096
Zi v[60:63],v5 offset:5120
Zg v[16:19],v[12:15],v[120:127],v1
Zi v[44:47],v6 offset:8192
Zo s10,63
s_cselect_b32 s34, s17, s34
Zg v[20:23],v[12:15],v[128:135],v1
s_xor_b32 s37, s37, 8192
Zg v[24:27],v[12:15],v[136:143],v1
Zg v[28:31],v[12:15],v[144:151],v1
Zg v[32:35],v[12:15],v[152:159],v1
Zf lgkmcnt(1)
Zg v[36:39],v[12:15],v[56:63],v1
Zi v[56:59],v5 offset:6144
Zi v[60:63],v5 offset:7168
Zg v[16:19],v[40:43],v[160:167],v1
Zi v[12:15],v6 offset:9216
Zg v[20:23],v[40:43],v[168:175],v1
Zg v[24:27],v[40:43],v[176:183],v1
Zf vmcnt(4)
Zg v[28:31],v[40:43],v[64:71],v1
Zi v[64:67],v5 offset:16384
Zi v[68:71],v5 offset:17408
Zf lgkmcnt(5)
Zg v[16:19],v[44:47],v[184:191],v1
Zf lgkmcnt(3)
Zg v[20:23],v[44:47],v[56:63],v1
Zi v[56:59],v5 offset:8192
Zi v[60:63],v5 offset:9216
Zf lgkmcnt(4)
Zg v[16:19],v[12:15],v[192:199],v1
Zg v[20:23],v[12:15],v[200:207],v1
Zg v[24:27],v[44:47],v[208:215],v1
v_xor_b32 v6, 8192, v6
Zf lgkmcnt(2)
Zg v[28:31],v[44:47],v[64:71],v1
Zl v16,v16,v18
Zb s19,s17,8192
Zh v[64:67],v0,s[4:7],s19 offen sc1 nt
Zh v[68:71],v0,s[4:7],s19 offen offset:1024 sc1 nt
Zf vmcnt(4)
Zg v[24:27],v[12:15],v[72:79],v1
Zl v17,v17,v19
Zf lgkmcnt(0)
Zg v[28:31],v[12:15],v[56:63],v1
Zl v20,v20,v22
Zg v[32:35],v[12:15],v[216:223],v1
Zl v21,v21,v23
Zw v16,s21,v16
Zi v[72:75],v6 offset:2048
Zi v[76:79],v6 offset:6144
Zg v[36:39],v[12:15],v[224:231],v1
Zw v17,s21,v17
Zw v20,s21,v20
Zw v21,s21,v21
Zj v18,v16,v20
Zj v19,v17,v21
ds_write2_b32 v8, v18, v19 offset0:0 offset1:72
Zi v[56:59],v6 offset:3072
Zi v[60:63],v6 offset:7168
Zl v24,v24,v26
Zl v25,v25,v27
Zl v28,v28,v30
Zl v29,v29,v31
Zj v12,v24,v28
Zj v13,v25,v29
ds_write_b32 v8, v12 offset:2304
ds_write_b32 v8, v13 offset:2592
Zg v[32:35],v[44:47],v[232:239],v1
Zg v[36:39],v[44:47],v[240:247],v1
Zf lgkmcnt(0)
s_barrier
Zi v[16:19],v9 offset:0
Zi v[20:23],v10 offset:0
Zi v[24:27],v9 offset:64
Zi v[28:31],v10 offset:64
Zg v[32:35],v[40:43],v[248:255],v1
Zf vmcnt(2)
Zg v[36:39],v[40:43],v[48:55],v1
Zi v[48:51],v6 offset:4096
Zi v[52:55],v6 offset:8192
s_nop 1
Zl v32,v32,v34
Zl v33,v33,v35
s_nop 1
Zl v36,v36,v38
Zl v37,v37,v39
Zj v14,v32,v33
Zj v15,v36,v37
Zr v[12:15],v0,s[4:7],s27 offen sc1 nt
Zf lgkmcnt(5)
Ze v[44:47],v[76:79],v[16:19],0
Zf lgkmcnt(4)
Ze v[32:35],v[20:23],v[16:19],0
Ze v[40:43],v[72:75],v[16:19],0
Zi v[16:19],v9 offset:128
Zi v[20:23],v10 offset:128
Zi v[72:75],v6 offset:5120
Zi v[76:79],v6 offset:9216
Zb m0,s37,2048
Zb s19,s34,0
Zh v0,s[4:7],s19 offen sc1 nt lds
Zf lgkmcnt(7)
Ze v[44:47],v[60:63],v[24:27],v[44:47]
Zs v36,0x3f803f80
Zs v37,0x3f803f80
Zf lgkmcnt(6)
Ze v[32:35],v[28:31],v[24:27],v[32:35]
Zs v38,0x3f803f80
Zs v39,0x3f803f80
Ze v[40:43],v[56:59],v[24:27],v[40:43]
Zi v[24:27],v9 offset:192
Zi v[28:31],v10 offset:192
Zi v[56:59],v5 offset:30720
Zi v[60:63],v5 offset:31744
Zb m0,s37,3072
Zb s19,s34,1024
Zh v0,s[4:7],s19 offen sc1 nt lds
Zf lgkmcnt(7)
Ze v[44:47],v[52:55],v[16:19],v[44:47]
Zf lgkmcnt(6)
Ze v[32:35],v[20:23],v[16:19],v[32:35]
Ze v[40:43],v[48:51],v[16:19],v[40:43]
Zi v[48:51],v5 offset:26624
Zi v[52:55],v5 offset:27648
Zf lgkmcnt(5)
Ze v[44:47],v[76:79],v[24:27],v[44:47]
Zs v21,0
Zs v22,0
Zf lgkmcnt(4)
Ze v[32:35],v[28:31],v[24:27],v[32:35]
Ze v[40:43],v[72:75],v[24:27],v[40:43]
Zp s23,0
SX_w0:
Zn v76,v44
Zn v77,v45
Zn v78,v46
Zn v79,v47
Zn v24,v32
Zn v25,v33
s_nop 0
Zn v72,v40
Zn v73,v41
Zn v74,v42
Zn v75,v43
Zj v18,v76,v77
Zj v19,v78,v79
Zj v16,v72,v73
Zj v17,v74,v75
Zj v20,v24,v25
Zj v23,v24,v25
Ze v[72:75],v[36:39],v[16:19],0
Zf vmcnt(4)
Ze v[24:27],v[64:67],v[16:19],0
Zf vmcnt(3)
Ze v[28:31],v[68:71],v[16:19],0
v_mfma_f32_16x16x16_bf16 v[72:75], v[36:37], v[20:21], v[72:75]
v_mfma_f32_16x16x16_bf16 v[24:27], v[14:15], v[20:21], v[24:27]
Zm v[76:77],0
Zm v[78:79],0
v_mfma_f32_16x16x16_bf16 v[28:31], v[14:15], v[22:23], v[28:31]
s_nop 2
v_subrev_u32 v73, s32, v72
v_rcp_f32 v74, v72
v_cmp_le_u32 vcc, s33, v73
Zs v75,v74
s_cbranch_vccnz FB_w0
SO_w0:
v_pk_mul_f32 v[24:25], v[24:25], v[74:75]
v_pk_mul_f32 v[26:27], v[26:27], v[74:75]
v_pk_mul_f32 v[28:29], v[28:29], v[74:75]
v_pk_mul_f32 v[30:31], v[30:31], v[74:75]
Zj v24,v24,v28
Zj v25,v25,v29
Zj v26,v26,v30
Zj v27,v27,v31
Zt v11,v[24:27]
Zm v[72:73],0
Zm v[74:75],0
Zm v[16:17],0
Zm v[18:19],0
Zm v[20:21],0
Zm v[22:23],0
Zm v[64:65],0
Zm v[66:67],0
Zm v[68:69],0
Zm v[70:71],0
Zf lgkmcnt(0)
s_barrier
Zi v[40:43],v0 offset:0
Zi v[44:47],v0 offset:1024
Zo s10,63
Zk CE_w0
Zm v[24:25],0
Zm v[26:27],0
Zm v[28:29],0
Zm v[30:31],0
Zb s17,s17,655360
Zf lgkmcnt(1)
Zg v[72:75],v[40:43],v[48:55],v1
Zm v[32:33],0
Zi v[48:51],v5 offset:28672
Zi v[52:55],v5 offset:29696
Zf lgkmcnt(2)
Zg v[72:75],v[44:47],v[56:63],v1
Zm v[34:35],0
Zi v[56:59],v5 offset:32768
Zi v[60:63],v5 offset:33792
Zg v[76:79],v[40:43],a[0:7],v1
Zm v[36:37],0
Zg v[76:79],v[44:47],a[8:15],v1
Zm v[38:39],0
Zg v[16:19],v[40:43],a[16:23],v1
Zl v72,v72,v74
Zg v[16:19],v[44:47],a[24:31],v1
Zl v73,v73,v75
Zg v[20:23],v[40:43],a[32:39],v1
Zl v76,v76,v78
Zf lgkmcnt(2)
Zg v[20:23],v[44:47],v[48:55],v1
Zl v77,v77,v79
Zf lgkmcnt(0)
Zg v[64:67],v[40:43],v[56:63],v1
Zl v16,v16,v18
Zg v[64:67],v[44:47],a[40:47],v1
Zl v17,v17,v19
Zg v[68:71],v[40:43],a[48:55],v1
Zl v20,v20,v22
Zj v12,v72,v76
Zg v[68:71],v[44:47],a[56:63],v1
Zl v21,v21,v23
Zj v48,v73,v77
Zg v[24:27],v[40:43],a[64:71],v1
Zl v64,v64,v66
Zj v13,v16,v20
Zg v[24:27],v[44:47],a[72:79],v1
Zl v65,v65,v67
Zj v49,v17,v21
Zg v[28:31],v[40:43],a[80:87],v1
Zl v68,v68,v70
v_bfi_b32 v12, 1, s39, v12
Zg v[28:31],v[44:47],a[88:95],v1
Zl v69,v69,v71
v_bfi_b32 v48, 1, s39, v48
Zg v[32:35],v[40:43],a[96:103],v1
Zl v24,v24,v26
Zj v14,v64,v68
Zg v[32:35],v[44:47],a[104:111],v1
Zl v25,v25,v27
Zj v50,v65,v69
Zg v[36:39],v[40:43],a[112:119],v1
Zl v28,v28,v30
Zj v15,v24,v28
Zr v[12:15],v2,s[4:7],s12 offen
Zg v[36:39],v[44:47],a[120:127],v1
Zl v29,v29,v31
Zj v51,v25,v29
Zr v[48:51],v2,s[4:7],s12 offen offset:1280
Zl v32,v32,v34
Zl v33,v33,v35
s_nop 2
Zl v36,v36,v38
Zj v56,v32,v36
v_bfi_b32 v56, 1, s39, v56
Zu v56,v3,s[4:7],s12 offen offset:0
Zl v37,v37,v39
Zj v57,v33,v37
v_bfi_b32 v57, 1, s39, v57
Zu v57,v3,s[4:7],s12 offen offset:1280
s_xor_b32 s16, s15, 0x4000
Zb s10,s10,1
Zb s11,s11,1
Zb s27,s27,655360
Zi v[12:15],v0 offset:23040
Zm v[38:39],-1
Zy v40,0x60,v0
v_lshl_add_u32 v40, v40, 3, s38
Zy v41,0x10,v0
v_lshl_add_u32 v40, v41, 1, v40
v_lshrrev_b32 v41, 5, v0
Zy v41,8,v41
v_add_u32 v40, v40, v41
Zy v41,0x280,v0
Zs v42,2130706432
v_cmp_ne_u32 vcc, 0, v41
s_nop 1
v_cndmask_b32 v40, v40, v42, vcc
Zf vmcnt(0)
Zf lgkmcnt(0)
Zh v[16:19],v4,s[4:7],s12 offen sc1
Zh v[20:23],v4,s[4:7],s13 offen sc1
Zh v[24:27],v4,s[4:7],s14 offen sc1
Zh v[28:31],v4,s[4:7],s59 offen sc1
Zb s19,s18,0
Zh v[48:51],v0,s[4:7],s19 offen offset:0
Zh v[52:55],v0,s[4:7],s19 offen offset:1024
Zb s19,s18,6144
Zh v[56:59],v0,s[4:7],s19 offen offset:0
Zh v[60:63],v0,s[4:7],s19 offen offset:1024
Zf vmcnt(7)
Ze v[32:35],v[12:15],v[16:19],0
v_xor_b32 v36, s39, v16
v_xor_b32 v37, v17, v16
Zv v37,v37,v18,v16 bitop3:0xf6
Zv v37,v37,v19,v16 bitop3:0xf6
Zf vmcnt(6)
Ze v[32:35],v[12:15],v[20:23],v[32:35]
Zv v36,v36,v20,s39 bitop3:0xf6
Zv v37,v37,v21,v20 bitop3:0xf6
Zv v37,v37,v22,v20 bitop3:0xf6
Zv v37,v37,v23,v20 bitop3:0xf6
Zf vmcnt(5)
Ze v[32:35],v[12:15],v[24:27],v[32:35]
Zv v36,v36,v24,s39 bitop3:0xf6
Zv v37,v37,v25,v24 bitop3:0xf6
Zv v37,v37,v26,v24 bitop3:0xf6
Zv v37,v37,v27,v24 bitop3:0xf6
Zf vmcnt(4)
Ze v[32:35],v[12:15],v[28:31],v[32:35]
Zv v36,v36,v28,s39 bitop3:0xf6
Zv v37,v37,v29,v28 bitop3:0xf6
Zv v37,v37,v30,v28 bitop3:0xf6
Zv v37,v37,v31,v28 bitop3:0xf6
v_and_or_b32 v36, v37, s36, v36
Zy v36,1,v36
v_cmp_ne_u32 vcc, 0, v36
s_cbranch_vccz P1D_w0
P1_w0:
Zh v[16:19],v4,s[4:7],s12 offen sc1
Zh v[20:23],v4,s[4:7],s13 offen sc1
Zh v[24:27],v4,s[4:7],s14 offen sc1
Zh v[28:31],v4,s[4:7],s59 offen sc1
Zf vmcnt(3)
Ze v[32:35],v[12:15],v[16:19],0
v_xor_b32 v36, s39, v16
v_xor_b32 v37, v17, v16
Zv v37,v37,v18,v16 bitop3:0xf6
Zv v37,v37,v19,v16 bitop3:0xf6
Zf vmcnt(2)
Ze v[32:35],v[12:15],v[20:23],v[32:35]
Zv v36,v36,v20,s39 bitop3:0xf6
Zv v37,v37,v21,v20 bitop3:0xf6
Zv v37,v37,v22,v20 bitop3:0xf6
Zv v37,v37,v23,v20 bitop3:0xf6
Zf vmcnt(1)
Ze v[32:35],v[12:15],v[24:27],v[32:35]
Zv v36,v36,v24,s39 bitop3:0xf6
Zv v37,v37,v25,v24 bitop3:0xf6
Zv v37,v37,v26,v24 bitop3:0xf6
Zv v37,v37,v27,v24 bitop3:0xf6
Zf vmcnt(0)
Ze v[32:35],v[12:15],v[28:31],v[32:35]
Zv v36,v36,v28,s39 bitop3:0xf6
Zv v37,v37,v29,v28 bitop3:0xf6
Zv v37,v37,v30,v28 bitop3:0xf6
Zv v37,v37,v31,v28 bitop3:0xf6
v_and_or_b32 v36, v37, s36, v36
Zy v36,1,v36
v_cmp_ne_u32 vcc, 0, v36
s_cbranch_vccz P1D_w0
s_sub_u32 s20, s20, 1
s_cmp_gt_i32 s20, 0
Zk P1_w0
P1D_w0:
v_add_f32_dpp v16, v32, v32 row_shl:8 row_mask:0xf bank_mask:0xf bound_ctrl:1
v_add_f32_dpp v17, v33, v33 row_shl:8 row_mask:0xf bank_mask:0xf bound_ctrl:1
v_add_f32_dpp v18, v34, v34 row_shl:8 row_mask:0xf bank_mask:0xf bound_ctrl:1
v_add_f32_dpp v19, v35, v35 row_shl:8 row_mask:0xf bank_mask:0xf bound_ctrl:1
Zj v36,v16,v17
Zj v37,v18,v19
buffer_store_dwordx2 v[36:37], v40, s[4:7], s15 offen
buffer_store_dwordx2 v[38:39], v40, s[4:7], s16 offen
s_barrier
Zb s19,s18,10240
Zh v[64:67],v0,s[4:7],s19 offen offset:0
Zh v[68:71],v0,s[4:7],s19 offen offset:1024
Zm v[18:19],0
Zm v[20:21],0
Zm v[22:23],0
Zm v[24:25],0
Zm v[26:27],0
Zm v[28:29],0
Zm v[30:31],0
Zm v[32:33],0
Zm v[34:35],0
Zm v[36:37],0
Zm v[38:39],0
s_xor_b32 s39, s39, 1
Zb s22,s15,0
Zf lgkmcnt(0)
Zh v[12:15],v0,s[4:7],s22 offen offset:0 sc1
Zh v[40:43],v0,s[4:7],s22 offen offset:1024 sc1
Zh v[44:47],v0,s[4:7],s22 offen offset:2048 sc1
Zf vmcnt(2)
Zb s19,s18,14336
Zh v[72:75],v0,s[4:7],s19 offen offset:0
Zh v[76:79],v0,s[4:7],s19 offen offset:1024
v_max3_u32 v16, v12, v13, v14
Zf vmcnt(3)
v_max3_u32 v16, v16, v15, v40
v_max3_u32 v16, v16, v41, v42
Zf vmcnt(2)
v_max3_u32 v16, v16, v43, v44
v_max3_u32 v16, v16, v45, v46
v_max_u32 v16, v16, v47
v_cmp_eq_u32 vcc, -1, v16
Zm v[16:17],0
s_cbranch_vccz P2D_w0
P2_w0:
Zh v[12:15],v0,s[4:7],s22 offen offset:0 sc1
Zh v[40:43],v0,s[4:7],s22 offen offset:1024 sc1
Zh v[44:47],v0,s[4:7],s22 offen offset:2048 sc1
Zf vmcnt(2)
v_max3_u32 v16, v12, v13, v14
Zf vmcnt(1)
v_max3_u32 v16, v16, v15, v40
v_max3_u32 v16, v16, v41, v42
Zf vmcnt(0)
v_max3_u32 v16, v16, v43, v44
v_max3_u32 v16, v16, v45, v46
v_max_u32 v16, v16, v47
v_cmp_eq_u32 vcc, -1, v16
Zm v[16:17],0
s_cbranch_vccz P2D_w0
s_sub_u32 s20, s20, 1
s_cmp_gt_i32 s20, 0
Zk P2_w0
P2D_w0:
Zp s15,s16
s_branch CS_w0
FB_w0:
s_cmp_lg_u32 s23, 0
Zk SO_w0
Zp s23,1
s_nop 11
v_max3_f32 v24, v40, v41, v42
v_max3_f32 v24, v24, v43, v44
v_max3_f32 v24, v24, v45, v46
v_max3_f32 v24, v24, v47, v32
v_max_f32 v24, v24, v33
Zs v25,v24
s_nop 1
v_permlane32_swap_b32 v24, v25
v_max_f32 v24, v24, v25
Zs v25,v24
s_nop 1
v_permlane16_swap_b32 v24, v25
v_max_f32 v24, v24, v25
Zx v40,v40,v24
Zx v41,v41,v24
Zx v42,v42,v24
Zx v43,v43,v24
Zx v44,v44,v24
Zx v45,v45,v24
Zx v46,v46,v24
Zx v47,v47,v24
Zx v32,v32,v24
Zx v33,v33,v24
Zf lgkmcnt(0)
s_branch SX_w0
CE_w0:
Zf vmcnt(0) lgkmcnt(0)
s_barrier
Zb s11,s11,1
Zb s27,s27,655360
Zb s17,s17,655360
Zp s15,2129920
Zf vmcnt(0)
s_cmp_lt_u32 s11, 128
Zk CL_w0
s_endpgm
L_w1:
Zy v0,63,v0
Zy v12,15,v0
v_lshrrev_b32 v13, 4, v0
Zz v0,4,v0
Zp s22,0x05040100
Zp s23,0x07060302
v_add_u32 v5, 59392, v0
s_mul_i32 s18, s8, 73728
Zb s18,s18,3164160
v_lshrrev_b32 v14, 1, v13
Zz v14,4,v14
Zy v1,1,v13
v_lshl_add_u32 v14, v1, 2, v14
s_load_dwordx2 s[24:25], s[0:1], 80
Zp s26,5242880
Zp s27,0x20000
v_mul_u32_u24 v2, 1280, v14
v_lshl_add_u32 v3, v12, 2, v2
v_lshl_add_u32 v2, v12, 4, v2
v_add_u32 v2, 256, v2
v_add_u32 v3, 1088, v3
s_mul_i32 s17, s8, 163840
Zb s19,s17,0
Zf lgkmcnt(0)
Zh v[80:83],v2,s[24:27],s19 offen
Za v208,v3,s[24:27],s19 offen
Zb s19,s17,1280
Zh v[84:87],v2,s[24:27],s19 offen
Za v209,v3,s[24:27],s19 offen
Zb s19,s17,10240
Zh v[88:91],v2,s[24:27],s19 offen
Za v210,v3,s[24:27],s19 offen
Zb s19,s17,11520
Zh v[92:95],v2,s[24:27],s19 offen
Za v211,v3,s[24:27],s19 offen
Zb s19,s17,2560
Zh v[96:99],v2,s[24:27],s19 offen
Za v212,v3,s[24:27],s19 offen
Zb s19,s17,3840
Zh v[100:103],v2,s[24:27],s19 offen
Za v213,v3,s[24:27],s19 offen
Zb s19,s17,12800
Zh v[104:107],v2,s[24:27],s19 offen
Za v214,v3,s[24:27],s19 offen
Zb s19,s17,14080
Zh v[108:111],v2,s[24:27],s19 offen
Za v215,v3,s[24:27],s19 offen
Zb s19,s17,40960
Zh v[112:115],v2,s[24:27],s19 offen
Za v216,v3,s[24:27],s19 offen
Zb s19,s17,42240
Zh v[116:119],v2,s[24:27],s19 offen
Za v217,v3,s[24:27],s19 offen
Zb s19,s17,51200
Zh v[120:123],v2,s[24:27],s19 offen
Za v218,v3,s[24:27],s19 offen
Zb s19,s17,52480
Zh v[124:127],v2,s[24:27],s19 offen
Za v219,v3,s[24:27],s19 offen
Zb s19,s17,43520
Zh v[128:131],v2,s[24:27],s19 offen
Za v220,v3,s[24:27],s19 offen
Zb s19,s17,44800
Zh v[132:135],v2,s[24:27],s19 offen
Za v221,v3,s[24:27],s19 offen
Zb s19,s17,53760
Zh v[136:139],v2,s[24:27],s19 offen
Za v222,v3,s[24:27],s19 offen
Zb s19,s17,55040
Zh v[140:143],v2,s[24:27],s19 offen
Za v223,v3,s[24:27],s19 offen
Zb s19,s17,81920
Zh v[144:147],v2,s[24:27],s19 offen
Za v224,v3,s[24:27],s19 offen
Zb s19,s17,83200
Zh v[148:151],v2,s[24:27],s19 offen
Za v225,v3,s[24:27],s19 offen
Zb s19,s17,92160
Zh v[152:155],v2,s[24:27],s19 offen
Za v226,v3,s[24:27],s19 offen
Zb s19,s17,93440
Zh v[156:159],v2,s[24:27],s19 offen
Za v227,v3,s[24:27],s19 offen
Zb s19,s17,84480
Zh v[160:163],v2,s[24:27],s19 offen
Za v228,v3,s[24:27],s19 offen
Zb s19,s17,85760
Zh v[164:167],v2,s[24:27],s19 offen
Za v229,v3,s[24:27],s19 offen
Zb s19,s17,94720
Zh v[168:171],v2,s[24:27],s19 offen
Za v230,v3,s[24:27],s19 offen
Zb s19,s17,96000
Zh v[172:175],v2,s[24:27],s19 offen
Za v231,v3,s[24:27],s19 offen
Zb s19,s17,122880
Zh v[176:179],v2,s[24:27],s19 offen
Za v232,v3,s[24:27],s19 offen
Zb s19,s17,124160
Zh v[180:183],v2,s[24:27],s19 offen
Za v233,v3,s[24:27],s19 offen
Zb s19,s17,133120
Zh v[184:187],v2,s[24:27],s19 offen
Za v234,v3,s[24:27],s19 offen
Zb s19,s17,134400
Zh v[188:191],v2,s[24:27],s19 offen
Za v235,v3,s[24:27],s19 offen
Zb s19,s17,125440
Zh v[192:195],v2,s[24:27],s19 offen
Za v236,v3,s[24:27],s19 offen
Zb s19,s17,126720
Zh v[196:199],v2,s[24:27],s19 offen
Za v237,v3,s[24:27],s19 offen
Zb s19,s17,135680
Zh v[200:203],v2,s[24:27],s19 offen
Za v238,v3,s[24:27],s19 offen
Zb s19,s17,136960
Zh v[204:207],v2,s[24:27],s19 offen
Za v239,v3,s[24:27],s19 offen
Zf vmcnt(62)
Zf vmcnt(61)
Zc v72,v84,v80,s22
Zf vmcnt(57)
Zc v73,v92,v88,s22
Zf vmcnt(53)
Zc v74,v100,v96,s22
Zf vmcnt(49)
Zc v75,v108,v104,s22
Zf vmcnt(45)
Zc v76,v116,v112,s22
Zf vmcnt(41)
Zc v77,v124,v120,s22
Zf vmcnt(37)
Zc v78,v132,v128,s22
Zf vmcnt(33)
Zc v79,v140,v136,s22
Zt v5,v[72:75] offset:26624
Zt v5,v[76:79] offset:27648
Zc v64,v84,v80,s23
Zc v65,v92,v88,s23
Zc v66,v100,v96,s23
Zc v67,v108,v104,s23
Zc v68,v116,v112,s23
Zc v69,v124,v120,s23
Zc v70,v132,v128,s23
Zc v71,v140,v136,s23
Zd a0,v64
Zd a1,v65
Zd a2,v66
Zd a3,v67
Zd a4,v68
Zd a5,v69
Zd a6,v70
Zd a7,v71
Zc v72,v85,v81,s22
Zc v73,v93,v89,s22
Zc v74,v101,v97,s22
Zc v75,v109,v105,s22
Zc v76,v117,v113,s22
Zc v77,v125,v121,s22
Zc v78,v133,v129,s22
Zc v79,v141,v137,s22
Zd a16,v72
Zd a17,v73
Zd a18,v74
Zd a19,v75
Zd a20,v76
Zd a21,v77
Zd a22,v78
Zd a23,v79
Zc v64,v85,v81,s23
Zc v65,v93,v89,s23
Zc v66,v101,v97,s23
Zc v67,v109,v105,s23
Zc v68,v117,v113,s23
Zc v69,v125,v121,s23
Zc v70,v133,v129,s23
Zc v71,v141,v137,s23
Zd a32,v64
Zd a33,v65
Zd a34,v66
Zd a35,v67
Zd a36,v68
Zd a37,v69
Zd a38,v70
Zd a39,v71
Zc v72,v86,v82,s22
Zc v73,v94,v90,s22
Zc v74,v102,v98,s22
Zc v75,v110,v106,s22
Zc v76,v118,v114,s22
Zc v77,v126,v122,s22
Zc v78,v134,v130,s22
Zc v79,v142,v138,s22
Zt v5,v[72:75] offset:32768
Zt v5,v[76:79] offset:33792
Zc v64,v86,v82,s23
Zc v65,v94,v90,s23
Zc v66,v102,v98,s23
Zc v67,v110,v106,s23
Zc v68,v118,v114,s23
Zc v69,v126,v122,s23
Zc v70,v134,v130,s23
Zc v71,v142,v138,s23
Zd a48,v64
Zd a49,v65
Zd a50,v66
Zd a51,v67
Zd a52,v68
Zd a53,v69
Zd a54,v70
Zd a55,v71
Zc v72,v87,v83,s22
Zc v73,v95,v91,s22
Zc v74,v103,v99,s22
Zc v75,v111,v107,s22
Zc v76,v119,v115,s22
Zc v77,v127,v123,s22
Zc v78,v135,v131,s22
Zc v79,v143,v139,s22
Zd a64,v72
Zd a65,v73
Zd a66,v74
Zd a67,v75
Zd a68,v76
Zd a69,v77
Zd a70,v78
Zd a71,v79
Zc v64,v87,v83,s23
Zc v65,v95,v91,s23
Zc v66,v103,v99,s23
Zc v67,v111,v107,s23
Zc v68,v119,v115,s23
Zc v69,v127,v123,s23
Zc v70,v135,v131,s23
Zc v71,v143,v139,s23
Zd a80,v64
Zd a81,v65
Zd a82,v66
Zd a83,v67
Zd a84,v68
Zd a85,v69
Zd a86,v70
Zd a87,v71
Zc v72,v209,v208,s22
Zc v73,v211,v210,s22
Zc v74,v213,v212,s22
Zc v75,v215,v214,s22
Zc v76,v217,v216,s22
Zc v77,v219,v218,s22
Zc v78,v221,v220,s22
Zf vmcnt(32)
Zc v79,v223,v222,s22
Zd a96,v72
Zd a97,v73
Zd a98,v74
Zd a99,v75
Zd a100,v76
Zd a101,v77
Zd a102,v78
Zd a103,v79
Zc v64,v209,v208,s23
Zc v65,v211,v210,s23
Zc v66,v213,v212,s23
Zc v67,v215,v214,s23
Zc v68,v217,v216,s23
Zc v69,v219,v218,s23
Zc v70,v221,v220,s23
Zc v71,v223,v222,s23
Zd a112,v64
Zd a113,v65
Zd a114,v66
Zd a115,v67
Zd a116,v68
Zd a117,v69
Zd a118,v70
Zd a119,v71
Zf vmcnt(29)
Zc v72,v148,v144,s22
Zf vmcnt(25)
Zc v73,v156,v152,s22
Zf vmcnt(21)
Zc v74,v164,v160,s22
Zf vmcnt(17)
Zc v75,v172,v168,s22
Zf vmcnt(13)
Zc v76,v180,v176,s22
Zf vmcnt(9)
Zc v77,v188,v184,s22
Zf vmcnt(5)
Zc v78,v196,v192,s22
Zf vmcnt(1)
Zc v79,v204,v200,s22
Zt v5,v[72:75] offset:30720
Zt v5,v[76:79] offset:31744
Zc v64,v148,v144,s23
Zc v65,v156,v152,s23
Zc v66,v164,v160,s23
Zc v67,v172,v168,s23
Zc v68,v180,v176,s23
Zc v69,v188,v184,s23
Zc v70,v196,v192,s23
Zc v71,v204,v200,s23
Zd a8,v64
Zd a9,v65
Zd a10,v66
Zd a11,v67
Zd a12,v68
Zd a13,v69
Zd a14,v70
Zd a15,v71
Zc v72,v149,v145,s22
Zc v73,v157,v153,s22
Zc v74,v165,v161,s22
Zc v75,v173,v169,s22
Zc v76,v181,v177,s22
Zc v77,v189,v185,s22
Zc v78,v197,v193,s22
Zc v79,v205,v201,s22
Zd a24,v72
Zd a25,v73
Zd a26,v74
Zd a27,v75
Zd a28,v76
Zd a29,v77
Zd a30,v78
Zd a31,v79
Zc v64,v149,v145,s23
Zc v65,v157,v153,s23
Zc v66,v165,v161,s23
Zc v67,v173,v169,s23
Zc v68,v181,v177,s23
Zc v69,v189,v185,s23
Zc v70,v197,v193,s23
Zc v71,v205,v201,s23
Zt v5,v[64:67] offset:28672
Zt v5,v[68:71] offset:29696
Zc v72,v150,v146,s22
Zc v73,v158,v154,s22
Zc v74,v166,v162,s22
Zc v75,v174,v170,s22
Zc v76,v182,v178,s22
Zc v77,v190,v186,s22
Zc v78,v198,v194,s22
Zc v79,v206,v202,s22
Zd a40,v72
Zd a41,v73
Zd a42,v74
Zd a43,v75
Zd a44,v76
Zd a45,v77
Zd a46,v78
Zd a47,v79
Zc v64,v150,v146,s23
Zc v65,v158,v154,s23
Zc v66,v166,v162,s23
Zc v67,v174,v170,s23
Zc v68,v182,v178,s23
Zc v69,v190,v186,s23
Zc v70,v198,v194,s23
Zc v71,v206,v202,s23
Zd a56,v64
Zd a57,v65
Zd a58,v66
Zd a59,v67
Zd a60,v68
Zd a61,v69
Zd a62,v70
Zd a63,v71
Zc v72,v151,v147,s22
Zc v73,v159,v155,s22
Zc v74,v167,v163,s22
Zc v75,v175,v171,s22
Zc v76,v183,v179,s22
Zc v77,v191,v187,s22
Zc v78,v199,v195,s22
Zc v79,v207,v203,s22
Zd a72,v72
Zd a73,v73
Zd a74,v74
Zd a75,v75
Zd a76,v76
Zd a77,v77
Zd a78,v78
Zd a79,v79
Zc v64,v151,v147,s23
Zc v65,v159,v155,s23
Zc v66,v167,v163,s23
Zc v67,v175,v171,s23
Zc v68,v183,v179,s23
Zc v69,v191,v187,s23
Zc v70,v199,v195,s23
Zc v71,v207,v203,s23
Zd a88,v64
Zd a89,v65
Zd a90,v66
Zd a91,v67
Zd a92,v68
Zd a93,v69
Zd a94,v70
Zd a95,v71
Zc v72,v225,v224,s22
Zc v73,v227,v226,s22
Zc v74,v229,v228,s22
Zc v75,v231,v230,s22
Zc v76,v233,v232,s22
Zc v77,v235,v234,s22
Zc v78,v237,v236,s22
Zf vmcnt(0)
Zc v79,v239,v238,s22
Zd a104,v72
Zd a105,v73
Zd a106,v74
Zd a107,v75
Zd a108,v76
Zd a109,v77
Zd a110,v78
Zd a111,v79
Zc v64,v225,v224,s23
Zc v65,v227,v226,s23
Zc v66,v229,v228,s23
Zc v67,v231,v230,s23
Zc v68,v233,v232,s23
Zc v69,v235,v234,s23
Zc v70,v237,v236,s23
Zc v71,v239,v238,s23
Zd a120,v64
Zd a121,v65
Zd a122,v66
Zd a123,v67
Zd a124,v68
Zd a125,v69
Zd a126,v70
Zd a127,v71
s_load_dwordx2 s[24:25], s[0:1], 56
Zp s26,5242880
Zp s27,0x20000
s_load_dwordx2 s[28:29], s[0:1], 64
Zp s30,5242880
Zp s31,0x20000
s_load_dwordx2 s[32:33], s[0:1], 72
Zp s34,5242880
Zp s35,0x20000
Zz v2,13,v14
v_lshl_add_u32 v2, v12, 2, v2
v_add_u32 v2, 64, v2
Zq s17,s8,8
Zb s19,s17,0
Zf lgkmcnt(0)
Za v16,v2,s[24:27],s19 offen
Zb s19,s17,8192
Za v17,v2,s[24:27],s19 offen
Zb s19,s17,65536
Za v18,v2,s[24:27],s19 offen
Zb s19,s17,73728
Za v19,v2,s[24:27],s19 offen
Zb s19,s17,16384
Za v20,v2,s[24:27],s19 offen
Zb s19,s17,24576
Za v21,v2,s[24:27],s19 offen
Zb s19,s17,81920
Za v22,v2,s[24:27],s19 offen
Zb s19,s17,90112
Za v23,v2,s[24:27],s19 offen
Zb s19,s17,262144
Za v24,v2,s[24:27],s19 offen
Zb s19,s17,270336
Za v25,v2,s[24:27],s19 offen
Zb s19,s17,327680
Za v26,v2,s[24:27],s19 offen
Zb s19,s17,335872
Za v27,v2,s[24:27],s19 offen
Zb s19,s17,278528
Za v28,v2,s[24:27],s19 offen
Zb s19,s17,286720
Za v29,v2,s[24:27],s19 offen
Zb s19,s17,344064
Za v30,v2,s[24:27],s19 offen
Zb s19,s17,352256
Za v31,v2,s[24:27],s19 offen
Zb s19,s17,524288
Za v32,v2,s[24:27],s19 offen
Zb s19,s17,532480
Za v33,v2,s[24:27],s19 offen
Zb s19,s17,589824
Za v34,v2,s[24:27],s19 offen
Zb s19,s17,598016
Za v35,v2,s[24:27],s19 offen
Zb s19,s17,540672
Za v36,v2,s[24:27],s19 offen
Zb s19,s17,548864
Za v37,v2,s[24:27],s19 offen
Zb s19,s17,606208
Za v38,v2,s[24:27],s19 offen
Zb s19,s17,614400
Za v39,v2,s[24:27],s19 offen
Zb s19,s17,786432
Za v40,v2,s[24:27],s19 offen
Zb s19,s17,794624
Za v41,v2,s[24:27],s19 offen
Zb s19,s17,851968
Za v42,v2,s[24:27],s19 offen
Zb s19,s17,860160
Za v43,v2,s[24:27],s19 offen
Zb s19,s17,802816
Za v44,v2,s[24:27],s19 offen
Zb s19,s17,811008
Za v45,v2,s[24:27],s19 offen
Zb s19,s17,868352
Za v46,v2,s[24:27],s19 offen
Zb s19,s17,876544
Za v47,v2,s[24:27],s19 offen
Zb s19,s17,1048576
Za v48,v2,s[24:27],s19 offen
Zb s19,s17,1056768
Za v49,v2,s[24:27],s19 offen
Zb s19,s17,1114112
Za v50,v2,s[24:27],s19 offen
Zb s19,s17,1122304
Za v51,v2,s[24:27],s19 offen
Zb s19,s17,1064960
Za v52,v2,s[24:27],s19 offen
Zb s19,s17,1073152
Za v53,v2,s[24:27],s19 offen
Zb s19,s17,1130496
Za v54,v2,s[24:27],s19 offen
Zb s19,s17,1138688
Za v55,v2,s[24:27],s19 offen
Zb s19,s17,1310720
Za v56,v2,s[24:27],s19 offen
Zb s19,s17,1318912
Za v57,v2,s[24:27],s19 offen
Zb s19,s17,1376256
Za v58,v2,s[24:27],s19 offen
Zb s19,s17,1384448
Za v59,v2,s[24:27],s19 offen
Zb s19,s17,1327104
Za v60,v2,s[24:27],s19 offen
Zb s19,s17,1335296
Za v61,v2,s[24:27],s19 offen
Zb s19,s17,1392640
Za v62,v2,s[24:27],s19 offen
Zb s19,s17,1400832
Za v63,v2,s[24:27],s19 offen
Zf vmcnt(46)
Zc v160,v17,v16,s22
Zf vmcnt(44)
Zc v161,v19,v18,s22
Zf vmcnt(42)
Zc v162,v21,v20,s22
Zf vmcnt(40)
Zc v163,v23,v22,s22
Zf vmcnt(38)
Zc v164,v25,v24,s22
Zf vmcnt(36)
Zc v165,v27,v26,s22
Zf vmcnt(34)
Zc v166,v29,v28,s22
Zf vmcnt(32)
Zc v167,v31,v30,s22
Zc v168,v17,v16,s23
Zc v169,v19,v18,s23
Zc v170,v21,v20,s23
Zc v171,v23,v22,s23
Zc v172,v25,v24,s23
Zc v173,v27,v26,s23
Zc v174,v29,v28,s23
Zc v175,v31,v30,s23
Zb s19,s17,1572864
Za v16,v2,s[24:27],s19 offen
Zb s19,s17,1581056
Za v17,v2,s[24:27],s19 offen
Zb s19,s17,1638400
Za v18,v2,s[24:27],s19 offen
Zb s19,s17,1646592
Za v19,v2,s[24:27],s19 offen
Zb s19,s17,1589248
Za v20,v2,s[24:27],s19 offen
Zb s19,s17,1597440
Za v21,v2,s[24:27],s19 offen
Zb s19,s17,1654784
Za v22,v2,s[24:27],s19 offen
Zb s19,s17,1662976
Za v23,v2,s[24:27],s19 offen
Zb s19,s17,1835008
Za v24,v2,s[24:27],s19 offen
Zb s19,s17,1843200
Za v25,v2,s[24:27],s19 offen
Zb s19,s17,1900544
Za v26,v2,s[24:27],s19 offen
Zb s19,s17,1908736
Za v27,v2,s[24:27],s19 offen
Zb s19,s17,1851392
Za v28,v2,s[24:27],s19 offen
Zb s19,s17,1859584
Za v29,v2,s[24:27],s19 offen
Zb s19,s17,1916928
Za v30,v2,s[24:27],s19 offen
Zb s19,s17,1925120
Za v31,v2,s[24:27],s19 offen
Zf vmcnt(46)
Zc v184,v33,v32,s22
Zf vmcnt(44)
Zc v185,v35,v34,s22
Zf vmcnt(42)
Zc v186,v37,v36,s22
Zf vmcnt(40)
Zc v187,v39,v38,s22
Zf vmcnt(38)
Zc v188,v41,v40,s22
Zf vmcnt(36)
Zc v189,v43,v42,s22
Zf vmcnt(34)
Zc v190,v45,v44,s22
Zf vmcnt(32)
Zc v191,v47,v46,s22
Zc v64,v33,v32,s23
Zc v65,v35,v34,s23
Zc v66,v37,v36,s23
Zc v67,v39,v38,s23
Zc v68,v41,v40,s23
Zc v69,v43,v42,s23
Zc v70,v45,v44,s23
Zc v71,v47,v46,s23
Zt v5,v[64:67] offset:6144
Zt v5,v[68:71] offset:7168
Zb s19,s17,2097152
Za v32,v2,s[24:27],s19 offen
Zb s19,s17,2105344
Za v33,v2,s[24:27],s19 offen
Zb s19,s17,2162688
Za v34,v2,s[24:27],s19 offen
Zb s19,s17,2170880
Za v35,v2,s[24:27],s19 offen
Zb s19,s17,2113536
Za v36,v2,s[24:27],s19 offen
Zb s19,s17,2121728
Za v37,v2,s[24:27],s19 offen
Zb s19,s17,2179072
Za v38,v2,s[24:27],s19 offen
Zb s19,s17,2187264
Za v39,v2,s[24:27],s19 offen
Zb s19,s17,2359296
Za v40,v2,s[24:27],s19 offen
Zb s19,s17,2367488
Za v41,v2,s[24:27],s19 offen
Zb s19,s17,2424832
Za v42,v2,s[24:27],s19 offen
Zb s19,s17,2433024
Za v43,v2,s[24:27],s19 offen
Zb s19,s17,2375680
Za v44,v2,s[24:27],s19 offen
Zb s19,s17,2383872
Za v45,v2,s[24:27],s19 offen
Zb s19,s17,2441216
Za v46,v2,s[24:27],s19 offen
Zb s19,s17,2449408
Za v47,v2,s[24:27],s19 offen
Zf vmcnt(46)
Zc v192,v49,v48,s22
Zf vmcnt(44)
Zc v193,v51,v50,s22
Zf vmcnt(42)
Zc v194,v53,v52,s22
Zf vmcnt(40)
Zc v195,v55,v54,s22
Zf vmcnt(38)
Zc v196,v57,v56,s22
Zf vmcnt(36)
Zc v197,v59,v58,s22
Zf vmcnt(34)
Zc v198,v61,v60,s22
Zf vmcnt(32)
Zc v199,v63,v62,s22
Zc v200,v49,v48,s23
Zc v201,v51,v50,s23
Zc v202,v53,v52,s23
Zc v203,v55,v54,s23
Zc v204,v57,v56,s23
Zc v205,v59,v58,s23
Zc v206,v61,v60,s23
Zc v207,v63,v62,s23
Zb s19,s17,2621440
Za v48,v2,s[24:27],s19 offen
Zb s19,s17,2629632
Za v49,v2,s[24:27],s19 offen
Zb s19,s17,2686976
Za v50,v2,s[24:27],s19 offen
Zb s19,s17,2695168
Za v51,v2,s[24:27],s19 offen
Zb s19,s17,2637824
Za v52,v2,s[24:27],s19 offen
Zb s19,s17,2646016
Za v53,v2,s[24:27],s19 offen
Zb s19,s17,2703360
Za v54,v2,s[24:27],s19 offen
Zb s19,s17,2711552
Za v55,v2,s[24:27],s19 offen
Zb s19,s17,2883584
Za v56,v2,s[24:27],s19 offen
Zb s19,s17,2891776
Za v57,v2,s[24:27],s19 offen
Zb s19,s17,2949120
Za v58,v2,s[24:27],s19 offen
Zb s19,s17,2957312
Za v59,v2,s[24:27],s19 offen
Zb s19,s17,2899968
Za v60,v2,s[24:27],s19 offen
Zb s19,s17,2908160
Za v61,v2,s[24:27],s19 offen
Zb s19,s17,2965504
Za v62,v2,s[24:27],s19 offen
Zb s19,s17,2973696
Za v63,v2,s[24:27],s19 offen
Zf vmcnt(46)
Zc v72,v17,v16,s22
Zf vmcnt(44)
Zc v73,v19,v18,s22
Zf vmcnt(42)
Zc v74,v21,v20,s22
Zf vmcnt(40)
Zc v75,v23,v22,s22
Zf vmcnt(38)
Zc v76,v25,v24,s22
Zf vmcnt(36)
Zc v77,v27,v26,s22
Zf vmcnt(34)
Zc v78,v29,v28,s22
Zf vmcnt(32)
Zc v79,v31,v30,s22
Zb s19,s18,0
Zr v[72:75],v0,s[4:7],s19 offen
Zr v[76:79],v0,s[4:7],s19 offen offset:1024
Zc v64,v17,v16,s23
Zc v65,v19,v18,s23
Zc v66,v21,v20,s23
Zc v67,v23,v22,s23
Zc v68,v25,v24,s23
Zc v69,v27,v26,s23
Zc v70,v29,v28,s23
Zc v71,v31,v30,s23
Zb s19,s18,6144
Zr v[64:67],v0,s[4:7],s19 offen
Zr v[68:71],v0,s[4:7],s19 offen offset:1024
Zb s19,s17,3145728
Za v16,v2,s[24:27],s19 offen
Zb s19,s17,3153920
Za v17,v2,s[24:27],s19 offen
Zb s19,s17,3211264
Za v18,v2,s[24:27],s19 offen
Zb s19,s17,3219456
Za v19,v2,s[24:27],s19 offen
Zb s19,s17,3162112
Za v20,v2,s[24:27],s19 offen
Zb s19,s17,3170304
Za v21,v2,s[24:27],s19 offen
Zb s19,s17,3227648
Za v22,v2,s[24:27],s19 offen
Zb s19,s17,3235840
Za v23,v2,s[24:27],s19 offen
Zb s19,s17,3407872
Za v24,v2,s[24:27],s19 offen
Zb s19,s17,3416064
Za v25,v2,s[24:27],s19 offen
Zb s19,s17,3473408
Za v26,v2,s[24:27],s19 offen
Zb s19,s17,3481600
Za v27,v2,s[24:27],s19 offen
Zb s19,s17,3424256
Za v28,v2,s[24:27],s19 offen
Zb s19,s17,3432448
Za v29,v2,s[24:27],s19 offen
Zb s19,s17,3489792
Za v30,v2,s[24:27],s19 offen
Zb s19,s17,3497984
Za v31,v2,s[24:27],s19 offen
Zf vmcnt(50)
Zc v72,v33,v32,s22
Zf vmcnt(48)
Zc v73,v35,v34,s22
Zf vmcnt(46)
Zc v74,v37,v36,s22
Zf vmcnt(44)
Zc v75,v39,v38,s22
Zf vmcnt(42)
Zc v76,v41,v40,s22
Zf vmcnt(40)
Zc v77,v43,v42,s22
Zf vmcnt(38)
Zc v78,v45,v44,s22
Zf vmcnt(36)
Zc v79,v47,v46,s22
Zd a144,v72
Zd a145,v73
Zd a146,v74
Zd a147,v75
Zd a148,v76
Zd a149,v77
Zd a150,v78
Zd a151,v79
Zc v64,v33,v32,s23
Zc v65,v35,v34,s23
Zc v66,v37,v36,s23
Zc v67,v39,v38,s23
Zc v68,v41,v40,s23
Zc v69,v43,v42,s23
Zc v70,v45,v44,s23
Zc v71,v47,v46,s23
Zt v5,v[64:67] offset:2048
Zt v5,v[68:71] offset:3072
Zb s19,s17,3670016
Za v32,v2,s[24:27],s19 offen
Zb s19,s17,3678208
Za v33,v2,s[24:27],s19 offen
Zb s19,s17,3735552
Za v34,v2,s[24:27],s19 offen
Zb s19,s17,3743744
Za v35,v2,s[24:27],s19 offen
Zb s19,s17,3686400
Za v36,v2,s[24:27],s19 offen
Zb s19,s17,3694592
Za v37,v2,s[24:27],s19 offen
Zb s19,s17,3751936
Za v38,v2,s[24:27],s19 offen
Zb s19,s17,3760128
Za v39,v2,s[24:27],s19 offen
Zb s19,s17,3932160
Za v40,v2,s[24:27],s19 offen
Zb s19,s17,3940352
Za v41,v2,s[24:27],s19 offen
Zb s19,s17,3997696
Za v42,v2,s[24:27],s19 offen
Zb s19,s17,4005888
Za v43,v2,s[24:27],s19 offen
Zb s19,s17,3948544
Za v44,v2,s[24:27],s19 offen
Zb s19,s17,3956736
Za v45,v2,s[24:27],s19 offen
Zb s19,s17,4014080
Za v46,v2,s[24:27],s19 offen
Zb s19,s17,4022272
Za v47,v2,s[24:27],s19 offen
Zf vmcnt(50)
Zc v72,v49,v48,s22
Zf vmcnt(48)
Zc v73,v51,v50,s22
Zf vmcnt(46)
Zc v74,v53,v52,s22
Zf vmcnt(44)
Zc v75,v55,v54,s22
Zf vmcnt(42)
Zc v76,v57,v56,s22
Zf vmcnt(40)
Zc v77,v59,v58,s22
Zf vmcnt(38)
Zc v78,v61,v60,s22
Zf vmcnt(36)
Zc v79,v63,v62,s22
Zd a168,v72
Zd a169,v73
Zd a170,v74
Zd a171,v75
Zd a172,v76
Zd a173,v77
Zd a174,v78
Zd a175,v79
Zc v64,v49,v48,s23
Zc v65,v51,v50,s23
Zc v66,v53,v52,s23
Zc v67,v55,v54,s23
Zc v68,v57,v56,s23
Zc v69,v59,v58,s23
Zc v70,v61,v60,s23
Zc v71,v63,v62,s23
Zt v5,v[64:67] offset:12288
Zt v5,v[68:71] offset:13312
Zb s19,s17,4194304
Za v48,v2,s[24:27],s19 offen
Zb s19,s17,4202496
Za v49,v2,s[24:27],s19 offen
Zb s19,s17,4259840
Za v50,v2,s[24:27],s19 offen
Zb s19,s17,4268032
Za v51,v2,s[24:27],s19 offen
Zb s19,s17,4210688
Za v52,v2,s[24:27],s19 offen
Zb s19,s17,4218880
Za v53,v2,s[24:27],s19 offen
Zb s19,s17,4276224
Za v54,v2,s[24:27],s19 offen
Zb s19,s17,4284416
Za v55,v2,s[24:27],s19 offen
Zb s19,s17,4456448
Za v56,v2,s[24:27],s19 offen
Zb s19,s17,4464640
Za v57,v2,s[24:27],s19 offen
Zb s19,s17,4521984
Za v58,v2,s[24:27],s19 offen
Zb s19,s17,4530176
Za v59,v2,s[24:27],s19 offen
Zb s19,s17,4472832
Za v60,v2,s[24:27],s19 offen
Zb s19,s17,4481024
Za v61,v2,s[24:27],s19 offen
Zb s19,s17,4538368
Za v62,v2,s[24:27],s19 offen
Zb s19,s17,4546560
Za v63,v2,s[24:27],s19 offen
Zf vmcnt(46)
Zc v72,v17,v16,s22
Zf vmcnt(44)
Zc v73,v19,v18,s22
Zf vmcnt(42)
Zc v74,v21,v20,s22
Zf vmcnt(40)
Zc v75,v23,v22,s22
Zf vmcnt(38)
Zc v76,v25,v24,s22
Zf vmcnt(36)
Zc v77,v27,v26,s22
Zf vmcnt(34)
Zc v78,v29,v28,s22
Zf vmcnt(32)
Zc v79,v31,v30,s22
Zd a200,v72
Zd a201,v73
Zd a202,v74
Zd a203,v75
Zd a204,v76
Zd a205,v77
Zd a206,v78
Zd a207,v79
Zc v64,v17,v16,s23
Zc v65,v19,v18,s23
Zc v66,v21,v20,s23
Zc v67,v23,v22,s23
Zc v68,v25,v24,s23
Zc v69,v27,v26,s23
Zc v70,v29,v28,s23
Zc v71,v31,v30,s23
Zt v5,v[64:67] offset:14336
Zt v5,v[68:71] offset:15360
Zb s19,s17,4718592
Za v16,v2,s[24:27],s19 offen
Zb s19,s17,4726784
Za v17,v2,s[24:27],s19 offen
Zb s19,s17,4784128
Za v18,v2,s[24:27],s19 offen
Zb s19,s17,4792320
Za v19,v2,s[24:27],s19 offen
Zb s19,s17,4734976
Za v20,v2,s[24:27],s19 offen
Zb s19,s17,4743168
Za v21,v2,s[24:27],s19 offen
Zb s19,s17,4800512
Za v22,v2,s[24:27],s19 offen
Zb s19,s17,4808704
Za v23,v2,s[24:27],s19 offen
Zb s19,s17,4980736
Za v24,v2,s[24:27],s19 offen
Zb s19,s17,4988928
Za v25,v2,s[24:27],s19 offen
Zb s19,s17,5046272
Za v26,v2,s[24:27],s19 offen
Zb s19,s17,5054464
Za v27,v2,s[24:27],s19 offen
Zb s19,s17,4997120
Za v28,v2,s[24:27],s19 offen
Zb s19,s17,5005312
Za v29,v2,s[24:27],s19 offen
Zb s19,s17,5062656
Za v30,v2,s[24:27],s19 offen
Zb s19,s17,5070848
Za v31,v2,s[24:27],s19 offen
Zf vmcnt(46)
Zc v72,v33,v32,s22
Zf vmcnt(44)
Zc v73,v35,v34,s22
Zf vmcnt(42)
Zc v74,v37,v36,s22
Zf vmcnt(40)
Zc v75,v39,v38,s22
Zf vmcnt(38)
Zc v76,v41,v40,s22
Zf vmcnt(36)
Zc v77,v43,v42,s22
Zf vmcnt(34)
Zc v78,v45,v44,s22
Zf vmcnt(32)
Zc v79,v47,v46,s22
Zd a232,v72
Zd a233,v73
Zd a234,v74
Zd a235,v75
Zd a236,v76
Zd a237,v77
Zd a238,v78
Zd a239,v79
Zc v64,v33,v32,s23
Zc v65,v35,v34,s23
Zc v66,v37,v36,s23
Zc v67,v39,v38,s23
Zc v68,v41,v40,s23
Zc v69,v43,v42,s23
Zc v70,v45,v44,s23
Zc v71,v47,v46,s23
Zd a240,v64
Zd a241,v65
Zd a242,v66
Zd a243,v67
Zd a244,v68
Zd a245,v69
Zd a246,v70
Zd a247,v71
Zb s19,s17,0
Za v32,v2,s[28:31],s19 offen
Zb s19,s17,8192
Za v33,v2,s[28:31],s19 offen
Zb s19,s17,65536
Za v34,v2,s[28:31],s19 offen
Zb s19,s17,73728
Za v35,v2,s[28:31],s19 offen
Zb s19,s17,16384
Za v36,v2,s[28:31],s19 offen
Zb s19,s17,24576
Za v37,v2,s[28:31],s19 offen
Zb s19,s17,81920
Za v38,v2,s[28:31],s19 offen
Zb s19,s17,90112
Za v39,v2,s[28:31],s19 offen
Zb s19,s17,262144
Za v40,v2,s[28:31],s19 offen
Zb s19,s17,270336
Za v41,v2,s[28:31],s19 offen
Zb s19,s17,327680
Za v42,v2,s[28:31],s19 offen
Zb s19,s17,335872
Za v43,v2,s[28:31],s19 offen
Zb s19,s17,278528
Za v44,v2,s[28:31],s19 offen
Zb s19,s17,286720
Za v45,v2,s[28:31],s19 offen
Zb s19,s17,344064
Za v46,v2,s[28:31],s19 offen
Zb s19,s17,352256
Za v47,v2,s[28:31],s19 offen
Zf vmcnt(46)
Zc v88,v49,v48,s22
Zf vmcnt(44)
Zc v89,v51,v50,s22
Zf vmcnt(42)
Zc v90,v53,v52,s22
Zf vmcnt(40)
Zc v91,v55,v54,s22
Zf vmcnt(38)
Zc v92,v57,v56,s22
Zf vmcnt(36)
Zc v93,v59,v58,s22
Zf vmcnt(34)
Zc v94,v61,v60,s22
Zf vmcnt(32)
Zc v95,v63,v62,s22
Zc v96,v49,v48,s23
Zc v97,v51,v50,s23
Zc v98,v53,v52,s23
Zc v99,v55,v54,s23
Zc v100,v57,v56,s23
Zc v101,v59,v58,s23
Zc v102,v61,v60,s23
Zc v103,v63,v62,s23
Zb s19,s17,524288
Za v48,v2,s[28:31],s19 offen
Zb s19,s17,532480
Za v49,v2,s[28:31],s19 offen
Zb s19,s17,589824
Za v50,v2,s[28:31],s19 offen
Zb s19,s17,598016
Za v51,v2,s[28:31],s19 offen
Zb s19,s17,540672
Za v52,v2,s[28:31],s19 offen
Zb s19,s17,548864
Za v53,v2,s[28:31],s19 offen
Zb s19,s17,606208
Za v54,v2,s[28:31],s19 offen
Zb s19,s17,614400
Za v55,v2,s[28:31],s19 offen
Zb s19,s17,786432
Za v56,v2,s[28:31],s19 offen
Zb s19,s17,794624
Za v57,v2,s[28:31],s19 offen
Zb s19,s17,851968
Za v58,v2,s[28:31],s19 offen
Zb s19,s17,860160
Za v59,v2,s[28:31],s19 offen
Zb s19,s17,802816
Za v60,v2,s[28:31],s19 offen
Zb s19,s17,811008
Za v61,v2,s[28:31],s19 offen
Zb s19,s17,868352
Za v62,v2,s[28:31],s19 offen
Zb s19,s17,876544
Za v63,v2,s[28:31],s19 offen
Zf vmcnt(46)
Zc v120,v17,v16,s22
Zf vmcnt(44)
Zc v121,v19,v18,s22
Zf vmcnt(42)
Zc v122,v21,v20,s22
Zf vmcnt(40)
Zc v123,v23,v22,s22
Zf vmcnt(38)
Zc v124,v25,v24,s22
Zf vmcnt(36)
Zc v125,v27,v26,s22
Zf vmcnt(34)
Zc v126,v29,v28,s22
Zf vmcnt(32)
Zc v127,v31,v30,s22
Zc v128,v17,v16,s23
Zc v129,v19,v18,s23
Zc v130,v21,v20,s23
Zc v131,v23,v22,s23
Zc v132,v25,v24,s23
Zc v133,v27,v26,s23
Zc v134,v29,v28,s23
Zc v135,v31,v30,s23
Zb s19,s17,1048576
Za v16,v2,s[28:31],s19 offen
Zb s19,s17,1056768
Za v17,v2,s[28:31],s19 offen
Zb s19,s17,1114112
Za v18,v2,s[28:31],s19 offen
Zb s19,s17,1122304
Za v19,v2,s[28:31],s19 offen
Zb s19,s17,1064960
Za v20,v2,s[28:31],s19 offen
Zb s19,s17,1073152
Za v21,v2,s[28:31],s19 offen
Zb s19,s17,1130496
Za v22,v2,s[28:31],s19 offen
Zb s19,s17,1138688
Za v23,v2,s[28:31],s19 offen
Zb s19,s17,1310720
Za v24,v2,s[28:31],s19 offen
Zb s19,s17,1318912
Za v25,v2,s[28:31],s19 offen
Zb s19,s17,1376256
Za v26,v2,s[28:31],s19 offen
Zb s19,s17,1384448
Za v27,v2,s[28:31],s19 offen
Zb s19,s17,1327104
Za v28,v2,s[28:31],s19 offen
Zb s19,s17,1335296
Za v29,v2,s[28:31],s19 offen
Zb s19,s17,1392640
Za v30,v2,s[28:31],s19 offen
Zb s19,s17,1400832
Za v31,v2,s[28:31],s19 offen
Zf vmcnt(46)
Zc v176,v33,v32,s22
Zf vmcnt(44)
Zc v177,v35,v34,s22
Zf vmcnt(42)
Zc v178,v37,v36,s22
Zf vmcnt(40)
Zc v179,v39,v38,s22
Zf vmcnt(38)
Zc v180,v41,v40,s22
Zf vmcnt(36)
Zc v181,v43,v42,s22
Zf vmcnt(34)
Zc v182,v45,v44,s22
Zf vmcnt(32)
Zc v183,v47,v46,s22
Zc v64,v33,v32,s23
Zc v65,v35,v34,s23
Zc v66,v37,v36,s23
Zc v67,v39,v38,s23
Zc v68,v41,v40,s23
Zc v69,v43,v42,s23
Zc v70,v45,v44,s23
Zc v71,v47,v46,s23
Zb s19,s18,12288
Zr v[64:67],v0,s[4:7],s19 offen
Zr v[68:71],v0,s[4:7],s19 offen offset:1024
Zb s19,s17,1572864
Za v32,v2,s[28:31],s19 offen
Zb s19,s17,1581056
Za v33,v2,s[28:31],s19 offen
Zb s19,s17,1638400
Za v34,v2,s[28:31],s19 offen
Zb s19,s17,1646592
Za v35,v2,s[28:31],s19 offen
Zb s19,s17,1589248
Za v36,v2,s[28:31],s19 offen
Zb s19,s17,1597440
Za v37,v2,s[28:31],s19 offen
Zb s19,s17,1654784
Za v38,v2,s[28:31],s19 offen
Zb s19,s17,1662976
Za v39,v2,s[28:31],s19 offen
Zb s19,s17,1835008
Za v40,v2,s[28:31],s19 offen
Zb s19,s17,1843200
Za v41,v2,s[28:31],s19 offen
Zb s19,s17,1900544
Za v42,v2,s[28:31],s19 offen
Zb s19,s17,1908736
Za v43,v2,s[28:31],s19 offen
Zb s19,s17,1851392
Za v44,v2,s[28:31],s19 offen
Zb s19,s17,1859584
Za v45,v2,s[28:31],s19 offen
Zb s19,s17,1916928
Za v46,v2,s[28:31],s19 offen
Zb s19,s17,1925120
Za v47,v2,s[28:31],s19 offen
Zf vmcnt(48)
Zc v208,v49,v48,s22
Zf vmcnt(46)
Zc v209,v51,v50,s22
Zf vmcnt(44)
Zc v210,v53,v52,s22
Zf vmcnt(42)
Zc v211,v55,v54,s22
Zf vmcnt(40)
Zc v212,v57,v56,s22
Zf vmcnt(38)
Zc v213,v59,v58,s22
Zf vmcnt(36)
Zc v214,v61,v60,s22
Zf vmcnt(34)
Zc v215,v63,v62,s22
Zc v64,v49,v48,s23
Zc v65,v51,v50,s23
Zc v66,v53,v52,s23
Zc v67,v55,v54,s23
Zc v68,v57,v56,s23
Zc v69,v59,v58,s23
Zc v70,v61,v60,s23
Zc v71,v63,v62,s23
Zt v5,v[64:67] offset:16384
Zt v5,v[68:71] offset:17408
Zb s19,s17,2097152
Za v48,v2,s[28:31],s19 offen
Zb s19,s17,2105344
Za v49,v2,s[28:31],s19 offen
Zb s19,s17,2162688
Za v50,v2,s[28:31],s19 offen
Zb s19,s17,2170880
Za v51,v2,s[28:31],s19 offen
Zb s19,s17,2113536
Za v52,v2,s[28:31],s19 offen
Zb s19,s17,2121728
Za v53,v2,s[28:31],s19 offen
Zb s19,s17,2179072
Za v54,v2,s[28:31],s19 offen
Zb s19,s17,2187264
Za v55,v2,s[28:31],s19 offen
Zb s19,s17,2359296
Za v56,v2,s[28:31],s19 offen
Zb s19,s17,2367488
Za v57,v2,s[28:31],s19 offen
Zb s19,s17,2424832
Za v58,v2,s[28:31],s19 offen
Zb s19,s17,2433024
Za v59,v2,s[28:31],s19 offen
Zb s19,s17,2375680
Za v60,v2,s[28:31],s19 offen
Zb s19,s17,2383872
Za v61,v2,s[28:31],s19 offen
Zb s19,s17,2441216
Za v62,v2,s[28:31],s19 offen
Zb s19,s17,2449408
Za v63,v2,s[28:31],s19 offen
Zf vmcnt(48)
Zc v72,v17,v16,s22
Zf vmcnt(46)
Zc v73,v19,v18,s22
Zf vmcnt(44)
Zc v74,v21,v20,s22
Zf vmcnt(42)
Zc v75,v23,v22,s22
Zf vmcnt(40)
Zc v76,v25,v24,s22
Zf vmcnt(38)
Zc v77,v27,v26,s22
Zf vmcnt(36)
Zc v78,v29,v28,s22
Zf vmcnt(34)
Zc v79,v31,v30,s22
Zb s19,s18,16384
Zr v[72:75],v0,s[4:7],s19 offen
Zr v[76:79],v0,s[4:7],s19 offen offset:1024
Zc v64,v17,v16,s23
Zc v65,v19,v18,s23
Zc v66,v21,v20,s23
Zc v67,v23,v22,s23
Zc v68,v25,v24,s23
Zc v69,v27,v26,s23
Zc v70,v29,v28,s23
Zc v71,v31,v30,s23
Zt v5,v[64:67] offset:8192
Zt v5,v[68:71] offset:9216
Zb s19,s17,2621440
Za v16,v2,s[28:31],s19 offen
Zb s19,s17,2629632
Za v17,v2,s[28:31],s19 offen
Zb s19,s17,2686976
Za v18,v2,s[28:31],s19 offen
Zb s19,s17,2695168
Za v19,v2,s[28:31],s19 offen
Zb s19,s17,2637824
Za v20,v2,s[28:31],s19 offen
Zb s19,s17,2646016
Za v21,v2,s[28:31],s19 offen
Zb s19,s17,2703360
Za v22,v2,s[28:31],s19 offen
Zb s19,s17,2711552
Za v23,v2,s[28:31],s19 offen
Zb s19,s17,2883584
Za v24,v2,s[28:31],s19 offen
Zb s19,s17,2891776
Za v25,v2,s[28:31],s19 offen
Zb s19,s17,2949120
Za v26,v2,s[28:31],s19 offen
Zb s19,s17,2957312
Za v27,v2,s[28:31],s19 offen
Zb s19,s17,2899968
Za v28,v2,s[28:31],s19 offen
Zb s19,s17,2908160
Za v29,v2,s[28:31],s19 offen
Zb s19,s17,2965504
Za v30,v2,s[28:31],s19 offen
Zb s19,s17,2973696
Za v31,v2,s[28:31],s19 offen
Zf vmcnt(48)
Zc v72,v33,v32,s22
Zf vmcnt(46)
Zc v73,v35,v34,s22
Zf vmcnt(44)
Zc v74,v37,v36,s22
Zf vmcnt(42)
Zc v75,v39,v38,s22
Zf vmcnt(40)
Zc v76,v41,v40,s22
Zf vmcnt(38)
Zc v77,v43,v42,s22
Zf vmcnt(36)
Zc v78,v45,v44,s22
Zf vmcnt(34)
Zc v79,v47,v46,s22
Zb s19,s18,10240
Zr v[72:75],v0,s[4:7],s19 offen
Zr v[76:79],v0,s[4:7],s19 offen offset:1024
Zc v64,v33,v32,s23
Zc v65,v35,v34,s23
Zc v66,v37,v36,s23
Zc v67,v39,v38,s23
Zc v68,v41,v40,s23
Zc v69,v43,v42,s23
Zc v70,v45,v44,s23
Zc v71,v47,v46,s23
Zb s19,s18,14336
Zr v[64:67],v0,s[4:7],s19 offen
Zr v[68:71],v0,s[4:7],s19 offen offset:1024
Zb s19,s17,3145728
Za v32,v2,s[28:31],s19 offen
Zb s19,s17,3153920
Za v33,v2,s[28:31],s19 offen
Zb s19,s17,3211264
Za v34,v2,s[28:31],s19 offen
Zb s19,s17,3219456
Za v35,v2,s[28:31],s19 offen
Zb s19,s17,3162112
Za v36,v2,s[28:31],s19 offen
Zb s19,s17,3170304
Za v37,v2,s[28:31],s19 offen
Zb s19,s17,3227648
Za v38,v2,s[28:31],s19 offen
Zb s19,s17,3235840
Za v39,v2,s[28:31],s19 offen
Zb s19,s17,3407872
Za v40,v2,s[28:31],s19 offen
Zb s19,s17,3416064
Za v41,v2,s[28:31],s19 offen
Zb s19,s17,3473408
Za v42,v2,s[28:31],s19 offen
Zb s19,s17,3481600
Za v43,v2,s[28:31],s19 offen
Zb s19,s17,3424256
Za v44,v2,s[28:31],s19 offen
Zb s19,s17,3432448
Za v45,v2,s[28:31],s19 offen
Zb s19,s17,3489792
Za v46,v2,s[28:31],s19 offen
Zb s19,s17,3497984
Za v47,v2,s[28:31],s19 offen
Zf vmcnt(52)
Zc v72,v49,v48,s22
Zf vmcnt(50)
Zc v73,v51,v50,s22
Zf vmcnt(48)
Zc v74,v53,v52,s22
Zf vmcnt(46)
Zc v75,v55,v54,s22
Zf vmcnt(44)
Zc v76,v57,v56,s22
Zf vmcnt(42)
Zc v77,v59,v58,s22
Zf vmcnt(40)
Zc v78,v61,v60,s22
Zf vmcnt(38)
Zc v79,v63,v62,s22
Zt v5,v[72:75] offset:10240
Zt v5,v[76:79] offset:11264
Zc v64,v49,v48,s23
Zc v65,v51,v50,s23
Zc v66,v53,v52,s23
Zc v67,v55,v54,s23
Zc v68,v57,v56,s23
Zc v69,v59,v58,s23
Zc v70,v61,v60,s23
Zc v71,v63,v62,s23
Zt v5,v[64:67] offset:18432
Zt v5,v[68:71] offset:19456
Zb s19,s17,3670016
Za v48,v2,s[28:31],s19 offen
Zb s19,s17,3678208
Za v49,v2,s[28:31],s19 offen
Zb s19,s17,3735552
Za v50,v2,s[28:31],s19 offen
Zb s19,s17,3743744
Za v51,v2,s[28:31],s19 offen
Zb s19,s17,3686400
Za v52,v2,s[28:31],s19 offen
Zb s19,s17,3694592
Za v53,v2,s[28:31],s19 offen
Zb s19,s17,3751936
Za v54,v2,s[28:31],s19 offen
Zb s19,s17,3760128
Za v55,v2,s[28:31],s19 offen
Zb s19,s17,3932160
Za v56,v2,s[28:31],s19 offen
Zb s19,s17,3940352
Za v57,v2,s[28:31],s19 offen
Zb s19,s17,3997696
Za v58,v2,s[28:31],s19 offen
Zb s19,s17,4005888
Za v59,v2,s[28:31],s19 offen
Zb s19,s17,3948544
Za v60,v2,s[28:31],s19 offen
Zb s19,s17,3956736
Za v61,v2,s[28:31],s19 offen
Zb s19,s17,4014080
Za v62,v2,s[28:31],s19 offen
Zb s19,s17,4022272
Za v63,v2,s[28:31],s19 offen
Zf vmcnt(50)
Zc v72,v17,v16,s22
Zf vmcnt(48)
Zc v73,v19,v18,s22
Zf vmcnt(46)
Zc v74,v21,v20,s22
Zf vmcnt(44)
Zc v75,v23,v22,s22
Zf vmcnt(42)
Zc v76,v25,v24,s22
Zf vmcnt(40)
Zc v77,v27,v26,s22
Zf vmcnt(38)
Zc v78,v29,v28,s22
Zf vmcnt(36)
Zc v79,v31,v30,s22
Zd a176,v72
Zd a177,v73
Zd a178,v74
Zd a179,v75
Zd a180,v76
Zd a181,v77
Zd a182,v78
Zd a183,v79
Zc v64,v17,v16,s23
Zc v65,v19,v18,s23
Zc v66,v21,v20,s23
Zc v67,v23,v22,s23
Zc v68,v25,v24,s23
Zc v69,v27,v26,s23
Zc v70,v29,v28,s23
Zc v71,v31,v30,s23
Zt v5,v[64:67] offset:20480
Zt v5,v[68:71] offset:21504
Zb s19,s17,4194304
Za v16,v2,s[28:31],s19 offen
Zb s19,s17,4202496
Za v17,v2,s[28:31],s19 offen
Zb s19,s17,4259840
Za v18,v2,s[28:31],s19 offen
Zb s19,s17,4268032
Za v19,v2,s[28:31],s19 offen
Zb s19,s17,4210688
Za v20,v2,s[28:31],s19 offen
Zb s19,s17,4218880
Za v21,v2,s[28:31],s19 offen
Zb s19,s17,4276224
Za v22,v2,s[28:31],s19 offen
Zb s19,s17,4284416
Za v23,v2,s[28:31],s19 offen
Zb s19,s17,4456448
Za v24,v2,s[28:31],s19 offen
Zb s19,s17,4464640
Za v25,v2,s[28:31],s19 offen
Zb s19,s17,4521984
Za v26,v2,s[28:31],s19 offen
Zb s19,s17,4530176
Za v27,v2,s[28:31],s19 offen
Zb s19,s17,4472832
Za v28,v2,s[28:31],s19 offen
Zb s19,s17,4481024
Za v29,v2,s[28:31],s19 offen
Zb s19,s17,4538368
Za v30,v2,s[28:31],s19 offen
Zb s19,s17,4546560
Za v31,v2,s[28:31],s19 offen
Zf vmcnt(46)
Zc v72,v33,v32,s22
Zf vmcnt(44)
Zc v73,v35,v34,s22
Zf vmcnt(42)
Zc v74,v37,v36,s22
Zf vmcnt(40)
Zc v75,v39,v38,s22
Zf vmcnt(38)
Zc v76,v41,v40,s22
Zf vmcnt(36)
Zc v77,v43,v42,s22
Zf vmcnt(34)
Zc v78,v45,v44,s22
Zf vmcnt(32)
Zc v79,v47,v46,s22
Zd a208,v72
Zd a209,v73
Zd a210,v74
Zd a211,v75
Zd a212,v76
Zd a213,v77
Zd a214,v78
Zd a215,v79
Zc v64,v33,v32,s23
Zc v65,v35,v34,s23
Zc v66,v37,v36,s23
Zc v67,v39,v38,s23
Zc v68,v41,v40,s23
Zc v69,v43,v42,s23
Zc v70,v45,v44,s23
Zc v71,v47,v46,s23
Zt v5,v[64:67] offset:22528
Zt v5,v[68:71] offset:23552
Zb s19,s17,4718592
Za v32,v2,s[28:31],s19 offen
Zb s19,s17,4726784
Za v33,v2,s[28:31],s19 offen
Zb s19,s17,4784128
Za v34,v2,s[28:31],s19 offen
Zb s19,s17,4792320
Za v35,v2,s[28:31],s19 offen
Zb s19,s17,4734976
Za v36,v2,s[28:31],s19 offen
Zb s19,s17,4743168
Za v37,v2,s[28:31],s19 offen
Zb s19,s17,4800512
Za v38,v2,s[28:31],s19 offen
Zb s19,s17,4808704
Za v39,v2,s[28:31],s19 offen
Zb s19,s17,4980736
Za v40,v2,s[28:31],s19 offen
Zb s19,s17,4988928
Za v41,v2,s[28:31],s19 offen
Zb s19,s17,5046272
Za v42,v2,s[28:31],s19 offen
Zb s19,s17,5054464
Za v43,v2,s[28:31],s19 offen
Zb s19,s17,4997120
Za v44,v2,s[28:31],s19 offen
Zb s19,s17,5005312
Za v45,v2,s[28:31],s19 offen
Zb s19,s17,5062656
Za v46,v2,s[28:31],s19 offen
Zb s19,s17,5070848
Za v47,v2,s[28:31],s19 offen
Zf vmcnt(46)
Zc v72,v49,v48,s22
Zf vmcnt(44)
Zc v73,v51,v50,s22
Zf vmcnt(42)
Zc v74,v53,v52,s22
Zf vmcnt(40)
Zc v75,v55,v54,s22
Zf vmcnt(38)
Zc v76,v57,v56,s22
Zf vmcnt(36)
Zc v77,v59,v58,s22
Zf vmcnt(34)
Zc v78,v61,v60,s22
Zf vmcnt(32)
Zc v79,v63,v62,s22
Zb s19,s18,2048
Zr v[72:75],v0,s[4:7],s19 offen
Zr v[76:79],v0,s[4:7],s19 offen offset:1024
Zc v64,v49,v48,s23
Zc v65,v51,v50,s23
Zc v66,v53,v52,s23
Zc v67,v55,v54,s23
Zc v68,v57,v56,s23
Zc v69,v59,v58,s23
Zc v70,v61,v60,s23
Zc v71,v63,v62,s23
Zt v5,v[64:67] offset:24576
Zt v5,v[68:71] offset:25600
Zb s19,s17,0
Za v48,v2,s[32:35],s19 offen
Zb s19,s17,8192
Za v49,v2,s[32:35],s19 offen
Zb s19,s17,65536
Za v50,v2,s[32:35],s19 offen
Zb s19,s17,73728
Za v51,v2,s[32:35],s19 offen
Zb s19,s17,16384
Za v52,v2,s[32:35],s19 offen
Zb s19,s17,24576
Za v53,v2,s[32:35],s19 offen
Zb s19,s17,81920
Za v54,v2,s[32:35],s19 offen
Zb s19,s17,90112
Za v55,v2,s[32:35],s19 offen
Zb s19,s17,262144
Za v56,v2,s[32:35],s19 offen
Zb s19,s17,270336
Za v57,v2,s[32:35],s19 offen
Zb s19,s17,327680
Za v58,v2,s[32:35],s19 offen
Zb s19,s17,335872
Za v59,v2,s[32:35],s19 offen
Zb s19,s17,278528
Za v60,v2,s[32:35],s19 offen
Zb s19,s17,286720
Za v61,v2,s[32:35],s19 offen
Zb s19,s17,344064
Za v62,v2,s[32:35],s19 offen
Zb s19,s17,352256
Za v63,v2,s[32:35],s19 offen
Zf vmcnt(48)
Zc v72,v17,v16,s22
Zf vmcnt(46)
Zc v73,v19,v18,s22
Zf vmcnt(44)
Zc v74,v21,v20,s22
Zf vmcnt(42)
Zc v75,v23,v22,s22
Zf vmcnt(40)
Zc v76,v25,v24,s22
Zf vmcnt(38)
Zc v77,v27,v26,s22
Zf vmcnt(36)
Zc v78,v29,v28,s22
Zf vmcnt(34)
Zc v79,v31,v30,s22
Zt v5,v[72:75] offset:0
Zt v5,v[76:79] offset:1024
Zc v104,v17,v16,s23
Zc v105,v19,v18,s23
Zc v106,v21,v20,s23
Zc v107,v23,v22,s23
Zc v108,v25,v24,s23
Zc v109,v27,v26,s23
Zc v110,v29,v28,s23
Zc v111,v31,v30,s23
Zb s19,s17,524288
Za v16,v2,s[32:35],s19 offen
Zb s19,s17,532480
Za v17,v2,s[32:35],s19 offen
Zb s19,s17,589824
Za v18,v2,s[32:35],s19 offen
Zb s19,s17,598016
Za v19,v2,s[32:35],s19 offen
Zb s19,s17,540672
Za v20,v2,s[32:35],s19 offen
Zb s19,s17,548864
Za v21,v2,s[32:35],s19 offen
Zb s19,s17,606208
Za v22,v2,s[32:35],s19 offen
Zb s19,s17,614400
Za v23,v2,s[32:35],s19 offen
Zb s19,s17,786432
Za v24,v2,s[32:35],s19 offen
Zb s19,s17,794624
Za v25,v2,s[32:35],s19 offen
Zb s19,s17,851968
Za v26,v2,s[32:35],s19 offen
Zb s19,s17,860160
Za v27,v2,s[32:35],s19 offen
Zb s19,s17,802816
Za v28,v2,s[32:35],s19 offen
Zb s19,s17,811008
Za v29,v2,s[32:35],s19 offen
Zb s19,s17,868352
Za v30,v2,s[32:35],s19 offen
Zb s19,s17,876544
Za v31,v2,s[32:35],s19 offen
Zf vmcnt(48)
Zc v136,v33,v32,s22
Zf vmcnt(46)
Zc v137,v35,v34,s22
Zf vmcnt(44)
Zc v138,v37,v36,s22
Zf vmcnt(42)
Zc v139,v39,v38,s22
Zf vmcnt(40)
Zc v140,v41,v40,s22
Zf vmcnt(38)
Zc v141,v43,v42,s22
Zf vmcnt(36)
Zc v142,v45,v44,s22
Zf vmcnt(34)
Zc v143,v47,v46,s22
Zc v144,v33,v32,s23
Zc v145,v35,v34,s23
Zc v146,v37,v36,s23
Zc v147,v39,v38,s23
Zc v148,v41,v40,s23
Zc v149,v43,v42,s23
Zc v150,v45,v44,s23
Zc v151,v47,v46,s23
Zb s19,s17,1048576
Za v32,v2,s[32:35],s19 offen
Zb s19,s17,1056768
Za v33,v2,s[32:35],s19 offen
Zb s19,s17,1114112
Za v34,v2,s[32:35],s19 offen
Zb s19,s17,1122304
Za v35,v2,s[32:35],s19 offen
Zb s19,s17,1064960
Za v36,v2,s[32:35],s19 offen
Zb s19,s17,1073152
Za v37,v2,s[32:35],s19 offen
Zb s19,s17,1130496
Za v38,v2,s[32:35],s19 offen
Zb s19,s17,1138688
Za v39,v2,s[32:35],s19 offen
Zb s19,s17,1310720
Za v40,v2,s[32:35],s19 offen
Zb s19,s17,1318912
Za v41,v2,s[32:35],s19 offen
Zb s19,s17,1376256
Za v42,v2,s[32:35],s19 offen
Zb s19,s17,1384448
Za v43,v2,s[32:35],s19 offen
Zb s19,s17,1327104
Za v44,v2,s[32:35],s19 offen
Zb s19,s17,1335296
Za v45,v2,s[32:35],s19 offen
Zb s19,s17,1392640
Za v46,v2,s[32:35],s19 offen
Zb s19,s17,1400832
Za v47,v2,s[32:35],s19 offen
Zf vmcnt(46)
Zc v248,v49,v48,s22
Zf vmcnt(44)
Zc v249,v51,v50,s22
Zf vmcnt(42)
Zc v250,v53,v52,s22
Zf vmcnt(40)
Zc v251,v55,v54,s22
Zf vmcnt(38)
Zc v252,v57,v56,s22
Zf vmcnt(36)
Zc v253,v59,v58,s22
Zf vmcnt(34)
Zc v254,v61,v60,s22
Zf vmcnt(32)
Zc v255,v63,v62,s22
Zc v64,v49,v48,s23
Zc v65,v51,v50,s23
Zc v66,v53,v52,s23
Zc v67,v55,v54,s23
Zc v68,v57,v56,s23
Zc v69,v59,v58,s23
Zc v70,v61,v60,s23
Zc v71,v63,v62,s23
Zb s19,s18,4096
Zr v[64:67],v0,s[4:7],s19 offen
Zr v[68:71],v0,s[4:7],s19 offen offset:1024
Zb s19,s17,1572864
Za v48,v2,s[32:35],s19 offen
Zb s19,s17,1581056
Za v49,v2,s[32:35],s19 offen
Zb s19,s17,1638400
Za v50,v2,s[32:35],s19 offen
Zb s19,s17,1646592
Za v51,v2,s[32:35],s19 offen
Zb s19,s17,1589248
Za v52,v2,s[32:35],s19 offen
Zb s19,s17,1597440
Za v53,v2,s[32:35],s19 offen
Zb s19,s17,1654784
Za v54,v2,s[32:35],s19 offen
Zb s19,s17,1662976
Za v55,v2,s[32:35],s19 offen
Zb s19,s17,1835008
Za v56,v2,s[32:35],s19 offen
Zb s19,s17,1843200
Za v57,v2,s[32:35],s19 offen
Zb s19,s17,1900544
Za v58,v2,s[32:35],s19 offen
Zb s19,s17,1908736
Za v59,v2,s[32:35],s19 offen
Zb s19,s17,1851392
Za v60,v2,s[32:35],s19 offen
Zb s19,s17,1859584
Za v61,v2,s[32:35],s19 offen
Zb s19,s17,1916928
Za v62,v2,s[32:35],s19 offen
Zb s19,s17,1925120
Za v63,v2,s[32:35],s19 offen
Zf vmcnt(48)
Zc v232,v17,v16,s22
Zf vmcnt(46)
Zc v233,v19,v18,s22
Zf vmcnt(44)
Zc v234,v21,v20,s22
Zf vmcnt(42)
Zc v235,v23,v22,s22
Zf vmcnt(40)
Zc v236,v25,v24,s22
Zf vmcnt(38)
Zc v237,v27,v26,s22
Zf vmcnt(36)
Zc v238,v29,v28,s22
Zf vmcnt(34)
Zc v239,v31,v30,s22
Zc v240,v17,v16,s23
Zc v241,v19,v18,s23
Zc v242,v21,v20,s23
Zc v243,v23,v22,s23
Zc v244,v25,v24,s23
Zc v245,v27,v26,s23
Zc v246,v29,v28,s23
Zc v247,v31,v30,s23
Zb s19,s17,2097152
Za v16,v2,s[32:35],s19 offen
Zb s19,s17,2105344
Za v17,v2,s[32:35],s19 offen
Zb s19,s17,2162688
Za v18,v2,s[32:35],s19 offen
Zb s19,s17,2170880
Za v19,v2,s[32:35],s19 offen
Zb s19,s17,2113536
Za v20,v2,s[32:35],s19 offen
Zb s19,s17,2121728
Za v21,v2,s[32:35],s19 offen
Zb s19,s17,2179072
Za v22,v2,s[32:35],s19 offen
Zb s19,s17,2187264
Za v23,v2,s[32:35],s19 offen
Zb s19,s17,2359296
Za v24,v2,s[32:35],s19 offen
Zb s19,s17,2367488
Za v25,v2,s[32:35],s19 offen
Zb s19,s17,2424832
Za v26,v2,s[32:35],s19 offen
Zb s19,s17,2433024
Za v27,v2,s[32:35],s19 offen
Zb s19,s17,2375680
Za v28,v2,s[32:35],s19 offen
Zb s19,s17,2383872
Za v29,v2,s[32:35],s19 offen
Zb s19,s17,2441216
Za v30,v2,s[32:35],s19 offen
Zb s19,s17,2449408
Za v31,v2,s[32:35],s19 offen
Zf vmcnt(48)
Zc v216,v33,v32,s22
Zf vmcnt(46)
Zc v217,v35,v34,s22
Zf vmcnt(44)
Zc v218,v37,v36,s22
Zf vmcnt(42)
Zc v219,v39,v38,s22
Zf vmcnt(40)
Zc v220,v41,v40,s22
Zf vmcnt(38)
Zc v221,v43,v42,s22
Zf vmcnt(36)
Zc v222,v45,v44,s22
Zf vmcnt(34)
Zc v223,v47,v46,s22
Zc v224,v33,v32,s23
Zc v225,v35,v34,s23
Zc v226,v37,v36,s23
Zc v227,v39,v38,s23
Zc v228,v41,v40,s23
Zc v229,v43,v42,s23
Zc v230,v45,v44,s23
Zc v231,v47,v46,s23
Zb s19,s17,2621440
Za v32,v2,s[32:35],s19 offen
Zb s19,s17,2629632
Za v33,v2,s[32:35],s19 offen
Zb s19,s17,2686976
Za v34,v2,s[32:35],s19 offen
Zb s19,s17,2695168
Za v35,v2,s[32:35],s19 offen
Zb s19,s17,2637824
Za v36,v2,s[32:35],s19 offen
Zb s19,s17,2646016
Za v37,v2,s[32:35],s19 offen
Zb s19,s17,2703360
Za v38,v2,s[32:35],s19 offen
Zb s19,s17,2711552
Za v39,v2,s[32:35],s19 offen
Zb s19,s17,2883584
Za v40,v2,s[32:35],s19 offen
Zb s19,s17,2891776
Za v41,v2,s[32:35],s19 offen
Zb s19,s17,2949120
Za v42,v2,s[32:35],s19 offen
Zb s19,s17,2957312
Za v43,v2,s[32:35],s19 offen
Zb s19,s17,2899968
Za v44,v2,s[32:35],s19 offen
Zb s19,s17,2908160
Za v45,v2,s[32:35],s19 offen
Zb s19,s17,2965504
Za v46,v2,s[32:35],s19 offen
Zb s19,s17,2973696
Za v47,v2,s[32:35],s19 offen
Zf vmcnt(46)
Zc v72,v49,v48,s22
Zf vmcnt(44)
Zc v73,v51,v50,s22
Zf vmcnt(42)
Zc v74,v53,v52,s22
Zf vmcnt(40)
Zc v75,v55,v54,s22
Zf vmcnt(38)
Zc v76,v57,v56,s22
Zf vmcnt(36)
Zc v77,v59,v58,s22
Zf vmcnt(34)
Zc v78,v61,v60,s22
Zf vmcnt(32)
Zc v79,v63,v62,s22
Zd a128,v72
Zd a129,v73
Zd a130,v74
Zd a131,v75
Zd a132,v76
Zd a133,v77
Zd a134,v78
Zd a135,v79
Zc v64,v49,v48,s23
Zc v65,v51,v50,s23
Zc v66,v53,v52,s23
Zc v67,v55,v54,s23
Zc v68,v57,v56,s23
Zc v69,v59,v58,s23
Zc v70,v61,v60,s23
Zc v71,v63,v62,s23
Zd a136,v64
Zd a137,v65
Zd a138,v66
Zd a139,v67
Zd a140,v68
Zd a141,v69
Zd a142,v70
Zd a143,v71
Zb s19,s17,3145728
Za v48,v2,s[32:35],s19 offen
Zb s19,s17,3153920
Za v49,v2,s[32:35],s19 offen
Zb s19,s17,3211264
Za v50,v2,s[32:35],s19 offen
Zb s19,s17,3219456
Za v51,v2,s[32:35],s19 offen
Zb s19,s17,3162112
Za v52,v2,s[32:35],s19 offen
Zb s19,s17,3170304
Za v53,v2,s[32:35],s19 offen
Zb s19,s17,3227648
Za v54,v2,s[32:35],s19 offen
Zb s19,s17,3235840
Za v55,v2,s[32:35],s19 offen
Zb s19,s17,3407872
Za v56,v2,s[32:35],s19 offen
Zb s19,s17,3416064
Za v57,v2,s[32:35],s19 offen
Zb s19,s17,3473408
Za v58,v2,s[32:35],s19 offen
Zb s19,s17,3481600
Za v59,v2,s[32:35],s19 offen
Zb s19,s17,3424256
Za v60,v2,s[32:35],s19 offen
Zb s19,s17,3432448
Za v61,v2,s[32:35],s19 offen
Zb s19,s17,3489792
Za v62,v2,s[32:35],s19 offen
Zb s19,s17,3497984
Za v63,v2,s[32:35],s19 offen
Zf vmcnt(46)
Zc v72,v17,v16,s22
Zf vmcnt(44)
Zc v73,v19,v18,s22
Zf vmcnt(42)
Zc v74,v21,v20,s22
Zf vmcnt(40)
Zc v75,v23,v22,s22
Zf vmcnt(38)
Zc v76,v25,v24,s22
Zf vmcnt(36)
Zc v77,v27,v26,s22
Zf vmcnt(34)
Zc v78,v29,v28,s22
Zf vmcnt(32)
Zc v79,v31,v30,s22
Zd a152,v72
Zd a153,v73
Zd a154,v74
Zd a155,v75
Zd a156,v76
Zd a157,v77
Zd a158,v78
Zd a159,v79
Zc v64,v17,v16,s23
Zc v65,v19,v18,s23
Zc v66,v21,v20,s23
Zc v67,v23,v22,s23
Zc v68,v25,v24,s23
Zc v69,v27,v26,s23
Zc v70,v29,v28,s23
Zc v71,v31,v30,s23
Zd a160,v64
Zd a161,v65
Zd a162,v66
Zd a163,v67
Zd a164,v68
Zd a165,v69
Zd a166,v70
Zd a167,v71
Zb s19,s17,3670016
Za v16,v2,s[32:35],s19 offen
Zb s19,s17,3678208
Za v17,v2,s[32:35],s19 offen
Zb s19,s17,3735552
Za v18,v2,s[32:35],s19 offen
Zb s19,s17,3743744
Za v19,v2,s[32:35],s19 offen
Zb s19,s17,3686400
Za v20,v2,s[32:35],s19 offen
Zb s19,s17,3694592
Za v21,v2,s[32:35],s19 offen
Zb s19,s17,3751936
Za v22,v2,s[32:35],s19 offen
Zb s19,s17,3760128
Za v23,v2,s[32:35],s19 offen
Zb s19,s17,3932160
Za v24,v2,s[32:35],s19 offen
Zb s19,s17,3940352
Za v25,v2,s[32:35],s19 offen
Zb s19,s17,3997696
Za v26,v2,s[32:35],s19 offen
Zb s19,s17,4005888
Za v27,v2,s[32:35],s19 offen
Zb s19,s17,3948544
Za v28,v2,s[32:35],s19 offen
Zb s19,s17,3956736
Za v29,v2,s[32:35],s19 offen
Zb s19,s17,4014080
Za v30,v2,s[32:35],s19 offen
Zb s19,s17,4022272
Za v31,v2,s[32:35],s19 offen
Zf vmcnt(46)
Zc v72,v33,v32,s22
Zf vmcnt(44)
Zc v73,v35,v34,s22
Zf vmcnt(42)
Zc v74,v37,v36,s22
Zf vmcnt(40)
Zc v75,v39,v38,s22
Zf vmcnt(38)
Zc v76,v41,v40,s22
Zf vmcnt(36)
Zc v77,v43,v42,s22
Zf vmcnt(34)
Zc v78,v45,v44,s22
Zf vmcnt(32)
Zc v79,v47,v46,s22
Zd a184,v72
Zd a185,v73
Zd a186,v74
Zd a187,v75
Zd a188,v76
Zd a189,v77
Zd a190,v78
Zd a191,v79
Zc v64,v33,v32,s23
Zc v65,v35,v34,s23
Zc v66,v37,v36,s23
Zc v67,v39,v38,s23
Zc v68,v41,v40,s23
Zc v69,v43,v42,s23
Zc v70,v45,v44,s23
Zc v71,v47,v46,s23
Zd a192,v64
Zd a193,v65
Zd a194,v66
Zd a195,v67
Zd a196,v68
Zd a197,v69
Zd a198,v70
Zd a199,v71
Zb s19,s17,4194304
Za v32,v2,s[32:35],s19 offen
Zb s19,s17,4202496
Za v33,v2,s[32:35],s19 offen
Zb s19,s17,4259840
Za v34,v2,s[32:35],s19 offen
Zb s19,s17,4268032
Za v35,v2,s[32:35],s19 offen
Zb s19,s17,4210688
Za v36,v2,s[32:35],s19 offen
Zb s19,s17,4218880
Za v37,v2,s[32:35],s19 offen
Zb s19,s17,4276224
Za v38,v2,s[32:35],s19 offen
Zb s19,s17,4284416
Za v39,v2,s[32:35],s19 offen
Zb s19,s17,4456448
Za v40,v2,s[32:35],s19 offen
Zb s19,s17,4464640
Za v41,v2,s[32:35],s19 offen
Zb s19,s17,4521984
Za v42,v2,s[32:35],s19 offen
Zb s19,s17,4530176
Za v43,v2,s[32:35],s19 offen
Zb s19,s17,4472832
Za v44,v2,s[32:35],s19 offen
Zb s19,s17,4481024
Za v45,v2,s[32:35],s19 offen
Zb s19,s17,4538368
Za v46,v2,s[32:35],s19 offen
Zb s19,s17,4546560
Za v47,v2,s[32:35],s19 offen
Zf vmcnt(46)
Zc v72,v49,v48,s22
Zf vmcnt(44)
Zc v73,v51,v50,s22
Zf vmcnt(42)
Zc v74,v53,v52,s22
Zf vmcnt(40)
Zc v75,v55,v54,s22
Zf vmcnt(38)
Zc v76,v57,v56,s22
Zf vmcnt(36)
Zc v77,v59,v58,s22
Zf vmcnt(34)
Zc v78,v61,v60,s22
Zf vmcnt(32)
Zc v79,v63,v62,s22
Zd a216,v72
Zd a217,v73
Zd a218,v74
Zd a219,v75
Zd a220,v76
Zd a221,v77
Zd a222,v78
Zd a223,v79
Zc v64,v49,v48,s23
Zc v65,v51,v50,s23
Zc v66,v53,v52,s23
Zc v67,v55,v54,s23
Zc v68,v57,v56,s23
Zc v69,v59,v58,s23
Zc v70,v61,v60,s23
Zc v71,v63,v62,s23
Zd a224,v64
Zd a225,v65
Zd a226,v66
Zd a227,v67
Zd a228,v68
Zd a229,v69
Zd a230,v70
Zd a231,v71
Zb s19,s17,4718592
Za v48,v2,s[32:35],s19 offen
Zb s19,s17,4726784
Za v49,v2,s[32:35],s19 offen
Zb s19,s17,4784128
Za v50,v2,s[32:35],s19 offen
Zb s19,s17,4792320
Za v51,v2,s[32:35],s19 offen
Zb s19,s17,4734976
Za v52,v2,s[32:35],s19 offen
Zb s19,s17,4743168
Za v53,v2,s[32:35],s19 offen
Zb s19,s17,4800512
Za v54,v2,s[32:35],s19 offen
Zb s19,s17,4808704
Za v55,v2,s[32:35],s19 offen
Zb s19,s17,4980736
Za v56,v2,s[32:35],s19 offen
Zb s19,s17,4988928
Za v57,v2,s[32:35],s19 offen
Zb s19,s17,5046272
Za v58,v2,s[32:35],s19 offen
Zb s19,s17,5054464
Za v59,v2,s[32:35],s19 offen
Zb s19,s17,4997120
Za v60,v2,s[32:35],s19 offen
Zb s19,s17,5005312
Za v61,v2,s[32:35],s19 offen
Zb s19,s17,5062656
Za v62,v2,s[32:35],s19 offen
Zb s19,s17,5070848
Za v63,v2,s[32:35],s19 offen
Zf vmcnt(46)
Zc v72,v17,v16,s22
Zf vmcnt(44)
Zc v73,v19,v18,s22
Zf vmcnt(42)
Zc v74,v21,v20,s22
Zf vmcnt(40)
Zc v75,v23,v22,s22
Zf vmcnt(38)
Zc v76,v25,v24,s22
Zf vmcnt(36)
Zc v77,v27,v26,s22
Zf vmcnt(34)
Zc v78,v29,v28,s22
Zf vmcnt(32)
Zc v79,v31,v30,s22
Zd a248,v72
Zd a249,v73
Zd a250,v74
Zd a251,v75
Zd a252,v76
Zd a253,v77
Zd a254,v78
Zd a255,v79
Zc v80,v17,v16,s23
Zc v81,v19,v18,s23
Zc v82,v21,v20,s23
Zc v83,v23,v22,s23
Zc v84,v25,v24,s23
Zc v85,v27,v26,s23
Zc v86,v29,v28,s23
Zc v87,v31,v30,s23
Zf vmcnt(30)
Zc v112,v33,v32,s22
Zf vmcnt(28)
Zc v113,v35,v34,s22
Zf vmcnt(26)
Zc v114,v37,v36,s22
Zf vmcnt(24)
Zc v115,v39,v38,s22
Zf vmcnt(22)
Zc v116,v41,v40,s22
Zf vmcnt(20)
Zc v117,v43,v42,s22
Zf vmcnt(18)
Zc v118,v45,v44,s22
Zf vmcnt(16)
Zc v119,v47,v46,s22
Zc v64,v33,v32,s23
Zc v65,v35,v34,s23
Zc v66,v37,v36,s23
Zc v67,v39,v38,s23
Zc v68,v41,v40,s23
Zc v69,v43,v42,s23
Zc v70,v45,v44,s23
Zc v71,v47,v46,s23
Zb s19,s18,8192
Zr v[64:67],v0,s[4:7],s19 offen
Zr v[68:71],v0,s[4:7],s19 offen offset:1024
Zf vmcnt(16)
Zc v152,v49,v48,s22
Zf vmcnt(14)
Zc v153,v51,v50,s22
Zf vmcnt(12)
Zc v154,v53,v52,s22
Zf vmcnt(10)
Zc v155,v55,v54,s22
Zf vmcnt(8)
Zc v156,v57,v56,s22
Zf vmcnt(6)
Zc v157,v59,v58,s22
Zf vmcnt(4)
Zc v158,v61,v60,s22
Zf vmcnt(2)
Zc v159,v63,v62,s22
Zc v64,v49,v48,s23
Zc v65,v51,v50,s23
Zc v66,v53,v52,s23
Zc v67,v55,v54,s23
Zc v68,v57,v56,s23
Zc v69,v59,v58,s23
Zc v70,v61,v60,s23
Zc v71,v63,v62,s23
Zt v5,v[64:67] offset:4096
Zt v5,v[68:71] offset:5120
v_lshrrev_b32 v14, 1, v12
Zy v14,1,v14
Zs v1,0x4444
Zs v15,0xeeee
v_cmp_eq_u32 vcc, 1, v14
s_nop 1
v_cndmask_b32 v1, v1, v15, vcc
v_lshrrev_b32 v15, 2, v12
Zz v15,1,v15
Zy v16,1,v12
v_add_u32 v15, v15, v16
v_mul_u32_u24 v7, 1280, v15
v_lshl_add_u32 v7, v13, 5, v7
v_lshl_add_u32 v7, v14, 4, v7
v_mul_u32_u24 v10, 288, v15
v_lshl_add_u32 v10, v13, 4, v10
v_add_u32 v10, 20736, v10
Zy v16,7,v12
v_mul_u32_u24 v9, 288, v16
v_lshl_add_u32 v9, v13, 4, v9
v_add_u32 v9, 18432, v9
v_mul_u32_u24 v8, 576, v13
v_lshl_add_u32 v8, v12, 2, v8
v_add_u32 v8, 18496, v8
v_lshrrev_b32 v17, 1, v16
Zz v17,2,v17
Zy v18,1,v16
v_add_u32 v17, v17, v18
Zy v18,1,v13
v_lshl_add_u32 v17, v18, 1, v17
v_lshrrev_b32 v18, 1, v13
v_lshl_add_u32 v17, v18, 4, v17
Zz v11,4,v17
v_add_u32 v11, 512, v11
s_mul_i32 s19, s8, 10368
v_mul_u32_u24 v2, 2560, v13
v_add_u32 v2, s19, v2
v_lshl_add_u32 v3, v12, 2, v2
v_add_u32 v3, 1088, v3
v_lshl_add_u32 v2, v12, 4, v2
v_add_u32 v2, 256, v2
v_lshrrev_b32 v16, 3, v12
v_lshl_add_u32 v16, v13, 1, v16
Zy v17,7,v12
Zq s19,s8,7
Zb s19,s19,4096
v_mul_u32_u24 v4, 10368, v16
v_lshl_add_u32 v4, v17, 4, v4
v_add_u32 v4, s19, v4
Zp s21,1040356334
Zp s20,400000
Zp s12,1048576
Zp s15,2097152
Zf vmcnt(0) lgkmcnt(0)
v_lshrrev_b32 v12, 2, v0
Zy v12,60,v12
L_md1:
global_load_dword v13, v12, s[36:37] sc1
Zf vmcnt(0)
v_readlane_b32 s40, v13, 0
v_readlane_b32 s41, v13, 1
v_readlane_b32 s42, v13, 2
v_readlane_b32 s43, v13, 3
v_readlane_b32 s44, v13, 4
v_readlane_b32 s45, v13, 5
v_readlane_b32 s46, v13, 6
v_readlane_b32 s47, v13, 7
v_readlane_b32 s48, v13, 8
s_cmp_ge_u32 s40, 32
Zk L_fa1
Zb s40,s40,s41
Zb s40,s40,s42
Zb s40,s40,s43
Zb s40,s40,s44
Zb s40,s40,s45
Zb s40,s40,s46
Zb s40,s40,s47
Zb s40,s40,s48
s_cmp_ge_u32 s40, 256
Zk L_sl1
s_sleep 2
s_sub_u32 s20, s20, 1
s_cmp_gt_i32 s20, 0
Zk L_md1
L_sl1:
Zq s24,s8,7
Zb s26,s24,4096
Zb s24,s24,0
Zp s11,0
s_mul_i32 s17, s8, 20480
Zb s17,s17,16777216
Zb s27,s17,17408
s_load_dwordx2 s[28:29], s[0:1], 48
Zp s30,10240
Zp s31,0x20000
Zp s39,0
Zb s90,s18,0
Zb s91,s18,4096
Zb s92,s18,8192
Zb s93,s18,12288
Zb s94,s18,16384
Zb s36,s8,32
s_mul_i32 s22, s36, 205
s_lshr_b32 s22, s22, 11
s_mul_i32 s23, s22, 10
s_sub_u32 s36, s36, s23
Zq s38,s36,10
s_lshr_b32 s23, s22, 1
Zq s23,s23,6
Zb s38,s38,s23
s_and_b32 s23, s22, 1
Zq s23,s23,4
Zb s38,s38,s23
s_cmp_ge_u32 s36, 8
s_cselect_b32 s36, 1, 0
Zb s13,s12,82944
Zb s14,s12,165888
Zb s59,s12,248832
Zp s32,394264576
Zp s33,1342177280
Zf lgkmcnt(0)
CL_w1x:
Zp s10,0
s_barrier
Zp s37,8192
Zs v6,v0
Zb m0,s37,4096
Zb s19,s17,2048
Zh v0,s[4:7],s19 offen sc1 nt lds
Zb m0,s37,5120
Zb s19,s17,3072
Zh v0,s[4:7],s19 offen sc1 nt lds
Zh v[12:15],v7,s[28:31],0 offen offset:384
Zh v[40:43],v7,s[28:31],0 offen offset:512
Zh v[44:47],v7,s[28:31],0 offen offset:640
Zb s19,s18,0
Zh v[48:51],v0,s[4:7],s19 offen offset:0
Zh v[52:55],v0,s[4:7],s19 offen offset:1024
Zb s19,s18,6144
Zh v[56:59],v0,s[4:7],s19 offen offset:0
Zh v[60:63],v0,s[4:7],s19 offen offset:1024
Zb s19,s18,10240
Zh v[64:67],v0,s[4:7],s19 offen offset:0
Zh v[68:71],v0,s[4:7],s19 offen offset:1024
Zb s19,s18,14336
Zh v[72:75],v0,s[4:7],s19 offen offset:0
Zh v[76:79],v0,s[4:7],s19 offen offset:1024
Zm v[16:17],0
Zm v[18:19],0
Zm v[20:21],0
Zm v[22:23],0
Zm v[24:25],0
Zm v[26:27],0
Zm v[28:29],0
Zm v[30:31],0
Zm v[32:33],0
Zm v[34:35],0
Zm v[36:37],0
Zm v[38:39],0
Zf vmcnt(0) lgkmcnt(0)
CS_w1x:
Zt v6,v[12:15] offset:3072
Zt v6,v[40:43] offset:4096
Zt v6,v[44:47] offset:5120
Zg v[16:19],v[12:15],v[48:55],v1
Zb s19,s18,2048
Zh v[48:51],v0,s[4:7],s19 offen offset:0
Zh v[52:55],v0,s[4:7],s19 offen offset:1024
Zg v[20:23],v[12:15],v[56:63],v1
Zi v[56:59],v5 offset:2048
Zi v[60:63],v5 offset:3072
Zg v[24:27],v[12:15],v[64:71],v1
Zi v[64:67],v5 offset:10240
Zi v[68:71],v5 offset:11264
Zf vmcnt(2)
Zg v[28:31],v[12:15],v[72:79],v1
Zi v[72:75],v5 offset:18432
Zi v[76:79],v5 offset:19456
Zg v[32:35],v[12:15],a[128:135],v1
Zg v[36:39],v[12:15],a[136:143],v1
Zf lgkmcnt(6)
s_barrier
Zi v[12:15],v6 offset:6144
Zg v[16:19],v[40:43],a[144:151],v1
Zf lgkmcnt(5)
Zg v[20:23],v[40:43],v[56:63],v1
Zb s19,s18,8192
Zh v[56:59],v0,s[4:7],s19 offen offset:0
Zh v[60:63],v0,s[4:7],s19 offen offset:1024
Zf lgkmcnt(3)
Zg v[24:27],v[40:43],v[64:71],v1
Zi v[64:67],v5 offset:12288
Zi v[68:71],v5 offset:13312
Zf lgkmcnt(3)
Zg v[28:31],v[40:43],v[72:79],v1
Zi v[72:75],v5 offset:20480
Zi v[76:79],v5 offset:21504
Zg v[32:35],v[40:43],a[152:159],v1
Zg v[36:39],v[40:43],a[160:167],v1
Zg v[16:19],v[44:47],a[168:175],v1
Zi v[40:43],v6 offset:7168
Zf lgkmcnt(3)
Zg v[20:23],v[44:47],v[64:71],v1
Zi v[64:67],v5 offset:14336
Zi v[68:71],v5 offset:15360
Zg v[24:27],v[44:47],a[176:183],v1
Zf lgkmcnt(3)
Zg v[28:31],v[44:47],v[72:79],v1
Zi v[72:75],v5 offset:22528
Zi v[76:79],v5 offset:23552
Zg v[32:35],v[44:47],a[184:191],v1
Zg v[36:39],v[44:47],a[192:199],v1
Zg v[16:19],v[12:15],a[200:207],v1
Zi v[44:47],v6 offset:8192
Zf lgkmcnt(3)
Zg v[20:23],v[12:15],v[64:71],v1
Zb s19,s18,12288
Zh v[64:67],v0,s[4:7],s19 offen offset:0
Zh v[68:71],v0,s[4:7],s19 offen offset:1024
Zg v[24:27],v[12:15],a[208:215],v1
Zf lgkmcnt(1)
Zg v[28:31],v[12:15],v[72:79],v1
Zi v[72:75],v5 offset:24576
Zi v[76:79],v5 offset:25600
Zg v[32:35],v[12:15],a[216:223],v1
Zg v[36:39],v[12:15],a[224:231],v1
Zg v[16:19],v[40:43],a[232:239],v1
Zi v[12:15],v6 offset:9216
Zg v[20:23],v[40:43],a[240:247],v1
Zf vmcnt(4)
Zg v[24:27],v[40:43],v[48:55],v1
Zi v[48:51],v5 offset:0
Zi v[52:55],v5 offset:1024
Zf lgkmcnt(3)
Zg v[28:31],v[40:43],v[72:79],v1
Zb s19,s18,16384
Zh v[72:75],v0,s[4:7],s19 offen offset:0
Zh v[76:79],v0,s[4:7],s19 offen offset:1024
Zg v[32:35],v[40:43],a[248:255],v1
Zg v[36:39],v[40:43],v[80:87],v1
Zg v[16:19],v[44:47],v[88:95],v1
Zi v[40:43],v0 offset:0
Zg v[20:23],v[44:47],v[96:103],v1
Zf lgkmcnt(1)
Zg v[24:27],v[44:47],v[48:55],v1
Zb s19,s18,4096
Zh v[48:51],v0,s[4:7],s19 offen offset:0
Zh v[52:55],v0,s[4:7],s19 offen offset:1024
Zg v[28:31],v[44:47],v[104:111],v1
Zg v[32:35],v[44:47],v[112:119],v1
Zf vmcnt(6)
Zg v[36:39],v[44:47],v[56:63],v1
Zb s34,s17,655360
Zi v[56:59],v5 offset:4096
Zi v[60:63],v5 offset:5120
Zg v[16:19],v[12:15],v[120:127],v1
Zi v[44:47],v0 offset:1024
Zo s10,63
s_cselect_b32 s34, s17, s34
Zg v[20:23],v[12:15],v[128:135],v1
s_xor_b32 s37, s37, 8192
Zg v[24:27],v[12:15],v[136:143],v1
Zg v[28:31],v[12:15],v[144:151],v1
Zg v[32:35],v[12:15],v[152:159],v1
Zf lgkmcnt(1)
Zg v[36:39],v[12:15],v[56:63],v1
Zi v[56:59],v5 offset:6144
Zi v[60:63],v5 offset:7168
Zg v[16:19],v[40:43],v[160:167],v1
Zi v[12:15],v6 offset:2048
Zg v[20:23],v[40:43],v[168:175],v1
Zg v[24:27],v[40:43],v[176:183],v1
Zf vmcnt(4)
Zg v[28:31],v[40:43],v[64:71],v1
Zi v[64:67],v5 offset:16384
Zi v[68:71],v5 offset:17408
Zf lgkmcnt(5)
Zg v[16:19],v[44:47],v[184:191],v1
Zf lgkmcnt(3)
Zg v[20:23],v[44:47],v[56:63],v1
Zi v[56:59],v5 offset:8192
Zi v[60:63],v5 offset:9216
Zf lgkmcnt(4)
Zg v[16:19],v[12:15],v[192:199],v1
Zg v[20:23],v[12:15],v[200:207],v1
Zg v[24:27],v[44:47],v[208:215],v1
v_xor_b32 v6, 8192, v6
Zf lgkmcnt(2)
Zg v[28:31],v[44:47],v[64:71],v1
Zl v16,v16,v18
Zb s19,s17,10240
Zh v[64:67],v0,s[4:7],s19 offen sc1 nt
Zh v[68:71],v0,s[4:7],s19 offen offset:1024 sc1 nt
Zf vmcnt(4)
Zg v[24:27],v[12:15],v[72:79],v1
Zl v17,v17,v19
Zf lgkmcnt(0)
Zg v[28:31],v[12:15],v[56:63],v1
Zl v20,v20,v22
Zg v[32:35],v[12:15],v[216:223],v1
Zl v21,v21,v23
Zw v16,s21,v16
Zi v[72:75],v6 offset:2048
Zi v[76:79],v6 offset:6144
Zg v[36:39],v[12:15],v[224:231],v1
Zw v17,s21,v17
Zw v20,s21,v20
Zw v21,s21,v21
Zj v18,v16,v20
Zj v19,v17,v21
ds_write2_b32 v8, v18, v19 offset0:0 offset1:72
Zi v[56:59],v6 offset:3072
Zi v[60:63],v6 offset:7168
Zl v24,v24,v26
Zl v25,v25,v27
Zl v28,v28,v30
Zl v29,v29,v31
Zj v12,v24,v28
Zj v13,v25,v29
ds_write_b32 v8, v12 offset:2304
ds_write_b32 v8, v13 offset:2592
Zg v[32:35],v[44:47],v[232:239],v1
Zg v[36:39],v[44:47],v[240:247],v1
Zf lgkmcnt(0)
s_barrier
Zi v[16:19],v9 offset:0
Zi v[20:23],v10 offset:0
Zi v[24:27],v9 offset:64
Zi v[28:31],v10 offset:64
Zg v[32:35],v[40:43],v[248:255],v1
Zf vmcnt(2)
Zg v[36:39],v[40:43],v[48:55],v1
Zi v[48:51],v6 offset:4096
Zi v[52:55],v6 offset:8192
s_nop 1
Zl v32,v32,v34
Zl v33,v33,v35
s_nop 1
Zl v36,v36,v38
Zl v37,v37,v39
Zj v14,v32,v33
Zj v15,v36,v37
Zr v[12:15],v0,s[4:7],s27 offen sc1 nt
Zf lgkmcnt(5)
Ze v[44:47],v[76:79],v[16:19],0
Zf lgkmcnt(4)
Ze v[32:35],v[20:23],v[16:19],0
Ze v[40:43],v[72:75],v[16:19],0
Zi v[16:19],v9 offset:128
Zi v[20:23],v10 offset:128
Zi v[72:75],v6 offset:5120
Zi v[76:79],v6 offset:9216
Zb m0,s37,4096
Zb s19,s34,2048
Zh v0,s[4:7],s19 offen sc1 nt lds
Zf lgkmcnt(7)
Ze v[44:47],v[60:63],v[24:27],v[44:47]
Zs v36,0x3f803f80
Zs v37,0x3f803f80
Zf lgkmcnt(6)
Ze v[32:35],v[28:31],v[24:27],v[32:35]
Zs v38,0x3f803f80
Zs v39,0x3f803f80
Ze v[40:43],v[56:59],v[24:27],v[40:43]
Zi v[24:27],v9 offset:192
Zi v[28:31],v10 offset:192
Zi v[56:59],v5 offset:30720
Zi v[60:63],v5 offset:31744
Zb m0,s37,5120
Zb s19,s34,3072
Zh v0,s[4:7],s19 offen sc1 nt lds
Zf lgkmcnt(7)
Ze v[44:47],v[52:55],v[16:19],v[44:47]
Zf lgkmcnt(6)
Ze v[32:35],v[20:23],v[16:19],v[32:35]
Ze v[40:43],v[48:51],v[16:19],v[40:43]
Zi v[48:51],v5 offset:26624
Zi v[52:55],v5 offset:27648
Zf lgkmcnt(5)
Ze v[44:47],v[76:79],v[24:27],v[44:47]
Zs v21,0
Zs v22,0
Zf lgkmcnt(4)
Ze v[32:35],v[28:31],v[24:27],v[32:35]
Ze v[40:43],v[72:75],v[24:27],v[40:43]
Zp s23,0
SX_w1x:
Zn v76,v44
Zn v77,v45
Zn v78,v46
Zn v79,v47
Zn v24,v32
Zn v25,v33
s_nop 0
Zn v72,v40
Zn v73,v41
Zn v74,v42
Zn v75,v43
Zj v18,v76,v77
Zj v19,v78,v79
Zj v16,v72,v73
Zj v17,v74,v75
Zj v20,v24,v25
Zj v23,v24,v25
Ze v[72:75],v[36:39],v[16:19],0
Zf vmcnt(4)
Ze v[24:27],v[64:67],v[16:19],0
Zf vmcnt(3)
Ze v[28:31],v[68:71],v[16:19],0
v_mfma_f32_16x16x16_bf16 v[72:75], v[36:37], v[20:21], v[72:75]
v_mfma_f32_16x16x16_bf16 v[24:27], v[14:15], v[20:21], v[24:27]
Zm v[76:77],0
Zm v[78:79],0
v_mfma_f32_16x16x16_bf16 v[28:31], v[14:15], v[22:23], v[28:31]
s_nop 2
v_subrev_u32 v73, s32, v72
v_rcp_f32 v74, v72
v_cmp_le_u32 vcc, s33, v73
Zs v75,v74
s_cbranch_vccnz FB_w1x
SO_w1x:
v_pk_mul_f32 v[24:25], v[24:25], v[74:75]
v_pk_mul_f32 v[26:27], v[26:27], v[74:75]
v_pk_mul_f32 v[28:29], v[28:29], v[74:75]
v_pk_mul_f32 v[30:31], v[30:31], v[74:75]
Zj v24,v24,v28
Zj v25,v25,v29
Zj v26,v26,v30
Zj v27,v27,v31
Zt v11,v[24:27]
Zm v[72:73],0
Zm v[74:75],0
Zm v[16:17],0
Zm v[18:19],0
Zm v[20:21],0
Zm v[22:23],0
Zm v[64:65],0
Zm v[66:67],0
Zm v[68:69],0
Zm v[70:71],0
Zf lgkmcnt(0)
s_barrier
Zi v[40:43],v0 offset:0
Zi v[44:47],v0 offset:1024
Zo s10,63
Zk CE_w1x
Zm v[24:25],0
Zm v[26:27],0
Zm v[28:29],0
Zm v[30:31],0
Zb s17,s17,655360
Zf lgkmcnt(1)
Zg v[72:75],v[40:43],v[48:55],v1
Zm v[32:33],0
Zi v[48:51],v5 offset:28672
Zi v[52:55],v5 offset:29696
Zf lgkmcnt(2)
Zg v[72:75],v[44:47],v[56:63],v1
Zm v[34:35],0
Zi v[56:59],v5 offset:32768
Zi v[60:63],v5 offset:33792
Zg v[76:79],v[40:43],a[0:7],v1
Zm v[36:37],0
Zg v[76:79],v[44:47],a[8:15],v1
Zm v[38:39],0
Zg v[16:19],v[40:43],a[16:23],v1
Zl v72,v72,v74
Zg v[16:19],v[44:47],a[24:31],v1
Zl v73,v73,v75
Zg v[20:23],v[40:43],a[32:39],v1
Zl v76,v76,v78
Zf lgkmcnt(2)
Zg v[20:23],v[44:47],v[48:55],v1
Zl v77,v77,v79
Zf lgkmcnt(0)
Zg v[64:67],v[40:43],v[56:63],v1
Zl v16,v16,v18
Zg v[64:67],v[44:47],a[40:47],v1
Zl v17,v17,v19
Zg v[68:71],v[40:43],a[48:55],v1
Zl v20,v20,v22
Zj v12,v72,v76
Zg v[68:71],v[44:47],a[56:63],v1
Zl v21,v21,v23
Zj v48,v73,v77
Zg v[24:27],v[40:43],a[64:71],v1
Zl v64,v64,v66
Zj v13,v16,v20
Zg v[24:27],v[44:47],a[72:79],v1
Zl v65,v65,v67
Zj v49,v17,v21
Zg v[28:31],v[40:43],a[80:87],v1
Zl v68,v68,v70
v_bfi_b32 v12, 1, s39, v12
Zg v[28:31],v[44:47],a[88:95],v1
Zl v69,v69,v71
v_bfi_b32 v48, 1, s39, v48
Zg v[32:35],v[40:43],a[96:103],v1
Zl v24,v24,v26
Zj v14,v64,v68
Zg v[32:35],v[44:47],a[104:111],v1
Zl v25,v25,v27
Zj v50,v65,v69
Zg v[36:39],v[40:43],a[112:119],v1
Zl v28,v28,v30
Zj v15,v24,v28
Zr v[12:15],v2,s[4:7],s12 offen sc1
Zg v[36:39],v[44:47],a[120:127],v1
Zl v29,v29,v31
Zj v51,v25,v29
Zr v[48:51],v2,s[4:7],s12 offen offset:1280 sc1
Zl v32,v32,v34
Zl v33,v33,v35
s_nop 2
Zl v36,v36,v38
Zj v56,v32,v36
v_bfi_b32 v56, 1, s39, v56
Zu v56,v3,s[4:7],s12 offen offset:0 sc1
Zl v37,v37,v39
Zj v57,v33,v37
v_bfi_b32 v57, 1, s39, v57
Zu v57,v3,s[4:7],s12 offen offset:1280 sc1
s_xor_b32 s16, s15, 0x4000
Zb s10,s10,1
Zb s11,s11,1
Zb s27,s27,655360
Zi v[12:15],v0 offset:23040
Zm v[38:39],-1
Zy v40,0x60,v0
v_lshl_add_u32 v40, v40, 3, s38
Zy v41,0x10,v0
v_lshl_add_u32 v40, v41, 1, v40
v_lshrrev_b32 v41, 5, v0
Zy v41,8,v41
v_add_u32 v40, v40, v41
Zy v41,0x280,v0
Zs v42,2130706432
v_cmp_ne_u32 vcc, 0, v41
s_nop 1
v_cndmask_b32 v40, v40, v42, vcc
Zf vmcnt(0)
Zf lgkmcnt(0)
Zh v[16:19],v4,s[4:7],s12 offen sc1
Zh v[20:23],v4,s[4:7],s13 offen sc1
Zh v[24:27],v4,s[4:7],s14 offen sc1
Zh v[28:31],v4,s[4:7],s59 offen sc1
Zb s19,s18,0
Zh v[48:51],v0,s[4:7],s19 offen offset:0
Zh v[52:55],v0,s[4:7],s19 offen offset:1024
Zb s19,s18,6144
Zh v[56:59],v0,s[4:7],s19 offen offset:0
Zh v[60:63],v0,s[4:7],s19 offen offset:1024
Zf vmcnt(7)
Ze v[32:35],v[12:15],v[16:19],0
v_xor_b32 v36, s39, v16
v_xor_b32 v37, v17, v16
Zv v37,v37,v18,v16 bitop3:0xf6
Zv v37,v37,v19,v16 bitop3:0xf6
Zf vmcnt(6)
Ze v[32:35],v[12:15],v[20:23],v[32:35]
Zv v36,v36,v20,s39 bitop3:0xf6
Zv v37,v37,v21,v20 bitop3:0xf6
Zv v37,v37,v22,v20 bitop3:0xf6
Zv v37,v37,v23,v20 bitop3:0xf6
Zf vmcnt(5)
Ze v[32:35],v[12:15],v[24:27],v[32:35]
Zv v36,v36,v24,s39 bitop3:0xf6
Zv v37,v37,v25,v24 bitop3:0xf6
Zv v37,v37,v26,v24 bitop3:0xf6
Zv v37,v37,v27,v24 bitop3:0xf6
Zf vmcnt(4)
Ze v[32:35],v[12:15],v[28:31],v[32:35]
Zv v36,v36,v28,s39 bitop3:0xf6
Zv v37,v37,v29,v28 bitop3:0xf6
Zv v37,v37,v30,v28 bitop3:0xf6
Zv v37,v37,v31,v28 bitop3:0xf6
v_and_or_b32 v36, v37, s36, v36
Zy v36,1,v36
v_cmp_ne_u32 vcc, 0, v36
s_cbranch_vccz P1D_w1x
P1_w1x:
Zh v[16:19],v4,s[4:7],s12 offen sc1
Zh v[20:23],v4,s[4:7],s13 offen sc1
Zh v[24:27],v4,s[4:7],s14 offen sc1
Zh v[28:31],v4,s[4:7],s59 offen sc1
Zf vmcnt(3)
Ze v[32:35],v[12:15],v[16:19],0
v_xor_b32 v36, s39, v16
v_xor_b32 v37, v17, v16
Zv v37,v37,v18,v16 bitop3:0xf6
Zv v37,v37,v19,v16 bitop3:0xf6
Zf vmcnt(2)
Ze v[32:35],v[12:15],v[20:23],v[32:35]
Zv v36,v36,v20,s39 bitop3:0xf6
Zv v37,v37,v21,v20 bitop3:0xf6
Zv v37,v37,v22,v20 bitop3:0xf6
Zv v37,v37,v23,v20 bitop3:0xf6
Zf vmcnt(1)
Ze v[32:35],v[12:15],v[24:27],v[32:35]
Zv v36,v36,v24,s39 bitop3:0xf6
Zv v37,v37,v25,v24 bitop3:0xf6
Zv v37,v37,v26,v24 bitop3:0xf6
Zv v37,v37,v27,v24 bitop3:0xf6
Zf vmcnt(0)
Ze v[32:35],v[12:15],v[28:31],v[32:35]
Zv v36,v36,v28,s39 bitop3:0xf6
Zv v37,v37,v29,v28 bitop3:0xf6
Zv v37,v37,v30,v28 bitop3:0xf6
Zv v37,v37,v31,v28 bitop3:0xf6
v_and_or_b32 v36, v37, s36, v36
Zy v36,1,v36
v_cmp_ne_u32 vcc, 0, v36
s_cbranch_vccz P1D_w1x
s_sub_u32 s20, s20, 1
s_cmp_gt_i32 s20, 0
Zk P1_w1x
P1D_w1x:
v_add_f32_dpp v16, v32, v32 row_shl:8 row_mask:0xf bank_mask:0xf bound_ctrl:1
v_add_f32_dpp v17, v33, v33 row_shl:8 row_mask:0xf bank_mask:0xf bound_ctrl:1
v_add_f32_dpp v18, v34, v34 row_shl:8 row_mask:0xf bank_mask:0xf bound_ctrl:1
v_add_f32_dpp v19, v35, v35 row_shl:8 row_mask:0xf bank_mask:0xf bound_ctrl:1
Zj v36,v16,v17
Zj v37,v18,v19
buffer_store_dwordx2 v[36:37], v40, s[4:7], s15 offen sc1
buffer_store_dwordx2 v[38:39], v40, s[4:7], s16 offen sc1
s_barrier
Zb s19,s18,10240
Zh v[64:67],v0,s[4:7],s19 offen offset:0
Zh v[68:71],v0,s[4:7],s19 offen offset:1024
Zm v[18:19],0
Zm v[20:21],0
Zm v[22:23],0
Zm v[24:25],0
Zm v[26:27],0
Zm v[28:29],0
Zm v[30:31],0
Zm v[32:33],0
Zm v[34:35],0
Zm v[36:37],0
Zm v[38:39],0
s_xor_b32 s39, s39, 1
Zb s22,s15,3072
Zf lgkmcnt(0)
Zh v[12:15],v0,s[4:7],s22 offen offset:0 sc1
Zh v[40:43],v0,s[4:7],s22 offen offset:1024 sc1
Zh v[44:47],v0,s[4:7],s22 offen offset:2048 sc1
Zf vmcnt(2)
Zb s19,s18,14336
Zh v[72:75],v0,s[4:7],s19 offen offset:0
Zh v[76:79],v0,s[4:7],s19 offen offset:1024
v_max3_u32 v16, v12, v13, v14
Zf vmcnt(3)
v_max3_u32 v16, v16, v15, v40
v_max3_u32 v16, v16, v41, v42
Zf vmcnt(2)
v_max3_u32 v16, v16, v43, v44
v_max3_u32 v16, v16, v45, v46
v_max_u32 v16, v16, v47
v_cmp_eq_u32 vcc, -1, v16
Zm v[16:17],0
s_cbranch_vccz P2D_w1x
P2_w1x:
Zh v[12:15],v0,s[4:7],s22 offen offset:0 sc1
Zh v[40:43],v0,s[4:7],s22 offen offset:1024 sc1
Zh v[44:47],v0,s[4:7],s22 offen offset:2048 sc1
Zf vmcnt(2)
v_max3_u32 v16, v12, v13, v14
Zf vmcnt(1)
v_max3_u32 v16, v16, v15, v40
v_max3_u32 v16, v16, v41, v42
Zf vmcnt(0)
v_max3_u32 v16, v16, v43, v44
v_max3_u32 v16, v16, v45, v46
v_max_u32 v16, v16, v47
v_cmp_eq_u32 vcc, -1, v16
Zm v[16:17],0
s_cbranch_vccz P2D_w1x
s_sub_u32 s20, s20, 1
s_cmp_gt_i32 s20, 0
Zk P2_w1x
P2D_w1x:
Zp s15,s16
s_branch CS_w1x
FB_w1x:
s_cmp_lg_u32 s23, 0
Zk SO_w1x
Zp s23,1
s_nop 11
v_max3_f32 v24, v40, v41, v42
v_max3_f32 v24, v24, v43, v44
v_max3_f32 v24, v24, v45, v46
v_max3_f32 v24, v24, v47, v32
v_max_f32 v24, v24, v33
Zs v25,v24
s_nop 1
v_permlane32_swap_b32 v24, v25
v_max_f32 v24, v24, v25
Zs v25,v24
s_nop 1
v_permlane16_swap_b32 v24, v25
v_max_f32 v24, v24, v25
Zx v40,v40,v24
Zx v41,v41,v24
Zx v42,v42,v24
Zx v43,v43,v24
Zx v44,v44,v24
Zx v45,v45,v24
Zx v46,v46,v24
Zx v47,v47,v24
Zx v32,v32,v24
Zx v33,v33,v24
Zf lgkmcnt(0)
s_branch SX_w1x
CE_w1x:
Zf vmcnt(0) lgkmcnt(0)
s_barrier
Zb s11,s11,1
Zb s27,s27,655360
Zb s17,s17,655360
Zp s15,2129920
Zf vmcnt(0)
s_cmp_lt_u32 s11, 128
Zk CL_w1x
s_endpgm
.p2align 6
L_fa1:
Zq s24,s8,7
Zb s26,s24,4096
Zb s24,s24,0
Zp s11,0
s_mul_i32 s17, s8, 20480
Zb s17,s17,16777216
Zb s27,s17,17408
s_load_dwordx2 s[28:29], s[0:1], 48
Zp s30,10240
Zp s31,0x20000
Zp s39,0
Zb s90,s18,0
Zb s91,s18,4096
Zb s92,s18,8192
Zb s93,s18,12288
Zb s94,s18,16384
Zb s36,s8,32
s_mul_i32 s22, s36, 205
s_lshr_b32 s22, s22, 11
s_mul_i32 s23, s22, 10
s_sub_u32 s36, s36, s23
Zq s38,s36,10
s_lshr_b32 s23, s22, 1
Zq s23,s23,6
Zb s38,s38,s23
s_and_b32 s23, s22, 1
Zq s23,s23,4
Zb s38,s38,s23
s_cmp_ge_u32 s36, 8
s_cselect_b32 s36, 1, 0
Zb s13,s12,82944
Zb s14,s12,165888
Zb s59,s12,248832
Zp s32,394264576
Zp s33,1342177280
Zf lgkmcnt(0)
CL_w1:
Zp s10,0
s_barrier
Zp s37,8192
Zs v6,v0
Zb m0,s37,4096
Zb s19,s17,2048
Zh v0,s[4:7],s19 offen sc1 nt lds
Zb m0,s37,5120
Zb s19,s17,3072
Zh v0,s[4:7],s19 offen sc1 nt lds
Zh v[12:15],v7,s[28:31],0 offen offset:384
Zh v[40:43],v7,s[28:31],0 offen offset:512
Zh v[44:47],v7,s[28:31],0 offen offset:640
Zb s19,s18,0
Zh v[48:51],v0,s[4:7],s19 offen offset:0
Zh v[52:55],v0,s[4:7],s19 offen offset:1024
Zb s19,s18,6144
Zh v[56:59],v0,s[4:7],s19 offen offset:0
Zh v[60:63],v0,s[4:7],s19 offen offset:1024
Zb s19,s18,10240
Zh v[64:67],v0,s[4:7],s19 offen offset:0
Zh v[68:71],v0,s[4:7],s19 offen offset:1024
Zb s19,s18,14336
Zh v[72:75],v0,s[4:7],s19 offen offset:0
Zh v[76:79],v0,s[4:7],s19 offen offset:1024
Zm v[16:17],0
Zm v[18:19],0
Zm v[20:21],0
Zm v[22:23],0
Zm v[24:25],0
Zm v[26:27],0
Zm v[28:29],0
Zm v[30:31],0
Zm v[32:33],0
Zm v[34:35],0
Zm v[36:37],0
Zm v[38:39],0
Zf vmcnt(0) lgkmcnt(0)
CS_w1:
Zt v6,v[12:15] offset:3072
Zt v6,v[40:43] offset:4096
Zt v6,v[44:47] offset:5120
Zg v[16:19],v[12:15],v[48:55],v1
Zb s19,s18,2048
Zh v[48:51],v0,s[4:7],s19 offen offset:0
Zh v[52:55],v0,s[4:7],s19 offen offset:1024
Zg v[20:23],v[12:15],v[56:63],v1
Zi v[56:59],v5 offset:2048
Zi v[60:63],v5 offset:3072
Zg v[24:27],v[12:15],v[64:71],v1
Zi v[64:67],v5 offset:10240
Zi v[68:71],v5 offset:11264
Zf vmcnt(2)
Zg v[28:31],v[12:15],v[72:79],v1
Zi v[72:75],v5 offset:18432
Zi v[76:79],v5 offset:19456
Zg v[32:35],v[12:15],a[128:135],v1
Zg v[36:39],v[12:15],a[136:143],v1
Zf lgkmcnt(6)
s_barrier
Zi v[12:15],v6 offset:6144
Zg v[16:19],v[40:43],a[144:151],v1
Zf lgkmcnt(5)
Zg v[20:23],v[40:43],v[56:63],v1
Zb s19,s18,8192
Zh v[56:59],v0,s[4:7],s19 offen offset:0
Zh v[60:63],v0,s[4:7],s19 offen offset:1024
Zf lgkmcnt(3)
Zg v[24:27],v[40:43],v[64:71],v1
Zi v[64:67],v5 offset:12288
Zi v[68:71],v5 offset:13312
Zf lgkmcnt(3)
Zg v[28:31],v[40:43],v[72:79],v1
Zi v[72:75],v5 offset:20480
Zi v[76:79],v5 offset:21504
Zg v[32:35],v[40:43],a[152:159],v1
Zg v[36:39],v[40:43],a[160:167],v1
Zg v[16:19],v[44:47],a[168:175],v1
Zi v[40:43],v6 offset:7168
Zf lgkmcnt(3)
Zg v[20:23],v[44:47],v[64:71],v1
Zi v[64:67],v5 offset:14336
Zi v[68:71],v5 offset:15360
Zg v[24:27],v[44:47],a[176:183],v1
Zf lgkmcnt(3)
Zg v[28:31],v[44:47],v[72:79],v1
Zi v[72:75],v5 offset:22528
Zi v[76:79],v5 offset:23552
Zg v[32:35],v[44:47],a[184:191],v1
Zg v[36:39],v[44:47],a[192:199],v1
Zg v[16:19],v[12:15],a[200:207],v1
Zi v[44:47],v6 offset:8192
Zf lgkmcnt(3)
Zg v[20:23],v[12:15],v[64:71],v1
Zb s19,s18,12288
Zh v[64:67],v0,s[4:7],s19 offen offset:0
Zh v[68:71],v0,s[4:7],s19 offen offset:1024
Zg v[24:27],v[12:15],a[208:215],v1
Zf lgkmcnt(1)
Zg v[28:31],v[12:15],v[72:79],v1
Zi v[72:75],v5 offset:24576
Zi v[76:79],v5 offset:25600
Zg v[32:35],v[12:15],a[216:223],v1
Zg v[36:39],v[12:15],a[224:231],v1
Zg v[16:19],v[40:43],a[232:239],v1
Zi v[12:15],v6 offset:9216
Zg v[20:23],v[40:43],a[240:247],v1
Zf vmcnt(4)
Zg v[24:27],v[40:43],v[48:55],v1
Zi v[48:51],v5 offset:0
Zi v[52:55],v5 offset:1024
Zf lgkmcnt(3)
Zg v[28:31],v[40:43],v[72:79],v1
Zb s19,s18,16384
Zh v[72:75],v0,s[4:7],s19 offen offset:0
Zh v[76:79],v0,s[4:7],s19 offen offset:1024
Zg v[32:35],v[40:43],a[248:255],v1
Zg v[36:39],v[40:43],v[80:87],v1
Zg v[16:19],v[44:47],v[88:95],v1
Zi v[40:43],v0 offset:0
Zg v[20:23],v[44:47],v[96:103],v1
Zf lgkmcnt(1)
Zg v[24:27],v[44:47],v[48:55],v1
Zb s19,s18,4096
Zh v[48:51],v0,s[4:7],s19 offen offset:0
Zh v[52:55],v0,s[4:7],s19 offen offset:1024
Zg v[28:31],v[44:47],v[104:111],v1
Zg v[32:35],v[44:47],v[112:119],v1
Zf vmcnt(6)
Zg v[36:39],v[44:47],v[56:63],v1
Zb s34,s17,655360
Zi v[56:59],v5 offset:4096
Zi v[60:63],v5 offset:5120
Zg v[16:19],v[12:15],v[120:127],v1
Zi v[44:47],v0 offset:1024
Zo s10,63
s_cselect_b32 s34, s17, s34
Zg v[20:23],v[12:15],v[128:135],v1
s_xor_b32 s37, s37, 8192
Zg v[24:27],v[12:15],v[136:143],v1
Zg v[28:31],v[12:15],v[144:151],v1
Zg v[32:35],v[12:15],v[152:159],v1
Zf lgkmcnt(1)
Zg v[36:39],v[12:15],v[56:63],v1
Zi v[56:59],v5 offset:6144
Zi v[60:63],v5 offset:7168
Zg v[16:19],v[40:43],v[160:167],v1
Zi v[12:15],v6 offset:2048
Zg v[20:23],v[40:43],v[168:175],v1
Zg v[24:27],v[40:43],v[176:183],v1
Zf vmcnt(4)
Zg v[28:31],v[40:43],v[64:71],v1
Zi v[64:67],v5 offset:16384
Zi v[68:71],v5 offset:17408
Zf lgkmcnt(5)
Zg v[16:19],v[44:47],v[184:191],v1
Zf lgkmcnt(3)
Zg v[20:23],v[44:47],v[56:63],v1
Zi v[56:59],v5 offset:8192
Zi v[60:63],v5 offset:9216
Zf lgkmcnt(4)
Zg v[16:19],v[12:15],v[192:199],v1
Zg v[20:23],v[12:15],v[200:207],v1
Zg v[24:27],v[44:47],v[208:215],v1
v_xor_b32 v6, 8192, v6
Zf lgkmcnt(2)
Zg v[28:31],v[44:47],v[64:71],v1
Zl v16,v16,v18
Zb s19,s17,10240
Zh v[64:67],v0,s[4:7],s19 offen sc1 nt
Zh v[68:71],v0,s[4:7],s19 offen offset:1024 sc1 nt
Zf vmcnt(4)
Zg v[24:27],v[12:15],v[72:79],v1
Zl v17,v17,v19
Zf lgkmcnt(0)
Zg v[28:31],v[12:15],v[56:63],v1
Zl v20,v20,v22
Zg v[32:35],v[12:15],v[216:223],v1
Zl v21,v21,v23
Zw v16,s21,v16
Zi v[72:75],v6 offset:2048
Zi v[76:79],v6 offset:6144
Zg v[36:39],v[12:15],v[224:231],v1
Zw v17,s21,v17
Zw v20,s21,v20
Zw v21,s21,v21
Zj v18,v16,v20
Zj v19,v17,v21
ds_write2_b32 v8, v18, v19 offset0:0 offset1:72
Zi v[56:59],v6 offset:3072
Zi v[60:63],v6 offset:7168
Zl v24,v24,v26
Zl v25,v25,v27
Zl v28,v28,v30
Zl v29,v29,v31
Zj v12,v24,v28
Zj v13,v25,v29
ds_write_b32 v8, v12 offset:2304
ds_write_b32 v8, v13 offset:2592
Zg v[32:35],v[44:47],v[232:239],v1
Zg v[36:39],v[44:47],v[240:247],v1
Zf lgkmcnt(0)
s_barrier
Zi v[16:19],v9 offset:0
Zi v[20:23],v10 offset:0
Zi v[24:27],v9 offset:64
Zi v[28:31],v10 offset:64
Zg v[32:35],v[40:43],v[248:255],v1
Zf vmcnt(2)
Zg v[36:39],v[40:43],v[48:55],v1
Zi v[48:51],v6 offset:4096
Zi v[52:55],v6 offset:8192
s_nop 1
Zl v32,v32,v34
Zl v33,v33,v35
s_nop 1
Zl v36,v36,v38
Zl v37,v37,v39
Zj v14,v32,v33
Zj v15,v36,v37
Zr v[12:15],v0,s[4:7],s27 offen sc1 nt
Zf lgkmcnt(5)
Ze v[44:47],v[76:79],v[16:19],0
Zf lgkmcnt(4)
Ze v[32:35],v[20:23],v[16:19],0
Ze v[40:43],v[72:75],v[16:19],0
Zi v[16:19],v9 offset:128
Zi v[20:23],v10 offset:128
Zi v[72:75],v6 offset:5120
Zi v[76:79],v6 offset:9216
Zb m0,s37,4096
Zb s19,s34,2048
Zh v0,s[4:7],s19 offen sc1 nt lds
Zf lgkmcnt(7)
Ze v[44:47],v[60:63],v[24:27],v[44:47]
Zs v36,0x3f803f80
Zs v37,0x3f803f80
Zf lgkmcnt(6)
Ze v[32:35],v[28:31],v[24:27],v[32:35]
Zs v38,0x3f803f80
Zs v39,0x3f803f80
Ze v[40:43],v[56:59],v[24:27],v[40:43]
Zi v[24:27],v9 offset:192
Zi v[28:31],v10 offset:192
Zi v[56:59],v5 offset:30720
Zi v[60:63],v5 offset:31744
Zb m0,s37,5120
Zb s19,s34,3072
Zh v0,s[4:7],s19 offen sc1 nt lds
Zf lgkmcnt(7)
Ze v[44:47],v[52:55],v[16:19],v[44:47]
Zf lgkmcnt(6)
Ze v[32:35],v[20:23],v[16:19],v[32:35]
Ze v[40:43],v[48:51],v[16:19],v[40:43]
Zi v[48:51],v5 offset:26624
Zi v[52:55],v5 offset:27648
Zf lgkmcnt(5)
Ze v[44:47],v[76:79],v[24:27],v[44:47]
Zs v21,0
Zs v22,0
Zf lgkmcnt(4)
Ze v[32:35],v[28:31],v[24:27],v[32:35]
Ze v[40:43],v[72:75],v[24:27],v[40:43]
Zp s23,0
SX_w1:
Zn v76,v44
Zn v77,v45
Zn v78,v46
Zn v79,v47
Zn v24,v32
Zn v25,v33
s_nop 0
Zn v72,v40
Zn v73,v41
Zn v74,v42
Zn v75,v43
Zj v18,v76,v77
Zj v19,v78,v79
Zj v16,v72,v73
Zj v17,v74,v75
Zj v20,v24,v25
Zj v23,v24,v25
Ze v[72:75],v[36:39],v[16:19],0
Zf vmcnt(4)
Ze v[24:27],v[64:67],v[16:19],0
Zf vmcnt(3)
Ze v[28:31],v[68:71],v[16:19],0
v_mfma_f32_16x16x16_bf16 v[72:75], v[36:37], v[20:21], v[72:75]
v_mfma_f32_16x16x16_bf16 v[24:27], v[14:15], v[20:21], v[24:27]
Zm v[76:77],0
Zm v[78:79],0
v_mfma_f32_16x16x16_bf16 v[28:31], v[14:15], v[22:23], v[28:31]
s_nop 2
v_subrev_u32 v73, s32, v72
v_rcp_f32 v74, v72
v_cmp_le_u32 vcc, s33, v73
Zs v75,v74
s_cbranch_vccnz FB_w1
SO_w1:
v_pk_mul_f32 v[24:25], v[24:25], v[74:75]
v_pk_mul_f32 v[26:27], v[26:27], v[74:75]
v_pk_mul_f32 v[28:29], v[28:29], v[74:75]
v_pk_mul_f32 v[30:31], v[30:31], v[74:75]
Zj v24,v24,v28
Zj v25,v25,v29
Zj v26,v26,v30
Zj v27,v27,v31
Zt v11,v[24:27]
Zm v[72:73],0
Zm v[74:75],0
Zm v[16:17],0
Zm v[18:19],0
Zm v[20:21],0
Zm v[22:23],0
Zm v[64:65],0
Zm v[66:67],0
Zm v[68:69],0
Zm v[70:71],0
Zf lgkmcnt(0)
s_barrier
Zi v[40:43],v0 offset:0
Zi v[44:47],v0 offset:1024
Zo s10,63
Zk CE_w1
Zm v[24:25],0
Zm v[26:27],0
Zm v[28:29],0
Zm v[30:31],0
Zb s17,s17,655360
Zf lgkmcnt(1)
Zg v[72:75],v[40:43],v[48:55],v1
Zm v[32:33],0
Zi v[48:51],v5 offset:28672
Zi v[52:55],v5 offset:29696
Zf lgkmcnt(2)
Zg v[72:75],v[44:47],v[56:63],v1
Zm v[34:35],0
Zi v[56:59],v5 offset:32768
Zi v[60:63],v5 offset:33792
Zg v[76:79],v[40:43],a[0:7],v1
Zm v[36:37],0
Zg v[76:79],v[44:47],a[8:15],v1
Zm v[38:39],0
Zg v[16:19],v[40:43],a[16:23],v1
Zl v72,v72,v74
Zg v[16:19],v[44:47],a[24:31],v1
Zl v73,v73,v75
Zg v[20:23],v[40:43],a[32:39],v1
Zl v76,v76,v78
Zf lgkmcnt(2)
Zg v[20:23],v[44:47],v[48:55],v1
Zl v77,v77,v79
Zf lgkmcnt(0)
Zg v[64:67],v[40:43],v[56:63],v1
Zl v16,v16,v18
Zg v[64:67],v[44:47],a[40:47],v1
Zl v17,v17,v19
Zg v[68:71],v[40:43],a[48:55],v1
Zl v20,v20,v22
Zj v12,v72,v76
Zg v[68:71],v[44:47],a[56:63],v1
Zl v21,v21,v23
Zj v48,v73,v77
Zg v[24:27],v[40:43],a[64:71],v1
Zl v64,v64,v66
Zj v13,v16,v20
Zg v[24:27],v[44:47],a[72:79],v1
Zl v65,v65,v67
Zj v49,v17,v21
Zg v[28:31],v[40:43],a[80:87],v1
Zl v68,v68,v70
v_bfi_b32 v12, 1, s39, v12
Zg v[28:31],v[44:47],a[88:95],v1
Zl v69,v69,v71
v_bfi_b32 v48, 1, s39, v48
Zg v[32:35],v[40:43],a[96:103],v1
Zl v24,v24,v26
Zj v14,v64,v68
Zg v[32:35],v[44:47],a[104:111],v1
Zl v25,v25,v27
Zj v50,v65,v69
Zg v[36:39],v[40:43],a[112:119],v1
Zl v28,v28,v30
Zj v15,v24,v28
Zr v[12:15],v2,s[4:7],s12 offen
Zg v[36:39],v[44:47],a[120:127],v1
Zl v29,v29,v31
Zj v51,v25,v29
Zr v[48:51],v2,s[4:7],s12 offen offset:1280
Zl v32,v32,v34
Zl v33,v33,v35
s_nop 2
Zl v36,v36,v38
Zj v56,v32,v36
v_bfi_b32 v56, 1, s39, v56
Zu v56,v3,s[4:7],s12 offen offset:0
Zl v37,v37,v39
Zj v57,v33,v37
v_bfi_b32 v57, 1, s39, v57
Zu v57,v3,s[4:7],s12 offen offset:1280
s_xor_b32 s16, s15, 0x4000
Zb s10,s10,1
Zb s11,s11,1
Zb s27,s27,655360
Zi v[12:15],v0 offset:23040
Zm v[38:39],-1
Zy v40,0x60,v0
v_lshl_add_u32 v40, v40, 3, s38
Zy v41,0x10,v0
v_lshl_add_u32 v40, v41, 1, v40
v_lshrrev_b32 v41, 5, v0
Zy v41,8,v41
v_add_u32 v40, v40, v41
Zy v41,0x280,v0
Zs v42,2130706432
v_cmp_ne_u32 vcc, 0, v41
s_nop 1
v_cndmask_b32 v40, v40, v42, vcc
Zf vmcnt(0)
Zf lgkmcnt(0)
Zh v[16:19],v4,s[4:7],s12 offen sc1
Zh v[20:23],v4,s[4:7],s13 offen sc1
Zh v[24:27],v4,s[4:7],s14 offen sc1
Zh v[28:31],v4,s[4:7],s59 offen sc1
Zb s19,s18,0
Zh v[48:51],v0,s[4:7],s19 offen offset:0
Zh v[52:55],v0,s[4:7],s19 offen offset:1024
Zb s19,s18,6144
Zh v[56:59],v0,s[4:7],s19 offen offset:0
Zh v[60:63],v0,s[4:7],s19 offen offset:1024
Zf vmcnt(7)
Ze v[32:35],v[12:15],v[16:19],0
v_xor_b32 v36, s39, v16
v_xor_b32 v37, v17, v16
Zv v37,v37,v18,v16 bitop3:0xf6
Zv v37,v37,v19,v16 bitop3:0xf6
Zf vmcnt(6)
Ze v[32:35],v[12:15],v[20:23],v[32:35]
Zv v36,v36,v20,s39 bitop3:0xf6
Zv v37,v37,v21,v20 bitop3:0xf6
Zv v37,v37,v22,v20 bitop3:0xf6
Zv v37,v37,v23,v20 bitop3:0xf6
Zf vmcnt(5)
Ze v[32:35],v[12:15],v[24:27],v[32:35]
Zv v36,v36,v24,s39 bitop3:0xf6
Zv v37,v37,v25,v24 bitop3:0xf6
Zv v37,v37,v26,v24 bitop3:0xf6
Zv v37,v37,v27,v24 bitop3:0xf6
Zf vmcnt(4)
Ze v[32:35],v[12:15],v[28:31],v[32:35]
Zv v36,v36,v28,s39 bitop3:0xf6
Zv v37,v37,v29,v28 bitop3:0xf6
Zv v37,v37,v30,v28 bitop3:0xf6
Zv v37,v37,v31,v28 bitop3:0xf6
v_and_or_b32 v36, v37, s36, v36
Zy v36,1,v36
v_cmp_ne_u32 vcc, 0, v36
s_cbranch_vccz P1D_w1
P1_w1:
Zh v[16:19],v4,s[4:7],s12 offen sc1
Zh v[20:23],v4,s[4:7],s13 offen sc1
Zh v[24:27],v4,s[4:7],s14 offen sc1
Zh v[28:31],v4,s[4:7],s59 offen sc1
Zf vmcnt(3)
Ze v[32:35],v[12:15],v[16:19],0
v_xor_b32 v36, s39, v16
v_xor_b32 v37, v17, v16
Zv v37,v37,v18,v16 bitop3:0xf6
Zv v37,v37,v19,v16 bitop3:0xf6
Zf vmcnt(2)
Ze v[32:35],v[12:15],v[20:23],v[32:35]
Zv v36,v36,v20,s39 bitop3:0xf6
Zv v37,v37,v21,v20 bitop3:0xf6
Zv v37,v37,v22,v20 bitop3:0xf6
Zv v37,v37,v23,v20 bitop3:0xf6
Zf vmcnt(1)
Ze v[32:35],v[12:15],v[24:27],v[32:35]
Zv v36,v36,v24,s39 bitop3:0xf6
Zv v37,v37,v25,v24 bitop3:0xf6
Zv v37,v37,v26,v24 bitop3:0xf6
Zv v37,v37,v27,v24 bitop3:0xf6
Zf vmcnt(0)
Ze v[32:35],v[12:15],v[28:31],v[32:35]
Zv v36,v36,v28,s39 bitop3:0xf6
Zv v37,v37,v29,v28 bitop3:0xf6
Zv v37,v37,v30,v28 bitop3:0xf6
Zv v37,v37,v31,v28 bitop3:0xf6
v_and_or_b32 v36, v37, s36, v36
Zy v36,1,v36
v_cmp_ne_u32 vcc, 0, v36
s_cbranch_vccz P1D_w1
s_sub_u32 s20, s20, 1
s_cmp_gt_i32 s20, 0
Zk P1_w1
P1D_w1:
v_add_f32_dpp v16, v32, v32 row_shl:8 row_mask:0xf bank_mask:0xf bound_ctrl:1
v_add_f32_dpp v17, v33, v33 row_shl:8 row_mask:0xf bank_mask:0xf bound_ctrl:1
v_add_f32_dpp v18, v34, v34 row_shl:8 row_mask:0xf bank_mask:0xf bound_ctrl:1
v_add_f32_dpp v19, v35, v35 row_shl:8 row_mask:0xf bank_mask:0xf bound_ctrl:1
Zj v36,v16,v17
Zj v37,v18,v19
buffer_store_dwordx2 v[36:37], v40, s[4:7], s15 offen
buffer_store_dwordx2 v[38:39], v40, s[4:7], s16 offen
s_barrier
Zb s19,s18,10240
Zh v[64:67],v0,s[4:7],s19 offen offset:0
Zh v[68:71],v0,s[4:7],s19 offen offset:1024
Zm v[18:19],0
Zm v[20:21],0
Zm v[22:23],0
Zm v[24:25],0
Zm v[26:27],0
Zm v[28:29],0
Zm v[30:31],0
Zm v[32:33],0
Zm v[34:35],0
Zm v[36:37],0
Zm v[38:39],0
s_xor_b32 s39, s39, 1
Zb s22,s15,3072
Zf lgkmcnt(0)
Zh v[12:15],v0,s[4:7],s22 offen offset:0 sc1
Zh v[40:43],v0,s[4:7],s22 offen offset:1024 sc1
Zh v[44:47],v0,s[4:7],s22 offen offset:2048 sc1
Zf vmcnt(2)
Zb s19,s18,14336
Zh v[72:75],v0,s[4:7],s19 offen offset:0
Zh v[76:79],v0,s[4:7],s19 offen offset:1024
v_max3_u32 v16, v12, v13, v14
Zf vmcnt(3)
v_max3_u32 v16, v16, v15, v40
v_max3_u32 v16, v16, v41, v42
Zf vmcnt(2)
v_max3_u32 v16, v16, v43, v44
v_max3_u32 v16, v16, v45, v46
v_max_u32 v16, v16, v47
v_cmp_eq_u32 vcc, -1, v16
Zm v[16:17],0
s_cbranch_vccz P2D_w1
P2_w1:
Zh v[12:15],v0,s[4:7],s22 offen offset:0 sc1
Zh v[40:43],v0,s[4:7],s22 offen offset:1024 sc1
Zh v[44:47],v0,s[4:7],s22 offen offset:2048 sc1
Zf vmcnt(2)
v_max3_u32 v16, v12, v13, v14
Zf vmcnt(1)
v_max3_u32 v16, v16, v15, v40
v_max3_u32 v16, v16, v41, v42
Zf vmcnt(0)
v_max3_u32 v16, v16, v43, v44
v_max3_u32 v16, v16, v45, v46
v_max_u32 v16, v16, v47
v_cmp_eq_u32 vcc, -1, v16
Zm v[16:17],0
s_cbranch_vccz P2D_w1
s_sub_u32 s20, s20, 1
s_cmp_gt_i32 s20, 0
Zk P2_w1
P2D_w1:
Zp s15,s16
s_branch CS_w1
FB_w1:
s_cmp_lg_u32 s23, 0
Zk SO_w1
Zp s23,1
s_nop 11
v_max3_f32 v24, v40, v41, v42
v_max3_f32 v24, v24, v43, v44
v_max3_f32 v24, v24, v45, v46
v_max3_f32 v24, v24, v47, v32
v_max_f32 v24, v24, v33
Zs v25,v24
s_nop 1
v_permlane32_swap_b32 v24, v25
v_max_f32 v24, v24, v25
Zs v25,v24
s_nop 1
v_permlane16_swap_b32 v24, v25
v_max_f32 v24, v24, v25
Zx v40,v40,v24
Zx v41,v41,v24
Zx v42,v42,v24
Zx v43,v43,v24
Zx v44,v44,v24
Zx v45,v45,v24
Zx v46,v46,v24
Zx v47,v47,v24
Zx v32,v32,v24
Zx v33,v33,v24
Zf lgkmcnt(0)
s_branch SX_w1
CE_w1:
Zf vmcnt(0) lgkmcnt(0)
s_barrier
Zb s11,s11,1
Zb s27,s27,655360
Zb s17,s17,655360
Zp s15,2129920
Zf vmcnt(0)
s_cmp_lt_u32 s11, 128
Zk CL_w1
s_endpgm
L_w2:
Zy v0,63,v0
Zy v12,15,v0
v_lshrrev_b32 v13, 4, v0
Zz v0,4,v0
Zp s22,0x05040100
Zp s23,0x07060302
v_add_u32 v5, 94208, v0
s_mul_i32 s18, s8, 73728
Zb s18,s18,3182592
v_lshrrev_b32 v14, 1, v13
Zz v14,4,v14
Zy v1,1,v13
v_lshl_add_u32 v14, v1, 2, v14
s_load_dwordx2 s[24:25], s[0:1], 80
Zp s26,5242880
Zp s27,0x20000
v_mul_u32_u24 v2, 1280, v14
v_lshl_add_u32 v3, v12, 2, v2
v_lshl_add_u32 v2, v12, 4, v2
v_add_u32 v2, 512, v2
v_add_u32 v3, 1152, v3
s_mul_i32 s17, s8, 163840
Zb s19,s17,0
Zf lgkmcnt(0)
Zh v[80:83],v2,s[24:27],s19 offen
Za v208,v3,s[24:27],s19 offen
Zb s19,s17,1280
Zh v[84:87],v2,s[24:27],s19 offen
Za v209,v3,s[24:27],s19 offen
Zb s19,s17,10240
Zh v[88:91],v2,s[24:27],s19 offen
Za v210,v3,s[24:27],s19 offen
Zb s19,s17,11520
Zh v[92:95],v2,s[24:27],s19 offen
Za v211,v3,s[24:27],s19 offen
Zb s19,s17,2560
Zh v[96:99],v2,s[24:27],s19 offen
Za v212,v3,s[24:27],s19 offen
Zb s19,s17,3840
Zh v[100:103],v2,s[24:27],s19 offen
Za v213,v3,s[24:27],s19 offen
Zb s19,s17,12800
Zh v[104:107],v2,s[24:27],s19 offen
Za v214,v3,s[24:27],s19 offen
Zb s19,s17,14080
Zh v[108:111],v2,s[24:27],s19 offen
Za v215,v3,s[24:27],s19 offen
Zb s19,s17,40960
Zh v[112:115],v2,s[24:27],s19 offen
Za v216,v3,s[24:27],s19 offen
Zb s19,s17,42240
Zh v[116:119],v2,s[24:27],s19 offen
Za v217,v3,s[24:27],s19 offen
Zb s19,s17,51200
Zh v[120:123],v2,s[24:27],s19 offen
Za v218,v3,s[24:27],s19 offen
Zb s19,s17,52480
Zh v[124:127],v2,s[24:27],s19 offen
Za v219,v3,s[24:27],s19 offen
Zb s19,s17,43520
Zh v[128:131],v2,s[24:27],s19 offen
Za v220,v3,s[24:27],s19 offen
Zb s19,s17,44800
Zh v[132:135],v2,s[24:27],s19 offen
Za v221,v3,s[24:27],s19 offen
Zb s19,s17,53760
Zh v[136:139],v2,s[24:27],s19 offen
Za v222,v3,s[24:27],s19 offen
Zb s19,s17,55040
Zh v[140:143],v2,s[24:27],s19 offen
Za v223,v3,s[24:27],s19 offen
Zb s19,s17,81920
Zh v[144:147],v2,s[24:27],s19 offen
Za v224,v3,s[24:27],s19 offen
Zb s19,s17,83200
Zh v[148:151],v2,s[24:27],s19 offen
Za v225,v3,s[24:27],s19 offen
Zb s19,s17,92160
Zh v[152:155],v2,s[24:27],s19 offen
Za v226,v3,s[24:27],s19 offen
Zb s19,s17,93440
Zh v[156:159],v2,s[24:27],s19 offen
Za v227,v3,s[24:27],s19 offen
Zb s19,s17,84480
Zh v[160:163],v2,s[24:27],s19 offen
Za v228,v3,s[24:27],s19 offen
Zb s19,s17,85760
Zh v[164:167],v2,s[24:27],s19 offen
Za v229,v3,s[24:27],s19 offen
Zb s19,s17,94720
Zh v[168:171],v2,s[24:27],s19 offen
Za v230,v3,s[24:27],s19 offen
Zb s19,s17,96000
Zh v[172:175],v2,s[24:27],s19 offen
Za v231,v3,s[24:27],s19 offen
Zb s19,s17,122880
Zh v[176:179],v2,s[24:27],s19 offen
Za v232,v3,s[24:27],s19 offen
Zb s19,s17,124160
Zh v[180:183],v2,s[24:27],s19 offen
Za v233,v3,s[24:27],s19 offen
Zb s19,s17,133120
Zh v[184:187],v2,s[24:27],s19 offen
Za v234,v3,s[24:27],s19 offen
Zb s19,s17,134400
Zh v[188:191],v2,s[24:27],s19 offen
Za v235,v3,s[24:27],s19 offen
Zb s19,s17,125440
Zh v[192:195],v2,s[24:27],s19 offen
Za v236,v3,s[24:27],s19 offen
Zb s19,s17,126720
Zh v[196:199],v2,s[24:27],s19 offen
Za v237,v3,s[24:27],s19 offen
Zb s19,s17,135680
Zh v[200:203],v2,s[24:27],s19 offen
Za v238,v3,s[24:27],s19 offen
Zb s19,s17,136960
Zh v[204:207],v2,s[24:27],s19 offen
Za v239,v3,s[24:27],s19 offen
Zf vmcnt(62)
Zf vmcnt(61)
Zc v72,v84,v80,s22
Zf vmcnt(57)
Zc v73,v92,v88,s22
Zf vmcnt(53)
Zc v74,v100,v96,s22
Zf vmcnt(49)
Zc v75,v108,v104,s22
Zf vmcnt(45)
Zc v76,v116,v112,s22
Zf vmcnt(41)
Zc v77,v124,v120,s22
Zf vmcnt(37)
Zc v78,v132,v128,s22
Zf vmcnt(33)
Zc v79,v140,v136,s22
Zt v5,v[72:75] offset:26624
Zt v5,v[76:79] offset:27648
Zc v64,v84,v80,s23
Zc v65,v92,v88,s23
Zc v66,v100,v96,s23
Zc v67,v108,v104,s23
Zc v68,v116,v112,s23
Zc v69,v124,v120,s23
Zc v70,v132,v128,s23
Zc v71,v140,v136,s23
Zd a0,v64
Zd a1,v65
Zd a2,v66
Zd a3,v67
Zd a4,v68
Zd a5,v69
Zd a6,v70
Zd a7,v71
Zc v72,v85,v81,s22
Zc v73,v93,v89,s22
Zc v74,v101,v97,s22
Zc v75,v109,v105,s22
Zc v76,v117,v113,s22
Zc v77,v125,v121,s22
Zc v78,v133,v129,s22
Zc v79,v141,v137,s22
Zd a16,v72
Zd a17,v73
Zd a18,v74
Zd a19,v75
Zd a20,v76
Zd a21,v77
Zd a22,v78
Zd a23,v79
Zc v64,v85,v81,s23
Zc v65,v93,v89,s23
Zc v66,v101,v97,s23
Zc v67,v109,v105,s23
Zc v68,v117,v113,s23
Zc v69,v125,v121,s23
Zc v70,v133,v129,s23
Zc v71,v141,v137,s23
Zd a32,v64
Zd a33,v65
Zd a34,v66
Zd a35,v67
Zd a36,v68
Zd a37,v69
Zd a38,v70
Zd a39,v71
Zc v72,v86,v82,s22
Zc v73,v94,v90,s22
Zc v74,v102,v98,s22
Zc v75,v110,v106,s22
Zc v76,v118,v114,s22
Zc v77,v126,v122,s22
Zc v78,v134,v130,s22
Zc v79,v142,v138,s22
Zt v5,v[72:75] offset:32768
Zt v5,v[76:79] offset:33792
Zc v64,v86,v82,s23
Zc v65,v94,v90,s23
Zc v66,v102,v98,s23
Zc v67,v110,v106,s23
Zc v68,v118,v114,s23
Zc v69,v126,v122,s23
Zc v70,v134,v130,s23
Zc v71,v142,v138,s23
Zd a48,v64
Zd a49,v65
Zd a50,v66
Zd a51,v67
Zd a52,v68
Zd a53,v69
Zd a54,v70
Zd a55,v71
Zc v72,v87,v83,s22
Zc v73,v95,v91,s22
Zc v74,v103,v99,s22
Zc v75,v111,v107,s22
Zc v76,v119,v115,s22
Zc v77,v127,v123,s22
Zc v78,v135,v131,s22
Zc v79,v143,v139,s22
Zd a64,v72
Zd a65,v73
Zd a66,v74
Zd a67,v75
Zd a68,v76
Zd a69,v77
Zd a70,v78
Zd a71,v79
Zc v64,v87,v83,s23
Zc v65,v95,v91,s23
Zc v66,v103,v99,s23
Zc v67,v111,v107,s23
Zc v68,v119,v115,s23
Zc v69,v127,v123,s23
Zc v70,v135,v131,s23
Zc v71,v143,v139,s23
Zd a80,v64
Zd a81,v65
Zd a82,v66
Zd a83,v67
Zd a84,v68
Zd a85,v69
Zd a86,v70
Zd a87,v71
Zc v72,v209,v208,s22
Zc v73,v211,v210,s22
Zc v74,v213,v212,s22
Zc v75,v215,v214,s22
Zc v76,v217,v216,s22
Zc v77,v219,v218,s22
Zc v78,v221,v220,s22
Zf vmcnt(32)
Zc v79,v223,v222,s22
Zd a96,v72
Zd a97,v73
Zd a98,v74
Zd a99,v75
Zd a100,v76
Zd a101,v77
Zd a102,v78
Zd a103,v79
Zc v64,v209,v208,s23
Zc v65,v211,v210,s23
Zc v66,v213,v212,s23
Zc v67,v215,v214,s23
Zc v68,v217,v216,s23
Zc v69,v219,v218,s23
Zc v70,v221,v220,s23
Zc v71,v223,v222,s23
Zd a112,v64
Zd a113,v65
Zd a114,v66
Zd a115,v67
Zd a116,v68
Zd a117,v69
Zd a118,v70
Zd a119,v71
Zf vmcnt(29)
Zc v72,v148,v144,s22
Zf vmcnt(25)
Zc v73,v156,v152,s22
Zf vmcnt(21)
Zc v74,v164,v160,s22
Zf vmcnt(17)
Zc v75,v172,v168,s22
Zf vmcnt(13)
Zc v76,v180,v176,s22
Zf vmcnt(9)
Zc v77,v188,v184,s22
Zf vmcnt(5)
Zc v78,v196,v192,s22
Zf vmcnt(1)
Zc v79,v204,v200,s22
Zt v5,v[72:75] offset:30720
Zt v5,v[76:79] offset:31744
Zc v64,v148,v144,s23
Zc v65,v156,v152,s23
Zc v66,v164,v160,s23
Zc v67,v172,v168,s23
Zc v68,v180,v176,s23
Zc v69,v188,v184,s23
Zc v70,v196,v192,s23
Zc v71,v204,v200,s23
Zd a8,v64
Zd a9,v65
Zd a10,v66
Zd a11,v67
Zd a12,v68
Zd a13,v69
Zd a14,v70
Zd a15,v71
Zc v72,v149,v145,s22
Zc v73,v157,v153,s22
Zc v74,v165,v161,s22
Zc v75,v173,v169,s22
Zc v76,v181,v177,s22
Zc v77,v189,v185,s22
Zc v78,v197,v193,s22
Zc v79,v205,v201,s22
Zd a24,v72
Zd a25,v73
Zd a26,v74
Zd a27,v75
Zd a28,v76
Zd a29,v77
Zd a30,v78
Zd a31,v79
Zc v64,v149,v145,s23
Zc v65,v157,v153,s23
Zc v66,v165,v161,s23
Zc v67,v173,v169,s23
Zc v68,v181,v177,s23
Zc v69,v189,v185,s23
Zc v70,v197,v193,s23
Zc v71,v205,v201,s23
Zt v5,v[64:67] offset:28672
Zt v5,v[68:71] offset:29696
Zc v72,v150,v146,s22
Zc v73,v158,v154,s22
Zc v74,v166,v162,s22
Zc v75,v174,v170,s22
Zc v76,v182,v178,s22
Zc v77,v190,v186,s22
Zc v78,v198,v194,s22
Zc v79,v206,v202,s22
Zd a40,v72
Zd a41,v73
Zd a42,v74
Zd a43,v75
Zd a44,v76
Zd a45,v77
Zd a46,v78
Zd a47,v79
Zc v64,v150,v146,s23
Zc v65,v158,v154,s23
Zc v66,v166,v162,s23
Zc v67,v174,v170,s23
Zc v68,v182,v178,s23
Zc v69,v190,v186,s23
Zc v70,v198,v194,s23
Zc v71,v206,v202,s23
Zd a56,v64
Zd a57,v65
Zd a58,v66
Zd a59,v67
Zd a60,v68
Zd a61,v69
Zd a62,v70
Zd a63,v71
Zc v72,v151,v147,s22
Zc v73,v159,v155,s22
Zc v74,v167,v163,s22
Zc v75,v175,v171,s22
Zc v76,v183,v179,s22
Zc v77,v191,v187,s22
Zc v78,v199,v195,s22
Zc v79,v207,v203,s22
Zd a72,v72
Zd a73,v73
Zd a74,v74
Zd a75,v75
Zd a76,v76
Zd a77,v77
Zd a78,v78
Zd a79,v79
Zc v64,v151,v147,s23
Zc v65,v159,v155,s23
Zc v66,v167,v163,s23
Zc v67,v175,v171,s23
Zc v68,v183,v179,s23
Zc v69,v191,v187,s23
Zc v70,v199,v195,s23
Zc v71,v207,v203,s23
Zd a88,v64
Zd a89,v65
Zd a90,v66
Zd a91,v67
Zd a92,v68
Zd a93,v69
Zd a94,v70
Zd a95,v71
Zc v72,v225,v224,s22
Zc v73,v227,v226,s22
Zc v74,v229,v228,s22
Zc v75,v231,v230,s22
Zc v76,v233,v232,s22
Zc v77,v235,v234,s22
Zc v78,v237,v236,s22
Zf vmcnt(0)
Zc v79,v239,v238,s22
Zd a104,v72
Zd a105,v73
Zd a106,v74
Zd a107,v75
Zd a108,v76
Zd a109,v77
Zd a110,v78
Zd a111,v79
Zc v64,v225,v224,s23
Zc v65,v227,v226,s23
Zc v66,v229,v228,s23
Zc v67,v231,v230,s23
Zc v68,v233,v232,s23
Zc v69,v235,v234,s23
Zc v70,v237,v236,s23
Zc v71,v239,v238,s23
Zd a120,v64
Zd a121,v65
Zd a122,v66
Zd a123,v67
Zd a124,v68
Zd a125,v69
Zd a126,v70
Zd a127,v71
s_load_dwordx2 s[24:25], s[0:1], 56
Zp s26,5242880
Zp s27,0x20000
s_load_dwordx2 s[28:29], s[0:1], 64
Zp s30,5242880
Zp s31,0x20000
s_load_dwordx2 s[32:33], s[0:1], 72
Zp s34,5242880
Zp s35,0x20000
Zz v2,13,v14
v_lshl_add_u32 v2, v12, 2, v2
v_add_u32 v2, 128, v2
Zq s17,s8,8
Zb s19,s17,0
Zf lgkmcnt(0)
Za v16,v2,s[24:27],s19 offen
Zb s19,s17,8192
Za v17,v2,s[24:27],s19 offen
Zb s19,s17,65536
Za v18,v2,s[24:27],s19 offen
Zb s19,s17,73728
Za v19,v2,s[24:27],s19 offen
Zb s19,s17,16384
Za v20,v2,s[24:27],s19 offen
Zb s19,s17,24576
Za v21,v2,s[24:27],s19 offen
Zb s19,s17,81920
Za v22,v2,s[24:27],s19 offen
Zb s19,s17,90112
Za v23,v2,s[24:27],s19 offen
Zb s19,s17,262144
Za v24,v2,s[24:27],s19 offen
Zb s19,s17,270336
Za v25,v2,s[24:27],s19 offen
Zb s19,s17,327680
Za v26,v2,s[24:27],s19 offen
Zb s19,s17,335872
Za v27,v2,s[24:27],s19 offen
Zb s19,s17,278528
Za v28,v2,s[24:27],s19 offen
Zb s19,s17,286720
Za v29,v2,s[24:27],s19 offen
Zb s19,s17,344064
Za v30,v2,s[24:27],s19 offen
Zb s19,s17,352256
Za v31,v2,s[24:27],s19 offen
Zb s19,s17,524288
Za v32,v2,s[24:27],s19 offen
Zb s19,s17,532480
Za v33,v2,s[24:27],s19 offen
Zb s19,s17,589824
Za v34,v2,s[24:27],s19 offen
Zb s19,s17,598016
Za v35,v2,s[24:27],s19 offen
Zb s19,s17,540672
Za v36,v2,s[24:27],s19 offen
Zb s19,s17,548864
Za v37,v2,s[24:27],s19 offen
Zb s19,s17,606208
Za v38,v2,s[24:27],s19 offen
Zb s19,s17,614400
Za v39,v2,s[24:27],s19 offen
Zb s19,s17,786432
Za v40,v2,s[24:27],s19 offen
Zb s19,s17,794624
Za v41,v2,s[24:27],s19 offen
Zb s19,s17,851968
Za v42,v2,s[24:27],s19 offen
Zb s19,s17,860160
Za v43,v2,s[24:27],s19 offen
Zb s19,s17,802816
Za v44,v2,s[24:27],s19 offen
Zb s19,s17,811008
Za v45,v2,s[24:27],s19 offen
Zb s19,s17,868352
Za v46,v2,s[24:27],s19 offen
Zb s19,s17,876544
Za v47,v2,s[24:27],s19 offen
Zb s19,s17,1048576
Za v48,v2,s[24:27],s19 offen
Zb s19,s17,1056768
Za v49,v2,s[24:27],s19 offen
Zb s19,s17,1114112
Za v50,v2,s[24:27],s19 offen
Zb s19,s17,1122304
Za v51,v2,s[24:27],s19 offen
Zb s19,s17,1064960
Za v52,v2,s[24:27],s19 offen
Zb s19,s17,1073152
Za v53,v2,s[24:27],s19 offen
Zb s19,s17,1130496
Za v54,v2,s[24:27],s19 offen
Zb s19,s17,1138688
Za v55,v2,s[24:27],s19 offen
Zb s19,s17,1310720
Za v56,v2,s[24:27],s19 offen
Zb s19,s17,1318912
Za v57,v2,s[24:27],s19 offen
Zb s19,s17,1376256
Za v58,v2,s[24:27],s19 offen
Zb s19,s17,1384448
Za v59,v2,s[24:27],s19 offen
Zb s19,s17,1327104
Za v60,v2,s[24:27],s19 offen
Zb s19,s17,1335296
Za v61,v2,s[24:27],s19 offen
Zb s19,s17,1392640
Za v62,v2,s[24:27],s19 offen
Zb s19,s17,1400832
Za v63,v2,s[24:27],s19 offen
Zf vmcnt(46)
Zc v72,v17,v16,s22
Zf vmcnt(44)
Zc v73,v19,v18,s22
Zf vmcnt(42)
Zc v74,v21,v20,s22
Zf vmcnt(40)
Zc v75,v23,v22,s22
Zf vmcnt(38)
Zc v76,v25,v24,s22
Zf vmcnt(36)
Zc v77,v27,v26,s22
Zf vmcnt(34)
Zc v78,v29,v28,s22
Zf vmcnt(32)
Zc v79,v31,v30,s22
Zd a232,v72
Zd a233,v73
Zd a234,v74
Zd a235,v75
Zd a236,v76
Zd a237,v77
Zd a238,v78
Zd a239,v79
Zc v64,v17,v16,s23
Zc v65,v19,v18,s23
Zc v66,v21,v20,s23
Zc v67,v23,v22,s23
Zc v68,v25,v24,s23
Zc v69,v27,v26,s23
Zc v70,v29,v28,s23
Zc v71,v31,v30,s23
Zd a240,v64
Zd a241,v65
Zd a242,v66
Zd a243,v67
Zd a244,v68
Zd a245,v69
Zd a246,v70
Zd a247,v71
Zb s19,s17,1572864
Za v16,v2,s[24:27],s19 offen
Zb s19,s17,1581056
Za v17,v2,s[24:27],s19 offen
Zb s19,s17,1638400
Za v18,v2,s[24:27],s19 offen
Zb s19,s17,1646592
Za v19,v2,s[24:27],s19 offen
Zb s19,s17,1589248
Za v20,v2,s[24:27],s19 offen
Zb s19,s17,1597440
Za v21,v2,s[24:27],s19 offen
Zb s19,s17,1654784
Za v22,v2,s[24:27],s19 offen
Zb s19,s17,1662976
Za v23,v2,s[24:27],s19 offen
Zb s19,s17,1835008
Za v24,v2,s[24:27],s19 offen
Zb s19,s17,1843200
Za v25,v2,s[24:27],s19 offen
Zb s19,s17,1900544
Za v26,v2,s[24:27],s19 offen
Zb s19,s17,1908736
Za v27,v2,s[24:27],s19 offen
Zb s19,s17,1851392
Za v28,v2,s[24:27],s19 offen
Zb s19,s17,1859584
Za v29,v2,s[24:27],s19 offen
Zb s19,s17,1916928
Za v30,v2,s[24:27],s19 offen
Zb s19,s17,1925120
Za v31,v2,s[24:27],s19 offen
Zf vmcnt(46)
Zc v88,v33,v32,s22
Zf vmcnt(44)
Zc v89,v35,v34,s22
Zf vmcnt(42)
Zc v90,v37,v36,s22
Zf vmcnt(40)
Zc v91,v39,v38,s22
Zf vmcnt(38)
Zc v92,v41,v40,s22
Zf vmcnt(36)
Zc v93,v43,v42,s22
Zf vmcnt(34)
Zc v94,v45,v44,s22
Zf vmcnt(32)
Zc v95,v47,v46,s22
Zc v96,v33,v32,s23
Zc v97,v35,v34,s23
Zc v98,v37,v36,s23
Zc v99,v39,v38,s23
Zc v100,v41,v40,s23
Zc v101,v43,v42,s23
Zc v102,v45,v44,s23
Zc v103,v47,v46,s23
Zb s19,s17,2097152
Za v32,v2,s[24:27],s19 offen
Zb s19,s17,2105344
Za v33,v2,s[24:27],s19 offen
Zb s19,s17,2162688
Za v34,v2,s[24:27],s19 offen
Zb s19,s17,2170880
Za v35,v2,s[24:27],s19 offen
Zb s19,s17,2113536
Za v36,v2,s[24:27],s19 offen
Zb s19,s17,2121728
Za v37,v2,s[24:27],s19 offen
Zb s19,s17,2179072
Za v38,v2,s[24:27],s19 offen
Zb s19,s17,2187264
Za v39,v2,s[24:27],s19 offen
Zb s19,s17,2359296
Za v40,v2,s[24:27],s19 offen
Zb s19,s17,2367488
Za v41,v2,s[24:27],s19 offen
Zb s19,s17,2424832
Za v42,v2,s[24:27],s19 offen
Zb s19,s17,2433024
Za v43,v2,s[24:27],s19 offen
Zb s19,s17,2375680
Za v44,v2,s[24:27],s19 offen
Zb s19,s17,2383872
Za v45,v2,s[24:27],s19 offen
Zb s19,s17,2441216
Za v46,v2,s[24:27],s19 offen
Zb s19,s17,2449408
Za v47,v2,s[24:27],s19 offen
Zf vmcnt(46)
Zc v120,v49,v48,s22
Zf vmcnt(44)
Zc v121,v51,v50,s22
Zf vmcnt(42)
Zc v122,v53,v52,s22
Zf vmcnt(40)
Zc v123,v55,v54,s22
Zf vmcnt(38)
Zc v124,v57,v56,s22
Zf vmcnt(36)
Zc v125,v59,v58,s22
Zf vmcnt(34)
Zc v126,v61,v60,s22
Zf vmcnt(32)
Zc v127,v63,v62,s22
Zc v128,v49,v48,s23
Zc v129,v51,v50,s23
Zc v130,v53,v52,s23
Zc v131,v55,v54,s23
Zc v132,v57,v56,s23
Zc v133,v59,v58,s23
Zc v134,v61,v60,s23
Zc v135,v63,v62,s23
Zb s19,s17,2621440
Za v48,v2,s[24:27],s19 offen
Zb s19,s17,2629632
Za v49,v2,s[24:27],s19 offen
Zb s19,s17,2686976
Za v50,v2,s[24:27],s19 offen
Zb s19,s17,2695168
Za v51,v2,s[24:27],s19 offen
Zb s19,s17,2637824
Za v52,v2,s[24:27],s19 offen
Zb s19,s17,2646016
Za v53,v2,s[24:27],s19 offen
Zb s19,s17,2703360
Za v54,v2,s[24:27],s19 offen
Zb s19,s17,2711552
Za v55,v2,s[24:27],s19 offen
Zb s19,s17,2883584
Za v56,v2,s[24:27],s19 offen
Zb s19,s17,2891776
Za v57,v2,s[24:27],s19 offen
Zb s19,s17,2949120
Za v58,v2,s[24:27],s19 offen
Zb s19,s17,2957312
Za v59,v2,s[24:27],s19 offen
Zb s19,s17,2899968
Za v60,v2,s[24:27],s19 offen
Zb s19,s17,2908160
Za v61,v2,s[24:27],s19 offen
Zb s19,s17,2965504
Za v62,v2,s[24:27],s19 offen
Zb s19,s17,2973696
Za v63,v2,s[24:27],s19 offen
Zf vmcnt(46)
Zc v160,v17,v16,s22
Zf vmcnt(44)
Zc v161,v19,v18,s22
Zf vmcnt(42)
Zc v162,v21,v20,s22
Zf vmcnt(40)
Zc v163,v23,v22,s22
Zf vmcnt(38)
Zc v164,v25,v24,s22
Zf vmcnt(36)
Zc v165,v27,v26,s22
Zf vmcnt(34)
Zc v166,v29,v28,s22
Zf vmcnt(32)
Zc v167,v31,v30,s22
Zc v168,v17,v16,s23
Zc v169,v19,v18,s23
Zc v170,v21,v20,s23
Zc v171,v23,v22,s23
Zc v172,v25,v24,s23
Zc v173,v27,v26,s23
Zc v174,v29,v28,s23
Zc v175,v31,v30,s23
Zb s19,s17,3145728
Za v16,v2,s[24:27],s19 offen
Zb s19,s17,3153920
Za v17,v2,s[24:27],s19 offen
Zb s19,s17,3211264
Za v18,v2,s[24:27],s19 offen
Zb s19,s17,3219456
Za v19,v2,s[24:27],s19 offen
Zb s19,s17,3162112
Za v20,v2,s[24:27],s19 offen
Zb s19,s17,3170304
Za v21,v2,s[24:27],s19 offen
Zb s19,s17,3227648
Za v22,v2,s[24:27],s19 offen
Zb s19,s17,3235840
Za v23,v2,s[24:27],s19 offen
Zb s19,s17,3407872
Za v24,v2,s[24:27],s19 offen
Zb s19,s17,3416064
Za v25,v2,s[24:27],s19 offen
Zb s19,s17,3473408
Za v26,v2,s[24:27],s19 offen
Zb s19,s17,3481600
Za v27,v2,s[24:27],s19 offen
Zb s19,s17,3424256
Za v28,v2,s[24:27],s19 offen
Zb s19,s17,3432448
Za v29,v2,s[24:27],s19 offen
Zb s19,s17,3489792
Za v30,v2,s[24:27],s19 offen
Zb s19,s17,3497984
Za v31,v2,s[24:27],s19 offen
Zf vmcnt(46)
Zc v184,v33,v32,s22
Zf vmcnt(44)
Zc v185,v35,v34,s22
Zf vmcnt(42)
Zc v186,v37,v36,s22
Zf vmcnt(40)
Zc v187,v39,v38,s22
Zf vmcnt(38)
Zc v188,v41,v40,s22
Zf vmcnt(36)
Zc v189,v43,v42,s22
Zf vmcnt(34)
Zc v190,v45,v44,s22
Zf vmcnt(32)
Zc v191,v47,v46,s22
Zc v64,v33,v32,s23
Zc v65,v35,v34,s23
Zc v66,v37,v36,s23
Zc v67,v39,v38,s23
Zc v68,v41,v40,s23
Zc v69,v43,v42,s23
Zc v70,v45,v44,s23
Zc v71,v47,v46,s23
Zt v5,v[64:67] offset:6144
Zt v5,v[68:71] offset:7168
Zb s19,s17,3670016
Za v32,v2,s[24:27],s19 offen
Zb s19,s17,3678208
Za v33,v2,s[24:27],s19 offen
Zb s19,s17,3735552
Za v34,v2,s[24:27],s19 offen
Zb s19,s17,3743744
Za v35,v2,s[24:27],s19 offen
Zb s19,s17,3686400
Za v36,v2,s[24:27],s19 offen
Zb s19,s17,3694592
Za v37,v2,s[24:27],s19 offen
Zb s19,s17,3751936
Za v38,v2,s[24:27],s19 offen
Zb s19,s17,3760128
Za v39,v2,s[24:27],s19 offen
Zb s19,s17,3932160
Za v40,v2,s[24:27],s19 offen
Zb s19,s17,3940352
Za v41,v2,s[24:27],s19 offen
Zb s19,s17,3997696
Za v42,v2,s[24:27],s19 offen
Zb s19,s17,4005888
Za v43,v2,s[24:27],s19 offen
Zb s19,s17,3948544
Za v44,v2,s[24:27],s19 offen
Zb s19,s17,3956736
Za v45,v2,s[24:27],s19 offen
Zb s19,s17,4014080
Za v46,v2,s[24:27],s19 offen
Zb s19,s17,4022272
Za v47,v2,s[24:27],s19 offen
Zf vmcnt(46)
Zc v192,v49,v48,s22
Zf vmcnt(44)
Zc v193,v51,v50,s22
Zf vmcnt(42)
Zc v194,v53,v52,s22
Zf vmcnt(40)
Zc v195,v55,v54,s22
Zf vmcnt(38)
Zc v196,v57,v56,s22
Zf vmcnt(36)
Zc v197,v59,v58,s22
Zf vmcnt(34)
Zc v198,v61,v60,s22
Zf vmcnt(32)
Zc v199,v63,v62,s22
Zc v200,v49,v48,s23
Zc v201,v51,v50,s23
Zc v202,v53,v52,s23
Zc v203,v55,v54,s23
Zc v204,v57,v56,s23
Zc v205,v59,v58,s23
Zc v206,v61,v60,s23
Zc v207,v63,v62,s23
Zb s19,s17,4194304
Za v48,v2,s[24:27],s19 offen
Zb s19,s17,4202496
Za v49,v2,s[24:27],s19 offen
Zb s19,s17,4259840
Za v50,v2,s[24:27],s19 offen
Zb s19,s17,4268032
Za v51,v2,s[24:27],s19 offen
Zb s19,s17,4210688
Za v52,v2,s[24:27],s19 offen
Zb s19,s17,4218880
Za v53,v2,s[24:27],s19 offen
Zb s19,s17,4276224
Za v54,v2,s[24:27],s19 offen
Zb s19,s17,4284416
Za v55,v2,s[24:27],s19 offen
Zb s19,s17,4456448
Za v56,v2,s[24:27],s19 offen
Zb s19,s17,4464640
Za v57,v2,s[24:27],s19 offen
Zb s19,s17,4521984
Za v58,v2,s[24:27],s19 offen
Zb s19,s17,4530176
Za v59,v2,s[24:27],s19 offen
Zb s19,s17,4472832
Za v60,v2,s[24:27],s19 offen
Zb s19,s17,4481024
Za v61,v2,s[24:27],s19 offen
Zb s19,s17,4538368
Za v62,v2,s[24:27],s19 offen
Zb s19,s17,4546560
Za v63,v2,s[24:27],s19 offen
Zf vmcnt(46)
Zc v72,v17,v16,s22
Zf vmcnt(44)
Zc v73,v19,v18,s22
Zf vmcnt(42)
Zc v74,v21,v20,s22
Zf vmcnt(40)
Zc v75,v23,v22,s22
Zf vmcnt(38)
Zc v76,v25,v24,s22
Zf vmcnt(36)
Zc v77,v27,v26,s22
Zf vmcnt(34)
Zc v78,v29,v28,s22
Zf vmcnt(32)
Zc v79,v31,v30,s22
Zb s19,s18,0
Zr v[72:75],v0,s[4:7],s19 offen
Zr v[76:79],v0,s[4:7],s19 offen offset:1024
Zc v64,v17,v16,s23
Zc v65,v19,v18,s23
Zc v66,v21,v20,s23
Zc v67,v23,v22,s23
Zc v68,v25,v24,s23
Zc v69,v27,v26,s23
Zc v70,v29,v28,s23
Zc v71,v31,v30,s23
Zb s19,s18,6144
Zr v[64:67],v0,s[4:7],s19 offen
Zr v[68:71],v0,s[4:7],s19 offen offset:1024
Zb s19,s17,4718592
Za v16,v2,s[24:27],s19 offen
Zb s19,s17,4726784
Za v17,v2,s[24:27],s19 offen
Zb s19,s17,4784128
Za v18,v2,s[24:27],s19 offen
Zb s19,s17,4792320
Za v19,v2,s[24:27],s19 offen
Zb s19,s17,4734976
Za v20,v2,s[24:27],s19 offen
Zb s19,s17,4743168
Za v21,v2,s[24:27],s19 offen
Zb s19,s17,4800512
Za v22,v2,s[24:27],s19 offen
Zb s19,s17,4808704
Za v23,v2,s[24:27],s19 offen
Zb s19,s17,4980736
Za v24,v2,s[24:27],s19 offen
Zb s19,s17,4988928
Za v25,v2,s[24:27],s19 offen
Zb s19,s17,5046272
Za v26,v2,s[24:27],s19 offen
Zb s19,s17,5054464
Za v27,v2,s[24:27],s19 offen
Zb s19,s17,4997120
Za v28,v2,s[24:27],s19 offen
Zb s19,s17,5005312
Za v29,v2,s[24:27],s19 offen
Zb s19,s17,5062656
Za v30,v2,s[24:27],s19 offen
Zb s19,s17,5070848
Za v31,v2,s[24:27],s19 offen
Zf vmcnt(50)
Zc v72,v33,v32,s22
Zf vmcnt(48)
Zc v73,v35,v34,s22
Zf vmcnt(46)
Zc v74,v37,v36,s22
Zf vmcnt(44)
Zc v75,v39,v38,s22
Zf vmcnt(42)
Zc v76,v41,v40,s22
Zf vmcnt(40)
Zc v77,v43,v42,s22
Zf vmcnt(38)
Zc v78,v45,v44,s22
Zf vmcnt(36)
Zc v79,v47,v46,s22
Zd a144,v72
Zd a145,v73
Zd a146,v74
Zd a147,v75
Zd a148,v76
Zd a149,v77
Zd a150,v78
Zd a151,v79
Zc v64,v33,v32,s23
Zc v65,v35,v34,s23
Zc v66,v37,v36,s23
Zc v67,v39,v38,s23
Zc v68,v41,v40,s23
Zc v69,v43,v42,s23
Zc v70,v45,v44,s23
Zc v71,v47,v46,s23
Zt v5,v[64:67] offset:2048
Zt v5,v[68:71] offset:3072
Zb s19,s17,0
Za v32,v2,s[28:31],s19 offen
Zb s19,s17,8192
Za v33,v2,s[28:31],s19 offen
Zb s19,s17,65536
Za v34,v2,s[28:31],s19 offen
Zb s19,s17,73728
Za v35,v2,s[28:31],s19 offen
Zb s19,s17,16384
Za v36,v2,s[28:31],s19 offen
Zb s19,s17,24576
Za v37,v2,s[28:31],s19 offen
Zb s19,s17,81920
Za v38,v2,s[28:31],s19 offen
Zb s19,s17,90112
Za v39,v2,s[28:31],s19 offen
Zb s19,s17,262144
Za v40,v2,s[28:31],s19 offen
Zb s19,s17,270336
Za v41,v2,s[28:31],s19 offen
Zb s19,s17,327680
Za v42,v2,s[28:31],s19 offen
Zb s19,s17,335872
Za v43,v2,s[28:31],s19 offen
Zb s19,s17,278528
Za v44,v2,s[28:31],s19 offen
Zb s19,s17,286720
Za v45,v2,s[28:31],s19 offen
Zb s19,s17,344064
Za v46,v2,s[28:31],s19 offen
Zb s19,s17,352256
Za v47,v2,s[28:31],s19 offen
Zf vmcnt(50)
Zc v72,v49,v48,s22
Zf vmcnt(48)
Zc v73,v51,v50,s22
Zf vmcnt(46)
Zc v74,v53,v52,s22
Zf vmcnt(44)
Zc v75,v55,v54,s22
Zf vmcnt(42)
Zc v76,v57,v56,s22
Zf vmcnt(40)
Zc v77,v59,v58,s22
Zf vmcnt(38)
Zc v78,v61,v60,s22
Zf vmcnt(36)
Zc v79,v63,v62,s22
Zd a168,v72
Zd a169,v73
Zd a170,v74
Zd a171,v75
Zd a172,v76
Zd a173,v77
Zd a174,v78
Zd a175,v79
Zc v64,v49,v48,s23
Zc v65,v51,v50,s23
Zc v66,v53,v52,s23
Zc v67,v55,v54,s23
Zc v68,v57,v56,s23
Zc v69,v59,v58,s23
Zc v70,v61,v60,s23
Zc v71,v63,v62,s23
Zt v5,v[64:67] offset:12288
Zt v5,v[68:71] offset:13312
Zb s19,s17,524288
Za v48,v2,s[28:31],s19 offen
Zb s19,s17,532480
Za v49,v2,s[28:31],s19 offen
Zb s19,s17,589824
Za v50,v2,s[28:31],s19 offen
Zb s19,s17,598016
Za v51,v2,s[28:31],s19 offen
Zb s19,s17,540672
Za v52,v2,s[28:31],s19 offen
Zb s19,s17,548864
Za v53,v2,s[28:31],s19 offen
Zb s19,s17,606208
Za v54,v2,s[28:31],s19 offen
Zb s19,s17,614400
Za v55,v2,s[28:31],s19 offen
Zb s19,s17,786432
Za v56,v2,s[28:31],s19 offen
Zb s19,s17,794624
Za v57,v2,s[28:31],s19 offen
Zb s19,s17,851968
Za v58,v2,s[28:31],s19 offen
Zb s19,s17,860160
Za v59,v2,s[28:31],s19 offen
Zb s19,s17,802816
Za v60,v2,s[28:31],s19 offen
Zb s19,s17,811008
Za v61,v2,s[28:31],s19 offen
Zb s19,s17,868352
Za v62,v2,s[28:31],s19 offen
Zb s19,s17,876544
Za v63,v2,s[28:31],s19 offen
Zf vmcnt(46)
Zc v72,v17,v16,s22
Zf vmcnt(44)
Zc v73,v19,v18,s22
Zf vmcnt(42)
Zc v74,v21,v20,s22
Zf vmcnt(40)
Zc v75,v23,v22,s22
Zf vmcnt(38)
Zc v76,v25,v24,s22
Zf vmcnt(36)
Zc v77,v27,v26,s22
Zf vmcnt(34)
Zc v78,v29,v28,s22
Zf vmcnt(32)
Zc v79,v31,v30,s22
Zd a200,v72
Zd a201,v73
Zd a202,v74
Zd a203,v75
Zd a204,v76
Zd a205,v77
Zd a206,v78
Zd a207,v79
Zc v64,v17,v16,s23
Zc v65,v19,v18,s23
Zc v66,v21,v20,s23
Zc v67,v23,v22,s23
Zc v68,v25,v24,s23
Zc v69,v27,v26,s23
Zc v70,v29,v28,s23
Zc v71,v31,v30,s23
Zt v5,v[64:67] offset:14336
Zt v5,v[68:71] offset:15360
Zb s19,s17,1048576
Za v16,v2,s[28:31],s19 offen
Zb s19,s17,1056768
Za v17,v2,s[28:31],s19 offen
Zb s19,s17,1114112
Za v18,v2,s[28:31],s19 offen
Zb s19,s17,1122304
Za v19,v2,s[28:31],s19 offen
Zb s19,s17,1064960
Za v20,v2,s[28:31],s19 offen
Zb s19,s17,1073152
Za v21,v2,s[28:31],s19 offen
Zb s19,s17,1130496
Za v22,v2,s[28:31],s19 offen
Zb s19,s17,1138688
Za v23,v2,s[28:31],s19 offen
Zb s19,s17,1310720
Za v24,v2,s[28:31],s19 offen
Zb s19,s17,1318912
Za v25,v2,s[28:31],s19 offen
Zb s19,s17,1376256
Za v26,v2,s[28:31],s19 offen
Zb s19,s17,1384448
Za v27,v2,s[28:31],s19 offen
Zb s19,s17,1327104
Za v28,v2,s[28:31],s19 offen
Zb s19,s17,1335296
Za v29,v2,s[28:31],s19 offen
Zb s19,s17,1392640
Za v30,v2,s[28:31],s19 offen
Zb s19,s17,1400832
Za v31,v2,s[28:31],s19 offen
Zf vmcnt(46)
Zc v72,v33,v32,s22
Zf vmcnt(44)
Zc v73,v35,v34,s22
Zf vmcnt(42)
Zc v74,v37,v36,s22
Zf vmcnt(40)
Zc v75,v39,v38,s22
Zf vmcnt(38)
Zc v76,v41,v40,s22
Zf vmcnt(36)
Zc v77,v43,v42,s22
Zf vmcnt(34)
Zc v78,v45,v44,s22
Zf vmcnt(32)
Zc v79,v47,v46,s22
Zb s19,s18,2048
Zr v[72:75],v0,s[4:7],s19 offen
Zr v[76:79],v0,s[4:7],s19 offen offset:1024
Zc v64,v33,v32,s23
Zc v65,v35,v34,s23
Zc v66,v37,v36,s23
Zc v67,v39,v38,s23
Zc v68,v41,v40,s23
Zc v69,v43,v42,s23
Zc v70,v45,v44,s23
Zc v71,v47,v46,s23
Zt v5,v[64:67] offset:24576
Zt v5,v[68:71] offset:25600
Zb s19,s17,1572864
Za v32,v2,s[28:31],s19 offen
Zb s19,s17,1581056
Za v33,v2,s[28:31],s19 offen
Zb s19,s17,1638400
Za v34,v2,s[28:31],s19 offen
Zb s19,s17,1646592
Za v35,v2,s[28:31],s19 offen
Zb s19,s17,1589248
Za v36,v2,s[28:31],s19 offen
Zb s19,s17,1597440
Za v37,v2,s[28:31],s19 offen
Zb s19,s17,1654784
Za v38,v2,s[28:31],s19 offen
Zb s19,s17,1662976
Za v39,v2,s[28:31],s19 offen
Zb s19,s17,1835008
Za v40,v2,s[28:31],s19 offen
Zb s19,s17,1843200
Za v41,v2,s[28:31],s19 offen
Zb s19,s17,1900544
Za v42,v2,s[28:31],s19 offen
Zb s19,s17,1908736
Za v43,v2,s[28:31],s19 offen
Zb s19,s17,1851392
Za v44,v2,s[28:31],s19 offen
Zb s19,s17,1859584
Za v45,v2,s[28:31],s19 offen
Zb s19,s17,1916928
Za v46,v2,s[28:31],s19 offen
Zb s19,s17,1925120
Za v47,v2,s[28:31],s19 offen
Zf vmcnt(48)
Zc v72,v49,v48,s22
Zf vmcnt(46)
Zc v73,v51,v50,s22
Zf vmcnt(44)
Zc v74,v53,v52,s22
Zf vmcnt(42)
Zc v75,v55,v54,s22
Zf vmcnt(40)
Zc v76,v57,v56,s22
Zf vmcnt(38)
Zc v77,v59,v58,s22
Zf vmcnt(36)
Zc v78,v61,v60,s22
Zf vmcnt(34)
Zc v79,v63,v62,s22
Zt v5,v[72:75] offset:0
Zt v5,v[76:79] offset:1024
Zc v104,v49,v48,s23
Zc v105,v51,v50,s23
Zc v106,v53,v52,s23
Zc v107,v55,v54,s23
Zc v108,v57,v56,s23
Zc v109,v59,v58,s23
Zc v110,v61,v60,s23
Zc v111,v63,v62,s23
Zb s19,s17,2097152
Za v48,v2,s[28:31],s19 offen
Zb s19,s17,2105344
Za v49,v2,s[28:31],s19 offen
Zb s19,s17,2162688
Za v50,v2,s[28:31],s19 offen
Zb s19,s17,2170880
Za v51,v2,s[28:31],s19 offen
Zb s19,s17,2113536
Za v52,v2,s[28:31],s19 offen
Zb s19,s17,2121728
Za v53,v2,s[28:31],s19 offen
Zb s19,s17,2179072
Za v54,v2,s[28:31],s19 offen
Zb s19,s17,2187264
Za v55,v2,s[28:31],s19 offen
Zb s19,s17,2359296
Za v56,v2,s[28:31],s19 offen
Zb s19,s17,2367488
Za v57,v2,s[28:31],s19 offen
Zb s19,s17,2424832
Za v58,v2,s[28:31],s19 offen
Zb s19,s17,2433024
Za v59,v2,s[28:31],s19 offen
Zb s19,s17,2375680
Za v60,v2,s[28:31],s19 offen
Zb s19,s17,2383872
Za v61,v2,s[28:31],s19 offen
Zb s19,s17,2441216
Za v62,v2,s[28:31],s19 offen
Zb s19,s17,2449408
Za v63,v2,s[28:31],s19 offen
Zf vmcnt(48)
Zc v136,v17,v16,s22
Zf vmcnt(46)
Zc v137,v19,v18,s22
Zf vmcnt(44)
Zc v138,v21,v20,s22
Zf vmcnt(42)
Zc v139,v23,v22,s22
Zf vmcnt(40)
Zc v140,v25,v24,s22
Zf vmcnt(38)
Zc v141,v27,v26,s22
Zf vmcnt(36)
Zc v142,v29,v28,s22
Zf vmcnt(34)
Zc v143,v31,v30,s22
Zc v144,v17,v16,s23
Zc v145,v19,v18,s23
Zc v146,v21,v20,s23
Zc v147,v23,v22,s23
Zc v148,v25,v24,s23
Zc v149,v27,v26,s23
Zc v150,v29,v28,s23
Zc v151,v31,v30,s23
Zb s19,s17,2621440
Za v16,v2,s[28:31],s19 offen
Zb s19,s17,2629632
Za v17,v2,s[28:31],s19 offen
Zb s19,s17,2686976
Za v18,v2,s[28:31],s19 offen
Zb s19,s17,2695168
Za v19,v2,s[28:31],s19 offen
Zb s19,s17,2637824
Za v20,v2,s[28:31],s19 offen
Zb s19,s17,2646016
Za v21,v2,s[28:31],s19 offen
Zb s19,s17,2703360
Za v22,v2,s[28:31],s19 offen
Zb s19,s17,2711552
Za v23,v2,s[28:31],s19 offen
Zb s19,s17,2883584
Za v24,v2,s[28:31],s19 offen
Zb s19,s17,2891776
Za v25,v2,s[28:31],s19 offen
Zb s19,s17,2949120
Za v26,v2,s[28:31],s19 offen
Zb s19,s17,2957312
Za v27,v2,s[28:31],s19 offen
Zb s19,s17,2899968
Za v28,v2,s[28:31],s19 offen
Zb s19,s17,2908160
Za v29,v2,s[28:31],s19 offen
Zb s19,s17,2965504
Za v30,v2,s[28:31],s19 offen
Zb s19,s17,2973696
Za v31,v2,s[28:31],s19 offen
Zf vmcnt(46)
Zc v176,v33,v32,s22
Zf vmcnt(44)
Zc v177,v35,v34,s22
Zf vmcnt(42)
Zc v178,v37,v36,s22
Zf vmcnt(40)
Zc v179,v39,v38,s22
Zf vmcnt(38)
Zc v180,v41,v40,s22
Zf vmcnt(36)
Zc v181,v43,v42,s22
Zf vmcnt(34)
Zc v182,v45,v44,s22
Zf vmcnt(32)
Zc v183,v47,v46,s22
Zc v64,v33,v32,s23
Zc v65,v35,v34,s23
Zc v66,v37,v36,s23
Zc v67,v39,v38,s23
Zc v68,v41,v40,s23
Zc v69,v43,v42,s23
Zc v70,v45,v44,s23
Zc v71,v47,v46,s23
Zb s19,s18,12288
Zr v[64:67],v0,s[4:7],s19 offen
Zr v[68:71],v0,s[4:7],s19 offen offset:1024
Zb s19,s17,3145728
Za v32,v2,s[28:31],s19 offen
Zb s19,s17,3153920
Za v33,v2,s[28:31],s19 offen
Zb s19,s17,3211264
Za v34,v2,s[28:31],s19 offen
Zb s19,s17,3219456
Za v35,v2,s[28:31],s19 offen
Zb s19,s17,3162112
Za v36,v2,s[28:31],s19 offen
Zb s19,s17,3170304
Za v37,v2,s[28:31],s19 offen
Zb s19,s17,3227648
Za v38,v2,s[28:31],s19 offen
Zb s19,s17,3235840
Za v39,v2,s[28:31],s19 offen
Zb s19,s17,3407872
Za v40,v2,s[28:31],s19 offen
Zb s19,s17,3416064
Za v41,v2,s[28:31],s19 offen
Zb s19,s17,3473408
Za v42,v2,s[28:31],s19 offen
Zb s19,s17,3481600
Za v43,v2,s[28:31],s19 offen
Zb s19,s17,3424256
Za v44,v2,s[28:31],s19 offen
Zb s19,s17,3432448
Za v45,v2,s[28:31],s19 offen
Zb s19,s17,3489792
Za v46,v2,s[28:31],s19 offen
Zb s19,s17,3497984
Za v47,v2,s[28:31],s19 offen
Zf vmcnt(48)
Zc v208,v49,v48,s22
Zf vmcnt(46)
Zc v209,v51,v50,s22
Zf vmcnt(44)
Zc v210,v53,v52,s22
Zf vmcnt(42)
Zc v211,v55,v54,s22
Zf vmcnt(40)
Zc v212,v57,v56,s22
Zf vmcnt(38)
Zc v213,v59,v58,s22
Zf vmcnt(36)
Zc v214,v61,v60,s22
Zf vmcnt(34)
Zc v215,v63,v62,s22
Zc v64,v49,v48,s23
Zc v65,v51,v50,s23
Zc v66,v53,v52,s23
Zc v67,v55,v54,s23
Zc v68,v57,v56,s23
Zc v69,v59,v58,s23
Zc v70,v61,v60,s23
Zc v71,v63,v62,s23
Zt v5,v[64:67] offset:16384
Zt v5,v[68:71] offset:17408
Zb s19,s17,3670016
Za v48,v2,s[28:31],s19 offen
Zb s19,s17,3678208
Za v49,v2,s[28:31],s19 offen
Zb s19,s17,3735552
Za v50,v2,s[28:31],s19 offen
Zb s19,s17,3743744
Za v51,v2,s[28:31],s19 offen
Zb s19,s17,3686400
Za v52,v2,s[28:31],s19 offen
Zb s19,s17,3694592
Za v53,v2,s[28:31],s19 offen
Zb s19,s17,3751936
Za v54,v2,s[28:31],s19 offen
Zb s19,s17,3760128
Za v55,v2,s[28:31],s19 offen
Zb s19,s17,3932160
Za v56,v2,s[28:31],s19 offen
Zb s19,s17,3940352
Za v57,v2,s[28:31],s19 offen
Zb s19,s17,3997696
Za v58,v2,s[28:31],s19 offen
Zb s19,s17,4005888
Za v59,v2,s[28:31],s19 offen
Zb s19,s17,3948544
Za v60,v2,s[28:31],s19 offen
Zb s19,s17,3956736
Za v61,v2,s[28:31],s19 offen
Zb s19,s17,4014080
Za v62,v2,s[28:31],s19 offen
Zb s19,s17,4022272
Za v63,v2,s[28:31],s19 offen
Zf vmcnt(48)
Zc v72,v17,v16,s22
Zf vmcnt(46)
Zc v73,v19,v18,s22
Zf vmcnt(44)
Zc v74,v21,v20,s22
Zf vmcnt(42)
Zc v75,v23,v22,s22
Zf vmcnt(40)
Zc v76,v25,v24,s22
Zf vmcnt(38)
Zc v77,v27,v26,s22
Zf vmcnt(36)
Zc v78,v29,v28,s22
Zf vmcnt(34)
Zc v79,v31,v30,s22
Zb s19,s18,16384
Zr v[72:75],v0,s[4:7],s19 offen
Zr v[76:79],v0,s[4:7],s19 offen offset:1024
Zc v64,v17,v16,s23
Zc v65,v19,v18,s23
Zc v66,v21,v20,s23
Zc v67,v23,v22,s23
Zc v68,v25,v24,s23
Zc v69,v27,v26,s23
Zc v70,v29,v28,s23
Zc v71,v31,v30,s23
Zt v5,v[64:67] offset:8192
Zt v5,v[68:71] offset:9216
Zb s19,s17,4194304
Za v16,v2,s[28:31],s19 offen
Zb s19,s17,4202496
Za v17,v2,s[28:31],s19 offen
Zb s19,s17,4259840
Za v18,v2,s[28:31],s19 offen
Zb s19,s17,4268032
Za v19,v2,s[28:31],s19 offen
Zb s19,s17,4210688
Za v20,v2,s[28:31],s19 offen
Zb s19,s17,4218880
Za v21,v2,s[28:31],s19 offen
Zb s19,s17,4276224
Za v22,v2,s[28:31],s19 offen
Zb s19,s17,4284416
Za v23,v2,s[28:31],s19 offen
Zb s19,s17,4456448
Za v24,v2,s[28:31],s19 offen
Zb s19,s17,4464640
Za v25,v2,s[28:31],s19 offen
Zb s19,s17,4521984
Za v26,v2,s[28:31],s19 offen
Zb s19,s17,4530176
Za v27,v2,s[28:31],s19 offen
Zb s19,s17,4472832
Za v28,v2,s[28:31],s19 offen
Zb s19,s17,4481024
Za v29,v2,s[28:31],s19 offen
Zb s19,s17,4538368
Za v30,v2,s[28:31],s19 offen
Zb s19,s17,4546560
Za v31,v2,s[28:31],s19 offen
Zf vmcnt(48)
Zc v72,v33,v32,s22
Zf vmcnt(46)
Zc v73,v35,v34,s22
Zf vmcnt(44)
Zc v74,v37,v36,s22
Zf vmcnt(42)
Zc v75,v39,v38,s22
Zf vmcnt(40)
Zc v76,v41,v40,s22
Zf vmcnt(38)
Zc v77,v43,v42,s22
Zf vmcnt(36)
Zc v78,v45,v44,s22
Zf vmcnt(34)
Zc v79,v47,v46,s22
Zb s19,s18,10240
Zr v[72:75],v0,s[4:7],s19 offen
Zr v[76:79],v0,s[4:7],s19 offen offset:1024
Zc v64,v33,v32,s23
Zc v65,v35,v34,s23
Zc v66,v37,v36,s23
Zc v67,v39,v38,s23
Zc v68,v41,v40,s23
Zc v69,v43,v42,s23
Zc v70,v45,v44,s23
Zc v71,v47,v46,s23
Zb s19,s18,14336
Zr v[64:67],v0,s[4:7],s19 offen
Zr v[68:71],v0,s[4:7],s19 offen offset:1024
Zb s19,s17,4718592
Za v32,v2,s[28:31],s19 offen
Zb s19,s17,4726784
Za v33,v2,s[28:31],s19 offen
Zb s19,s17,4784128
Za v34,v2,s[28:31],s19 offen
Zb s19,s17,4792320
Za v35,v2,s[28:31],s19 offen
Zb s19,s17,4734976
Za v36,v2,s[28:31],s19 offen
Zb s19,s17,4743168
Za v37,v2,s[28:31],s19 offen
Zb s19,s17,4800512
Za v38,v2,s[28:31],s19 offen
Zb s19,s17,4808704
Za v39,v2,s[28:31],s19 offen
Zb s19,s17,4980736
Za v40,v2,s[28:31],s19 offen
Zb s19,s17,4988928
Za v41,v2,s[28:31],s19 offen
Zb s19,s17,5046272
Za v42,v2,s[28:31],s19 offen
Zb s19,s17,5054464
Za v43,v2,s[28:31],s19 offen
Zb s19,s17,4997120
Za v44,v2,s[28:31],s19 offen
Zb s19,s17,5005312
Za v45,v2,s[28:31],s19 offen
Zb s19,s17,5062656
Za v46,v2,s[28:31],s19 offen
Zb s19,s17,5070848
Za v47,v2,s[28:31],s19 offen
Zf vmcnt(52)
Zc v72,v49,v48,s22
Zf vmcnt(50)
Zc v73,v51,v50,s22
Zf vmcnt(48)
Zc v74,v53,v52,s22
Zf vmcnt(46)
Zc v75,v55,v54,s22
Zf vmcnt(44)
Zc v76,v57,v56,s22
Zf vmcnt(42)
Zc v77,v59,v58,s22
Zf vmcnt(40)
Zc v78,v61,v60,s22
Zf vmcnt(38)
Zc v79,v63,v62,s22
Zt v5,v[72:75] offset:10240
Zt v5,v[76:79] offset:11264
Zc v64,v49,v48,s23
Zc v65,v51,v50,s23
Zc v66,v53,v52,s23
Zc v67,v55,v54,s23
Zc v68,v57,v56,s23
Zc v69,v59,v58,s23
Zc v70,v61,v60,s23
Zc v71,v63,v62,s23
Zt v5,v[64:67] offset:18432
Zt v5,v[68:71] offset:19456
Zb s19,s17,0
Za v48,v2,s[32:35],s19 offen
Zb s19,s17,8192
Za v49,v2,s[32:35],s19 offen
Zb s19,s17,65536
Za v50,v2,s[32:35],s19 offen
Zb s19,s17,73728
Za v51,v2,s[32:35],s19 offen
Zb s19,s17,16384
Za v52,v2,s[32:35],s19 offen
Zb s19,s17,24576
Za v53,v2,s[32:35],s19 offen
Zb s19,s17,81920
Za v54,v2,s[32:35],s19 offen
Zb s19,s17,90112
Za v55,v2,s[32:35],s19 offen
Zb s19,s17,262144
Za v56,v2,s[32:35],s19 offen
Zb s19,s17,270336
Za v57,v2,s[32:35],s19 offen
Zb s19,s17,327680
Za v58,v2,s[32:35],s19 offen
Zb s19,s17,335872
Za v59,v2,s[32:35],s19 offen
Zb s19,s17,278528
Za v60,v2,s[32:35],s19 offen
Zb s19,s17,286720
Za v61,v2,s[32:35],s19 offen
Zb s19,s17,344064
Za v62,v2,s[32:35],s19 offen
Zb s19,s17,352256
Za v63,v2,s[32:35],s19 offen
Zf vmcnt(50)
Zc v72,v17,v16,s22
Zf vmcnt(48)
Zc v73,v19,v18,s22
Zf vmcnt(46)
Zc v74,v21,v20,s22
Zf vmcnt(44)
Zc v75,v23,v22,s22
Zf vmcnt(42)
Zc v76,v25,v24,s22
Zf vmcnt(40)
Zc v77,v27,v26,s22
Zf vmcnt(38)
Zc v78,v29,v28,s22
Zf vmcnt(36)
Zc v79,v31,v30,s22
Zd a176,v72
Zd a177,v73
Zd a178,v74
Zd a179,v75
Zd a180,v76
Zd a181,v77
Zd a182,v78
Zd a183,v79
Zc v64,v17,v16,s23
Zc v65,v19,v18,s23
Zc v66,v21,v20,s23
Zc v67,v23,v22,s23
Zc v68,v25,v24,s23
Zc v69,v27,v26,s23
Zc v70,v29,v28,s23
Zc v71,v31,v30,s23
Zt v5,v[64:67] offset:20480
Zt v5,v[68:71] offset:21504
Zb s19,s17,524288
Za v16,v2,s[32:35],s19 offen
Zb s19,s17,532480
Za v17,v2,s[32:35],s19 offen
Zb s19,s17,589824
Za v18,v2,s[32:35],s19 offen
Zb s19,s17,598016
Za v19,v2,s[32:35],s19 offen
Zb s19,s17,540672
Za v20,v2,s[32:35],s19 offen
Zb s19,s17,548864
Za v21,v2,s[32:35],s19 offen
Zb s19,s17,606208
Za v22,v2,s[32:35],s19 offen
Zb s19,s17,614400
Za v23,v2,s[32:35],s19 offen
Zb s19,s17,786432
Za v24,v2,s[32:35],s19 offen
Zb s19,s17,794624
Za v25,v2,s[32:35],s19 offen
Zb s19,s17,851968
Za v26,v2,s[32:35],s19 offen
Zb s19,s17,860160
Za v27,v2,s[32:35],s19 offen
Zb s19,s17,802816
Za v28,v2,s[32:35],s19 offen
Zb s19,s17,811008
Za v29,v2,s[32:35],s19 offen
Zb s19,s17,868352
Za v30,v2,s[32:35],s19 offen
Zb s19,s17,876544
Za v31,v2,s[32:35],s19 offen
Zf vmcnt(46)
Zc v72,v33,v32,s22
Zf vmcnt(44)
Zc v73,v35,v34,s22
Zf vmcnt(42)
Zc v74,v37,v36,s22
Zf vmcnt(40)
Zc v75,v39,v38,s22
Zf vmcnt(38)
Zc v76,v41,v40,s22
Zf vmcnt(36)
Zc v77,v43,v42,s22
Zf vmcnt(34)
Zc v78,v45,v44,s22
Zf vmcnt(32)
Zc v79,v47,v46,s22
Zd a208,v72
Zd a209,v73
Zd a210,v74
Zd a211,v75
Zd a212,v76
Zd a213,v77
Zd a214,v78
Zd a215,v79
Zc v64,v33,v32,s23
Zc v65,v35,v34,s23
Zc v66,v37,v36,s23
Zc v67,v39,v38,s23
Zc v68,v41,v40,s23
Zc v69,v43,v42,s23
Zc v70,v45,v44,s23
Zc v71,v47,v46,s23
Zt v5,v[64:67] offset:22528
Zt v5,v[68:71] offset:23552
Zb s19,s17,1048576
Za v32,v2,s[32:35],s19 offen
Zb s19,s17,1056768
Za v33,v2,s[32:35],s19 offen
Zb s19,s17,1114112
Za v34,v2,s[32:35],s19 offen
Zb s19,s17,1122304
Za v35,v2,s[32:35],s19 offen
Zb s19,s17,1064960
Za v36,v2,s[32:35],s19 offen
Zb s19,s17,1073152
Za v37,v2,s[32:35],s19 offen
Zb s19,s17,1130496
Za v38,v2,s[32:35],s19 offen
Zb s19,s17,1138688
Za v39,v2,s[32:35],s19 offen
Zb s19,s17,1310720
Za v40,v2,s[32:35],s19 offen
Zb s19,s17,1318912
Za v41,v2,s[32:35],s19 offen
Zb s19,s17,1376256
Za v42,v2,s[32:35],s19 offen
Zb s19,s17,1384448
Za v43,v2,s[32:35],s19 offen
Zb s19,s17,1327104
Za v44,v2,s[32:35],s19 offen
Zb s19,s17,1335296
Za v45,v2,s[32:35],s19 offen
Zb s19,s17,1392640
Za v46,v2,s[32:35],s19 offen
Zb s19,s17,1400832
Za v47,v2,s[32:35],s19 offen
Zf vmcnt(46)
Zc v72,v49,v48,s22
Zf vmcnt(44)
Zc v73,v51,v50,s22
Zf vmcnt(42)
Zc v74,v53,v52,s22
Zf vmcnt(40)
Zc v75,v55,v54,s22
Zf vmcnt(38)
Zc v76,v57,v56,s22
Zf vmcnt(36)
Zc v77,v59,v58,s22
Zf vmcnt(34)
Zc v78,v61,v60,s22
Zf vmcnt(32)
Zc v79,v63,v62,s22
Zd a248,v72
Zd a249,v73
Zd a250,v74
Zd a251,v75
Zd a252,v76
Zd a253,v77
Zd a254,v78
Zd a255,v79
Zc v80,v49,v48,s23
Zc v81,v51,v50,s23
Zc v82,v53,v52,s23
Zc v83,v55,v54,s23
Zc v84,v57,v56,s23
Zc v85,v59,v58,s23
Zc v86,v61,v60,s23
Zc v87,v63,v62,s23
Zb s19,s17,1572864
Za v48,v2,s[32:35],s19 offen
Zb s19,s17,1581056
Za v49,v2,s[32:35],s19 offen
Zb s19,s17,1638400
Za v50,v2,s[32:35],s19 offen
Zb s19,s17,1646592
Za v51,v2,s[32:35],s19 offen
Zb s19,s17,1589248
Za v52,v2,s[32:35],s19 offen
Zb s19,s17,1597440
Za v53,v2,s[32:35],s19 offen
Zb s19,s17,1654784
Za v54,v2,s[32:35],s19 offen
Zb s19,s17,1662976
Za v55,v2,s[32:35],s19 offen
Zb s19,s17,1835008
Za v56,v2,s[32:35],s19 offen
Zb s19,s17,1843200
Za v57,v2,s[32:35],s19 offen
Zb s19,s17,1900544
Za v58,v2,s[32:35],s19 offen
Zb s19,s17,1908736
Za v59,v2,s[32:35],s19 offen
Zb s19,s17,1851392
Za v60,v2,s[32:35],s19 offen
Zb s19,s17,1859584
Za v61,v2,s[32:35],s19 offen
Zb s19,s17,1916928
Za v62,v2,s[32:35],s19 offen
Zb s19,s17,1925120
Za v63,v2,s[32:35],s19 offen
Zf vmcnt(46)
Zc v112,v17,v16,s22
Zf vmcnt(44)
Zc v113,v19,v18,s22
Zf vmcnt(42)
Zc v114,v21,v20,s22
Zf vmcnt(40)
Zc v115,v23,v22,s22
Zf vmcnt(38)
Zc v116,v25,v24,s22
Zf vmcnt(36)
Zc v117,v27,v26,s22
Zf vmcnt(34)
Zc v118,v29,v28,s22
Zf vmcnt(32)
Zc v119,v31,v30,s22
Zc v64,v17,v16,s23
Zc v65,v19,v18,s23
Zc v66,v21,v20,s23
Zc v67,v23,v22,s23
Zc v68,v25,v24,s23
Zc v69,v27,v26,s23
Zc v70,v29,v28,s23
Zc v71,v31,v30,s23
Zb s19,s18,8192
Zr v[64:67],v0,s[4:7],s19 offen
Zr v[68:71],v0,s[4:7],s19 offen offset:1024
Zb s19,s17,2097152
Za v16,v2,s[32:35],s19 offen
Zb s19,s17,2105344
Za v17,v2,s[32:35],s19 offen
Zb s19,s17,2162688
Za v18,v2,s[32:35],s19 offen
Zb s19,s17,2170880
Za v19,v2,s[32:35],s19 offen
Zb s19,s17,2113536
Za v20,v2,s[32:35],s19 offen
Zb s19,s17,2121728
Za v21,v2,s[32:35],s19 offen
Zb s19,s17,2179072
Za v22,v2,s[32:35],s19 offen
Zb s19,s17,2187264
Za v23,v2,s[32:35],s19 offen
Zb s19,s17,2359296
Za v24,v2,s[32:35],s19 offen
Zb s19,s17,2367488
Za v25,v2,s[32:35],s19 offen
Zb s19,s17,2424832
Za v26,v2,s[32:35],s19 offen
Zb s19,s17,2433024
Za v27,v2,s[32:35],s19 offen
Zb s19,s17,2375680
Za v28,v2,s[32:35],s19 offen
Zb s19,s17,2383872
Za v29,v2,s[32:35],s19 offen
Zb s19,s17,2441216
Za v30,v2,s[32:35],s19 offen
Zb s19,s17,2449408
Za v31,v2,s[32:35],s19 offen
Zf vmcnt(48)
Zc v152,v33,v32,s22
Zf vmcnt(46)
Zc v153,v35,v34,s22
Zf vmcnt(44)
Zc v154,v37,v36,s22
Zf vmcnt(42)
Zc v155,v39,v38,s22
Zf vmcnt(40)
Zc v156,v41,v40,s22
Zf vmcnt(38)
Zc v157,v43,v42,s22
Zf vmcnt(36)
Zc v158,v45,v44,s22
Zf vmcnt(34)
Zc v159,v47,v46,s22
Zc v64,v33,v32,s23
Zc v65,v35,v34,s23
Zc v66,v37,v36,s23
Zc v67,v39,v38,s23
Zc v68,v41,v40,s23
Zc v69,v43,v42,s23
Zc v70,v45,v44,s23
Zc v71,v47,v46,s23
Zt v5,v[64:67] offset:4096
Zt v5,v[68:71] offset:5120
Zb s19,s17,2621440
Za v32,v2,s[32:35],s19 offen
Zb s19,s17,2629632
Za v33,v2,s[32:35],s19 offen
Zb s19,s17,2686976
Za v34,v2,s[32:35],s19 offen
Zb s19,s17,2695168
Za v35,v2,s[32:35],s19 offen
Zb s19,s17,2637824
Za v36,v2,s[32:35],s19 offen
Zb s19,s17,2646016
Za v37,v2,s[32:35],s19 offen
Zb s19,s17,2703360
Za v38,v2,s[32:35],s19 offen
Zb s19,s17,2711552
Za v39,v2,s[32:35],s19 offen
Zb s19,s17,2883584
Za v40,v2,s[32:35],s19 offen
Zb s19,s17,2891776
Za v41,v2,s[32:35],s19 offen
Zb s19,s17,2949120
Za v42,v2,s[32:35],s19 offen
Zb s19,s17,2957312
Za v43,v2,s[32:35],s19 offen
Zb s19,s17,2899968
Za v44,v2,s[32:35],s19 offen
Zb s19,s17,2908160
Za v45,v2,s[32:35],s19 offen
Zb s19,s17,2965504
Za v46,v2,s[32:35],s19 offen
Zb s19,s17,2973696
Za v47,v2,s[32:35],s19 offen
Zf vmcnt(48)
Zc v248,v49,v48,s22
Zf vmcnt(46)
Zc v249,v51,v50,s22
Zf vmcnt(44)
Zc v250,v53,v52,s22
Zf vmcnt(42)
Zc v251,v55,v54,s22
Zf vmcnt(40)
Zc v252,v57,v56,s22
Zf vmcnt(38)
Zc v253,v59,v58,s22
Zf vmcnt(36)
Zc v254,v61,v60,s22
Zf vmcnt(34)
Zc v255,v63,v62,s22
Zc v64,v49,v48,s23
Zc v65,v51,v50,s23
Zc v66,v53,v52,s23
Zc v67,v55,v54,s23
Zc v68,v57,v56,s23
Zc v69,v59,v58,s23
Zc v70,v61,v60,s23
Zc v71,v63,v62,s23
Zb s19,s18,4096
Zr v[64:67],v0,s[4:7],s19 offen
Zr v[68:71],v0,s[4:7],s19 offen offset:1024
Zb s19,s17,3145728
Za v48,v2,s[32:35],s19 offen
Zb s19,s17,3153920
Za v49,v2,s[32:35],s19 offen
Zb s19,s17,3211264
Za v50,v2,s[32:35],s19 offen
Zb s19,s17,3219456
Za v51,v2,s[32:35],s19 offen
Zb s19,s17,3162112
Za v52,v2,s[32:35],s19 offen
Zb s19,s17,3170304
Za v53,v2,s[32:35],s19 offen
Zb s19,s17,3227648
Za v54,v2,s[32:35],s19 offen
Zb s19,s17,3235840
Za v55,v2,s[32:35],s19 offen
Zb s19,s17,3407872
Za v56,v2,s[32:35],s19 offen
Zb s19,s17,3416064
Za v57,v2,s[32:35],s19 offen
Zb s19,s17,3473408
Za v58,v2,s[32:35],s19 offen
Zb s19,s17,3481600
Za v59,v2,s[32:35],s19 offen
Zb s19,s17,3424256
Za v60,v2,s[32:35],s19 offen
Zb s19,s17,3432448
Za v61,v2,s[32:35],s19 offen
Zb s19,s17,3489792
Za v62,v2,s[32:35],s19 offen
Zb s19,s17,3497984
Za v63,v2,s[32:35],s19 offen
Zf vmcnt(48)
Zc v232,v17,v16,s22
Zf vmcnt(46)
Zc v233,v19,v18,s22
Zf vmcnt(44)
Zc v234,v21,v20,s22
Zf vmcnt(42)
Zc v235,v23,v22,s22
Zf vmcnt(40)
Zc v236,v25,v24,s22
Zf vmcnt(38)
Zc v237,v27,v26,s22
Zf vmcnt(36)
Zc v238,v29,v28,s22
Zf vmcnt(34)
Zc v239,v31,v30,s22
Zc v240,v17,v16,s23
Zc v241,v19,v18,s23
Zc v242,v21,v20,s23
Zc v243,v23,v22,s23
Zc v244,v25,v24,s23
Zc v245,v27,v26,s23
Zc v246,v29,v28,s23
Zc v247,v31,v30,s23
Zb s19,s17,3670016
Za v16,v2,s[32:35],s19 offen
Zb s19,s17,3678208
Za v17,v2,s[32:35],s19 offen
Zb s19,s17,3735552
Za v18,v2,s[32:35],s19 offen
Zb s19,s17,3743744
Za v19,v2,s[32:35],s19 offen
Zb s19,s17,3686400
Za v20,v2,s[32:35],s19 offen
Zb s19,s17,3694592
Za v21,v2,s[32:35],s19 offen
Zb s19,s17,3751936
Za v22,v2,s[32:35],s19 offen
Zb s19,s17,3760128
Za v23,v2,s[32:35],s19 offen
Zb s19,s17,3932160
Za v24,v2,s[32:35],s19 offen
Zb s19,s17,3940352
Za v25,v2,s[32:35],s19 offen
Zb s19,s17,3997696
Za v26,v2,s[32:35],s19 offen
Zb s19,s17,4005888
Za v27,v2,s[32:35],s19 offen
Zb s19,s17,3948544
Za v28,v2,s[32:35],s19 offen
Zb s19,s17,3956736
Za v29,v2,s[32:35],s19 offen
Zb s19,s17,4014080
Za v30,v2,s[32:35],s19 offen
Zb s19,s17,4022272
Za v31,v2,s[32:35],s19 offen
Zf vmcnt(48)
Zc v216,v33,v32,s22
Zf vmcnt(46)
Zc v217,v35,v34,s22
Zf vmcnt(44)
Zc v218,v37,v36,s22
Zf vmcnt(42)
Zc v219,v39,v38,s22
Zf vmcnt(40)
Zc v220,v41,v40,s22
Zf vmcnt(38)
Zc v221,v43,v42,s22
Zf vmcnt(36)
Zc v222,v45,v44,s22
Zf vmcnt(34)
Zc v223,v47,v46,s22
Zc v224,v33,v32,s23
Zc v225,v35,v34,s23
Zc v226,v37,v36,s23
Zc v227,v39,v38,s23
Zc v228,v41,v40,s23
Zc v229,v43,v42,s23
Zc v230,v45,v44,s23
Zc v231,v47,v46,s23
Zb s19,s17,4194304
Za v32,v2,s[32:35],s19 offen
Zb s19,s17,4202496
Za v33,v2,s[32:35],s19 offen
Zb s19,s17,4259840
Za v34,v2,s[32:35],s19 offen
Zb s19,s17,4268032
Za v35,v2,s[32:35],s19 offen
Zb s19,s17,4210688
Za v36,v2,s[32:35],s19 offen
Zb s19,s17,4218880
Za v37,v2,s[32:35],s19 offen
Zb s19,s17,4276224
Za v38,v2,s[32:35],s19 offen
Zb s19,s17,4284416
Za v39,v2,s[32:35],s19 offen
Zb s19,s17,4456448
Za v40,v2,s[32:35],s19 offen
Zb s19,s17,4464640
Za v41,v2,s[32:35],s19 offen
Zb s19,s17,4521984
Za v42,v2,s[32:35],s19 offen
Zb s19,s17,4530176
Za v43,v2,s[32:35],s19 offen
Zb s19,s17,4472832
Za v44,v2,s[32:35],s19 offen
Zb s19,s17,4481024
Za v45,v2,s[32:35],s19 offen
Zb s19,s17,4538368
Za v46,v2,s[32:35],s19 offen
Zb s19,s17,4546560
Za v47,v2,s[32:35],s19 offen
Zf vmcnt(46)
Zc v72,v49,v48,s22
Zf vmcnt(44)
Zc v73,v51,v50,s22
Zf vmcnt(42)
Zc v74,v53,v52,s22
Zf vmcnt(40)
Zc v75,v55,v54,s22
Zf vmcnt(38)
Zc v76,v57,v56,s22
Zf vmcnt(36)
Zc v77,v59,v58,s22
Zf vmcnt(34)
Zc v78,v61,v60,s22
Zf vmcnt(32)
Zc v79,v63,v62,s22
Zd a128,v72
Zd a129,v73
Zd a130,v74
Zd a131,v75
Zd a132,v76
Zd a133,v77
Zd a134,v78
Zd a135,v79
Zc v64,v49,v48,s23
Zc v65,v51,v50,s23
Zc v66,v53,v52,s23
Zc v67,v55,v54,s23
Zc v68,v57,v56,s23
Zc v69,v59,v58,s23
Zc v70,v61,v60,s23
Zc v71,v63,v62,s23
Zd a136,v64
Zd a137,v65
Zd a138,v66
Zd a139,v67
Zd a140,v68
Zd a141,v69
Zd a142,v70
Zd a143,v71
Zb s19,s17,4718592
Za v48,v2,s[32:35],s19 offen
Zb s19,s17,4726784
Za v49,v2,s[32:35],s19 offen
Zb s19,s17,4784128
Za v50,v2,s[32:35],s19 offen
Zb s19,s17,4792320
Za v51,v2,s[32:35],s19 offen
Zb s19,s17,4734976
Za v52,v2,s[32:35],s19 offen
Zb s19,s17,4743168
Za v53,v2,s[32:35],s19 offen
Zb s19,s17,4800512
Za v54,v2,s[32:35],s19 offen
Zb s19,s17,4808704
Za v55,v2,s[32:35],s19 offen
Zb s19,s17,4980736
Za v56,v2,s[32:35],s19 offen
Zb s19,s17,4988928
Za v57,v2,s[32:35],s19 offen
Zb s19,s17,5046272
Za v58,v2,s[32:35],s19 offen
Zb s19,s17,5054464
Za v59,v2,s[32:35],s19 offen
Zb s19,s17,4997120
Za v60,v2,s[32:35],s19 offen
Zb s19,s17,5005312
Za v61,v2,s[32:35],s19 offen
Zb s19,s17,5062656
Za v62,v2,s[32:35],s19 offen
Zb s19,s17,5070848
Za v63,v2,s[32:35],s19 offen
Zf vmcnt(46)
Zc v72,v17,v16,s22
Zf vmcnt(44)
Zc v73,v19,v18,s22
Zf vmcnt(42)
Zc v74,v21,v20,s22
Zf vmcnt(40)
Zc v75,v23,v22,s22
Zf vmcnt(38)
Zc v76,v25,v24,s22
Zf vmcnt(36)
Zc v77,v27,v26,s22
Zf vmcnt(34)
Zc v78,v29,v28,s22
Zf vmcnt(32)
Zc v79,v31,v30,s22
Zd a152,v72
Zd a153,v73
Zd a154,v74
Zd a155,v75
Zd a156,v76
Zd a157,v77
Zd a158,v78
Zd a159,v79
Zc v64,v17,v16,s23
Zc v65,v19,v18,s23
Zc v66,v21,v20,s23
Zc v67,v23,v22,s23
Zc v68,v25,v24,s23
Zc v69,v27,v26,s23
Zc v70,v29,v28,s23
Zc v71,v31,v30,s23
Zd a160,v64
Zd a161,v65
Zd a162,v66
Zd a163,v67
Zd a164,v68
Zd a165,v69
Zd a166,v70
Zd a167,v71
Zf vmcnt(30)
Zc v72,v33,v32,s22
Zf vmcnt(28)
Zc v73,v35,v34,s22
Zf vmcnt(26)
Zc v74,v37,v36,s22
Zf vmcnt(24)
Zc v75,v39,v38,s22
Zf vmcnt(22)
Zc v76,v41,v40,s22
Zf vmcnt(20)
Zc v77,v43,v42,s22
Zf vmcnt(18)
Zc v78,v45,v44,s22
Zf vmcnt(16)
Zc v79,v47,v46,s22
Zd a184,v72
Zd a185,v73
Zd a186,v74
Zd a187,v75
Zd a188,v76
Zd a189,v77
Zd a190,v78
Zd a191,v79
Zc v64,v33,v32,s23
Zc v65,v35,v34,s23
Zc v66,v37,v36,s23
Zc v67,v39,v38,s23
Zc v68,v41,v40,s23
Zc v69,v43,v42,s23
Zc v70,v45,v44,s23
Zc v71,v47,v46,s23
Zd a192,v64
Zd a193,v65
Zd a194,v66
Zd a195,v67
Zd a196,v68
Zd a197,v69
Zd a198,v70
Zd a199,v71
Zf vmcnt(14)
Zc v72,v49,v48,s22
Zf vmcnt(12)
Zc v73,v51,v50,s22
Zf vmcnt(10)
Zc v74,v53,v52,s22
Zf vmcnt(8)
Zc v75,v55,v54,s22
Zf vmcnt(6)
Zc v76,v57,v56,s22
Zf vmcnt(4)
Zc v77,v59,v58,s22
Zf vmcnt(2)
Zc v78,v61,v60,s22
Zf vmcnt(0)
Zc v79,v63,v62,s22
Zd a216,v72
Zd a217,v73
Zd a218,v74
Zd a219,v75
Zd a220,v76
Zd a221,v77
Zd a222,v78
Zd a223,v79
Zc v64,v49,v48,s23
Zc v65,v51,v50,s23
Zc v66,v53,v52,s23
Zc v67,v55,v54,s23
Zc v68,v57,v56,s23
Zc v69,v59,v58,s23
Zc v70,v61,v60,s23
Zc v71,v63,v62,s23
Zd a224,v64
Zd a225,v65
Zd a226,v66
Zd a227,v67
Zd a228,v68
Zd a229,v69
Zd a230,v70
Zd a231,v71
v_lshrrev_b32 v14, 1, v12
Zy v14,1,v14
Zs v1,0x4444
Zs v15,0xeeee
v_cmp_eq_u32 vcc, 1, v14
s_nop 1
v_cndmask_b32 v1, v1, v15, vcc
v_lshrrev_b32 v15, 2, v12
Zz v15,1,v15
Zy v16,1,v12
v_add_u32 v15, v15, v16
v_mul_u32_u24 v7, 1280, v15
v_lshl_add_u32 v7, v13, 5, v7
v_lshl_add_u32 v7, v14, 4, v7
v_mul_u32_u24 v10, 288, v15
v_lshl_add_u32 v10, v13, 4, v10
v_add_u32 v10, 20736, v10
Zy v16,7,v12
v_mul_u32_u24 v9, 288, v16
v_lshl_add_u32 v9, v13, 4, v9
v_add_u32 v9, 18432, v9
v_mul_u32_u24 v8, 576, v13
v_lshl_add_u32 v8, v12, 2, v8
v_add_u32 v8, 18560, v8
v_lshrrev_b32 v17, 1, v16
Zz v17,2,v17
Zy v18,1,v16
v_add_u32 v17, v17, v18
Zy v18,1,v13
v_lshl_add_u32 v17, v18, 1, v17
v_lshrrev_b32 v18, 1, v13
v_lshl_add_u32 v17, v18, 4, v17
Zz v11,4,v17
v_add_u32 v11, 1024, v11
s_mul_i32 s19, s8, 10368
v_mul_u32_u24 v2, 2560, v13
v_add_u32 v2, s19, v2
v_lshl_add_u32 v3, v12, 2, v2
v_add_u32 v3, 1152, v3
v_lshl_add_u32 v2, v12, 4, v2
v_add_u32 v2, 512, v2
v_lshrrev_b32 v16, 3, v12
v_lshl_add_u32 v16, v13, 1, v16
Zy v17,7,v12
Zq s19,s8,7
Zb s19,s19,8192
v_mul_u32_u24 v4, 10368, v16
v_lshl_add_u32 v4, v17, 4, v4
v_add_u32 v4, s19, v4
Zp s21,1040356334
Zp s20,400000
Zp s12,1048576
Zp s15,2097152
Zf vmcnt(0) lgkmcnt(0)
v_lshrrev_b32 v12, 2, v0
Zy v12,60,v12
L_md2:
global_load_dword v13, v12, s[36:37] sc1
Zf vmcnt(0)
v_readlane_b32 s40, v13, 0
v_readlane_b32 s41, v13, 1
v_readlane_b32 s42, v13, 2
v_readlane_b32 s43, v13, 3
v_readlane_b32 s44, v13, 4
v_readlane_b32 s45, v13, 5
v_readlane_b32 s46, v13, 6
v_readlane_b32 s47, v13, 7
v_readlane_b32 s48, v13, 8
s_cmp_ge_u32 s40, 32
Zk L_fa2
Zb s40,s40,s41
Zb s40,s40,s42
Zb s40,s40,s43
Zb s40,s40,s44
Zb s40,s40,s45
Zb s40,s40,s46
Zb s40,s40,s47
Zb s40,s40,s48
s_cmp_ge_u32 s40, 256
Zk L_sl2
s_sleep 2
s_sub_u32 s20, s20, 1
s_cmp_gt_i32 s20, 0
Zk L_md2
L_sl2:
Zq s24,s8,7
Zb s26,s24,4096
Zb s24,s24,0
Zp s11,0
s_mul_i32 s17, s8, 20480
Zb s17,s17,16777216
Zb s27,s17,18432
s_load_dwordx2 s[28:29], s[0:1], 48
Zp s30,10240
Zp s31,0x20000
Zp s39,0
Zb s90,s18,0
Zb s91,s18,4096
Zb s92,s18,8192
Zb s93,s18,12288
Zb s94,s18,16384
Zb s36,s8,64
s_mul_i32 s22, s36, 205
s_lshr_b32 s22, s22, 11
s_mul_i32 s23, s22, 10
s_sub_u32 s36, s36, s23
Zq s38,s36,10
s_lshr_b32 s23, s22, 1
Zq s23,s23,6
Zb s38,s38,s23
s_and_b32 s23, s22, 1
Zq s23,s23,4
Zb s38,s38,s23
s_cmp_ge_u32 s36, 8
s_cselect_b32 s36, 1, 0
Zb s13,s12,82944
Zb s14,s12,165888
Zb s59,s12,248832
Zp s32,394264576
Zp s33,1342177280
Zf lgkmcnt(0)
CL_w2x:
Zp s10,0
s_barrier
Zp s37,8192
Zs v6,v0
Zb m0,s37,6144
Zb s19,s17,4096
Zh v0,s[4:7],s19 offen sc1 nt lds
Zb m0,s37,7168
Zb s19,s17,5120
Zh v0,s[4:7],s19 offen sc1 nt lds
Zh v[12:15],v7,s[28:31],0 offen offset:768
Zh v[40:43],v7,s[28:31],0 offen offset:896
Zb s19,s18,0
Zh v[48:51],v0,s[4:7],s19 offen offset:0
Zh v[52:55],v0,s[4:7],s19 offen offset:1024
Zb s19,s18,6144
Zh v[56:59],v0,s[4:7],s19 offen offset:0
Zh v[60:63],v0,s[4:7],s19 offen offset:1024
Zb s19,s18,10240
Zh v[64:67],v0,s[4:7],s19 offen offset:0
Zh v[68:71],v0,s[4:7],s19 offen offset:1024
Zb s19,s18,14336
Zh v[72:75],v0,s[4:7],s19 offen offset:0
Zh v[76:79],v0,s[4:7],s19 offen offset:1024
Zm v[16:17],0
Zm v[18:19],0
Zm v[20:21],0
Zm v[22:23],0
Zm v[24:25],0
Zm v[26:27],0
Zm v[28:29],0
Zm v[30:31],0
Zm v[32:33],0
Zm v[34:35],0
Zm v[36:37],0
Zm v[38:39],0
Zf vmcnt(0) lgkmcnt(0)
CS_w2x:
Zt v6,v[12:15] offset:6144
Zt v6,v[40:43] offset:7168
Zg v[16:19],v[12:15],v[48:55],v1
Zb s19,s18,2048
Zh v[48:51],v0,s[4:7],s19 offen offset:0
Zh v[52:55],v0,s[4:7],s19 offen offset:1024
Zg v[20:23],v[12:15],v[56:63],v1
Zi v[56:59],v5 offset:2048
Zi v[60:63],v5 offset:3072
Zg v[24:27],v[12:15],v[64:71],v1
Zi v[64:67],v5 offset:10240
Zi v[68:71],v5 offset:11264
Zf vmcnt(2)
Zg v[28:31],v[12:15],v[72:79],v1
Zi v[72:75],v5 offset:18432
Zi v[76:79],v5 offset:19456
Zf lgkmcnt(6)
s_barrier
Zi v[44:47],v6 offset:8192
Zg v[32:35],v[12:15],a[128:135],v1
Zg v[36:39],v[12:15],a[136:143],v1
Zg v[16:19],v[40:43],a[144:151],v1
Zi v[12:15],v6 offset:9216
Zf lgkmcnt(6)
Zg v[20:23],v[40:43],v[56:63],v1
Zb s19,s18,8192
Zh v[56:59],v0,s[4:7],s19 offen offset:0
Zh v[60:63],v0,s[4:7],s19 offen offset:1024
Zf lgkmcnt(4)
Zg v[24:27],v[40:43],v[64:71],v1
Zi v[64:67],v5 offset:12288
Zi v[68:71],v5 offset:13312
Zf lgkmcnt(4)
Zg v[28:31],v[40:43],v[72:79],v1
Zi v[72:75],v5 offset:20480
Zi v[76:79],v5 offset:21504
Zg v[32:35],v[40:43],a[152:159],v1
Zg v[36:39],v[40:43],a[160:167],v1
Zf lgkmcnt(5)
Zg v[16:19],v[44:47],a[168:175],v1
Zi v[40:43],v0 offset:0
Zf lgkmcnt(3)
Zg v[20:23],v[44:47],v[64:71],v1
Zi v[64:67],v5 offset:14336
Zi v[68:71],v5 offset:15360
Zg v[24:27],v[44:47],a[176:183],v1
Zf lgkmcnt(3)
Zg v[28:31],v[44:47],v[72:79],v1
Zi v[72:75],v5 offset:22528
Zi v[76:79],v5 offset:23552
Zg v[32:35],v[44:47],a[184:191],v1
Zg v[36:39],v[44:47],a[192:199],v1
Zg v[16:19],v[12:15],a[200:207],v1
Zi v[44:47],v0 offset:1024
Zf lgkmcnt(3)
Zg v[20:23],v[12:15],v[64:71],v1
Zb s19,s18,12288
Zh v[64:67],v0,s[4:7],s19 offen offset:0
Zh v[68:71],v0,s[4:7],s19 offen offset:1024
Zg v[24:27],v[12:15],a[208:215],v1
Zf lgkmcnt(1)
Zg v[28:31],v[12:15],v[72:79],v1
Zi v[72:75],v5 offset:24576
Zi v[76:79],v5 offset:25600
Zg v[32:35],v[12:15],a[216:223],v1
Zg v[36:39],v[12:15],a[224:231],v1
Zg v[16:19],v[40:43],a[232:239],v1
Zi v[12:15],v6 offset:2048
Zg v[20:23],v[40:43],a[240:247],v1
Zf vmcnt(4)
Zg v[24:27],v[40:43],v[48:55],v1
Zi v[48:51],v5 offset:0
Zi v[52:55],v5 offset:1024
Zf lgkmcnt(3)
Zg v[28:31],v[40:43],v[72:79],v1
Zb s19,s18,16384
Zh v[72:75],v0,s[4:7],s19 offen offset:0
Zh v[76:79],v0,s[4:7],s19 offen offset:1024
Zg v[32:35],v[40:43],a[248:255],v1
Zg v[36:39],v[40:43],v[80:87],v1
Zg v[16:19],v[44:47],v[88:95],v1
Zi v[40:43],v6 offset:3072
Zg v[20:23],v[44:47],v[96:103],v1
Zf lgkmcnt(1)
Zg v[24:27],v[44:47],v[48:55],v1
Zb s19,s18,4096
Zh v[48:51],v0,s[4:7],s19 offen offset:0
Zh v[52:55],v0,s[4:7],s19 offen offset:1024
Zg v[28:31],v[44:47],v[104:111],v1
Zg v[32:35],v[44:47],v[112:119],v1
Zf vmcnt(6)
Zg v[36:39],v[44:47],v[56:63],v1
Zb s34,s17,655360
Zi v[56:59],v5 offset:4096
Zi v[60:63],v5 offset:5120
Zg v[16:19],v[12:15],v[120:127],v1
Zi v[44:47],v6 offset:4096
Zo s10,63
s_cselect_b32 s34, s17, s34
Zg v[20:23],v[12:15],v[128:135],v1
s_xor_b32 s37, s37, 8192
Zg v[24:27],v[12:15],v[136:143],v1
Zg v[28:31],v[12:15],v[144:151],v1
Zg v[32:35],v[12:15],v[152:159],v1
Zf lgkmcnt(1)
Zg v[36:39],v[12:15],v[56:63],v1
Zi v[56:59],v5 offset:6144
Zi v[60:63],v5 offset:7168
Zg v[16:19],v[40:43],v[160:167],v1
Zi v[12:15],v6 offset:5120
Zg v[20:23],v[40:43],v[168:175],v1
Zg v[24:27],v[40:43],v[176:183],v1
Zf vmcnt(4)
Zg v[28:31],v[40:43],v[64:71],v1
Zi v[64:67],v5 offset:16384
Zi v[68:71],v5 offset:17408
Zf lgkmcnt(5)
Zg v[16:19],v[44:47],v[184:191],v1
Zf lgkmcnt(3)
Zg v[20:23],v[44:47],v[56:63],v1
Zi v[56:59],v5 offset:8192
Zi v[60:63],v5 offset:9216
Zf lgkmcnt(4)
Zg v[16:19],v[12:15],v[192:199],v1
Zg v[20:23],v[12:15],v[200:207],v1
Zg v[24:27],v[44:47],v[208:215],v1
v_xor_b32 v6, 8192, v6
Zf lgkmcnt(2)
Zg v[28:31],v[44:47],v[64:71],v1
Zl v16,v16,v18
Zb s19,s17,12288
Zh v[64:67],v0,s[4:7],s19 offen sc1 nt
Zh v[68:71],v0,s[4:7],s19 offen offset:1024 sc1 nt
Zf vmcnt(4)
Zg v[24:27],v[12:15],v[72:79],v1
Zl v17,v17,v19
Zf lgkmcnt(0)
Zg v[28:31],v[12:15],v[56:63],v1
Zl v20,v20,v22
Zg v[32:35],v[12:15],v[216:223],v1
Zl v21,v21,v23
Zw v16,s21,v16
Zi v[72:75],v6 offset:2048
Zi v[76:79],v6 offset:6144
Zg v[36:39],v[12:15],v[224:231],v1
Zw v17,s21,v17
Zw v20,s21,v20
Zw v21,s21,v21
Zj v18,v16,v20
Zj v19,v17,v21
ds_write2_b32 v8, v18, v19 offset0:0 offset1:72
Zi v[56:59],v6 offset:3072
Zi v[60:63],v6 offset:7168
Zl v24,v24,v26
Zl v25,v25,v27
Zl v28,v28,v30
Zl v29,v29,v31
Zj v12,v24,v28
Zj v13,v25,v29
ds_write_b32 v8, v12 offset:2304
ds_write_b32 v8, v13 offset:2592
Zg v[32:35],v[44:47],v[232:239],v1
Zg v[36:39],v[44:47],v[240:247],v1
Zf lgkmcnt(0)
s_barrier
Zi v[16:19],v9 offset:0
Zi v[20:23],v10 offset:0
Zi v[24:27],v9 offset:64
Zi v[28:31],v10 offset:64
Zg v[32:35],v[40:43],v[248:255],v1
Zf vmcnt(2)
Zg v[36:39],v[40:43],v[48:55],v1
Zi v[48:51],v6 offset:4096
Zi v[52:55],v6 offset:8192
s_nop 1
Zl v32,v32,v34
Zl v33,v33,v35
s_nop 1
Zl v36,v36,v38
Zl v37,v37,v39
Zj v14,v32,v33
Zj v15,v36,v37
Zr v[12:15],v0,s[4:7],s27 offen sc1 nt
Zf lgkmcnt(5)
Ze v[44:47],v[76:79],v[16:19],0
Zf lgkmcnt(4)
Ze v[32:35],v[20:23],v[16:19],0
Ze v[40:43],v[72:75],v[16:19],0
Zi v[16:19],v9 offset:128
Zi v[20:23],v10 offset:128
Zi v[72:75],v6 offset:5120
Zi v[76:79],v6 offset:9216
Zb m0,s37,6144
Zb s19,s34,4096
Zh v0,s[4:7],s19 offen sc1 nt lds
Zf lgkmcnt(7)
Ze v[44:47],v[60:63],v[24:27],v[44:47]
Zs v36,0x3f803f80
Zs v37,0x3f803f80
Zf lgkmcnt(6)
Ze v[32:35],v[28:31],v[24:27],v[32:35]
Zs v38,0x3f803f80
Zs v39,0x3f803f80
Ze v[40:43],v[56:59],v[24:27],v[40:43]
Zi v[24:27],v9 offset:192
Zi v[28:31],v10 offset:192
Zi v[56:59],v5 offset:30720
Zi v[60:63],v5 offset:31744
Zb m0,s37,7168
Zb s19,s34,5120
Zh v0,s[4:7],s19 offen sc1 nt lds
Zf lgkmcnt(7)
Ze v[44:47],v[52:55],v[16:19],v[44:47]
Zf lgkmcnt(6)
Ze v[32:35],v[20:23],v[16:19],v[32:35]
Ze v[40:43],v[48:51],v[16:19],v[40:43]
Zi v[48:51],v5 offset:26624
Zi v[52:55],v5 offset:27648
Zf lgkmcnt(5)
Ze v[44:47],v[76:79],v[24:27],v[44:47]
Zs v21,0
Zs v22,0
Zf lgkmcnt(4)
Ze v[32:35],v[28:31],v[24:27],v[32:35]
Ze v[40:43],v[72:75],v[24:27],v[40:43]
Zp s23,0
SX_w2x:
Zn v76,v44
Zn v77,v45
Zn v78,v46
Zn v79,v47
Zn v24,v32
Zn v25,v33
s_nop 0
Zn v72,v40
Zn v73,v41
Zn v74,v42
Zn v75,v43
Zj v18,v76,v77
Zj v19,v78,v79
Zj v16,v72,v73
Zj v17,v74,v75
Zj v20,v24,v25
Zj v23,v24,v25
Ze v[72:75],v[36:39],v[16:19],0
Zf vmcnt(4)
Ze v[24:27],v[64:67],v[16:19],0
Zf vmcnt(3)
Ze v[28:31],v[68:71],v[16:19],0
v_mfma_f32_16x16x16_bf16 v[72:75], v[36:37], v[20:21], v[72:75]
v_mfma_f32_16x16x16_bf16 v[24:27], v[14:15], v[20:21], v[24:27]
Zm v[76:77],0
Zm v[78:79],0
v_mfma_f32_16x16x16_bf16 v[28:31], v[14:15], v[22:23], v[28:31]
s_nop 2
v_subrev_u32 v73, s32, v72
v_rcp_f32 v74, v72
v_cmp_le_u32 vcc, s33, v73
Zs v75,v74
s_cbranch_vccnz FB_w2x
SO_w2x:
v_pk_mul_f32 v[24:25], v[24:25], v[74:75]
v_pk_mul_f32 v[26:27], v[26:27], v[74:75]
v_pk_mul_f32 v[28:29], v[28:29], v[74:75]
v_pk_mul_f32 v[30:31], v[30:31], v[74:75]
Zj v24,v24,v28
Zj v25,v25,v29
Zj v26,v26,v30
Zj v27,v27,v31
Zt v11,v[24:27]
Zm v[72:73],0
Zm v[74:75],0
Zm v[16:17],0
Zm v[18:19],0
Zm v[20:21],0
Zm v[22:23],0
Zm v[64:65],0
Zm v[66:67],0
Zm v[68:69],0
Zm v[70:71],0
Zf lgkmcnt(0)
s_barrier
Zi v[40:43],v0 offset:0
Zi v[44:47],v0 offset:1024
Zo s10,63
Zk CE_w2x
Zm v[24:25],0
Zm v[26:27],0
Zm v[28:29],0
Zm v[30:31],0
Zb s17,s17,655360
Zf lgkmcnt(1)
Zg v[72:75],v[40:43],v[48:55],v1
Zm v[32:33],0
Zi v[48:51],v5 offset:28672
Zi v[52:55],v5 offset:29696
Zf lgkmcnt(2)
Zg v[72:75],v[44:47],v[56:63],v1
Zm v[34:35],0
Zi v[56:59],v5 offset:32768
Zi v[60:63],v5 offset:33792
Zg v[76:79],v[40:43],a[0:7],v1
Zm v[36:37],0
Zg v[76:79],v[44:47],a[8:15],v1
Zm v[38:39],0
Zg v[16:19],v[40:43],a[16:23],v1
Zl v72,v72,v74
Zg v[16:19],v[44:47],a[24:31],v1
Zl v73,v73,v75
Zg v[20:23],v[40:43],a[32:39],v1
Zl v76,v76,v78
Zf lgkmcnt(2)
Zg v[20:23],v[44:47],v[48:55],v1
Zl v77,v77,v79
Zf lgkmcnt(0)
Zg v[64:67],v[40:43],v[56:63],v1
Zl v16,v16,v18
Zg v[64:67],v[44:47],a[40:47],v1
Zl v17,v17,v19
Zg v[68:71],v[40:43],a[48:55],v1
Zl v20,v20,v22
Zj v12,v72,v76
Zg v[68:71],v[44:47],a[56:63],v1
Zl v21,v21,v23
Zj v48,v73,v77
Zg v[24:27],v[40:43],a[64:71],v1
Zl v64,v64,v66
Zj v13,v16,v20
Zg v[24:27],v[44:47],a[72:79],v1
Zl v65,v65,v67
Zj v49,v17,v21
Zg v[28:31],v[40:43],a[80:87],v1
Zl v68,v68,v70
v_bfi_b32 v12, 1, s39, v12
Zg v[28:31],v[44:47],a[88:95],v1
Zl v69,v69,v71
v_bfi_b32 v48, 1, s39, v48
Zg v[32:35],v[40:43],a[96:103],v1
Zl v24,v24,v26
Zj v14,v64,v68
Zg v[32:35],v[44:47],a[104:111],v1
Zl v25,v25,v27
Zj v50,v65,v69
Zg v[36:39],v[40:43],a[112:119],v1
Zl v28,v28,v30
Zj v15,v24,v28
Zr v[12:15],v2,s[4:7],s12 offen sc1
Zg v[36:39],v[44:47],a[120:127],v1
Zl v29,v29,v31
Zj v51,v25,v29
Zr v[48:51],v2,s[4:7],s12 offen offset:1280 sc1
Zl v32,v32,v34
Zl v33,v33,v35
s_nop 2
Zl v36,v36,v38
Zj v56,v32,v36
v_bfi_b32 v56, 1, s39, v56
Zu v56,v3,s[4:7],s12 offen offset:0 sc1
Zl v37,v37,v39
Zj v57,v33,v37
v_bfi_b32 v57, 1, s39, v57
Zu v57,v3,s[4:7],s12 offen offset:1280 sc1
s_xor_b32 s16, s15, 0x4000
Zb s10,s10,1
Zb s11,s11,1
Zb s27,s27,655360
s_cmp_lt_u32 s8, 16
Zk P1G_w2x
Zb s19,s18,0
Zh v[48:51],v0,s[4:7],s19 offen offset:0
Zh v[52:55],v0,s[4:7],s19 offen offset:1024
Zb s19,s18,6144
Zh v[56:59],v0,s[4:7],s19 offen offset:0
Zh v[60:63],v0,s[4:7],s19 offen offset:1024
s_branch P1S_w2x
P1G_w2x:
Zi v[12:15],v0 offset:23040
Zm v[38:39],-1
Zy v40,0x60,v0
v_lshl_add_u32 v40, v40, 3, s38
Zy v41,0x10,v0
v_lshl_add_u32 v40, v41, 1, v40
v_lshrrev_b32 v41, 5, v0
Zy v41,8,v41
v_add_u32 v40, v40, v41
Zy v41,0x280,v0
Zs v42,2130706432
v_cmp_ne_u32 vcc, 0, v41
s_nop 1
v_cndmask_b32 v40, v40, v42, vcc
Zf vmcnt(0)
Zf lgkmcnt(0)
Zh v[16:19],v4,s[4:7],s12 offen sc1
Zh v[20:23],v4,s[4:7],s13 offen sc1
Zh v[24:27],v4,s[4:7],s14 offen sc1
Zh v[28:31],v4,s[4:7],s59 offen sc1
Zb s19,s18,0
Zh v[48:51],v0,s[4:7],s19 offen offset:0
Zh v[52:55],v0,s[4:7],s19 offen offset:1024
Zb s19,s18,6144
Zh v[56:59],v0,s[4:7],s19 offen offset:0
Zh v[60:63],v0,s[4:7],s19 offen offset:1024
Zf vmcnt(7)
Ze v[32:35],v[12:15],v[16:19],0
v_xor_b32 v36, s39, v16
v_xor_b32 v37, v17, v16
Zv v37,v37,v18,v16 bitop3:0xf6
Zv v37,v37,v19,v16 bitop3:0xf6
Zf vmcnt(6)
Ze v[32:35],v[12:15],v[20:23],v[32:35]
Zv v36,v36,v20,s39 bitop3:0xf6
Zv v37,v37,v21,v20 bitop3:0xf6
Zv v37,v37,v22,v20 bitop3:0xf6
Zv v37,v37,v23,v20 bitop3:0xf6
Zf vmcnt(5)
Ze v[32:35],v[12:15],v[24:27],v[32:35]
Zv v36,v36,v24,s39 bitop3:0xf6
Zv v37,v37,v25,v24 bitop3:0xf6
Zv v37,v37,v26,v24 bitop3:0xf6
Zv v37,v37,v27,v24 bitop3:0xf6
Zf vmcnt(4)
Ze v[32:35],v[12:15],v[28:31],v[32:35]
Zv v36,v36,v28,s39 bitop3:0xf6
Zv v37,v37,v29,v28 bitop3:0xf6
Zv v37,v37,v30,v28 bitop3:0xf6
Zv v37,v37,v31,v28 bitop3:0xf6
v_and_or_b32 v36, v37, s36, v36
Zy v36,1,v36
v_cmp_ne_u32 vcc, 0, v36
s_cbranch_vccz P1D_w2x
P1_w2x:
Zh v[16:19],v4,s[4:7],s12 offen sc1
Zh v[20:23],v4,s[4:7],s13 offen sc1
Zh v[24:27],v4,s[4:7],s14 offen sc1
Zh v[28:31],v4,s[4:7],s59 offen sc1
Zf vmcnt(3)
Ze v[32:35],v[12:15],v[16:19],0
v_xor_b32 v36, s39, v16
v_xor_b32 v37, v17, v16
Zv v37,v37,v18,v16 bitop3:0xf6
Zv v37,v37,v19,v16 bitop3:0xf6
Zf vmcnt(2)
Ze v[32:35],v[12:15],v[20:23],v[32:35]
Zv v36,v36,v20,s39 bitop3:0xf6
Zv v37,v37,v21,v20 bitop3:0xf6
Zv v37,v37,v22,v20 bitop3:0xf6
Zv v37,v37,v23,v20 bitop3:0xf6
Zf vmcnt(1)
Ze v[32:35],v[12:15],v[24:27],v[32:35]
Zv v36,v36,v24,s39 bitop3:0xf6
Zv v37,v37,v25,v24 bitop3:0xf6
Zv v37,v37,v26,v24 bitop3:0xf6
Zv v37,v37,v27,v24 bitop3:0xf6
Zf vmcnt(0)
Ze v[32:35],v[12:15],v[28:31],v[32:35]
Zv v36,v36,v28,s39 bitop3:0xf6
Zv v37,v37,v29,v28 bitop3:0xf6
Zv v37,v37,v30,v28 bitop3:0xf6
Zv v37,v37,v31,v28 bitop3:0xf6
v_and_or_b32 v36, v37, s36, v36
Zy v36,1,v36
v_cmp_ne_u32 vcc, 0, v36
s_cbranch_vccz P1D_w2x
s_sub_u32 s20, s20, 1
s_cmp_gt_i32 s20, 0
Zk P1_w2x
P1D_w2x:
v_add_f32_dpp v16, v32, v32 row_shl:8 row_mask:0xf bank_mask:0xf bound_ctrl:1
v_add_f32_dpp v17, v33, v33 row_shl:8 row_mask:0xf bank_mask:0xf bound_ctrl:1
v_add_f32_dpp v18, v34, v34 row_shl:8 row_mask:0xf bank_mask:0xf bound_ctrl:1
v_add_f32_dpp v19, v35, v35 row_shl:8 row_mask:0xf bank_mask:0xf bound_ctrl:1
Zj v36,v16,v17
Zj v37,v18,v19
buffer_store_dwordx2 v[36:37], v40, s[4:7], s15 offen sc1
buffer_store_dwordx2 v[38:39], v40, s[4:7], s16 offen sc1
P1S_w2x:
s_barrier
Zb s19,s18,10240
Zh v[64:67],v0,s[4:7],s19 offen offset:0
Zh v[68:71],v0,s[4:7],s19 offen offset:1024
Zm v[18:19],0
Zm v[20:21],0
Zm v[22:23],0
Zm v[24:25],0
Zm v[26:27],0
Zm v[28:29],0
Zm v[30:31],0
Zm v[32:33],0
Zm v[34:35],0
Zm v[36:37],0
Zm v[38:39],0
s_xor_b32 s39, s39, 1
Zb s22,s15,6144
Zf lgkmcnt(0)
Zh v[12:15],v0,s[4:7],s22 offen offset:0 sc1
Zh v[40:43],v0,s[4:7],s22 offen offset:1024 sc1
Zf vmcnt(1)
Zb s19,s18,14336
Zh v[72:75],v0,s[4:7],s19 offen offset:0
Zh v[76:79],v0,s[4:7],s19 offen offset:1024
v_max3_u32 v16, v12, v13, v14
Zf vmcnt(2)
v_max3_u32 v16, v16, v15, v40
v_max3_u32 v16, v16, v41, v42
v_max_u32 v16, v16, v43
v_cmp_eq_u32 vcc, -1, v16
Zm v[16:17],0
s_cbranch_vccz P2D_w2x
P2_w2x:
Zh v[12:15],v0,s[4:7],s22 offen offset:0 sc1
Zh v[40:43],v0,s[4:7],s22 offen offset:1024 sc1
Zf vmcnt(1)
v_max3_u32 v16, v12, v13, v14
Zf vmcnt(0)
v_max3_u32 v16, v16, v15, v40
v_max3_u32 v16, v16, v41, v42
v_max_u32 v16, v16, v43
v_cmp_eq_u32 vcc, -1, v16
Zm v[16:17],0
s_cbranch_vccz P2D_w2x
s_sub_u32 s20, s20, 1
s_cmp_gt_i32 s20, 0
Zk P2_w2x
P2D_w2x:
Zp s15,s16
s_branch CS_w2x
FB_w2x:
s_cmp_lg_u32 s23, 0
Zk SO_w2x
Zp s23,1
s_nop 11
v_max3_f32 v24, v40, v41, v42
v_max3_f32 v24, v24, v43, v44
v_max3_f32 v24, v24, v45, v46
v_max3_f32 v24, v24, v47, v32
v_max_f32 v24, v24, v33
Zs v25,v24
s_nop 1
v_permlane32_swap_b32 v24, v25
v_max_f32 v24, v24, v25
Zs v25,v24
s_nop 1
v_permlane16_swap_b32 v24, v25
v_max_f32 v24, v24, v25
Zx v40,v40,v24
Zx v41,v41,v24
Zx v42,v42,v24
Zx v43,v43,v24
Zx v44,v44,v24
Zx v45,v45,v24
Zx v46,v46,v24
Zx v47,v47,v24
Zx v32,v32,v24
Zx v33,v33,v24
Zf lgkmcnt(0)
s_branch SX_w2x
CE_w2x:
Zf vmcnt(0) lgkmcnt(0)
s_barrier
Zb s11,s11,1
Zb s27,s27,655360
Zb s17,s17,655360
Zp s15,2129920
Zf vmcnt(0)
s_cmp_lt_u32 s11, 128
Zk CL_w2x
s_endpgm
.p2align 6
L_fa2:
Zq s24,s8,7
Zb s26,s24,4096
Zb s24,s24,0
Zp s11,0
s_mul_i32 s17, s8, 20480
Zb s17,s17,16777216
Zb s27,s17,18432
s_load_dwordx2 s[28:29], s[0:1], 48
Zp s30,10240
Zp s31,0x20000
Zp s39,0
Zb s90,s18,0
Zb s91,s18,4096
Zb s92,s18,8192
Zb s93,s18,12288
Zb s94,s18,16384
Zb s36,s8,64
s_mul_i32 s22, s36, 205
s_lshr_b32 s22, s22, 11
s_mul_i32 s23, s22, 10
s_sub_u32 s36, s36, s23
Zq s38,s36,10
s_lshr_b32 s23, s22, 1
Zq s23,s23,6
Zb s38,s38,s23
s_and_b32 s23, s22, 1
Zq s23,s23,4
Zb s38,s38,s23
s_cmp_ge_u32 s36, 8
s_cselect_b32 s36, 1, 0
Zb s13,s12,82944
Zb s14,s12,165888
Zb s59,s12,248832
Zp s32,394264576
Zp s33,1342177280
Zf lgkmcnt(0)
CL_w2:
Zp s10,0
s_barrier
Zp s37,8192
Zs v6,v0
Zb m0,s37,6144
Zb s19,s17,4096
Zh v0,s[4:7],s19 offen sc1 nt lds
Zb m0,s37,7168
Zb s19,s17,5120
Zh v0,s[4:7],s19 offen sc1 nt lds
Zh v[12:15],v7,s[28:31],0 offen offset:768
Zh v[40:43],v7,s[28:31],0 offen offset:896
Zb s19,s18,0
Zh v[48:51],v0,s[4:7],s19 offen offset:0
Zh v[52:55],v0,s[4:7],s19 offen offset:1024
Zb s19,s18,6144
Zh v[56:59],v0,s[4:7],s19 offen offset:0
Zh v[60:63],v0,s[4:7],s19 offen offset:1024
Zb s19,s18,10240
Zh v[64:67],v0,s[4:7],s19 offen offset:0
Zh v[68:71],v0,s[4:7],s19 offen offset:1024
Zb s19,s18,14336
Zh v[72:75],v0,s[4:7],s19 offen offset:0
Zh v[76:79],v0,s[4:7],s19 offen offset:1024
Zm v[16:17],0
Zm v[18:19],0
Zm v[20:21],0
Zm v[22:23],0
Zm v[24:25],0
Zm v[26:27],0
Zm v[28:29],0
Zm v[30:31],0
Zm v[32:33],0
Zm v[34:35],0
Zm v[36:37],0
Zm v[38:39],0
Zf vmcnt(0) lgkmcnt(0)
CS_w2:
Zt v6,v[12:15] offset:6144
Zt v6,v[40:43] offset:7168
Zg v[16:19],v[12:15],v[48:55],v1
Zb s19,s18,2048
Zh v[48:51],v0,s[4:7],s19 offen offset:0
Zh v[52:55],v0,s[4:7],s19 offen offset:1024
Zg v[20:23],v[12:15],v[56:63],v1
Zi v[56:59],v5 offset:2048
Zi v[60:63],v5 offset:3072
Zg v[24:27],v[12:15],v[64:71],v1
Zi v[64:67],v5 offset:10240
Zi v[68:71],v5 offset:11264
Zf vmcnt(2)
Zg v[28:31],v[12:15],v[72:79],v1
Zi v[72:75],v5 offset:18432
Zi v[76:79],v5 offset:19456
Zf lgkmcnt(6)
s_barrier
Zi v[44:47],v6 offset:8192
Zg v[32:35],v[12:15],a[128:135],v1
Zg v[36:39],v[12:15],a[136:143],v1
Zg v[16:19],v[40:43],a[144:151],v1
Zi v[12:15],v6 offset:9216
Zf lgkmcnt(6)
Zg v[20:23],v[40:43],v[56:63],v1
Zb s19,s18,8192
Zh v[56:59],v0,s[4:7],s19 offen offset:0
Zh v[60:63],v0,s[4:7],s19 offen offset:1024
Zf lgkmcnt(4)
Zg v[24:27],v[40:43],v[64:71],v1
Zi v[64:67],v5 offset:12288
Zi v[68:71],v5 offset:13312
Zf lgkmcnt(4)
Zg v[28:31],v[40:43],v[72:79],v1
Zi v[72:75],v5 offset:20480
Zi v[76:79],v5 offset:21504
Zg v[32:35],v[40:43],a[152:159],v1
Zg v[36:39],v[40:43],a[160:167],v1
Zf lgkmcnt(5)
Zg v[16:19],v[44:47],a[168:175],v1
Zi v[40:43],v0 offset:0
Zf lgkmcnt(3)
Zg v[20:23],v[44:47],v[64:71],v1
Zi v[64:67],v5 offset:14336
Zi v[68:71],v5 offset:15360
Zg v[24:27],v[44:47],a[176:183],v1
Zf lgkmcnt(3)
Zg v[28:31],v[44:47],v[72:79],v1
Zi v[72:75],v5 offset:22528
Zi v[76:79],v5 offset:23552
Zg v[32:35],v[44:47],a[184:191],v1
Zg v[36:39],v[44:47],a[192:199],v1
Zg v[16:19],v[12:15],a[200:207],v1
Zi v[44:47],v0 offset:1024
Zf lgkmcnt(3)
Zg v[20:23],v[12:15],v[64:71],v1
Zb s19,s18,12288
Zh v[64:67],v0,s[4:7],s19 offen offset:0
Zh v[68:71],v0,s[4:7],s19 offen offset:1024
Zg v[24:27],v[12:15],a[208:215],v1
Zf lgkmcnt(1)
Zg v[28:31],v[12:15],v[72:79],v1
Zi v[72:75],v5 offset:24576
Zi v[76:79],v5 offset:25600
Zg v[32:35],v[12:15],a[216:223],v1
Zg v[36:39],v[12:15],a[224:231],v1
Zg v[16:19],v[40:43],a[232:239],v1
Zi v[12:15],v6 offset:2048
Zg v[20:23],v[40:43],a[240:247],v1
Zf vmcnt(4)
Zg v[24:27],v[40:43],v[48:55],v1
Zi v[48:51],v5 offset:0
Zi v[52:55],v5 offset:1024
Zf lgkmcnt(3)
Zg v[28:31],v[40:43],v[72:79],v1
Zb s19,s18,16384
Zh v[72:75],v0,s[4:7],s19 offen offset:0
Zh v[76:79],v0,s[4:7],s19 offen offset:1024
Zg v[32:35],v[40:43],a[248:255],v1
Zg v[36:39],v[40:43],v[80:87],v1
Zg v[16:19],v[44:47],v[88:95],v1
Zi v[40:43],v6 offset:3072
Zg v[20:23],v[44:47],v[96:103],v1
Zf lgkmcnt(1)
Zg v[24:27],v[44:47],v[48:55],v1
Zb s19,s18,4096
Zh v[48:51],v0,s[4:7],s19 offen offset:0
Zh v[52:55],v0,s[4:7],s19 offen offset:1024
Zg v[28:31],v[44:47],v[104:111],v1
Zg v[32:35],v[44:47],v[112:119],v1
Zf vmcnt(6)
Zg v[36:39],v[44:47],v[56:63],v1
Zb s34,s17,655360
Zi v[56:59],v5 offset:4096
Zi v[60:63],v5 offset:5120
Zg v[16:19],v[12:15],v[120:127],v1
Zi v[44:47],v6 offset:4096
Zo s10,63
s_cselect_b32 s34, s17, s34
Zg v[20:23],v[12:15],v[128:135],v1
s_xor_b32 s37, s37, 8192
Zg v[24:27],v[12:15],v[136:143],v1
Zg v[28:31],v[12:15],v[144:151],v1
Zg v[32:35],v[12:15],v[152:159],v1
Zf lgkmcnt(1)
Zg v[36:39],v[12:15],v[56:63],v1
Zi v[56:59],v5 offset:6144
Zi v[60:63],v5 offset:7168
Zg v[16:19],v[40:43],v[160:167],v1
Zi v[12:15],v6 offset:5120
Zg v[20:23],v[40:43],v[168:175],v1
Zg v[24:27],v[40:43],v[176:183],v1
Zf vmcnt(4)
Zg v[28:31],v[40:43],v[64:71],v1
Zi v[64:67],v5 offset:16384
Zi v[68:71],v5 offset:17408
Zf lgkmcnt(5)
Zg v[16:19],v[44:47],v[184:191],v1
Zf lgkmcnt(3)
Zg v[20:23],v[44:47],v[56:63],v1
Zi v[56:59],v5 offset:8192
Zi v[60:63],v5 offset:9216
Zf lgkmcnt(4)
Zg v[16:19],v[12:15],v[192:199],v1
Zg v[20:23],v[12:15],v[200:207],v1
Zg v[24:27],v[44:47],v[208:215],v1
v_xor_b32 v6, 8192, v6
Zf lgkmcnt(2)
Zg v[28:31],v[44:47],v[64:71],v1
Zl v16,v16,v18
Zb s19,s17,12288
Zh v[64:67],v0,s[4:7],s19 offen sc1 nt
Zh v[68:71],v0,s[4:7],s19 offen offset:1024 sc1 nt
Zf vmcnt(4)
Zg v[24:27],v[12:15],v[72:79],v1
Zl v17,v17,v19
Zf lgkmcnt(0)
Zg v[28:31],v[12:15],v[56:63],v1
Zl v20,v20,v22
Zg v[32:35],v[12:15],v[216:223],v1
Zl v21,v21,v23
Zw v16,s21,v16
Zi v[72:75],v6 offset:2048
Zi v[76:79],v6 offset:6144
Zg v[36:39],v[12:15],v[224:231],v1
Zw v17,s21,v17
Zw v20,s21,v20
Zw v21,s21,v21
Zj v18,v16,v20
Zj v19,v17,v21
ds_write2_b32 v8, v18, v19 offset0:0 offset1:72
Zi v[56:59],v6 offset:3072
Zi v[60:63],v6 offset:7168
Zl v24,v24,v26
Zl v25,v25,v27
Zl v28,v28,v30
Zl v29,v29,v31
Zj v12,v24,v28
Zj v13,v25,v29
ds_write_b32 v8, v12 offset:2304
ds_write_b32 v8, v13 offset:2592
Zg v[32:35],v[44:47],v[232:239],v1
Zg v[36:39],v[44:47],v[240:247],v1
Zf lgkmcnt(0)
s_barrier
Zi v[16:19],v9 offset:0
Zi v[20:23],v10 offset:0
Zi v[24:27],v9 offset:64
Zi v[28:31],v10 offset:64
Zg v[32:35],v[40:43],v[248:255],v1
Zf vmcnt(2)
Zg v[36:39],v[40:43],v[48:55],v1
Zi v[48:51],v6 offset:4096
Zi v[52:55],v6 offset:8192
s_nop 1
Zl v32,v32,v34
Zl v33,v33,v35
s_nop 1
Zl v36,v36,v38
Zl v37,v37,v39
Zj v14,v32,v33
Zj v15,v36,v37
Zr v[12:15],v0,s[4:7],s27 offen sc1 nt
Zf lgkmcnt(5)
Ze v[44:47],v[76:79],v[16:19],0
Zf lgkmcnt(4)
Ze v[32:35],v[20:23],v[16:19],0
Ze v[40:43],v[72:75],v[16:19],0
Zi v[16:19],v9 offset:128
Zi v[20:23],v10 offset:128
Zi v[72:75],v6 offset:5120
Zi v[76:79],v6 offset:9216
Zb m0,s37,6144
Zb s19,s34,4096
Zh v0,s[4:7],s19 offen sc1 nt lds
Zf lgkmcnt(7)
Ze v[44:47],v[60:63],v[24:27],v[44:47]
Zs v36,0x3f803f80
Zs v37,0x3f803f80
Zf lgkmcnt(6)
Ze v[32:35],v[28:31],v[24:27],v[32:35]
Zs v38,0x3f803f80
Zs v39,0x3f803f80
Ze v[40:43],v[56:59],v[24:27],v[40:43]
Zi v[24:27],v9 offset:192
Zi v[28:31],v10 offset:192
Zi v[56:59],v5 offset:30720
Zi v[60:63],v5 offset:31744
Zb m0,s37,7168
Zb s19,s34,5120
Zh v0,s[4:7],s19 offen sc1 nt lds
Zf lgkmcnt(7)
Ze v[44:47],v[52:55],v[16:19],v[44:47]
Zf lgkmcnt(6)
Ze v[32:35],v[20:23],v[16:19],v[32:35]
Ze v[40:43],v[48:51],v[16:19],v[40:43]
Zi v[48:51],v5 offset:26624
Zi v[52:55],v5 offset:27648
Zf lgkmcnt(5)
Ze v[44:47],v[76:79],v[24:27],v[44:47]
Zs v21,0
Zs v22,0
Zf lgkmcnt(4)
Ze v[32:35],v[28:31],v[24:27],v[32:35]
Ze v[40:43],v[72:75],v[24:27],v[40:43]
Zp s23,0
SX_w2:
Zn v76,v44
Zn v77,v45
Zn v78,v46
Zn v79,v47
Zn v24,v32
Zn v25,v33
s_nop 0
Zn v72,v40
Zn v73,v41
Zn v74,v42
Zn v75,v43
Zj v18,v76,v77
Zj v19,v78,v79
Zj v16,v72,v73
Zj v17,v74,v75
Zj v20,v24,v25
Zj v23,v24,v25
Ze v[72:75],v[36:39],v[16:19],0
Zf vmcnt(4)
Ze v[24:27],v[64:67],v[16:19],0
Zf vmcnt(3)
Ze v[28:31],v[68:71],v[16:19],0
v_mfma_f32_16x16x16_bf16 v[72:75], v[36:37], v[20:21], v[72:75]
v_mfma_f32_16x16x16_bf16 v[24:27], v[14:15], v[20:21], v[24:27]
Zm v[76:77],0
Zm v[78:79],0
v_mfma_f32_16x16x16_bf16 v[28:31], v[14:15], v[22:23], v[28:31]
s_nop 2
v_subrev_u32 v73, s32, v72
v_rcp_f32 v74, v72
v_cmp_le_u32 vcc, s33, v73
Zs v75,v74
s_cbranch_vccnz FB_w2
SO_w2:
v_pk_mul_f32 v[24:25], v[24:25], v[74:75]
v_pk_mul_f32 v[26:27], v[26:27], v[74:75]
v_pk_mul_f32 v[28:29], v[28:29], v[74:75]
v_pk_mul_f32 v[30:31], v[30:31], v[74:75]
Zj v24,v24,v28
Zj v25,v25,v29
Zj v26,v26,v30
Zj v27,v27,v31
Zt v11,v[24:27]
Zm v[72:73],0
Zm v[74:75],0
Zm v[16:17],0
Zm v[18:19],0
Zm v[20:21],0
Zm v[22:23],0
Zm v[64:65],0
Zm v[66:67],0
Zm v[68:69],0
Zm v[70:71],0
Zf lgkmcnt(0)
s_barrier
Zi v[40:43],v0 offset:0
Zi v[44:47],v0 offset:1024
Zo s10,63
Zk CE_w2
Zm v[24:25],0
Zm v[26:27],0
Zm v[28:29],0
Zm v[30:31],0
Zb s17,s17,655360
Zf lgkmcnt(1)
Zg v[72:75],v[40:43],v[48:55],v1
Zm v[32:33],0
Zi v[48:51],v5 offset:28672
Zi v[52:55],v5 offset:29696
Zf lgkmcnt(2)
Zg v[72:75],v[44:47],v[56:63],v1
Zm v[34:35],0
Zi v[56:59],v5 offset:32768
Zi v[60:63],v5 offset:33792
Zg v[76:79],v[40:43],a[0:7],v1
Zm v[36:37],0
Zg v[76:79],v[44:47],a[8:15],v1
Zm v[38:39],0
Zg v[16:19],v[40:43],a[16:23],v1
Zl v72,v72,v74
Zg v[16:19],v[44:47],a[24:31],v1
Zl v73,v73,v75
Zg v[20:23],v[40:43],a[32:39],v1
Zl v76,v76,v78
Zf lgkmcnt(2)
Zg v[20:23],v[44:47],v[48:55],v1
Zl v77,v77,v79
Zf lgkmcnt(0)
Zg v[64:67],v[40:43],v[56:63],v1
Zl v16,v16,v18
Zg v[64:67],v[44:47],a[40:47],v1
Zl v17,v17,v19
Zg v[68:71],v[40:43],a[48:55],v1
Zl v20,v20,v22
Zj v12,v72,v76
Zg v[68:71],v[44:47],a[56:63],v1
Zl v21,v21,v23
Zj v48,v73,v77
Zg v[24:27],v[40:43],a[64:71],v1
Zl v64,v64,v66
Zj v13,v16,v20
Zg v[24:27],v[44:47],a[72:79],v1
Zl v65,v65,v67
Zj v49,v17,v21
Zg v[28:31],v[40:43],a[80:87],v1
Zl v68,v68,v70
v_bfi_b32 v12, 1, s39, v12
Zg v[28:31],v[44:47],a[88:95],v1
Zl v69,v69,v71
v_bfi_b32 v48, 1, s39, v48
Zg v[32:35],v[40:43],a[96:103],v1
Zl v24,v24,v26
Zj v14,v64,v68
Zg v[32:35],v[44:47],a[104:111],v1
Zl v25,v25,v27
Zj v50,v65,v69
Zg v[36:39],v[40:43],a[112:119],v1
Zl v28,v28,v30
Zj v15,v24,v28
Zr v[12:15],v2,s[4:7],s12 offen
Zg v[36:39],v[44:47],a[120:127],v1
Zl v29,v29,v31
Zj v51,v25,v29
Zr v[48:51],v2,s[4:7],s12 offen offset:1280
Zl v32,v32,v34
Zl v33,v33,v35
s_nop 2
Zl v36,v36,v38
Zj v56,v32,v36
v_bfi_b32 v56, 1, s39, v56
Zu v56,v3,s[4:7],s12 offen offset:0
Zl v37,v37,v39
Zj v57,v33,v37
v_bfi_b32 v57, 1, s39, v57
Zu v57,v3,s[4:7],s12 offen offset:1280
s_xor_b32 s16, s15, 0x4000
Zb s10,s10,1
Zb s11,s11,1
Zb s27,s27,655360
s_cmp_lt_u32 s8, 16
Zk P1G_w2
Zb s19,s18,0
Zh v[48:51],v0,s[4:7],s19 offen offset:0
Zh v[52:55],v0,s[4:7],s19 offen offset:1024
Zb s19,s18,6144
Zh v[56:59],v0,s[4:7],s19 offen offset:0
Zh v[60:63],v0,s[4:7],s19 offen offset:1024
s_branch P1S_w2
P1G_w2:
Zi v[12:15],v0 offset:23040
Zm v[38:39],-1
Zy v40,0x60,v0
v_lshl_add_u32 v40, v40, 3, s38
Zy v41,0x10,v0
v_lshl_add_u32 v40, v41, 1, v40
v_lshrrev_b32 v41, 5, v0
Zy v41,8,v41
v_add_u32 v40, v40, v41
Zy v41,0x280,v0
Zs v42,2130706432
v_cmp_ne_u32 vcc, 0, v41
s_nop 1
v_cndmask_b32 v40, v40, v42, vcc
Zf vmcnt(0)
Zf lgkmcnt(0)
Zh v[16:19],v4,s[4:7],s12 offen sc1
Zh v[20:23],v4,s[4:7],s13 offen sc1
Zh v[24:27],v4,s[4:7],s14 offen sc1
Zh v[28:31],v4,s[4:7],s59 offen sc1
Zb s19,s18,0
Zh v[48:51],v0,s[4:7],s19 offen offset:0
Zh v[52:55],v0,s[4:7],s19 offen offset:1024
Zb s19,s18,6144
Zh v[56:59],v0,s[4:7],s19 offen offset:0
Zh v[60:63],v0,s[4:7],s19 offen offset:1024
Zf vmcnt(7)
Ze v[32:35],v[12:15],v[16:19],0
v_xor_b32 v36, s39, v16
v_xor_b32 v37, v17, v16
Zv v37,v37,v18,v16 bitop3:0xf6
Zv v37,v37,v19,v16 bitop3:0xf6
Zf vmcnt(6)
Ze v[32:35],v[12:15],v[20:23],v[32:35]
Zv v36,v36,v20,s39 bitop3:0xf6
Zv v37,v37,v21,v20 bitop3:0xf6
Zv v37,v37,v22,v20 bitop3:0xf6
Zv v37,v37,v23,v20 bitop3:0xf6
Zf vmcnt(5)
Ze v[32:35],v[12:15],v[24:27],v[32:35]
Zv v36,v36,v24,s39 bitop3:0xf6
Zv v37,v37,v25,v24 bitop3:0xf6
Zv v37,v37,v26,v24 bitop3:0xf6
Zv v37,v37,v27,v24 bitop3:0xf6
Zf vmcnt(4)
Ze v[32:35],v[12:15],v[28:31],v[32:35]
Zv v36,v36,v28,s39 bitop3:0xf6
Zv v37,v37,v29,v28 bitop3:0xf6
Zv v37,v37,v30,v28 bitop3:0xf6
Zv v37,v37,v31,v28 bitop3:0xf6
v_and_or_b32 v36, v37, s36, v36
Zy v36,1,v36
v_cmp_ne_u32 vcc, 0, v36
s_cbranch_vccz P1D_w2
P1_w2:
Zh v[16:19],v4,s[4:7],s12 offen sc1
Zh v[20:23],v4,s[4:7],s13 offen sc1
Zh v[24:27],v4,s[4:7],s14 offen sc1
Zh v[28:31],v4,s[4:7],s59 offen sc1
Zf vmcnt(3)
Ze v[32:35],v[12:15],v[16:19],0
v_xor_b32 v36, s39, v16
v_xor_b32 v37, v17, v16
Zv v37,v37,v18,v16 bitop3:0xf6
Zv v37,v37,v19,v16 bitop3:0xf6
Zf vmcnt(2)
Ze v[32:35],v[12:15],v[20:23],v[32:35]
Zv v36,v36,v20,s39 bitop3:0xf6
Zv v37,v37,v21,v20 bitop3:0xf6
Zv v37,v37,v22,v20 bitop3:0xf6
Zv v37,v37,v23,v20 bitop3:0xf6
Zf vmcnt(1)
Ze v[32:35],v[12:15],v[24:27],v[32:35]
Zv v36,v36,v24,s39 bitop3:0xf6
Zv v37,v37,v25,v24 bitop3:0xf6
Zv v37,v37,v26,v24 bitop3:0xf6
Zv v37,v37,v27,v24 bitop3:0xf6
Zf vmcnt(0)
Ze v[32:35],v[12:15],v[28:31],v[32:35]
Zv v36,v36,v28,s39 bitop3:0xf6
Zv v37,v37,v29,v28 bitop3:0xf6
Zv v37,v37,v30,v28 bitop3:0xf6
Zv v37,v37,v31,v28 bitop3:0xf6
v_and_or_b32 v36, v37, s36, v36
Zy v36,1,v36
v_cmp_ne_u32 vcc, 0, v36
s_cbranch_vccz P1D_w2
s_sub_u32 s20, s20, 1
s_cmp_gt_i32 s20, 0
Zk P1_w2
P1D_w2:
v_add_f32_dpp v16, v32, v32 row_shl:8 row_mask:0xf bank_mask:0xf bound_ctrl:1
v_add_f32_dpp v17, v33, v33 row_shl:8 row_mask:0xf bank_mask:0xf bound_ctrl:1
v_add_f32_dpp v18, v34, v34 row_shl:8 row_mask:0xf bank_mask:0xf bound_ctrl:1
v_add_f32_dpp v19, v35, v35 row_shl:8 row_mask:0xf bank_mask:0xf bound_ctrl:1
Zj v36,v16,v17
Zj v37,v18,v19
buffer_store_dwordx2 v[36:37], v40, s[4:7], s15 offen
buffer_store_dwordx2 v[38:39], v40, s[4:7], s16 offen
P1S_w2:
s_barrier
Zb s19,s18,10240
Zh v[64:67],v0,s[4:7],s19 offen offset:0
Zh v[68:71],v0,s[4:7],s19 offen offset:1024
Zm v[18:19],0
Zm v[20:21],0
Zm v[22:23],0
Zm v[24:25],0
Zm v[26:27],0
Zm v[28:29],0
Zm v[30:31],0
Zm v[32:33],0
Zm v[34:35],0
Zm v[36:37],0
Zm v[38:39],0
s_xor_b32 s39, s39, 1
Zb s22,s15,6144
Zf lgkmcnt(0)
Zh v[12:15],v0,s[4:7],s22 offen offset:0 sc1
Zh v[40:43],v0,s[4:7],s22 offen offset:1024 sc1
Zf vmcnt(1)
Zb s19,s18,14336
Zh v[72:75],v0,s[4:7],s19 offen offset:0
Zh v[76:79],v0,s[4:7],s19 offen offset:1024
v_max3_u32 v16, v12, v13, v14
Zf vmcnt(2)
v_max3_u32 v16, v16, v15, v40
v_max3_u32 v16, v16, v41, v42
v_max_u32 v16, v16, v43
v_cmp_eq_u32 vcc, -1, v16
Zm v[16:17],0
s_cbranch_vccz P2D_w2
P2_w2:
Zh v[12:15],v0,s[4:7],s22 offen offset:0 sc1
Zh v[40:43],v0,s[4:7],s22 offen offset:1024 sc1
Zf vmcnt(1)
v_max3_u32 v16, v12, v13, v14
Zf vmcnt(0)
v_max3_u32 v16, v16, v15, v40
v_max3_u32 v16, v16, v41, v42
v_max_u32 v16, v16, v43
v_cmp_eq_u32 vcc, -1, v16
Zm v[16:17],0
s_cbranch_vccz P2D_w2
s_sub_u32 s20, s20, 1
s_cmp_gt_i32 s20, 0
Zk P2_w2
P2D_w2:
Zp s15,s16
s_branch CS_w2
FB_w2:
s_cmp_lg_u32 s23, 0
Zk SO_w2
Zp s23,1
s_nop 11
v_max3_f32 v24, v40, v41, v42
v_max3_f32 v24, v24, v43, v44
v_max3_f32 v24, v24, v45, v46
v_max3_f32 v24, v24, v47, v32
v_max_f32 v24, v24, v33
Zs v25,v24
s_nop 1
v_permlane32_swap_b32 v24, v25
v_max_f32 v24, v24, v25
Zs v25,v24
s_nop 1
v_permlane16_swap_b32 v24, v25
v_max_f32 v24, v24, v25
Zx v40,v40,v24
Zx v41,v41,v24
Zx v42,v42,v24
Zx v43,v43,v24
Zx v44,v44,v24
Zx v45,v45,v24
Zx v46,v46,v24
Zx v47,v47,v24
Zx v32,v32,v24
Zx v33,v33,v24
Zf lgkmcnt(0)
s_branch SX_w2
CE_w2:
Zf vmcnt(0) lgkmcnt(0)
s_barrier
Zb s11,s11,1
Zb s27,s27,655360
Zb s17,s17,655360
Zp s15,2129920
Zf vmcnt(0)
s_cmp_lt_u32 s11, 128
Zk CL_w2
s_endpgm
L_w3:
Zy v0,63,v0
Zy v12,15,v0
v_lshrrev_b32 v13, 4, v0
Zz v0,4,v0
Zp s22,0x05040100
Zp s23,0x07060302
v_add_u32 v5, 129024, v0
s_mul_i32 s18, s8, 73728
Zb s18,s18,3201024
v_lshrrev_b32 v14, 1, v13
Zz v14,4,v14
Zy v1,1,v13
v_lshl_add_u32 v14, v1, 2, v14
s_load_dwordx2 s[24:25], s[0:1], 80
Zp s26,5242880
Zp s27,0x20000
v_mul_u32_u24 v2, 1280, v14
v_lshl_add_u32 v3, v12, 2, v2
v_lshl_add_u32 v2, v12, 4, v2
v_add_u32 v2, 768, v2
v_add_u32 v3, 1216, v3
s_mul_i32 s17, s8, 163840
Zb s19,s17,0
Zf lgkmcnt(0)
Zh v[80:83],v2,s[24:27],s19 offen
Za v208,v3,s[24:27],s19 offen
Zb s19,s17,1280
Zh v[84:87],v2,s[24:27],s19 offen
Za v209,v3,s[24:27],s19 offen
Zb s19,s17,10240
Zh v[88:91],v2,s[24:27],s19 offen
Za v210,v3,s[24:27],s19 offen
Zb s19,s17,11520
Zh v[92:95],v2,s[24:27],s19 offen
Za v211,v3,s[24:27],s19 offen
Zb s19,s17,2560
Zh v[96:99],v2,s[24:27],s19 offen
Za v212,v3,s[24:27],s19 offen
Zb s19,s17,3840
Zh v[100:103],v2,s[24:27],s19 offen
Za v213,v3,s[24:27],s19 offen
Zb s19,s17,12800
Zh v[104:107],v2,s[24:27],s19 offen
Za v214,v3,s[24:27],s19 offen
Zb s19,s17,14080
Zh v[108:111],v2,s[24:27],s19 offen
Za v215,v3,s[24:27],s19 offen
Zb s19,s17,40960
Zh v[112:115],v2,s[24:27],s19 offen
Za v216,v3,s[24:27],s19 offen
Zb s19,s17,42240
Zh v[116:119],v2,s[24:27],s19 offen
Za v217,v3,s[24:27],s19 offen
Zb s19,s17,51200
Zh v[120:123],v2,s[24:27],s19 offen
Za v218,v3,s[24:27],s19 offen
Zb s19,s17,52480
Zh v[124:127],v2,s[24:27],s19 offen
Za v219,v3,s[24:27],s19 offen
Zb s19,s17,43520
Zh v[128:131],v2,s[24:27],s19 offen
Za v220,v3,s[24:27],s19 offen
Zb s19,s17,44800
Zh v[132:135],v2,s[24:27],s19 offen
Za v221,v3,s[24:27],s19 offen
Zb s19,s17,53760
Zh v[136:139],v2,s[24:27],s19 offen
Za v222,v3,s[24:27],s19 offen
Zb s19,s17,55040
Zh v[140:143],v2,s[24:27],s19 offen
Za v223,v3,s[24:27],s19 offen
Zb s19,s17,81920
Zh v[144:147],v2,s[24:27],s19 offen
Za v224,v3,s[24:27],s19 offen
Zb s19,s17,83200
Zh v[148:151],v2,s[24:27],s19 offen
Za v225,v3,s[24:27],s19 offen
Zb s19,s17,92160
Zh v[152:155],v2,s[24:27],s19 offen
Za v226,v3,s[24:27],s19 offen
Zb s19,s17,93440
Zh v[156:159],v2,s[24:27],s19 offen
Za v227,v3,s[24:27],s19 offen
Zb s19,s17,84480
Zh v[160:163],v2,s[24:27],s19 offen
Za v228,v3,s[24:27],s19 offen
Zb s19,s17,85760
Zh v[164:167],v2,s[24:27],s19 offen
Za v229,v3,s[24:27],s19 offen
Zb s19,s17,94720
Zh v[168:171],v2,s[24:27],s19 offen
Za v230,v3,s[24:27],s19 offen
Zb s19,s17,96000
Zh v[172:175],v2,s[24:27],s19 offen
Za v231,v3,s[24:27],s19 offen
Zb s19,s17,122880
Zh v[176:179],v2,s[24:27],s19 offen
Za v232,v3,s[24:27],s19 offen
Zb s19,s17,124160
Zh v[180:183],v2,s[24:27],s19 offen
Za v233,v3,s[24:27],s19 offen
Zb s19,s17,133120
Zh v[184:187],v2,s[24:27],s19 offen
Za v234,v3,s[24:27],s19 offen
Zb s19,s17,134400
Zh v[188:191],v2,s[24:27],s19 offen
Za v235,v3,s[24:27],s19 offen
Zb s19,s17,125440
Zh v[192:195],v2,s[24:27],s19 offen
Za v236,v3,s[24:27],s19 offen
Zb s19,s17,126720
Zh v[196:199],v2,s[24:27],s19 offen
Za v237,v3,s[24:27],s19 offen
Zb s19,s17,135680
Zh v[200:203],v2,s[24:27],s19 offen
Za v238,v3,s[24:27],s19 offen
Zb s19,s17,136960
Zh v[204:207],v2,s[24:27],s19 offen
Za v239,v3,s[24:27],s19 offen
Zf vmcnt(62)
Zf vmcnt(61)
Zc v72,v84,v80,s22
Zf vmcnt(57)
Zc v73,v92,v88,s22
Zf vmcnt(53)
Zc v74,v100,v96,s22
Zf vmcnt(49)
Zc v75,v108,v104,s22
Zf vmcnt(45)
Zc v76,v116,v112,s22
Zf vmcnt(41)
Zc v77,v124,v120,s22
Zf vmcnt(37)
Zc v78,v132,v128,s22
Zf vmcnt(33)
Zc v79,v140,v136,s22
Zt v5,v[72:75] offset:26624
Zt v5,v[76:79] offset:27648
Zc v64,v84,v80,s23
Zc v65,v92,v88,s23
Zc v66,v100,v96,s23
Zc v67,v108,v104,s23
Zc v68,v116,v112,s23
Zc v69,v124,v120,s23
Zc v70,v132,v128,s23
Zc v71,v140,v136,s23
Zd a0,v64
Zd a1,v65
Zd a2,v66
Zd a3,v67
Zd a4,v68
Zd a5,v69
Zd a6,v70
Zd a7,v71
Zc v72,v85,v81,s22
Zc v73,v93,v89,s22
Zc v74,v101,v97,s22
Zc v75,v109,v105,s22
Zc v76,v117,v113,s22
Zc v77,v125,v121,s22
Zc v78,v133,v129,s22
Zc v79,v141,v137,s22
Zd a16,v72
Zd a17,v73
Zd a18,v74
Zd a19,v75
Zd a20,v76
Zd a21,v77
Zd a22,v78
Zd a23,v79
Zc v64,v85,v81,s23
Zc v65,v93,v89,s23
Zc v66,v101,v97,s23
Zc v67,v109,v105,s23
Zc v68,v117,v113,s23
Zc v69,v125,v121,s23
Zc v70,v133,v129,s23
Zc v71,v141,v137,s23
Zd a32,v64
Zd a33,v65
Zd a34,v66
Zd a35,v67
Zd a36,v68
Zd a37,v69
Zd a38,v70
Zd a39,v71
Zc v72,v86,v82,s22
Zc v73,v94,v90,s22
Zc v74,v102,v98,s22
Zc v75,v110,v106,s22
Zc v76,v118,v114,s22
Zc v77,v126,v122,s22
Zc v78,v134,v130,s22
Zc v79,v142,v138,s22
Zt v5,v[72:75] offset:32768
Zt v5,v[76:79] offset:33792
Zc v64,v86,v82,s23
Zc v65,v94,v90,s23
Zc v66,v102,v98,s23
Zc v67,v110,v106,s23
Zc v68,v118,v114,s23
Zc v69,v126,v122,s23
Zc v70,v134,v130,s23
Zc v71,v142,v138,s23
Zd a48,v64
Zd a49,v65
Zd a50,v66
Zd a51,v67
Zd a52,v68
Zd a53,v69
Zd a54,v70
Zd a55,v71
Zc v72,v87,v83,s22
Zc v73,v95,v91,s22
Zc v74,v103,v99,s22
Zc v75,v111,v107,s22
Zc v76,v119,v115,s22
Zc v77,v127,v123,s22
Zc v78,v135,v131,s22
Zc v79,v143,v139,s22
Zd a64,v72
Zd a65,v73
Zd a66,v74
Zd a67,v75
Zd a68,v76
Zd a69,v77
Zd a70,v78
Zd a71,v79
Zc v64,v87,v83,s23
Zc v65,v95,v91,s23
Zc v66,v103,v99,s23
Zc v67,v111,v107,s23
Zc v68,v119,v115,s23
Zc v69,v127,v123,s23
Zc v70,v135,v131,s23
Zc v71,v143,v139,s23
Zd a80,v64
Zd a81,v65
Zd a82,v66
Zd a83,v67
Zd a84,v68
Zd a85,v69
Zd a86,v70
Zd a87,v71
Zc v72,v209,v208,s22
Zc v73,v211,v210,s22
Zc v74,v213,v212,s22
Zc v75,v215,v214,s22
Zc v76,v217,v216,s22
Zc v77,v219,v218,s22
Zc v78,v221,v220,s22
Zf vmcnt(32)
Zc v79,v223,v222,s22
Zd a96,v72
Zd a97,v73
Zd a98,v74
Zd a99,v75
Zd a100,v76
Zd a101,v77
Zd a102,v78
Zd a103,v79
Zc v64,v209,v208,s23
Zc v65,v211,v210,s23
Zc v66,v213,v212,s23
Zc v67,v215,v214,s23
Zc v68,v217,v216,s23
Zc v69,v219,v218,s23
Zc v70,v221,v220,s23
Zc v71,v223,v222,s23
Zd a112,v64
Zd a113,v65
Zd a114,v66
Zd a115,v67
Zd a116,v68
Zd a117,v69
Zd a118,v70
Zd a119,v71
Zf vmcnt(29)
Zc v72,v148,v144,s22
Zf vmcnt(25)
Zc v73,v156,v152,s22
Zf vmcnt(21)
Zc v74,v164,v160,s22
Zf vmcnt(17)
Zc v75,v172,v168,s22
Zf vmcnt(13)
Zc v76,v180,v176,s22
Zf vmcnt(9)
Zc v77,v188,v184,s22
Zf vmcnt(5)
Zc v78,v196,v192,s22
Zf vmcnt(1)
Zc v79,v204,v200,s22
Zt v5,v[72:75] offset:30720
Zt v5,v[76:79] offset:31744
Zc v64,v148,v144,s23
Zc v65,v156,v152,s23
Zc v66,v164,v160,s23
Zc v67,v172,v168,s23
Zc v68,v180,v176,s23
Zc v69,v188,v184,s23
Zc v70,v196,v192,s23
Zc v71,v204,v200,s23
Zd a8,v64
Zd a9,v65
Zd a10,v66
Zd a11,v67
Zd a12,v68
Zd a13,v69
Zd a14,v70
Zd a15,v71
Zc v72,v149,v145,s22
Zc v73,v157,v153,s22
Zc v74,v165,v161,s22
Zc v75,v173,v169,s22
Zc v76,v181,v177,s22
Zc v77,v189,v185,s22
Zc v78,v197,v193,s22
Zc v79,v205,v201,s22
Zd a24,v72
Zd a25,v73
Zd a26,v74
Zd a27,v75
Zd a28,v76
Zd a29,v77
Zd a30,v78
Zd a31,v79
Zc v64,v149,v145,s23
Zc v65,v157,v153,s23
Zc v66,v165,v161,s23
Zc v67,v173,v169,s23
Zc v68,v181,v177,s23
Zc v69,v189,v185,s23
Zc v70,v197,v193,s23
Zc v71,v205,v201,s23
Zt v5,v[64:67] offset:28672
Zt v5,v[68:71] offset:29696
Zc v72,v150,v146,s22
Zc v73,v158,v154,s22
Zc v74,v166,v162,s22
Zc v75,v174,v170,s22
Zc v76,v182,v178,s22
Zc v77,v190,v186,s22
Zc v78,v198,v194,s22
Zc v79,v206,v202,s22
Zd a40,v72
Zd a41,v73
Zd a42,v74
Zd a43,v75
Zd a44,v76
Zd a45,v77
Zd a46,v78
Zd a47,v79
Zc v64,v150,v146,s23
Zc v65,v158,v154,s23
Zc v66,v166,v162,s23
Zc v67,v174,v170,s23
Zc v68,v182,v178,s23
Zc v69,v190,v186,s23
Zc v70,v198,v194,s23
Zc v71,v206,v202,s23
Zd a56,v64
Zd a57,v65
Zd a58,v66
Zd a59,v67
Zd a60,v68
Zd a61,v69
Zd a62,v70
Zd a63,v71
Zc v72,v151,v147,s22
Zc v73,v159,v155,s22
Zc v74,v167,v163,s22
Zc v75,v175,v171,s22
Zc v76,v183,v179,s22
Zc v77,v191,v187,s22
Zc v78,v199,v195,s22
Zc v79,v207,v203,s22
Zd a72,v72
Zd a73,v73
Zd a74,v74
Zd a75,v75
Zd a76,v76
Zd a77,v77
Zd a78,v78
Zd a79,v79
Zc v64,v151,v147,s23
Zc v65,v159,v155,s23
Zc v66,v167,v163,s23
Zc v67,v175,v171,s23
Zc v68,v183,v179,s23
Zc v69,v191,v187,s23
Zc v70,v199,v195,s23
Zc v71,v207,v203,s23
Zd a88,v64
Zd a89,v65
Zd a90,v66
Zd a91,v67
Zd a92,v68
Zd a93,v69
Zd a94,v70
Zd a95,v71
Zc v72,v225,v224,s22
Zc v73,v227,v226,s22
Zc v74,v229,v228,s22
Zc v75,v231,v230,s22
Zc v76,v233,v232,s22
Zc v77,v235,v234,s22
Zc v78,v237,v236,s22
Zf vmcnt(0)
Zc v79,v239,v238,s22
Zd a104,v72
Zd a105,v73
Zd a106,v74
Zd a107,v75
Zd a108,v76
Zd a109,v77
Zd a110,v78
Zd a111,v79
Zc v64,v225,v224,s23
Zc v65,v227,v226,s23
Zc v66,v229,v228,s23
Zc v67,v231,v230,s23
Zc v68,v233,v232,s23
Zc v69,v235,v234,s23
Zc v70,v237,v236,s23
Zc v71,v239,v238,s23
Zd a120,v64
Zd a121,v65
Zd a122,v66
Zd a123,v67
Zd a124,v68
Zd a125,v69
Zd a126,v70
Zd a127,v71
s_load_dwordx2 s[24:25], s[0:1], 56
Zp s26,5242880
Zp s27,0x20000
s_load_dwordx2 s[28:29], s[0:1], 64
Zp s30,5242880
Zp s31,0x20000
s_load_dwordx2 s[32:33], s[0:1], 72
Zp s34,5242880
Zp s35,0x20000
Zz v2,13,v14
v_lshl_add_u32 v2, v12, 2, v2
v_add_u32 v2, 192, v2
Zq s17,s8,8
Zb s19,s17,0
Zf lgkmcnt(0)
Za v16,v2,s[24:27],s19 offen
Zb s19,s17,8192
Za v17,v2,s[24:27],s19 offen
Zb s19,s17,65536
Za v18,v2,s[24:27],s19 offen
Zb s19,s17,73728
Za v19,v2,s[24:27],s19 offen
Zb s19,s17,16384
Za v20,v2,s[24:27],s19 offen
Zb s19,s17,24576
Za v21,v2,s[24:27],s19 offen
Zb s19,s17,81920
Za v22,v2,s[24:27],s19 offen
Zb s19,s17,90112
Za v23,v2,s[24:27],s19 offen
Zb s19,s17,262144
Za v24,v2,s[24:27],s19 offen
Zb s19,s17,270336
Za v25,v2,s[24:27],s19 offen
Zb s19,s17,327680
Za v26,v2,s[24:27],s19 offen
Zb s19,s17,335872
Za v27,v2,s[24:27],s19 offen
Zb s19,s17,278528
Za v28,v2,s[24:27],s19 offen
Zb s19,s17,286720
Za v29,v2,s[24:27],s19 offen
Zb s19,s17,344064
Za v30,v2,s[24:27],s19 offen
Zb s19,s17,352256
Za v31,v2,s[24:27],s19 offen
Zb s19,s17,524288
Za v32,v2,s[24:27],s19 offen
Zb s19,s17,532480
Za v33,v2,s[24:27],s19 offen
Zb s19,s17,589824
Za v34,v2,s[24:27],s19 offen
Zb s19,s17,598016
Za v35,v2,s[24:27],s19 offen
Zb s19,s17,540672
Za v36,v2,s[24:27],s19 offen
Zb s19,s17,548864
Za v37,v2,s[24:27],s19 offen
Zb s19,s17,606208
Za v38,v2,s[24:27],s19 offen
Zb s19,s17,614400
Za v39,v2,s[24:27],s19 offen
Zb s19,s17,786432
Za v40,v2,s[24:27],s19 offen
Zb s19,s17,794624
Za v41,v2,s[24:27],s19 offen
Zb s19,s17,851968
Za v42,v2,s[24:27],s19 offen
Zb s19,s17,860160
Za v43,v2,s[24:27],s19 offen
Zb s19,s17,802816
Za v44,v2,s[24:27],s19 offen
Zb s19,s17,811008
Za v45,v2,s[24:27],s19 offen
Zb s19,s17,868352
Za v46,v2,s[24:27],s19 offen
Zb s19,s17,876544
Za v47,v2,s[24:27],s19 offen
Zb s19,s17,1048576
Za v48,v2,s[24:27],s19 offen
Zb s19,s17,1056768
Za v49,v2,s[24:27],s19 offen
Zb s19,s17,1114112
Za v50,v2,s[24:27],s19 offen
Zb s19,s17,1122304
Za v51,v2,s[24:27],s19 offen
Zb s19,s17,1064960
Za v52,v2,s[24:27],s19 offen
Zb s19,s17,1073152
Za v53,v2,s[24:27],s19 offen
Zb s19,s17,1130496
Za v54,v2,s[24:27],s19 offen
Zb s19,s17,1138688
Za v55,v2,s[24:27],s19 offen
Zb s19,s17,1310720
Za v56,v2,s[24:27],s19 offen
Zb s19,s17,1318912
Za v57,v2,s[24:27],s19 offen
Zb s19,s17,1376256
Za v58,v2,s[24:27],s19 offen
Zb s19,s17,1384448
Za v59,v2,s[24:27],s19 offen
Zb s19,s17,1327104
Za v60,v2,s[24:27],s19 offen
Zb s19,s17,1335296
Za v61,v2,s[24:27],s19 offen
Zb s19,s17,1392640
Za v62,v2,s[24:27],s19 offen
Zb s19,s17,1400832
Za v63,v2,s[24:27],s19 offen
Zf vmcnt(46)
Zc v72,v17,v16,s22
Zf vmcnt(44)
Zc v73,v19,v18,s22
Zf vmcnt(42)
Zc v74,v21,v20,s22
Zf vmcnt(40)
Zc v75,v23,v22,s22
Zf vmcnt(38)
Zc v76,v25,v24,s22
Zf vmcnt(36)
Zc v77,v27,v26,s22
Zf vmcnt(34)
Zc v78,v29,v28,s22
Zf vmcnt(32)
Zc v79,v31,v30,s22
Zd a168,v72
Zd a169,v73
Zd a170,v74
Zd a171,v75
Zd a172,v76
Zd a173,v77
Zd a174,v78
Zd a175,v79
Zc v64,v17,v16,s23
Zc v65,v19,v18,s23
Zc v66,v21,v20,s23
Zc v67,v23,v22,s23
Zc v68,v25,v24,s23
Zc v69,v27,v26,s23
Zc v70,v29,v28,s23
Zc v71,v31,v30,s23
Zt v5,v[64:67] offset:12288
Zt v5,v[68:71] offset:13312
Zb s19,s17,1572864
Za v16,v2,s[24:27],s19 offen
Zb s19,s17,1581056
Za v17,v2,s[24:27],s19 offen
Zb s19,s17,1638400
Za v18,v2,s[24:27],s19 offen
Zb s19,s17,1646592
Za v19,v2,s[24:27],s19 offen
Zb s19,s17,1589248
Za v20,v2,s[24:27],s19 offen
Zb s19,s17,1597440
Za v21,v2,s[24:27],s19 offen
Zb s19,s17,1654784
Za v22,v2,s[24:27],s19 offen
Zb s19,s17,1662976
Za v23,v2,s[24:27],s19 offen
Zb s19,s17,1835008
Za v24,v2,s[24:27],s19 offen
Zb s19,s17,1843200
Za v25,v2,s[24:27],s19 offen
Zb s19,s17,1900544
Za v26,v2,s[24:27],s19 offen
Zb s19,s17,1908736
Za v27,v2,s[24:27],s19 offen
Zb s19,s17,1851392
Za v28,v2,s[24:27],s19 offen
Zb s19,s17,1859584
Za v29,v2,s[24:27],s19 offen
Zb s19,s17,1916928
Za v30,v2,s[24:27],s19 offen
Zb s19,s17,1925120
Za v31,v2,s[24:27],s19 offen
Zf vmcnt(46)
Zc v72,v33,v32,s22
Zf vmcnt(44)
Zc v73,v35,v34,s22
Zf vmcnt(42)
Zc v74,v37,v36,s22
Zf vmcnt(40)
Zc v75,v39,v38,s22
Zf vmcnt(38)
Zc v76,v41,v40,s22
Zf vmcnt(36)
Zc v77,v43,v42,s22
Zf vmcnt(34)
Zc v78,v45,v44,s22
Zf vmcnt(32)
Zc v79,v47,v46,s22
Zd a200,v72
Zd a201,v73
Zd a202,v74
Zd a203,v75
Zd a204,v76
Zd a205,v77
Zd a206,v78
Zd a207,v79
Zc v64,v33,v32,s23
Zc v65,v35,v34,s23
Zc v66,v37,v36,s23
Zc v67,v39,v38,s23
Zc v68,v41,v40,s23
Zc v69,v43,v42,s23
Zc v70,v45,v44,s23
Zc v71,v47,v46,s23
Zt v5,v[64:67] offset:14336
Zt v5,v[68:71] offset:15360
Zb s19,s17,2097152
Za v32,v2,s[24:27],s19 offen
Zb s19,s17,2105344
Za v33,v2,s[24:27],s19 offen
Zb s19,s17,2162688
Za v34,v2,s[24:27],s19 offen
Zb s19,s17,2170880
Za v35,v2,s[24:27],s19 offen
Zb s19,s17,2113536
Za v36,v2,s[24:27],s19 offen
Zb s19,s17,2121728
Za v37,v2,s[24:27],s19 offen
Zb s19,s17,2179072
Za v38,v2,s[24:27],s19 offen
Zb s19,s17,2187264
Za v39,v2,s[24:27],s19 offen
Zb s19,s17,2359296
Za v40,v2,s[24:27],s19 offen
Zb s19,s17,2367488
Za v41,v2,s[24:27],s19 offen
Zb s19,s17,2424832
Za v42,v2,s[24:27],s19 offen
Zb s19,s17,2433024
Za v43,v2,s[24:27],s19 offen
Zb s19,s17,2375680
Za v44,v2,s[24:27],s19 offen
Zb s19,s17,2383872
Za v45,v2,s[24:27],s19 offen
Zb s19,s17,2441216
Za v46,v2,s[24:27],s19 offen
Zb s19,s17,2449408
Za v47,v2,s[24:27],s19 offen
Zf vmcnt(46)
Zc v72,v49,v48,s22
Zf vmcnt(44)
Zc v73,v51,v50,s22
Zf vmcnt(42)
Zc v74,v53,v52,s22
Zf vmcnt(40)
Zc v75,v55,v54,s22
Zf vmcnt(38)
Zc v76,v57,v56,s22
Zf vmcnt(36)
Zc v77,v59,v58,s22
Zf vmcnt(34)
Zc v78,v61,v60,s22
Zf vmcnt(32)
Zc v79,v63,v62,s22
Zd a232,v72
Zd a233,v73
Zd a234,v74
Zd a235,v75
Zd a236,v76
Zd a237,v77
Zd a238,v78
Zd a239,v79
Zc v64,v49,v48,s23
Zc v65,v51,v50,s23
Zc v66,v53,v52,s23
Zc v67,v55,v54,s23
Zc v68,v57,v56,s23
Zc v69,v59,v58,s23
Zc v70,v61,v60,s23
Zc v71,v63,v62,s23
Zd a240,v64
Zd a241,v65
Zd a242,v66
Zd a243,v67
Zd a244,v68
Zd a245,v69
Zd a246,v70
Zd a247,v71
Zb s19,s17,2621440
Za v48,v2,s[24:27],s19 offen
Zb s19,s17,2629632
Za v49,v2,s[24:27],s19 offen
Zb s19,s17,2686976
Za v50,v2,s[24:27],s19 offen
Zb s19,s17,2695168
Za v51,v2,s[24:27],s19 offen
Zb s19,s17,2637824
Za v52,v2,s[24:27],s19 offen
Zb s19,s17,2646016
Za v53,v2,s[24:27],s19 offen
Zb s19,s17,2703360
Za v54,v2,s[24:27],s19 offen
Zb s19,s17,2711552
Za v55,v2,s[24:27],s19 offen
Zb s19,s17,2883584
Za v56,v2,s[24:27],s19 offen
Zb s19,s17,2891776
Za v57,v2,s[24:27],s19 offen
Zb s19,s17,2949120
Za v58,v2,s[24:27],s19 offen
Zb s19,s17,2957312
Za v59,v2,s[24:27],s19 offen
Zb s19,s17,2899968
Za v60,v2,s[24:27],s19 offen
Zb s19,s17,2908160
Za v61,v2,s[24:27],s19 offen
Zb s19,s17,2965504
Za v62,v2,s[24:27],s19 offen
Zb s19,s17,2973696
Za v63,v2,s[24:27],s19 offen
Zf vmcnt(46)
Zc v88,v17,v16,s22
Zf vmcnt(44)
Zc v89,v19,v18,s22
Zf vmcnt(42)
Zc v90,v21,v20,s22
Zf vmcnt(40)
Zc v91,v23,v22,s22
Zf vmcnt(38)
Zc v92,v25,v24,s22
Zf vmcnt(36)
Zc v93,v27,v26,s22
Zf vmcnt(34)
Zc v94,v29,v28,s22
Zf vmcnt(32)
Zc v95,v31,v30,s22
Zc v96,v17,v16,s23
Zc v97,v19,v18,s23
Zc v98,v21,v20,s23
Zc v99,v23,v22,s23
Zc v100,v25,v24,s23
Zc v101,v27,v26,s23
Zc v102,v29,v28,s23
Zc v103,v31,v30,s23
Zb s19,s17,3145728
Za v16,v2,s[24:27],s19 offen
Zb s19,s17,3153920
Za v17,v2,s[24:27],s19 offen
Zb s19,s17,3211264
Za v18,v2,s[24:27],s19 offen
Zb s19,s17,3219456
Za v19,v2,s[24:27],s19 offen
Zb s19,s17,3162112
Za v20,v2,s[24:27],s19 offen
Zb s19,s17,3170304
Za v21,v2,s[24:27],s19 offen
Zb s19,s17,3227648
Za v22,v2,s[24:27],s19 offen
Zb s19,s17,3235840
Za v23,v2,s[24:27],s19 offen
Zb s19,s17,3407872
Za v24,v2,s[24:27],s19 offen
Zb s19,s17,3416064
Za v25,v2,s[24:27],s19 offen
Zb s19,s17,3473408
Za v26,v2,s[24:27],s19 offen
Zb s19,s17,3481600
Za v27,v2,s[24:27],s19 offen
Zb s19,s17,3424256
Za v28,v2,s[24:27],s19 offen
Zb s19,s17,3432448
Za v29,v2,s[24:27],s19 offen
Zb s19,s17,3489792
Za v30,v2,s[24:27],s19 offen
Zb s19,s17,3497984
Za v31,v2,s[24:27],s19 offen
Zf vmcnt(46)
Zc v120,v33,v32,s22
Zf vmcnt(44)
Zc v121,v35,v34,s22
Zf vmcnt(42)
Zc v122,v37,v36,s22
Zf vmcnt(40)
Zc v123,v39,v38,s22
Zf vmcnt(38)
Zc v124,v41,v40,s22
Zf vmcnt(36)
Zc v125,v43,v42,s22
Zf vmcnt(34)
Zc v126,v45,v44,s22
Zf vmcnt(32)
Zc v127,v47,v46,s22
Zc v128,v33,v32,s23
Zc v129,v35,v34,s23
Zc v130,v37,v36,s23
Zc v131,v39,v38,s23
Zc v132,v41,v40,s23
Zc v133,v43,v42,s23
Zc v134,v45,v44,s23
Zc v135,v47,v46,s23
Zb s19,s17,3670016
Za v32,v2,s[24:27],s19 offen
Zb s19,s17,3678208
Za v33,v2,s[24:27],s19 offen
Zb s19,s17,3735552
Za v34,v2,s[24:27],s19 offen
Zb s19,s17,3743744
Za v35,v2,s[24:27],s19 offen
Zb s19,s17,3686400
Za v36,v2,s[24:27],s19 offen
Zb s19,s17,3694592
Za v37,v2,s[24:27],s19 offen
Zb s19,s17,3751936
Za v38,v2,s[24:27],s19 offen
Zb s19,s17,3760128
Za v39,v2,s[24:27],s19 offen
Zb s19,s17,3932160
Za v40,v2,s[24:27],s19 offen
Zb s19,s17,3940352
Za v41,v2,s[24:27],s19 offen
Zb s19,s17,3997696
Za v42,v2,s[24:27],s19 offen
Zb s19,s17,4005888
Za v43,v2,s[24:27],s19 offen
Zb s19,s17,3948544
Za v44,v2,s[24:27],s19 offen
Zb s19,s17,3956736
Za v45,v2,s[24:27],s19 offen
Zb s19,s17,4014080
Za v46,v2,s[24:27],s19 offen
Zb s19,s17,4022272
Za v47,v2,s[24:27],s19 offen
Zf vmcnt(46)
Zc v160,v49,v48,s22
Zf vmcnt(44)
Zc v161,v51,v50,s22
Zf vmcnt(42)
Zc v162,v53,v52,s22
Zf vmcnt(40)
Zc v163,v55,v54,s22
Zf vmcnt(38)
Zc v164,v57,v56,s22
Zf vmcnt(36)
Zc v165,v59,v58,s22
Zf vmcnt(34)
Zc v166,v61,v60,s22
Zf vmcnt(32)
Zc v167,v63,v62,s22
Zc v168,v49,v48,s23
Zc v169,v51,v50,s23
Zc v170,v53,v52,s23
Zc v171,v55,v54,s23
Zc v172,v57,v56,s23
Zc v173,v59,v58,s23
Zc v174,v61,v60,s23
Zc v175,v63,v62,s23
Zb s19,s17,4194304
Za v48,v2,s[24:27],s19 offen
Zb s19,s17,4202496
Za v49,v2,s[24:27],s19 offen
Zb s19,s17,4259840
Za v50,v2,s[24:27],s19 offen
Zb s19,s17,4268032
Za v51,v2,s[24:27],s19 offen
Zb s19,s17,4210688
Za v52,v2,s[24:27],s19 offen
Zb s19,s17,4218880
Za v53,v2,s[24:27],s19 offen
Zb s19,s17,4276224
Za v54,v2,s[24:27],s19 offen
Zb s19,s17,4284416
Za v55,v2,s[24:27],s19 offen
Zb s19,s17,4456448
Za v56,v2,s[24:27],s19 offen
Zb s19,s17,4464640
Za v57,v2,s[24:27],s19 offen
Zb s19,s17,4521984
Za v58,v2,s[24:27],s19 offen
Zb s19,s17,4530176
Za v59,v2,s[24:27],s19 offen
Zb s19,s17,4472832
Za v60,v2,s[24:27],s19 offen
Zb s19,s17,4481024
Za v61,v2,s[24:27],s19 offen
Zb s19,s17,4538368
Za v62,v2,s[24:27],s19 offen
Zb s19,s17,4546560
Za v63,v2,s[24:27],s19 offen
Zf vmcnt(46)
Zc v184,v17,v16,s22
Zf vmcnt(44)
Zc v185,v19,v18,s22
Zf vmcnt(42)
Zc v186,v21,v20,s22
Zf vmcnt(40)
Zc v187,v23,v22,s22
Zf vmcnt(38)
Zc v188,v25,v24,s22
Zf vmcnt(36)
Zc v189,v27,v26,s22
Zf vmcnt(34)
Zc v190,v29,v28,s22
Zf vmcnt(32)
Zc v191,v31,v30,s22
Zc v64,v17,v16,s23
Zc v65,v19,v18,s23
Zc v66,v21,v20,s23
Zc v67,v23,v22,s23
Zc v68,v25,v24,s23
Zc v69,v27,v26,s23
Zc v70,v29,v28,s23
Zc v71,v31,v30,s23
Zt v5,v[64:67] offset:6144
Zt v5,v[68:71] offset:7168
Zb s19,s17,4718592
Za v16,v2,s[24:27],s19 offen
Zb s19,s17,4726784
Za v17,v2,s[24:27],s19 offen
Zb s19,s17,4784128
Za v18,v2,s[24:27],s19 offen
Zb s19,s17,4792320
Za v19,v2,s[24:27],s19 offen
Zb s19,s17,4734976
Za v20,v2,s[24:27],s19 offen
Zb s19,s17,4743168
Za v21,v2,s[24:27],s19 offen
Zb s19,s17,4800512
Za v22,v2,s[24:27],s19 offen
Zb s19,s17,4808704
Za v23,v2,s[24:27],s19 offen
Zb s19,s17,4980736
Za v24,v2,s[24:27],s19 offen
Zb s19,s17,4988928
Za v25,v2,s[24:27],s19 offen
Zb s19,s17,5046272
Za v26,v2,s[24:27],s19 offen
Zb s19,s17,5054464
Za v27,v2,s[24:27],s19 offen
Zb s19,s17,4997120
Za v28,v2,s[24:27],s19 offen
Zb s19,s17,5005312
Za v29,v2,s[24:27],s19 offen
Zb s19,s17,5062656
Za v30,v2,s[24:27],s19 offen
Zb s19,s17,5070848
Za v31,v2,s[24:27],s19 offen
Zf vmcnt(46)
Zc v192,v33,v32,s22
Zf vmcnt(44)
Zc v193,v35,v34,s22
Zf vmcnt(42)
Zc v194,v37,v36,s22
Zf vmcnt(40)
Zc v195,v39,v38,s22
Zf vmcnt(38)
Zc v196,v41,v40,s22
Zf vmcnt(36)
Zc v197,v43,v42,s22
Zf vmcnt(34)
Zc v198,v45,v44,s22
Zf vmcnt(32)
Zc v199,v47,v46,s22
Zc v200,v33,v32,s23
Zc v201,v35,v34,s23
Zc v202,v37,v36,s23
Zc v203,v39,v38,s23
Zc v204,v41,v40,s23
Zc v205,v43,v42,s23
Zc v206,v45,v44,s23
Zc v207,v47,v46,s23
Zb s19,s17,0
Za v32,v2,s[28:31],s19 offen
Zb s19,s17,8192
Za v33,v2,s[28:31],s19 offen
Zb s19,s17,65536
Za v34,v2,s[28:31],s19 offen
Zb s19,s17,73728
Za v35,v2,s[28:31],s19 offen
Zb s19,s17,16384
Za v36,v2,s[28:31],s19 offen
Zb s19,s17,24576
Za v37,v2,s[28:31],s19 offen
Zb s19,s17,81920
Za v38,v2,s[28:31],s19 offen
Zb s19,s17,90112
Za v39,v2,s[28:31],s19 offen
Zb s19,s17,262144
Za v40,v2,s[28:31],s19 offen
Zb s19,s17,270336
Za v41,v2,s[28:31],s19 offen
Zb s19,s17,327680
Za v42,v2,s[28:31],s19 offen
Zb s19,s17,335872
Za v43,v2,s[28:31],s19 offen
Zb s19,s17,278528
Za v44,v2,s[28:31],s19 offen
Zb s19,s17,286720
Za v45,v2,s[28:31],s19 offen
Zb s19,s17,344064
Za v46,v2,s[28:31],s19 offen
Zb s19,s17,352256
Za v47,v2,s[28:31],s19 offen
Zf vmcnt(46)
Zc v72,v49,v48,s22
Zf vmcnt(44)
Zc v73,v51,v50,s22
Zf vmcnt(42)
Zc v74,v53,v52,s22
Zf vmcnt(40)
Zc v75,v55,v54,s22
Zf vmcnt(38)
Zc v76,v57,v56,s22
Zf vmcnt(36)
Zc v77,v59,v58,s22
Zf vmcnt(34)
Zc v78,v61,v60,s22
Zf vmcnt(32)
Zc v79,v63,v62,s22
Zb s19,s18,0
Zr v[72:75],v0,s[4:7],s19 offen
Zr v[76:79],v0,s[4:7],s19 offen offset:1024
Zc v64,v49,v48,s23
Zc v65,v51,v50,s23
Zc v66,v53,v52,s23
Zc v67,v55,v54,s23
Zc v68,v57,v56,s23
Zc v69,v59,v58,s23
Zc v70,v61,v60,s23
Zc v71,v63,v62,s23
Zb s19,s18,6144
Zr v[64:67],v0,s[4:7],s19 offen
Zr v[68:71],v0,s[4:7],s19 offen offset:1024
Zb s19,s17,524288
Za v48,v2,s[28:31],s19 offen
Zb s19,s17,532480
Za v49,v2,s[28:31],s19 offen
Zb s19,s17,589824
Za v50,v2,s[28:31],s19 offen
Zb s19,s17,598016
Za v51,v2,s[28:31],s19 offen
Zb s19,s17,540672
Za v52,v2,s[28:31],s19 offen
Zb s19,s17,548864
Za v53,v2,s[28:31],s19 offen
Zb s19,s17,606208
Za v54,v2,s[28:31],s19 offen
Zb s19,s17,614400
Za v55,v2,s[28:31],s19 offen
Zb s19,s17,786432
Za v56,v2,s[28:31],s19 offen
Zb s19,s17,794624
Za v57,v2,s[28:31],s19 offen
Zb s19,s17,851968
Za v58,v2,s[28:31],s19 offen
Zb s19,s17,860160
Za v59,v2,s[28:31],s19 offen
Zb s19,s17,802816
Za v60,v2,s[28:31],s19 offen
Zb s19,s17,811008
Za v61,v2,s[28:31],s19 offen
Zb s19,s17,868352
Za v62,v2,s[28:31],s19 offen
Zb s19,s17,876544
Za v63,v2,s[28:31],s19 offen
Zf vmcnt(50)
Zc v72,v17,v16,s22
Zf vmcnt(48)
Zc v73,v19,v18,s22
Zf vmcnt(46)
Zc v74,v21,v20,s22
Zf vmcnt(44)
Zc v75,v23,v22,s22
Zf vmcnt(42)
Zc v76,v25,v24,s22
Zf vmcnt(40)
Zc v77,v27,v26,s22
Zf vmcnt(38)
Zc v78,v29,v28,s22
Zf vmcnt(36)
Zc v79,v31,v30,s22
Zd a144,v72
Zd a145,v73
Zd a146,v74
Zd a147,v75
Zd a148,v76
Zd a149,v77
Zd a150,v78
Zd a151,v79
Zc v64,v17,v16,s23
Zc v65,v19,v18,s23
Zc v66,v21,v20,s23
Zc v67,v23,v22,s23
Zc v68,v25,v24,s23
Zc v69,v27,v26,s23
Zc v70,v29,v28,s23
Zc v71,v31,v30,s23
Zt v5,v[64:67] offset:2048
Zt v5,v[68:71] offset:3072
Zb s19,s17,1048576
Za v16,v2,s[28:31],s19 offen
Zb s19,s17,1056768
Za v17,v2,s[28:31],s19 offen
Zb s19,s17,1114112
Za v18,v2,s[28:31],s19 offen
Zb s19,s17,1122304
Za v19,v2,s[28:31],s19 offen
Zb s19,s17,1064960
Za v20,v2,s[28:31],s19 offen
Zb s19,s17,1073152
Za v21,v2,s[28:31],s19 offen
Zb s19,s17,1130496
Za v22,v2,s[28:31],s19 offen
Zb s19,s17,1138688
Za v23,v2,s[28:31],s19 offen
Zb s19,s17,1310720
Za v24,v2,s[28:31],s19 offen
Zb s19,s17,1318912
Za v25,v2,s[28:31],s19 offen
Zb s19,s17,1376256
Za v26,v2,s[28:31],s19 offen
Zb s19,s17,1384448
Za v27,v2,s[28:31],s19 offen
Zb s19,s17,1327104
Za v28,v2,s[28:31],s19 offen
Zb s19,s17,1335296
Za v29,v2,s[28:31],s19 offen
Zb s19,s17,1392640
Za v30,v2,s[28:31],s19 offen
Zb s19,s17,1400832
Za v31,v2,s[28:31],s19 offen
Zf vmcnt(50)
Zc v72,v33,v32,s22
Zf vmcnt(48)
Zc v73,v35,v34,s22
Zf vmcnt(46)
Zc v74,v37,v36,s22
Zf vmcnt(44)
Zc v75,v39,v38,s22
Zf vmcnt(42)
Zc v76,v41,v40,s22
Zf vmcnt(40)
Zc v77,v43,v42,s22
Zf vmcnt(38)
Zc v78,v45,v44,s22
Zf vmcnt(36)
Zc v79,v47,v46,s22
Zd a176,v72
Zd a177,v73
Zd a178,v74
Zd a179,v75
Zd a180,v76
Zd a181,v77
Zd a182,v78
Zd a183,v79
Zc v64,v33,v32,s23
Zc v65,v35,v34,s23
Zc v66,v37,v36,s23
Zc v67,v39,v38,s23
Zc v68,v41,v40,s23
Zc v69,v43,v42,s23
Zc v70,v45,v44,s23
Zc v71,v47,v46,s23
Zt v5,v[64:67] offset:20480
Zt v5,v[68:71] offset:21504
Zb s19,s17,1572864
Za v32,v2,s[28:31],s19 offen
Zb s19,s17,1581056
Za v33,v2,s[28:31],s19 offen
Zb s19,s17,1638400
Za v34,v2,s[28:31],s19 offen
Zb s19,s17,1646592
Za v35,v2,s[28:31],s19 offen
Zb s19,s17,1589248
Za v36,v2,s[28:31],s19 offen
Zb s19,s17,1597440
Za v37,v2,s[28:31],s19 offen
Zb s19,s17,1654784
Za v38,v2,s[28:31],s19 offen
Zb s19,s17,1662976
Za v39,v2,s[28:31],s19 offen
Zb s19,s17,1835008
Za v40,v2,s[28:31],s19 offen
Zb s19,s17,1843200
Za v41,v2,s[28:31],s19 offen
Zb s19,s17,1900544
Za v42,v2,s[28:31],s19 offen
Zb s19,s17,1908736
Za v43,v2,s[28:31],s19 offen
Zb s19,s17,1851392
Za v44,v2,s[28:31],s19 offen
Zb s19,s17,1859584
Za v45,v2,s[28:31],s19 offen
Zb s19,s17,1916928
Za v46,v2,s[28:31],s19 offen
Zb s19,s17,1925120
Za v47,v2,s[28:31],s19 offen
Zf vmcnt(46)
Zc v72,v49,v48,s22
Zf vmcnt(44)
Zc v73,v51,v50,s22
Zf vmcnt(42)
Zc v74,v53,v52,s22
Zf vmcnt(40)
Zc v75,v55,v54,s22
Zf vmcnt(38)
Zc v76,v57,v56,s22
Zf vmcnt(36)
Zc v77,v59,v58,s22
Zf vmcnt(34)
Zc v78,v61,v60,s22
Zf vmcnt(32)
Zc v79,v63,v62,s22
Zd a208,v72
Zd a209,v73
Zd a210,v74
Zd a211,v75
Zd a212,v76
Zd a213,v77
Zd a214,v78
Zd a215,v79
Zc v64,v49,v48,s23
Zc v65,v51,v50,s23
Zc v66,v53,v52,s23
Zc v67,v55,v54,s23
Zc v68,v57,v56,s23
Zc v69,v59,v58,s23
Zc v70,v61,v60,s23
Zc v71,v63,v62,s23
Zt v5,v[64:67] offset:22528
Zt v5,v[68:71] offset:23552
Zb s19,s17,2097152
Za v48,v2,s[28:31],s19 offen
Zb s19,s17,2105344
Za v49,v2,s[28:31],s19 offen
Zb s19,s17,2162688
Za v50,v2,s[28:31],s19 offen
Zb s19,s17,2170880
Za v51,v2,s[28:31],s19 offen
Zb s19,s17,2113536
Za v52,v2,s[28:31],s19 offen
Zb s19,s17,2121728
Za v53,v2,s[28:31],s19 offen
Zb s19,s17,2179072
Za v54,v2,s[28:31],s19 offen
Zb s19,s17,2187264
Za v55,v2,s[28:31],s19 offen
Zb s19,s17,2359296
Za v56,v2,s[28:31],s19 offen
Zb s19,s17,2367488
Za v57,v2,s[28:31],s19 offen
Zb s19,s17,2424832
Za v58,v2,s[28:31],s19 offen
Zb s19,s17,2433024
Za v59,v2,s[28:31],s19 offen
Zb s19,s17,2375680
Za v60,v2,s[28:31],s19 offen
Zb s19,s17,2383872
Za v61,v2,s[28:31],s19 offen
Zb s19,s17,2441216
Za v62,v2,s[28:31],s19 offen
Zb s19,s17,2449408
Za v63,v2,s[28:31],s19 offen
Zf vmcnt(46)
Zc v72,v17,v16,s22
Zf vmcnt(44)
Zc v73,v19,v18,s22
Zf vmcnt(42)
Zc v74,v21,v20,s22
Zf vmcnt(40)
Zc v75,v23,v22,s22
Zf vmcnt(38)
Zc v76,v25,v24,s22
Zf vmcnt(36)
Zc v77,v27,v26,s22
Zf vmcnt(34)
Zc v78,v29,v28,s22
Zf vmcnt(32)
Zc v79,v31,v30,s22
Zb s19,s18,2048
Zr v[72:75],v0,s[4:7],s19 offen
Zr v[76:79],v0,s[4:7],s19 offen offset:1024
Zc v64,v17,v16,s23
Zc v65,v19,v18,s23
Zc v66,v21,v20,s23
Zc v67,v23,v22,s23
Zc v68,v25,v24,s23
Zc v69,v27,v26,s23
Zc v70,v29,v28,s23
Zc v71,v31,v30,s23
Zt v5,v[64:67] offset:24576
Zt v5,v[68:71] offset:25600
Zb s19,s17,2621440
Za v16,v2,s[28:31],s19 offen
Zb s19,s17,2629632
Za v17,v2,s[28:31],s19 offen
Zb s19,s17,2686976
Za v18,v2,s[28:31],s19 offen
Zb s19,s17,2695168
Za v19,v2,s[28:31],s19 offen
Zb s19,s17,2637824
Za v20,v2,s[28:31],s19 offen
Zb s19,s17,2646016
Za v21,v2,s[28:31],s19 offen
Zb s19,s17,2703360
Za v22,v2,s[28:31],s19 offen
Zb s19,s17,2711552
Za v23,v2,s[28:31],s19 offen
Zb s19,s17,2883584
Za v24,v2,s[28:31],s19 offen
Zb s19,s17,2891776
Za v25,v2,s[28:31],s19 offen
Zb s19,s17,2949120
Za v26,v2,s[28:31],s19 offen
Zb s19,s17,2957312
Za v27,v2,s[28:31],s19 offen
Zb s19,s17,2899968
Za v28,v2,s[28:31],s19 offen
Zb s19,s17,2908160
Za v29,v2,s[28:31],s19 offen
Zb s19,s17,2965504
Za v30,v2,s[28:31],s19 offen
Zb s19,s17,2973696
Za v31,v2,s[28:31],s19 offen
Zf vmcnt(48)
Zc v72,v33,v32,s22
Zf vmcnt(46)
Zc v73,v35,v34,s22
Zf vmcnt(44)
Zc v74,v37,v36,s22
Zf vmcnt(42)
Zc v75,v39,v38,s22
Zf vmcnt(40)
Zc v76,v41,v40,s22
Zf vmcnt(38)
Zc v77,v43,v42,s22
Zf vmcnt(36)
Zc v78,v45,v44,s22
Zf vmcnt(34)
Zc v79,v47,v46,s22
Zt v5,v[72:75] offset:0
Zt v5,v[76:79] offset:1024
Zc v104,v33,v32,s23
Zc v105,v35,v34,s23
Zc v106,v37,v36,s23
Zc v107,v39,v38,s23
Zc v108,v41,v40,s23
Zc v109,v43,v42,s23
Zc v110,v45,v44,s23
Zc v111,v47,v46,s23
Zb s19,s17,3145728
Za v32,v2,s[28:31],s19 offen
Zb s19,s17,3153920
Za v33,v2,s[28:31],s19 offen
Zb s19,s17,3211264
Za v34,v2,s[28:31],s19 offen
Zb s19,s17,3219456
Za v35,v2,s[28:31],s19 offen
Zb s19,s17,3162112
Za v36,v2,s[28:31],s19 offen
Zb s19,s17,3170304
Za v37,v2,s[28:31],s19 offen
Zb s19,s17,3227648
Za v38,v2,s[28:31],s19 offen
Zb s19,s17,3235840
Za v39,v2,s[28:31],s19 offen
Zb s19,s17,3407872
Za v40,v2,s[28:31],s19 offen
Zb s19,s17,3416064
Za v41,v2,s[28:31],s19 offen
Zb s19,s17,3473408
Za v42,v2,s[28:31],s19 offen
Zb s19,s17,3481600
Za v43,v2,s[28:31],s19 offen
Zb s19,s17,3424256
Za v44,v2,s[28:31],s19 offen
Zb s19,s17,3432448
Za v45,v2,s[28:31],s19 offen
Zb s19,s17,3489792
Za v46,v2,s[28:31],s19 offen
Zb s19,s17,3497984
Za v47,v2,s[28:31],s19 offen
Zf vmcnt(48)
Zc v136,v49,v48,s22
Zf vmcnt(46)
Zc v137,v51,v50,s22
Zf vmcnt(44)
Zc v138,v53,v52,s22
Zf vmcnt(42)
Zc v139,v55,v54,s22
Zf vmcnt(40)
Zc v140,v57,v56,s22
Zf vmcnt(38)
Zc v141,v59,v58,s22
Zf vmcnt(36)
Zc v142,v61,v60,s22
Zf vmcnt(34)
Zc v143,v63,v62,s22
Zc v144,v49,v48,s23
Zc v145,v51,v50,s23
Zc v146,v53,v52,s23
Zc v147,v55,v54,s23
Zc v148,v57,v56,s23
Zc v149,v59,v58,s23
Zc v150,v61,v60,s23
Zc v151,v63,v62,s23
Zb s19,s17,3670016
Za v48,v2,s[28:31],s19 offen
Zb s19,s17,3678208
Za v49,v2,s[28:31],s19 offen
Zb s19,s17,3735552
Za v50,v2,s[28:31],s19 offen
Zb s19,s17,3743744
Za v51,v2,s[28:31],s19 offen
Zb s19,s17,3686400
Za v52,v2,s[28:31],s19 offen
Zb s19,s17,3694592
Za v53,v2,s[28:31],s19 offen
Zb s19,s17,3751936
Za v54,v2,s[28:31],s19 offen
Zb s19,s17,3760128
Za v55,v2,s[28:31],s19 offen
Zb s19,s17,3932160
Za v56,v2,s[28:31],s19 offen
Zb s19,s17,3940352
Za v57,v2,s[28:31],s19 offen
Zb s19,s17,3997696
Za v58,v2,s[28:31],s19 offen
Zb s19,s17,4005888
Za v59,v2,s[28:31],s19 offen
Zb s19,s17,3948544
Za v60,v2,s[28:31],s19 offen
Zb s19,s17,3956736
Za v61,v2,s[28:31],s19 offen
Zb s19,s17,4014080
Za v62,v2,s[28:31],s19 offen
Zb s19,s17,4022272
Za v63,v2,s[28:31],s19 offen
Zf vmcnt(46)
Zc v176,v17,v16,s22
Zf vmcnt(44)
Zc v177,v19,v18,s22
Zf vmcnt(42)
Zc v178,v21,v20,s22
Zf vmcnt(40)
Zc v179,v23,v22,s22
Zf vmcnt(38)
Zc v180,v25,v24,s22
Zf vmcnt(36)
Zc v181,v27,v26,s22
Zf vmcnt(34)
Zc v182,v29,v28,s22
Zf vmcnt(32)
Zc v183,v31,v30,s22
Zc v64,v17,v16,s23
Zc v65,v19,v18,s23
Zc v66,v21,v20,s23
Zc v67,v23,v22,s23
Zc v68,v25,v24,s23
Zc v69,v27,v26,s23
Zc v70,v29,v28,s23
Zc v71,v31,v30,s23
Zb s19,s18,12288
Zr v[64:67],v0,s[4:7],s19 offen
Zr v[68:71],v0,s[4:7],s19 offen offset:1024
Zb s19,s17,4194304
Za v16,v2,s[28:31],s19 offen
Zb s19,s17,4202496
Za v17,v2,s[28:31],s19 offen
Zb s19,s17,4259840
Za v18,v2,s[28:31],s19 offen
Zb s19,s17,4268032
Za v19,v2,s[28:31],s19 offen
Zb s19,s17,4210688
Za v20,v2,s[28:31],s19 offen
Zb s19,s17,4218880
Za v21,v2,s[28:31],s19 offen
Zb s19,s17,4276224
Za v22,v2,s[28:31],s19 offen
Zb s19,s17,4284416
Za v23,v2,s[28:31],s19 offen
Zb s19,s17,4456448
Za v24,v2,s[28:31],s19 offen
Zb s19,s17,4464640
Za v25,v2,s[28:31],s19 offen
Zb s19,s17,4521984
Za v26,v2,s[28:31],s19 offen
Zb s19,s17,4530176
Za v27,v2,s[28:31],s19 offen
Zb s19,s17,4472832
Za v28,v2,s[28:31],s19 offen
Zb s19,s17,4481024
Za v29,v2,s[28:31],s19 offen
Zb s19,s17,4538368
Za v30,v2,s[28:31],s19 offen
Zb s19,s17,4546560
Za v31,v2,s[28:31],s19 offen
Zf vmcnt(48)
Zc v208,v33,v32,s22
Zf vmcnt(46)
Zc v209,v35,v34,s22
Zf vmcnt(44)
Zc v210,v37,v36,s22
Zf vmcnt(42)
Zc v211,v39,v38,s22
Zf vmcnt(40)
Zc v212,v41,v40,s22
Zf vmcnt(38)
Zc v213,v43,v42,s22
Zf vmcnt(36)
Zc v214,v45,v44,s22
Zf vmcnt(34)
Zc v215,v47,v46,s22
Zc v64,v33,v32,s23
Zc v65,v35,v34,s23
Zc v66,v37,v36,s23
Zc v67,v39,v38,s23
Zc v68,v41,v40,s23
Zc v69,v43,v42,s23
Zc v70,v45,v44,s23
Zc v71,v47,v46,s23
Zt v5,v[64:67] offset:16384
Zt v5,v[68:71] offset:17408
Zb s19,s17,4718592
Za v32,v2,s[28:31],s19 offen
Zb s19,s17,4726784
Za v33,v2,s[28:31],s19 offen
Zb s19,s17,4784128
Za v34,v2,s[28:31],s19 offen
Zb s19,s17,4792320
Za v35,v2,s[28:31],s19 offen
Zb s19,s17,4734976
Za v36,v2,s[28:31],s19 offen
Zb s19,s17,4743168
Za v37,v2,s[28:31],s19 offen
Zb s19,s17,4800512
Za v38,v2,s[28:31],s19 offen
Zb s19,s17,4808704
Za v39,v2,s[28:31],s19 offen
Zb s19,s17,4980736
Za v40,v2,s[28:31],s19 offen
Zb s19,s17,4988928
Za v41,v2,s[28:31],s19 offen
Zb s19,s17,5046272
Za v42,v2,s[28:31],s19 offen
Zb s19,s17,5054464
Za v43,v2,s[28:31],s19 offen
Zb s19,s17,4997120
Za v44,v2,s[28:31],s19 offen
Zb s19,s17,5005312
Za v45,v2,s[28:31],s19 offen
Zb s19,s17,5062656
Za v46,v2,s[28:31],s19 offen
Zb s19,s17,5070848
Za v47,v2,s[28:31],s19 offen
Zf vmcnt(48)
Zc v72,v49,v48,s22
Zf vmcnt(46)
Zc v73,v51,v50,s22
Zf vmcnt(44)
Zc v74,v53,v52,s22
Zf vmcnt(42)
Zc v75,v55,v54,s22
Zf vmcnt(40)
Zc v76,v57,v56,s22
Zf vmcnt(38)
Zc v77,v59,v58,s22
Zf vmcnt(36)
Zc v78,v61,v60,s22
Zf vmcnt(34)
Zc v79,v63,v62,s22
Zb s19,s18,16384
Zr v[72:75],v0,s[4:7],s19 offen
Zr v[76:79],v0,s[4:7],s19 offen offset:1024
Zc v64,v49,v48,s23
Zc v65,v51,v50,s23
Zc v66,v53,v52,s23
Zc v67,v55,v54,s23
Zc v68,v57,v56,s23
Zc v69,v59,v58,s23
Zc v70,v61,v60,s23
Zc v71,v63,v62,s23
Zt v5,v[64:67] offset:8192
Zt v5,v[68:71] offset:9216
Zb s19,s17,0
Za v48,v2,s[32:35],s19 offen
Zb s19,s17,8192
Za v49,v2,s[32:35],s19 offen
Zb s19,s17,65536
Za v50,v2,s[32:35],s19 offen
Zb s19,s17,73728
Za v51,v2,s[32:35],s19 offen
Zb s19,s17,16384
Za v52,v2,s[32:35],s19 offen
Zb s19,s17,24576
Za v53,v2,s[32:35],s19 offen
Zb s19,s17,81920
Za v54,v2,s[32:35],s19 offen
Zb s19,s17,90112
Za v55,v2,s[32:35],s19 offen
Zb s19,s17,262144
Za v56,v2,s[32:35],s19 offen
Zb s19,s17,270336
Za v57,v2,s[32:35],s19 offen
Zb s19,s17,327680
Za v58,v2,s[32:35],s19 offen
Zb s19,s17,335872
Za v59,v2,s[32:35],s19 offen
Zb s19,s17,278528
Za v60,v2,s[32:35],s19 offen
Zb s19,s17,286720
Za v61,v2,s[32:35],s19 offen
Zb s19,s17,344064
Za v62,v2,s[32:35],s19 offen
Zb s19,s17,352256
Za v63,v2,s[32:35],s19 offen
Zf vmcnt(48)
Zc v72,v17,v16,s22
Zf vmcnt(46)
Zc v73,v19,v18,s22
Zf vmcnt(44)
Zc v74,v21,v20,s22
Zf vmcnt(42)
Zc v75,v23,v22,s22
Zf vmcnt(40)
Zc v76,v25,v24,s22
Zf vmcnt(38)
Zc v77,v27,v26,s22
Zf vmcnt(36)
Zc v78,v29,v28,s22
Zf vmcnt(34)
Zc v79,v31,v30,s22
Zb s19,s18,10240
Zr v[72:75],v0,s[4:7],s19 offen
Zr v[76:79],v0,s[4:7],s19 offen offset:1024
Zc v64,v17,v16,s23
Zc v65,v19,v18,s23
Zc v66,v21,v20,s23
Zc v67,v23,v22,s23
Zc v68,v25,v24,s23
Zc v69,v27,v26,s23
Zc v70,v29,v28,s23
Zc v71,v31,v30,s23
Zb s19,s18,14336
Zr v[64:67],v0,s[4:7],s19 offen
Zr v[68:71],v0,s[4:7],s19 offen offset:1024
Zb s19,s17,524288
Za v16,v2,s[32:35],s19 offen
Zb s19,s17,532480
Za v17,v2,s[32:35],s19 offen
Zb s19,s17,589824
Za v18,v2,s[32:35],s19 offen
Zb s19,s17,598016
Za v19,v2,s[32:35],s19 offen
Zb s19,s17,540672
Za v20,v2,s[32:35],s19 offen
Zb s19,s17,548864
Za v21,v2,s[32:35],s19 offen
Zb s19,s17,606208
Za v22,v2,s[32:35],s19 offen
Zb s19,s17,614400
Za v23,v2,s[32:35],s19 offen
Zb s19,s17,786432
Za v24,v2,s[32:35],s19 offen
Zb s19,s17,794624
Za v25,v2,s[32:35],s19 offen
Zb s19,s17,851968
Za v26,v2,s[32:35],s19 offen
Zb s19,s17,860160
Za v27,v2,s[32:35],s19 offen
Zb s19,s17,802816
Za v28,v2,s[32:35],s19 offen
Zb s19,s17,811008
Za v29,v2,s[32:35],s19 offen
Zb s19,s17,868352
Za v30,v2,s[32:35],s19 offen
Zb s19,s17,876544
Za v31,v2,s[32:35],s19 offen
Zf vmcnt(52)
Zc v72,v33,v32,s22
Zf vmcnt(50)
Zc v73,v35,v34,s22
Zf vmcnt(48)
Zc v74,v37,v36,s22
Zf vmcnt(46)
Zc v75,v39,v38,s22
Zf vmcnt(44)
Zc v76,v41,v40,s22
Zf vmcnt(42)
Zc v77,v43,v42,s22
Zf vmcnt(40)
Zc v78,v45,v44,s22
Zf vmcnt(38)
Zc v79,v47,v46,s22
Zt v5,v[72:75] offset:10240
Zt v5,v[76:79] offset:11264
Zc v64,v33,v32,s23
Zc v65,v35,v34,s23
Zc v66,v37,v36,s23
Zc v67,v39,v38,s23
Zc v68,v41,v40,s23
Zc v69,v43,v42,s23
Zc v70,v45,v44,s23
Zc v71,v47,v46,s23
Zt v5,v[64:67] offset:18432
Zt v5,v[68:71] offset:19456
Zb s19,s17,1048576
Za v32,v2,s[32:35],s19 offen
Zb s19,s17,1056768
Za v33,v2,s[32:35],s19 offen
Zb s19,s17,1114112
Za v34,v2,s[32:35],s19 offen
Zb s19,s17,1122304
Za v35,v2,s[32:35],s19 offen
Zb s19,s17,1064960
Za v36,v2,s[32:35],s19 offen
Zb s19,s17,1073152
Za v37,v2,s[32:35],s19 offen
Zb s19,s17,1130496
Za v38,v2,s[32:35],s19 offen
Zb s19,s17,1138688
Za v39,v2,s[32:35],s19 offen
Zb s19,s17,1310720
Za v40,v2,s[32:35],s19 offen
Zb s19,s17,1318912
Za v41,v2,s[32:35],s19 offen
Zb s19,s17,1376256
Za v42,v2,s[32:35],s19 offen
Zb s19,s17,1384448
Za v43,v2,s[32:35],s19 offen
Zb s19,s17,1327104
Za v44,v2,s[32:35],s19 offen
Zb s19,s17,1335296
Za v45,v2,s[32:35],s19 offen
Zb s19,s17,1392640
Za v46,v2,s[32:35],s19 offen
Zb s19,s17,1400832
Za v47,v2,s[32:35],s19 offen
Zf vmcnt(50)
Zc v72,v49,v48,s22
Zf vmcnt(48)
Zc v73,v51,v50,s22
Zf vmcnt(46)
Zc v74,v53,v52,s22
Zf vmcnt(44)
Zc v75,v55,v54,s22
Zf vmcnt(42)
Zc v76,v57,v56,s22
Zf vmcnt(40)
Zc v77,v59,v58,s22
Zf vmcnt(38)
Zc v78,v61,v60,s22
Zf vmcnt(36)
Zc v79,v63,v62,s22
Zd a184,v72
Zd a185,v73
Zd a186,v74
Zd a187,v75
Zd a188,v76
Zd a189,v77
Zd a190,v78
Zd a191,v79
Zc v64,v49,v48,s23
Zc v65,v51,v50,s23
Zc v66,v53,v52,s23
Zc v67,v55,v54,s23
Zc v68,v57,v56,s23
Zc v69,v59,v58,s23
Zc v70,v61,v60,s23
Zc v71,v63,v62,s23
Zd a192,v64
Zd a193,v65
Zd a194,v66
Zd a195,v67
Zd a196,v68
Zd a197,v69
Zd a198,v70
Zd a199,v71
Zb s19,s17,1572864
Za v48,v2,s[32:35],s19 offen
Zb s19,s17,1581056
Za v49,v2,s[32:35],s19 offen
Zb s19,s17,1638400
Za v50,v2,s[32:35],s19 offen
Zb s19,s17,1646592
Za v51,v2,s[32:35],s19 offen
Zb s19,s17,1589248
Za v52,v2,s[32:35],s19 offen
Zb s19,s17,1597440
Za v53,v2,s[32:35],s19 offen
Zb s19,s17,1654784
Za v54,v2,s[32:35],s19 offen
Zb s19,s17,1662976
Za v55,v2,s[32:35],s19 offen
Zb s19,s17,1835008
Za v56,v2,s[32:35],s19 offen
Zb s19,s17,1843200
Za v57,v2,s[32:35],s19 offen
Zb s19,s17,1900544
Za v58,v2,s[32:35],s19 offen
Zb s19,s17,1908736
Za v59,v2,s[32:35],s19 offen
Zb s19,s17,1851392
Za v60,v2,s[32:35],s19 offen
Zb s19,s17,1859584
Za v61,v2,s[32:35],s19 offen
Zb s19,s17,1916928
Za v62,v2,s[32:35],s19 offen
Zb s19,s17,1925120
Za v63,v2,s[32:35],s19 offen
Zf vmcnt(46)
Zc v72,v17,v16,s22
Zf vmcnt(44)
Zc v73,v19,v18,s22
Zf vmcnt(42)
Zc v74,v21,v20,s22
Zf vmcnt(40)
Zc v75,v23,v22,s22
Zf vmcnt(38)
Zc v76,v25,v24,s22
Zf vmcnt(36)
Zc v77,v27,v26,s22
Zf vmcnt(34)
Zc v78,v29,v28,s22
Zf vmcnt(32)
Zc v79,v31,v30,s22
Zd a216,v72
Zd a217,v73
Zd a218,v74
Zd a219,v75
Zd a220,v76
Zd a221,v77
Zd a222,v78
Zd a223,v79
Zc v64,v17,v16,s23
Zc v65,v19,v18,s23
Zc v66,v21,v20,s23
Zc v67,v23,v22,s23
Zc v68,v25,v24,s23
Zc v69,v27,v26,s23
Zc v70,v29,v28,s23
Zc v71,v31,v30,s23
Zd a224,v64
Zd a225,v65
Zd a226,v66
Zd a227,v67
Zd a228,v68
Zd a229,v69
Zd a230,v70
Zd a231,v71
Zb s19,s17,2097152
Za v16,v2,s[32:35],s19 offen
Zb s19,s17,2105344
Za v17,v2,s[32:35],s19 offen
Zb s19,s17,2162688
Za v18,v2,s[32:35],s19 offen
Zb s19,s17,2170880
Za v19,v2,s[32:35],s19 offen
Zb s19,s17,2113536
Za v20,v2,s[32:35],s19 offen
Zb s19,s17,2121728
Za v21,v2,s[32:35],s19 offen
Zb s19,s17,2179072
Za v22,v2,s[32:35],s19 offen
Zb s19,s17,2187264
Za v23,v2,s[32:35],s19 offen
Zb s19,s17,2359296
Za v24,v2,s[32:35],s19 offen
Zb s19,s17,2367488
Za v25,v2,s[32:35],s19 offen
Zb s19,s17,2424832
Za v26,v2,s[32:35],s19 offen
Zb s19,s17,2433024
Za v27,v2,s[32:35],s19 offen
Zb s19,s17,2375680
Za v28,v2,s[32:35],s19 offen
Zb s19,s17,2383872
Za v29,v2,s[32:35],s19 offen
Zb s19,s17,2441216
Za v30,v2,s[32:35],s19 offen
Zb s19,s17,2449408
Za v31,v2,s[32:35],s19 offen
Zf vmcnt(46)
Zc v72,v33,v32,s22
Zf vmcnt(44)
Zc v73,v35,v34,s22
Zf vmcnt(42)
Zc v74,v37,v36,s22
Zf vmcnt(40)
Zc v75,v39,v38,s22
Zf vmcnt(38)
Zc v76,v41,v40,s22
Zf vmcnt(36)
Zc v77,v43,v42,s22
Zf vmcnt(34)
Zc v78,v45,v44,s22
Zf vmcnt(32)
Zc v79,v47,v46,s22
Zd a248,v72
Zd a249,v73
Zd a250,v74
Zd a251,v75
Zd a252,v76
Zd a253,v77
Zd a254,v78
Zd a255,v79
Zc v80,v33,v32,s23
Zc v81,v35,v34,s23
Zc v82,v37,v36,s23
Zc v83,v39,v38,s23
Zc v84,v41,v40,s23
Zc v85,v43,v42,s23
Zc v86,v45,v44,s23
Zc v87,v47,v46,s23
Zb s19,s17,2621440
Za v32,v2,s[32:35],s19 offen
Zb s19,s17,2629632
Za v33,v2,s[32:35],s19 offen
Zb s19,s17,2686976
Za v34,v2,s[32:35],s19 offen
Zb s19,s17,2695168
Za v35,v2,s[32:35],s19 offen
Zb s19,s17,2637824
Za v36,v2,s[32:35],s19 offen
Zb s19,s17,2646016
Za v37,v2,s[32:35],s19 offen
Zb s19,s17,2703360
Za v38,v2,s[32:35],s19 offen
Zb s19,s17,2711552
Za v39,v2,s[32:35],s19 offen
Zb s19,s17,2883584
Za v40,v2,s[32:35],s19 offen
Zb s19,s17,2891776
Za v41,v2,s[32:35],s19 offen
Zb s19,s17,2949120
Za v42,v2,s[32:35],s19 offen
Zb s19,s17,2957312
Za v43,v2,s[32:35],s19 offen
Zb s19,s17,2899968
Za v44,v2,s[32:35],s19 offen
Zb s19,s17,2908160
Za v45,v2,s[32:35],s19 offen
Zb s19,s17,2965504
Za v46,v2,s[32:35],s19 offen
Zb s19,s17,2973696
Za v47,v2,s[32:35],s19 offen
Zf vmcnt(46)
Zc v112,v49,v48,s22
Zf vmcnt(44)
Zc v113,v51,v50,s22
Zf vmcnt(42)
Zc v114,v53,v52,s22
Zf vmcnt(40)
Zc v115,v55,v54,s22
Zf vmcnt(38)
Zc v116,v57,v56,s22
Zf vmcnt(36)
Zc v117,v59,v58,s22
Zf vmcnt(34)
Zc v118,v61,v60,s22
Zf vmcnt(32)
Zc v119,v63,v62,s22
Zc v64,v49,v48,s23
Zc v65,v51,v50,s23
Zc v66,v53,v52,s23
Zc v67,v55,v54,s23
Zc v68,v57,v56,s23
Zc v69,v59,v58,s23
Zc v70,v61,v60,s23
Zc v71,v63,v62,s23
Zb s19,s18,8192
Zr v[64:67],v0,s[4:7],s19 offen
Zr v[68:71],v0,s[4:7],s19 offen offset:1024
Zb s19,s17,3145728
Za v48,v2,s[32:35],s19 offen
Zb s19,s17,3153920
Za v49,v2,s[32:35],s19 offen
Zb s19,s17,3211264
Za v50,v2,s[32:35],s19 offen
Zb s19,s17,3219456
Za v51,v2,s[32:35],s19 offen
Zb s19,s17,3162112
Za v52,v2,s[32:35],s19 offen
Zb s19,s17,3170304
Za v53,v2,s[32:35],s19 offen
Zb s19,s17,3227648
Za v54,v2,s[32:35],s19 offen
Zb s19,s17,3235840
Za v55,v2,s[32:35],s19 offen
Zb s19,s17,3407872
Za v56,v2,s[32:35],s19 offen
Zb s19,s17,3416064
Za v57,v2,s[32:35],s19 offen
Zb s19,s17,3473408
Za v58,v2,s[32:35],s19 offen
Zb s19,s17,3481600
Za v59,v2,s[32:35],s19 offen
Zb s19,s17,3424256
Za v60,v2,s[32:35],s19 offen
Zb s19,s17,3432448
Za v61,v2,s[32:35],s19 offen
Zb s19,s17,3489792
Za v62,v2,s[32:35],s19 offen
Zb s19,s17,3497984
Za v63,v2,s[32:35],s19 offen
Zf vmcnt(48)
Zc v152,v17,v16,s22
Zf vmcnt(46)
Zc v153,v19,v18,s22
Zf vmcnt(44)
Zc v154,v21,v20,s22
Zf vmcnt(42)
Zc v155,v23,v22,s22
Zf vmcnt(40)
Zc v156,v25,v24,s22
Zf vmcnt(38)
Zc v157,v27,v26,s22
Zf vmcnt(36)
Zc v158,v29,v28,s22
Zf vmcnt(34)
Zc v159,v31,v30,s22
Zc v64,v17,v16,s23
Zc v65,v19,v18,s23
Zc v66,v21,v20,s23
Zc v67,v23,v22,s23
Zc v68,v25,v24,s23
Zc v69,v27,v26,s23
Zc v70,v29,v28,s23
Zc v71,v31,v30,s23
Zt v5,v[64:67] offset:4096
Zt v5,v[68:71] offset:5120
Zb s19,s17,3670016
Za v16,v2,s[32:35],s19 offen
Zb s19,s17,3678208
Za v17,v2,s[32:35],s19 offen
Zb s19,s17,3735552
Za v18,v2,s[32:35],s19 offen
Zb s19,s17,3743744
Za v19,v2,s[32:35],s19 offen
Zb s19,s17,3686400
Za v20,v2,s[32:35],s19 offen
Zb s19,s17,3694592
Za v21,v2,s[32:35],s19 offen
Zb s19,s17,3751936
Za v22,v2,s[32:35],s19 offen
Zb s19,s17,3760128
Za v23,v2,s[32:35],s19 offen
Zb s19,s17,3932160
Za v24,v2,s[32:35],s19 offen
Zb s19,s17,3940352
Za v25,v2,s[32:35],s19 offen
Zb s19,s17,3997696
Za v26,v2,s[32:35],s19 offen
Zb s19,s17,4005888
Za v27,v2,s[32:35],s19 offen
Zb s19,s17,3948544
Za v28,v2,s[32:35],s19 offen
Zb s19,s17,3956736
Za v29,v2,s[32:35],s19 offen
Zb s19,s17,4014080
Za v30,v2,s[32:35],s19 offen
Zb s19,s17,4022272
Za v31,v2,s[32:35],s19 offen
Zf vmcnt(48)
Zc v248,v33,v32,s22
Zf vmcnt(46)
Zc v249,v35,v34,s22
Zf vmcnt(44)
Zc v250,v37,v36,s22
Zf vmcnt(42)
Zc v251,v39,v38,s22
Zf vmcnt(40)
Zc v252,v41,v40,s22
Zf vmcnt(38)
Zc v253,v43,v42,s22
Zf vmcnt(36)
Zc v254,v45,v44,s22
Zf vmcnt(34)
Zc v255,v47,v46,s22
Zc v64,v33,v32,s23
Zc v65,v35,v34,s23
Zc v66,v37,v36,s23
Zc v67,v39,v38,s23
Zc v68,v41,v40,s23
Zc v69,v43,v42,s23
Zc v70,v45,v44,s23
Zc v71,v47,v46,s23
Zb s19,s18,4096
Zr v[64:67],v0,s[4:7],s19 offen
Zr v[68:71],v0,s[4:7],s19 offen offset:1024
Zb s19,s17,4194304
Za v32,v2,s[32:35],s19 offen
Zb s19,s17,4202496
Za v33,v2,s[32:35],s19 offen
Zb s19,s17,4259840
Za v34,v2,s[32:35],s19 offen
Zb s19,s17,4268032
Za v35,v2,s[32:35],s19 offen
Zb s19,s17,4210688
Za v36,v2,s[32:35],s19 offen
Zb s19,s17,4218880
Za v37,v2,s[32:35],s19 offen
Zb s19,s17,4276224
Za v38,v2,s[32:35],s19 offen
Zb s19,s17,4284416
Za v39,v2,s[32:35],s19 offen
Zb s19,s17,4456448
Za v40,v2,s[32:35],s19 offen
Zb s19,s17,4464640
Za v41,v2,s[32:35],s19 offen
Zb s19,s17,4521984
Za v42,v2,s[32:35],s19 offen
Zb s19,s17,4530176
Za v43,v2,s[32:35],s19 offen
Zb s19,s17,4472832
Za v44,v2,s[32:35],s19 offen
Zb s19,s17,4481024
Za v45,v2,s[32:35],s19 offen
Zb s19,s17,4538368
Za v46,v2,s[32:35],s19 offen
Zb s19,s17,4546560
Za v47,v2,s[32:35],s19 offen
Zf vmcnt(48)
Zc v232,v49,v48,s22
Zf vmcnt(46)
Zc v233,v51,v50,s22
Zf vmcnt(44)
Zc v234,v53,v52,s22
Zf vmcnt(42)
Zc v235,v55,v54,s22
Zf vmcnt(40)
Zc v236,v57,v56,s22
Zf vmcnt(38)
Zc v237,v59,v58,s22
Zf vmcnt(36)
Zc v238,v61,v60,s22
Zf vmcnt(34)
Zc v239,v63,v62,s22
Zc v240,v49,v48,s23
Zc v241,v51,v50,s23
Zc v242,v53,v52,s23
Zc v243,v55,v54,s23
Zc v244,v57,v56,s23
Zc v245,v59,v58,s23
Zc v246,v61,v60,s23
Zc v247,v63,v62,s23
Zb s19,s17,4718592
Za v48,v2,s[32:35],s19 offen
Zb s19,s17,4726784
Za v49,v2,s[32:35],s19 offen
Zb s19,s17,4784128
Za v50,v2,s[32:35],s19 offen
Zb s19,s17,4792320
Za v51,v2,s[32:35],s19 offen
Zb s19,s17,4734976
Za v52,v2,s[32:35],s19 offen
Zb s19,s17,4743168
Za v53,v2,s[32:35],s19 offen
Zb s19,s17,4800512
Za v54,v2,s[32:35],s19 offen
Zb s19,s17,4808704
Za v55,v2,s[32:35],s19 offen
Zb s19,s17,4980736
Za v56,v2,s[32:35],s19 offen
Zb s19,s17,4988928
Za v57,v2,s[32:35],s19 offen
Zb s19,s17,5046272
Za v58,v2,s[32:35],s19 offen
Zb s19,s17,5054464
Za v59,v2,s[32:35],s19 offen
Zb s19,s17,4997120
Za v60,v2,s[32:35],s19 offen
Zb s19,s17,5005312
Za v61,v2,s[32:35],s19 offen
Zb s19,s17,5062656
Za v62,v2,s[32:35],s19 offen
Zb s19,s17,5070848
Za v63,v2,s[32:35],s19 offen
Zf vmcnt(48)
Zc v216,v17,v16,s22
Zf vmcnt(46)
Zc v217,v19,v18,s22
Zf vmcnt(44)
Zc v218,v21,v20,s22
Zf vmcnt(42)
Zc v219,v23,v22,s22
Zf vmcnt(40)
Zc v220,v25,v24,s22
Zf vmcnt(38)
Zc v221,v27,v26,s22
Zf vmcnt(36)
Zc v222,v29,v28,s22
Zf vmcnt(34)
Zc v223,v31,v30,s22
Zc v224,v17,v16,s23
Zc v225,v19,v18,s23
Zc v226,v21,v20,s23
Zc v227,v23,v22,s23
Zc v228,v25,v24,s23
Zc v229,v27,v26,s23
Zc v230,v29,v28,s23
Zc v231,v31,v30,s23
Zf vmcnt(30)
Zc v72,v33,v32,s22
Zf vmcnt(28)
Zc v73,v35,v34,s22
Zf vmcnt(26)
Zc v74,v37,v36,s22
Zf vmcnt(24)
Zc v75,v39,v38,s22
Zf vmcnt(22)
Zc v76,v41,v40,s22
Zf vmcnt(20)
Zc v77,v43,v42,s22
Zf vmcnt(18)
Zc v78,v45,v44,s22
Zf vmcnt(16)
Zc v79,v47,v46,s22
Zd a128,v72
Zd a129,v73
Zd a130,v74
Zd a131,v75
Zd a132,v76
Zd a133,v77
Zd a134,v78
Zd a135,v79
Zc v64,v33,v32,s23
Zc v65,v35,v34,s23
Zc v66,v37,v36,s23
Zc v67,v39,v38,s23
Zc v68,v41,v40,s23
Zc v69,v43,v42,s23
Zc v70,v45,v44,s23
Zc v71,v47,v46,s23
Zd a136,v64
Zd a137,v65
Zd a138,v66
Zd a139,v67
Zd a140,v68
Zd a141,v69
Zd a142,v70
Zd a143,v71
Zf vmcnt(14)
Zc v72,v49,v48,s22
Zf vmcnt(12)
Zc v73,v51,v50,s22
Zf vmcnt(10)
Zc v74,v53,v52,s22
Zf vmcnt(8)
Zc v75,v55,v54,s22
Zf vmcnt(6)
Zc v76,v57,v56,s22
Zf vmcnt(4)
Zc v77,v59,v58,s22
Zf vmcnt(2)
Zc v78,v61,v60,s22
Zf vmcnt(0)
Zc v79,v63,v62,s22
Zd a152,v72
Zd a153,v73
Zd a154,v74
Zd a155,v75
Zd a156,v76
Zd a157,v77
Zd a158,v78
Zd a159,v79
Zc v64,v49,v48,s23
Zc v65,v51,v50,s23
Zc v66,v53,v52,s23
Zc v67,v55,v54,s23
Zc v68,v57,v56,s23
Zc v69,v59,v58,s23
Zc v70,v61,v60,s23
Zc v71,v63,v62,s23
Zd a160,v64
Zd a161,v65
Zd a162,v66
Zd a163,v67
Zd a164,v68
Zd a165,v69
Zd a166,v70
Zd a167,v71
v_lshrrev_b32 v14, 1, v12
Zy v14,1,v14
Zs v1,0x4444
Zs v15,0xeeee
v_cmp_eq_u32 vcc, 1, v14
s_nop 1
v_cndmask_b32 v1, v1, v15, vcc
v_lshrrev_b32 v15, 2, v12
Zz v15,1,v15
Zy v16,1,v12
v_add_u32 v15, v15, v16
v_mul_u32_u24 v7, 1280, v15
v_lshl_add_u32 v7, v13, 5, v7
v_lshl_add_u32 v7, v14, 4, v7
v_mul_u32_u24 v10, 288, v15
v_lshl_add_u32 v10, v13, 4, v10
v_add_u32 v10, 20736, v10
Zy v16,7,v12
v_mul_u32_u24 v9, 288, v16
v_lshl_add_u32 v9, v13, 4, v9
v_add_u32 v9, 18432, v9
v_mul_u32_u24 v8, 576, v13
v_lshl_add_u32 v8, v12, 2, v8
v_add_u32 v8, 18624, v8
v_lshrrev_b32 v17, 1, v16
Zz v17,2,v17
Zy v18,1,v16
v_add_u32 v17, v17, v18
Zy v18,1,v13
v_lshl_add_u32 v17, v18, 1, v17
v_lshrrev_b32 v18, 1, v13
v_lshl_add_u32 v17, v18, 4, v17
Zz v11,4,v17
v_add_u32 v11, 1536, v11
s_mul_i32 s19, s8, 10368
v_mul_u32_u24 v2, 2560, v13
v_add_u32 v2, s19, v2
v_lshl_add_u32 v3, v12, 2, v2
v_add_u32 v3, 1216, v3
v_lshl_add_u32 v2, v12, 4, v2
v_add_u32 v2, 768, v2
v_lshrrev_b32 v16, 3, v12
v_lshl_add_u32 v16, v13, 1, v16
Zy v17,7,v12
Zq s19,s8,7
Zb s19,s19,12288
v_mul_u32_u24 v4, 10368, v16
v_lshl_add_u32 v4, v17, 4, v4
v_add_u32 v4, s19, v4
Zp s21,1040356334
Zp s20,400000
Zp s12,1048576
Zp s15,2097152
Zf vmcnt(0) lgkmcnt(0)
v_lshrrev_b32 v12, 2, v0
Zy v12,60,v12
L_md3:
global_load_dword v13, v12, s[36:37] sc1
Zf vmcnt(0)
v_readlane_b32 s40, v13, 0
v_readlane_b32 s41, v13, 1
v_readlane_b32 s42, v13, 2
v_readlane_b32 s43, v13, 3
v_readlane_b32 s44, v13, 4
v_readlane_b32 s45, v13, 5
v_readlane_b32 s46, v13, 6
v_readlane_b32 s47, v13, 7
v_readlane_b32 s48, v13, 8
s_cmp_ge_u32 s40, 32
Zk L_fa3
Zb s40,s40,s41
Zb s40,s40,s42
Zb s40,s40,s43
Zb s40,s40,s44
Zb s40,s40,s45
Zb s40,s40,s46
Zb s40,s40,s47
Zb s40,s40,s48
s_cmp_ge_u32 s40, 256
Zk L_sl3
s_sleep 2
s_sub_u32 s20, s20, 1
s_cmp_gt_i32 s20, 0
Zk L_md3
L_sl3:
Zq s24,s8,7
Zb s26,s24,4096
Zb s24,s24,0
Zp s11,0
s_mul_i32 s17, s8, 20480
Zb s17,s17,16777216
Zb s27,s17,19456
s_load_dwordx2 s[28:29], s[0:1], 48
Zp s30,10240
Zp s31,0x20000
Zp s39,0
Zb s90,s18,0
Zb s91,s18,4096
Zb s92,s18,8192
Zb s93,s18,12288
Zb s94,s18,16384
Zb s36,s8,96
s_mul_i32 s22, s36, 205
s_lshr_b32 s22, s22, 11
s_mul_i32 s23, s22, 10
s_sub_u32 s36, s36, s23
Zq s38,s36,10
s_lshr_b32 s23, s22, 1
Zq s23,s23,6
Zb s38,s38,s23
s_and_b32 s23, s22, 1
Zq s23,s23,4
Zb s38,s38,s23
s_cmp_ge_u32 s36, 8
s_cselect_b32 s36, 1, 0
Zb s13,s12,82944
Zb s14,s12,165888
Zb s59,s12,248832
Zp s32,394264576
Zp s33,1342177280
Zz v4,3,v0
Zm v[12:13],0
Zs v14,24320
ds_write_b64 v14, v[12:13]
Zf lgkmcnt(0)
CL_w3x:
Zp s10,0
Zb s22,s11,1
CF_199:
buffer_load_dwordx2 v[12:13], off, s[4:7], s24 sc1
Zf vmcnt(0)
v_min_u32 v12, v12, v13
s_nop 0
v_readfirstlane_b32 s25, v12
s_cmp_ge_u32 s25, s22
Zk CFD_200
s_sleep 2
s_sub_u32 s20, s20, 1
s_cmp_gt_i32 s20, 0
Zk CF_199
CFD_200:
s_barrier
Zp s37,8192
Zs v6,v0
Zb m0,s37,8192
Zb s19,s17,6144
Zh v0,s[4:7],s19 offen sc1 nt lds
Zb m0,s37,9216
Zb s19,s17,7168
Zh v0,s[4:7],s19 offen sc1 nt lds
Zh v[12:15],v7,s[28:31],0 offen offset:1024
Zh v[40:43],v7,s[28:31],0 offen offset:1152
Zb s19,s18,0
Zh v[48:51],v0,s[4:7],s19 offen offset:0
Zh v[52:55],v0,s[4:7],s19 offen offset:1024
Zb s19,s18,6144
Zh v[56:59],v0,s[4:7],s19 offen offset:0
Zh v[60:63],v0,s[4:7],s19 offen offset:1024
Zb s19,s18,10240
Zh v[64:67],v0,s[4:7],s19 offen offset:0
Zh v[68:71],v0,s[4:7],s19 offen offset:1024
Zb s19,s18,14336
Zh v[72:75],v0,s[4:7],s19 offen offset:0
Zh v[76:79],v0,s[4:7],s19 offen offset:1024
Zm v[16:17],0
Zm v[18:19],0
Zm v[20:21],0
Zm v[22:23],0
Zm v[24:25],0
Zm v[26:27],0
Zm v[28:29],0
Zm v[30:31],0
Zm v[32:33],0
Zm v[34:35],0
Zm v[36:37],0
Zm v[38:39],0
Zf vmcnt(0) lgkmcnt(0)
CS_w3x:
Zt v6,v[12:15] offset:8192
Zt v6,v[40:43] offset:9216
Zg v[16:19],v[12:15],v[48:55],v1
Zb s19,s18,2048
Zh v[48:51],v0,s[4:7],s19 offen offset:0
Zh v[52:55],v0,s[4:7],s19 offen offset:1024
Zg v[20:23],v[12:15],v[56:63],v1
Zi v[56:59],v5 offset:2048
Zi v[60:63],v5 offset:3072
Zg v[24:27],v[12:15],v[64:71],v1
Zi v[64:67],v5 offset:10240
Zi v[68:71],v5 offset:11264
Zf vmcnt(2)
Zg v[28:31],v[12:15],v[72:79],v1
Zi v[72:75],v5 offset:18432
Zi v[76:79],v5 offset:19456
Zf lgkmcnt(6)
s_barrier
Zi v[44:47],v0 offset:0
Zg v[32:35],v[12:15],a[128:135],v1
Zg v[36:39],v[12:15],a[136:143],v1
Zg v[16:19],v[40:43],a[144:151],v1
Zi v[12:15],v0 offset:1024
Zf lgkmcnt(6)
Zg v[20:23],v[40:43],v[56:63],v1
Zb s19,s18,8192
Zh v[56:59],v0,s[4:7],s19 offen offset:0
Zh v[60:63],v0,s[4:7],s19 offen offset:1024
Zf lgkmcnt(4)
Zg v[24:27],v[40:43],v[64:71],v1
Zi v[64:67],v5 offset:12288
Zi v[68:71],v5 offset:13312
Zf lgkmcnt(4)
Zg v[28:31],v[40:43],v[72:79],v1
Zi v[72:75],v5 offset:20480
Zi v[76:79],v5 offset:21504
Zg v[32:35],v[40:43],a[152:159],v1
Zg v[36:39],v[40:43],a[160:167],v1
Zf lgkmcnt(5)
Zg v[16:19],v[44:47],a[168:175],v1
Zi v[40:43],v6 offset:2048
Zf lgkmcnt(3)
Zg v[20:23],v[44:47],v[64:71],v1
Zi v[64:67],v5 offset:14336
Zi v[68:71],v5 offset:15360
Zg v[24:27],v[44:47],a[176:183],v1
Zf lgkmcnt(3)
Zg v[28:31],v[44:47],v[72:79],v1
Zi v[72:75],v5 offset:22528
Zi v[76:79],v5 offset:23552
Zg v[32:35],v[44:47],a[184:191],v1
Zg v[36:39],v[44:47],a[192:199],v1
Zg v[16:19],v[12:15],a[200:207],v1
Zi v[44:47],v6 offset:3072
Zf lgkmcnt(3)
Zg v[20:23],v[12:15],v[64:71],v1
Zb s19,s18,12288
Zh v[64:67],v0,s[4:7],s19 offen offset:0
Zh v[68:71],v0,s[4:7],s19 offen offset:1024
Zg v[24:27],v[12:15],a[208:215],v1
Zf lgkmcnt(1)
Zg v[28:31],v[12:15],v[72:79],v1
Zi v[72:75],v5 offset:24576
Zi v[76:79],v5 offset:25600
Zg v[32:35],v[12:15],a[216:223],v1
Zg v[36:39],v[12:15],a[224:231],v1
Zg v[16:19],v[40:43],a[232:239],v1
Zi v[12:15],v6 offset:4096
Zg v[20:23],v[40:43],a[240:247],v1
Zf vmcnt(4)
Zg v[24:27],v[40:43],v[48:55],v1
Zi v[48:51],v5 offset:0
Zi v[52:55],v5 offset:1024
Zf lgkmcnt(3)
Zg v[28:31],v[40:43],v[72:79],v1
Zb s19,s18,16384
Zh v[72:75],v0,s[4:7],s19 offen offset:0
Zh v[76:79],v0,s[4:7],s19 offen offset:1024
Zg v[32:35],v[40:43],a[248:255],v1
Zg v[36:39],v[40:43],v[80:87],v1
Zg v[16:19],v[44:47],v[88:95],v1
Zi v[40:43],v6 offset:5120
Zg v[20:23],v[44:47],v[96:103],v1
Zf lgkmcnt(1)
Zg v[24:27],v[44:47],v[48:55],v1
Zb s19,s18,4096
Zh v[48:51],v0,s[4:7],s19 offen offset:0
Zh v[52:55],v0,s[4:7],s19 offen offset:1024
Zg v[28:31],v[44:47],v[104:111],v1
Zg v[32:35],v[44:47],v[112:119],v1
Zf vmcnt(6)
Zg v[36:39],v[44:47],v[56:63],v1
Zb s34,s17,655360
Zi v[56:59],v5 offset:4096
Zi v[60:63],v5 offset:5120
Zg v[16:19],v[12:15],v[120:127],v1
Zi v[44:47],v6 offset:6144
Zo s10,63
s_cselect_b32 s34, s17, s34
Zg v[20:23],v[12:15],v[128:135],v1
s_xor_b32 s37, s37, 8192
Zg v[24:27],v[12:15],v[136:143],v1
Zb s35,s34,8192
Zg v[28:31],v[12:15],v[144:151],v1
Zg v[32:35],v[12:15],v[152:159],v1
Zf lgkmcnt(1)
Zg v[36:39],v[12:15],v[56:63],v1
Zi v[56:59],v5 offset:6144
Zi v[60:63],v5 offset:7168
Zg v[16:19],v[40:43],v[160:167],v1
Zi v[12:15],v6 offset:7168
Zg v[20:23],v[40:43],v[168:175],v1
Zg v[24:27],v[40:43],v[176:183],v1
Zf vmcnt(4)
Zg v[28:31],v[40:43],v[64:71],v1
Zi v[64:67],v5 offset:16384
Zi v[68:71],v5 offset:17408
Zf lgkmcnt(5)
Zg v[16:19],v[44:47],v[184:191],v1
Zf lgkmcnt(3)
Zg v[20:23],v[44:47],v[56:63],v1
Zi v[56:59],v5 offset:8192
Zi v[60:63],v5 offset:9216
Zf lgkmcnt(4)
Zg v[16:19],v[12:15],v[192:199],v1
Zg v[20:23],v[12:15],v[200:207],v1
Zg v[24:27],v[44:47],v[208:215],v1
v_xor_b32 v6, 8192, v6
Zf lgkmcnt(2)
Zg v[28:31],v[44:47],v[64:71],v1
Zl v16,v16,v18
Zb s19,s17,14336
Zh v[64:67],v0,s[4:7],s19 offen sc1 nt
Zh v[68:71],v0,s[4:7],s19 offen offset:1024 sc1 nt
Zf vmcnt(4)
Zg v[24:27],v[12:15],v[72:79],v1
Zl v17,v17,v19
Zf lgkmcnt(0)
Zg v[28:31],v[12:15],v[56:63],v1
Zl v20,v20,v22
Zg v[32:35],v[12:15],v[216:223],v1
Zl v21,v21,v23
Zw v16,s21,v16
Zi v[72:75],v6 offset:2048
Zi v[76:79],v6 offset:6144
Zg v[36:39],v[12:15],v[224:231],v1
Zw v17,s21,v17
Zw v20,s21,v20
Zw v21,s21,v21
Zj v18,v16,v20
Zj v19,v17,v21
ds_write2_b32 v8, v18, v19 offset0:0 offset1:72
Zi v[56:59],v6 offset:3072
Zi v[60:63],v6 offset:7168
Zl v24,v24,v26
Zl v25,v25,v27
Zl v28,v28,v30
Zl v29,v29,v31
Zj v12,v24,v28
Zj v13,v25,v29
ds_write_b32 v8, v12 offset:2304
ds_write_b32 v8, v13 offset:2592
Zg v[32:35],v[44:47],v[232:239],v1
Zg v[36:39],v[44:47],v[240:247],v1
Zb s22,s11,2
s_cmp_ge_u32 s25, s22
Zk CN_201
Zo s10,63
Zk CN_201
CF_202:
buffer_load_dwordx2 v[14:15], off, s[4:7], s24 sc1
Zf vmcnt(0)
v_min_u32 v14, v14, v15
s_nop 0
v_readfirstlane_b32 s25, v14
s_cmp_ge_u32 s25, s22
Zk CFD_203
s_sleep 2
s_sub_u32 s20, s20, 1
s_cmp_gt_i32 s20, 0
Zk CF_202
CFD_203:
CN_201:
Zf lgkmcnt(0)
s_barrier
Zi v[16:19],v9 offset:0
Zi v[20:23],v10 offset:0
Zi v[24:27],v9 offset:64
Zi v[28:31],v10 offset:64
Zg v[32:35],v[40:43],v[248:255],v1
Zf vmcnt(2)
Zg v[36:39],v[40:43],v[48:55],v1
Zp m0,24064
s_nop 0
Za v4,s[4:7],s35 offen sc1 lds
Zi v[48:51],v6 offset:4096
Zi v[52:55],v6 offset:8192
Zl v32,v32,v34
Zl v33,v33,v35
s_nop 0
Zl v36,v36,v38
Zl v37,v37,v39
Zj v14,v32,v33
Zj v15,v36,v37
Zr v[12:15],v0,s[4:7],s27 offen sc1 nt
Zf lgkmcnt(5)
Ze v[44:47],v[76:79],v[16:19],0
Zf lgkmcnt(4)
Ze v[32:35],v[20:23],v[16:19],0
Ze v[40:43],v[72:75],v[16:19],0
Zi v[16:19],v9 offset:128
Zi v[20:23],v10 offset:128
Zi v[72:75],v6 offset:5120
Zi v[76:79],v6 offset:9216
Zb m0,s37,8192
Zb s19,s34,6144
Zh v0,s[4:7],s19 offen sc1 nt lds
Zf lgkmcnt(7)
Ze v[44:47],v[60:63],v[24:27],v[44:47]
Zs v36,0x3f803f80
Zs v37,0x3f803f80
Zf lgkmcnt(6)
Ze v[32:35],v[28:31],v[24:27],v[32:35]
Zs v38,0x3f803f80
Zs v39,0x3f803f80
Ze v[40:43],v[56:59],v[24:27],v[40:43]
Zi v[24:27],v9 offset:192
Zi v[28:31],v10 offset:192
Zi v[56:59],v5 offset:30720
Zi v[60:63],v5 offset:31744
Zb m0,s37,9216
Zb s19,s34,7168
Zh v0,s[4:7],s19 offen sc1 nt lds
Zf lgkmcnt(7)
Ze v[44:47],v[52:55],v[16:19],v[44:47]
Zf lgkmcnt(6)
Ze v[32:35],v[20:23],v[16:19],v[32:35]
Ze v[40:43],v[48:51],v[16:19],v[40:43]
Zi v[48:51],v5 offset:26624
Zi v[52:55],v5 offset:27648
Zs v12,s11
Zu v12,off,s[4:7],s26 sc1
Zp m0,24320
v_lshrrev_b32 v13, 2, v0
Za v13,s[4:7],s24 offen sc1 lds
Zf lgkmcnt(5)
Ze v[44:47],v[76:79],v[24:27],v[44:47]
Zs v21,0
Zs v22,0
Zf lgkmcnt(4)
Ze v[32:35],v[28:31],v[24:27],v[32:35]
Ze v[40:43],v[72:75],v[24:27],v[40:43]
Zp s23,0
SX_w3x:
Zn v76,v44
Zn v77,v45
Zn v78,v46
Zn v79,v47
Zn v24,v32
Zn v25,v33
s_nop 0
Zn v72,v40
Zn v73,v41
Zn v74,v42
Zn v75,v43
Zj v18,v76,v77
Zj v19,v78,v79
Zj v16,v72,v73
Zj v17,v74,v75
Zj v20,v24,v25
Zj v23,v24,v25
Ze v[72:75],v[36:39],v[16:19],0
Zf vmcnt(7)
Ze v[24:27],v[64:67],v[16:19],0
Zf vmcnt(6)
Ze v[28:31],v[68:71],v[16:19],0
v_mfma_f32_16x16x16_bf16 v[72:75], v[36:37], v[20:21], v[72:75]
v_mfma_f32_16x16x16_bf16 v[24:27], v[14:15], v[20:21], v[24:27]
Zm v[76:77],0
Zm v[78:79],0
v_mfma_f32_16x16x16_bf16 v[28:31], v[14:15], v[22:23], v[28:31]
s_nop 2
v_subrev_u32 v73, s32, v72
v_rcp_f32 v74, v72
v_cmp_le_u32 vcc, s33, v73
Zs v75,v74
s_cbranch_vccnz FB_w3x
SO_w3x:
v_pk_mul_f32 v[24:25], v[24:25], v[74:75]
v_pk_mul_f32 v[26:27], v[26:27], v[74:75]
v_pk_mul_f32 v[28:29], v[28:29], v[74:75]
v_pk_mul_f32 v[30:31], v[30:31], v[74:75]
Zj v24,v24,v28
Zj v25,v25,v29
Zj v26,v26,v30
Zj v27,v27,v31
Zt v11,v[24:27]
Zm v[72:73],0
Zm v[74:75],0
Zm v[16:17],0
Zm v[18:19],0
Zm v[20:21],0
Zm v[22:23],0
Zm v[64:65],0
Zm v[66:67],0
Zm v[68:69],0
Zm v[70:71],0
Zf lgkmcnt(0)
s_barrier
Zi v[40:43],v0 offset:0
Zi v[44:47],v0 offset:1024
Zo s10,63
Zk CE_w3x
Zm v[24:25],0
Zm v[26:27],0
Zm v[28:29],0
Zm v[30:31],0
Zb s17,s17,655360
Zf lgkmcnt(1)
Zg v[72:75],v[40:43],v[48:55],v1
Zm v[32:33],0
Zi v[48:51],v5 offset:28672
Zi v[52:55],v5 offset:29696
Zf lgkmcnt(2)
Zg v[72:75],v[44:47],v[56:63],v1
Zm v[34:35],0
Zi v[56:59],v5 offset:32768
Zi v[60:63],v5 offset:33792
Zg v[76:79],v[40:43],a[0:7],v1
Zm v[36:37],0
Zg v[76:79],v[44:47],a[8:15],v1
Zm v[38:39],0
Zg v[16:19],v[40:43],a[16:23],v1
Zl v72,v72,v74
Zg v[16:19],v[44:47],a[24:31],v1
Zl v73,v73,v75
Zg v[20:23],v[40:43],a[32:39],v1
Zl v76,v76,v78
Zf lgkmcnt(2)
Zg v[20:23],v[44:47],v[48:55],v1
Zl v77,v77,v79
Zf lgkmcnt(0)
Zg v[64:67],v[40:43],v[56:63],v1
Zl v16,v16,v18
Zg v[64:67],v[44:47],a[40:47],v1
Zl v17,v17,v19
Zg v[68:71],v[40:43],a[48:55],v1
Zl v20,v20,v22
Zj v12,v72,v76
Zg v[68:71],v[44:47],a[56:63],v1
Zl v21,v21,v23
Zj v48,v73,v77
Zg v[24:27],v[40:43],a[64:71],v1
Zl v64,v64,v66
Zj v13,v16,v20
Zg v[24:27],v[44:47],a[72:79],v1
Zl v65,v65,v67
Zj v49,v17,v21
Zg v[28:31],v[40:43],a[80:87],v1
Zl v68,v68,v70
v_bfi_b32 v12, 1, s39, v12
Zg v[28:31],v[44:47],a[88:95],v1
Zl v69,v69,v71
v_bfi_b32 v48, 1, s39, v48
Zg v[32:35],v[40:43],a[96:103],v1
Zl v24,v24,v26
Zj v14,v64,v68
Zg v[32:35],v[44:47],a[104:111],v1
Zl v25,v25,v27
Zj v50,v65,v69
Zg v[36:39],v[40:43],a[112:119],v1
Zl v28,v28,v30
Zj v15,v24,v28
Zr v[12:15],v2,s[4:7],s12 offen sc1
Zg v[36:39],v[44:47],a[120:127],v1
Zl v29,v29,v31
Zj v51,v25,v29
Zr v[48:51],v2,s[4:7],s12 offen offset:1280 sc1
Zl v32,v32,v34
Zl v33,v33,v35
s_nop 2
Zl v36,v36,v38
Zj v56,v32,v36
v_bfi_b32 v56, 1, s39, v56
Zu v56,v3,s[4:7],s12 offen offset:0 sc1
Zl v37,v37,v39
Zj v57,v33,v37
v_bfi_b32 v57, 1, s39, v57
Zu v57,v3,s[4:7],s12 offen offset:1280 sc1
s_xor_b32 s16, s15, 0x4000
Zb s10,s10,1
Zb s11,s11,1
Zb s27,s27,655360
Zb s19,s18,0
Zh v[48:51],v0,s[4:7],s19 offen offset:0
Zh v[52:55],v0,s[4:7],s19 offen offset:1024
Zb s19,s18,6144
Zh v[56:59],v0,s[4:7],s19 offen offset:0
Zh v[60:63],v0,s[4:7],s19 offen offset:1024
Zf vmcnt(4)
Zs v14,24320
ds_read_b64 v[14:15], v14
Zf lgkmcnt(0)
v_min_u32 v14, v14, v15
s_nop 0
v_readfirstlane_b32 s22, v14
s_max_u32 s25, s25, s22
s_barrier
Zb s19,s18,10240
Zh v[64:67],v0,s[4:7],s19 offen offset:0
Zh v[68:71],v0,s[4:7],s19 offen offset:1024
Zm v[18:19],0
Zm v[20:21],0
Zm v[22:23],0
Zm v[24:25],0
Zm v[26:27],0
Zm v[28:29],0
Zm v[30:31],0
Zm v[32:33],0
Zm v[34:35],0
Zm v[36:37],0
Zm v[38:39],0
s_xor_b32 s39, s39, 1
Zb s22,s15,8192
Zf lgkmcnt(0)
Zh v[12:15],v0,s[4:7],s22 offen offset:0 sc1
Zh v[40:43],v0,s[4:7],s22 offen offset:1024 sc1
Zf vmcnt(1)
Zb s19,s18,14336
Zh v[72:75],v0,s[4:7],s19 offen offset:0
Zh v[76:79],v0,s[4:7],s19 offen offset:1024
v_max3_u32 v16, v12, v13, v14
Zf vmcnt(2)
v_max3_u32 v16, v16, v15, v40
v_max3_u32 v16, v16, v41, v42
v_max_u32 v16, v16, v43
v_cmp_eq_u32 vcc, -1, v16
Zm v[16:17],0
s_cbranch_vccz P2D_w3x
P2_w3x:
Zh v[12:15],v0,s[4:7],s22 offen offset:0 sc1
Zh v[40:43],v0,s[4:7],s22 offen offset:1024 sc1
Zf vmcnt(1)
v_max3_u32 v16, v12, v13, v14
Zf vmcnt(0)
v_max3_u32 v16, v16, v15, v40
v_max3_u32 v16, v16, v41, v42
v_max_u32 v16, v16, v43
v_cmp_eq_u32 vcc, -1, v16
Zm v[16:17],0
s_cbranch_vccz P2D_w3x
s_sub_u32 s20, s20, 1
s_cmp_gt_i32 s20, 0
Zk P2_w3x
P2D_w3x:
Zp s15,s16
s_branch CS_w3x
FB_w3x:
s_cmp_lg_u32 s23, 0
Zk SO_w3x
Zp s23,1
s_nop 11
v_max3_f32 v24, v40, v41, v42
v_max3_f32 v24, v24, v43, v44
v_max3_f32 v24, v24, v45, v46
v_max3_f32 v24, v24, v47, v32
v_max_f32 v24, v24, v33
Zs v25,v24
s_nop 1
v_permlane32_swap_b32 v24, v25
v_max_f32 v24, v24, v25
Zs v25,v24
s_nop 1
v_permlane16_swap_b32 v24, v25
v_max_f32 v24, v24, v25
Zx v40,v40,v24
Zx v41,v41,v24
Zx v42,v42,v24
Zx v43,v43,v24
Zx v44,v44,v24
Zx v45,v45,v24
Zx v46,v46,v24
Zx v47,v47,v24
Zx v32,v32,v24
Zx v33,v33,v24
Zf lgkmcnt(0)
s_branch SX_w3x
CE_w3x:
Zf vmcnt(0) lgkmcnt(0)
s_barrier
Zb s11,s11,1
Zb s27,s27,655360
Zb s17,s17,655360
Zs v12,s11
Zu v12,off,s[4:7],s26 sc1
Zp s15,2129920
Zf vmcnt(0)
s_cmp_lt_u32 s11, 128
Zk CL_w3x
s_endpgm
.p2align 6
L_fa3:
Zq s24,s8,7
Zb s26,s24,4096
Zb s24,s24,0
Zp s11,0
s_mul_i32 s17, s8, 20480
Zb s17,s17,16777216
Zb s27,s17,19456
s_load_dwordx2 s[28:29], s[0:1], 48
Zp s30,10240
Zp s31,0x20000
Zp s39,0
Zb s90,s18,0
Zb s91,s18,4096
Zb s92,s18,8192
Zb s93,s18,12288
Zb s94,s18,16384
Zb s36,s8,96
s_mul_i32 s22, s36, 205
s_lshr_b32 s22, s22, 11
s_mul_i32 s23, s22, 10
s_sub_u32 s36, s36, s23
Zq s38,s36,10
s_lshr_b32 s23, s22, 1
Zq s23,s23,6
Zb s38,s38,s23
s_and_b32 s23, s22, 1
Zq s23,s23,4
Zb s38,s38,s23
s_cmp_ge_u32 s36, 8
s_cselect_b32 s36, 1, 0
Zb s13,s12,82944
Zb s14,s12,165888
Zb s59,s12,248832
Zp s32,394264576
Zp s33,1342177280
Zz v4,3,v0
Zm v[12:13],0
Zs v14,24320
ds_write_b64 v14, v[12:13]
Zf lgkmcnt(0)
CL_w3:
Zp s10,0
Zb s22,s11,1
CF_204:
buffer_load_dwordx2 v[12:13], off, s[4:7], s24 sc1
Zf vmcnt(0)
v_min_u32 v12, v12, v13
s_nop 0
v_readfirstlane_b32 s25, v12
s_cmp_ge_u32 s25, s22
Zk CFD_205
s_sleep 2
s_sub_u32 s20, s20, 1
s_cmp_gt_i32 s20, 0
Zk CF_204
CFD_205:
s_barrier
Zp s37,8192
Zs v6,v0
Zb m0,s37,8192
Zb s19,s17,6144
Zh v0,s[4:7],s19 offen sc1 nt lds
Zb m0,s37,9216
Zb s19,s17,7168
Zh v0,s[4:7],s19 offen sc1 nt lds
Zh v[12:15],v7,s[28:31],0 offen offset:1024
Zh v[40:43],v7,s[28:31],0 offen offset:1152
Zb s19,s18,0
Zh v[48:51],v0,s[4:7],s19 offen offset:0
Zh v[52:55],v0,s[4:7],s19 offen offset:1024
Zb s19,s18,6144
Zh v[56:59],v0,s[4:7],s19 offen offset:0
Zh v[60:63],v0,s[4:7],s19 offen offset:1024
Zb s19,s18,10240
Zh v[64:67],v0,s[4:7],s19 offen offset:0
Zh v[68:71],v0,s[4:7],s19 offen offset:1024
Zb s19,s18,14336
Zh v[72:75],v0,s[4:7],s19 offen offset:0
Zh v[76:79],v0,s[4:7],s19 offen offset:1024
Zm v[16:17],0
Zm v[18:19],0
Zm v[20:21],0
Zm v[22:23],0
Zm v[24:25],0
Zm v[26:27],0
Zm v[28:29],0
Zm v[30:31],0
Zm v[32:33],0
Zm v[34:35],0
Zm v[36:37],0
Zm v[38:39],0
Zf vmcnt(0) lgkmcnt(0)
CS_w3:
Zt v6,v[12:15] offset:8192
Zt v6,v[40:43] offset:9216
Zg v[16:19],v[12:15],v[48:55],v1
Zb s19,s18,2048
Zh v[48:51],v0,s[4:7],s19 offen offset:0
Zh v[52:55],v0,s[4:7],s19 offen offset:1024
Zg v[20:23],v[12:15],v[56:63],v1
Zi v[56:59],v5 offset:2048
Zi v[60:63],v5 offset:3072
Zg v[24:27],v[12:15],v[64:71],v1
Zi v[64:67],v5 offset:10240
Zi v[68:71],v5 offset:11264
Zf vmcnt(2)
Zg v[28:31],v[12:15],v[72:79],v1
Zi v[72:75],v5 offset:18432
Zi v[76:79],v5 offset:19456
Zf lgkmcnt(6)
s_barrier
Zi v[44:47],v0 offset:0
Zg v[32:35],v[12:15],a[128:135],v1
Zg v[36:39],v[12:15],a[136:143],v1
Zg v[16:19],v[40:43],a[144:151],v1
Zi v[12:15],v0 offset:1024
Zf lgkmcnt(6)
Zg v[20:23],v[40:43],v[56:63],v1
Zb s19,s18,8192
Zh v[56:59],v0,s[4:7],s19 offen offset:0
Zh v[60:63],v0,s[4:7],s19 offen offset:1024
Zf lgkmcnt(4)
Zg v[24:27],v[40:43],v[64:71],v1
Zi v[64:67],v5 offset:12288
Zi v[68:71],v5 offset:13312
Zf lgkmcnt(4)
Zg v[28:31],v[40:43],v[72:79],v1
Zi v[72:75],v5 offset:20480
Zi v[76:79],v5 offset:21504
Zg v[32:35],v[40:43],a[152:159],v1
Zg v[36:39],v[40:43],a[160:167],v1
Zf lgkmcnt(5)
Zg v[16:19],v[44:47],a[168:175],v1
Zi v[40:43],v6 offset:2048
Zf lgkmcnt(3)
Zg v[20:23],v[44:47],v[64:71],v1
Zi v[64:67],v5 offset:14336
Zi v[68:71],v5 offset:15360
Zg v[24:27],v[44:47],a[176:183],v1
Zf lgkmcnt(3)
Zg v[28:31],v[44:47],v[72:79],v1
Zi v[72:75],v5 offset:22528
Zi v[76:79],v5 offset:23552
Zg v[32:35],v[44:47],a[184:191],v1
Zg v[36:39],v[44:47],a[192:199],v1
Zg v[16:19],v[12:15],a[200:207],v1
Zi v[44:47],v6 offset:3072
Zf lgkmcnt(3)
Zg v[20:23],v[12:15],v[64:71],v1
Zb s19,s18,12288
Zh v[64:67],v0,s[4:7],s19 offen offset:0
Zh v[68:71],v0,s[4:7],s19 offen offset:1024
Zg v[24:27],v[12:15],a[208:215],v1
Zf lgkmcnt(1)
Zg v[28:31],v[12:15],v[72:79],v1
Zi v[72:75],v5 offset:24576
Zi v[76:79],v5 offset:25600
Zg v[32:35],v[12:15],a[216:223],v1
Zg v[36:39],v[12:15],a[224:231],v1
Zg v[16:19],v[40:43],a[232:239],v1
Zi v[12:15],v6 offset:4096
Zg v[20:23],v[40:43],a[240:247],v1
Zf vmcnt(4)
Zg v[24:27],v[40:43],v[48:55],v1
Zi v[48:51],v5 offset:0
Zi v[52:55],v5 offset:1024
Zf lgkmcnt(3)
Zg v[28:31],v[40:43],v[72:79],v1
Zb s19,s18,16384
Zh v[72:75],v0,s[4:7],s19 offen offset:0
Zh v[76:79],v0,s[4:7],s19 offen offset:1024
Zg v[32:35],v[40:43],a[248:255],v1
Zg v[36:39],v[40:43],v[80:87],v1
Zg v[16:19],v[44:47],v[88:95],v1
Zi v[40:43],v6 offset:5120
Zg v[20:23],v[44:47],v[96:103],v1
Zf lgkmcnt(1)
Zg v[24:27],v[44:47],v[48:55],v1
Zb s19,s18,4096
Zh v[48:51],v0,s[4:7],s19 offen offset:0
Zh v[52:55],v0,s[4:7],s19 offen offset:1024
Zg v[28:31],v[44:47],v[104:111],v1
Zg v[32:35],v[44:47],v[112:119],v1
Zf vmcnt(6)
Zg v[36:39],v[44:47],v[56:63],v1
Zb s34,s17,655360
Zi v[56:59],v5 offset:4096
Zi v[60:63],v5 offset:5120
Zg v[16:19],v[12:15],v[120:127],v1
Zi v[44:47],v6 offset:6144
Zo s10,63
s_cselect_b32 s34, s17, s34
Zg v[20:23],v[12:15],v[128:135],v1
s_xor_b32 s37, s37, 8192
Zg v[24:27],v[12:15],v[136:143],v1
Zb s35,s34,8192
Zg v[28:31],v[12:15],v[144:151],v1
Zg v[32:35],v[12:15],v[152:159],v1
Zf lgkmcnt(1)
Zg v[36:39],v[12:15],v[56:63],v1
Zi v[56:59],v5 offset:6144
Zi v[60:63],v5 offset:7168
Zg v[16:19],v[40:43],v[160:167],v1
Zi v[12:15],v6 offset:7168
Zg v[20:23],v[40:43],v[168:175],v1
Zg v[24:27],v[40:43],v[176:183],v1
Zf vmcnt(4)
Zg v[28:31],v[40:43],v[64:71],v1
Zi v[64:67],v5 offset:16384
Zi v[68:71],v5 offset:17408
Zf lgkmcnt(5)
Zg v[16:19],v[44:47],v[184:191],v1
Zf lgkmcnt(3)
Zg v[20:23],v[44:47],v[56:63],v1
Zi v[56:59],v5 offset:8192
Zi v[60:63],v5 offset:9216
Zf lgkmcnt(4)
Zg v[16:19],v[12:15],v[192:199],v1
Zg v[20:23],v[12:15],v[200:207],v1
Zg v[24:27],v[44:47],v[208:215],v1
v_xor_b32 v6, 8192, v6
Zf lgkmcnt(2)
Zg v[28:31],v[44:47],v[64:71],v1
Zl v16,v16,v18
Zb s19,s17,14336
Zh v[64:67],v0,s[4:7],s19 offen sc1 nt
Zh v[68:71],v0,s[4:7],s19 offen offset:1024 sc1 nt
Zf vmcnt(4)
Zg v[24:27],v[12:15],v[72:79],v1
Zl v17,v17,v19
Zf lgkmcnt(0)
Zg v[28:31],v[12:15],v[56:63],v1
Zl v20,v20,v22
Zg v[32:35],v[12:15],v[216:223],v1
Zl v21,v21,v23
Zw v16,s21,v16
Zi v[72:75],v6 offset:2048
Zi v[76:79],v6 offset:6144
Zg v[36:39],v[12:15],v[224:231],v1
Zw v17,s21,v17
Zw v20,s21,v20
Zw v21,s21,v21
Zj v18,v16,v20
Zj v19,v17,v21
ds_write2_b32 v8, v18, v19 offset0:0 offset1:72
Zi v[56:59],v6 offset:3072
Zi v[60:63],v6 offset:7168
Zl v24,v24,v26
Zl v25,v25,v27
Zl v28,v28,v30
Zl v29,v29,v31
Zj v12,v24,v28
Zj v13,v25,v29
ds_write_b32 v8, v12 offset:2304
ds_write_b32 v8, v13 offset:2592
Zg v[32:35],v[44:47],v[232:239],v1
Zg v[36:39],v[44:47],v[240:247],v1
Zb s22,s11,2
s_cmp_ge_u32 s25, s22
Zk CN_206
Zo s10,63
Zk CN_206
CF_207:
buffer_load_dwordx2 v[14:15], off, s[4:7], s24 sc1
Zf vmcnt(0)
v_min_u32 v14, v14, v15
s_nop 0
v_readfirstlane_b32 s25, v14
s_cmp_ge_u32 s25, s22
Zk CFD_208
s_sleep 2
s_sub_u32 s20, s20, 1
s_cmp_gt_i32 s20, 0
Zk CF_207
CFD_208:
CN_206:
Zf lgkmcnt(0)
s_barrier
Zi v[16:19],v9 offset:0
Zi v[20:23],v10 offset:0
Zi v[24:27],v9 offset:64
Zi v[28:31],v10 offset:64
Zg v[32:35],v[40:43],v[248:255],v1
Zf vmcnt(2)
Zg v[36:39],v[40:43],v[48:55],v1
Zp m0,24064
s_nop 0
Za v4,s[4:7],s35 offen sc1 lds
Zi v[48:51],v6 offset:4096
Zi v[52:55],v6 offset:8192
Zl v32,v32,v34
Zl v33,v33,v35
s_nop 0
Zl v36,v36,v38
Zl v37,v37,v39
Zj v14,v32,v33
Zj v15,v36,v37
Zr v[12:15],v0,s[4:7],s27 offen sc1 nt
Zf lgkmcnt(5)
Ze v[44:47],v[76:79],v[16:19],0
Zf lgkmcnt(4)
Ze v[32:35],v[20:23],v[16:19],0
Ze v[40:43],v[72:75],v[16:19],0
Zi v[16:19],v9 offset:128
Zi v[20:23],v10 offset:128
Zi v[72:75],v6 offset:5120
Zi v[76:79],v6 offset:9216
Zb m0,s37,8192
Zb s19,s34,6144
Zh v0,s[4:7],s19 offen sc1 nt lds
Zf lgkmcnt(7)
Ze v[44:47],v[60:63],v[24:27],v[44:47]
Zs v36,0x3f803f80
Zs v37,0x3f803f80
Zf lgkmcnt(6)
Ze v[32:35],v[28:31],v[24:27],v[32:35]
Zs v38,0x3f803f80
Zs v39,0x3f803f80
Ze v[40:43],v[56:59],v[24:27],v[40:43]
Zi v[24:27],v9 offset:192
Zi v[28:31],v10 offset:192
Zi v[56:59],v5 offset:30720
Zi v[60:63],v5 offset:31744
Zb m0,s37,9216
Zb s19,s34,7168
Zh v0,s[4:7],s19 offen sc1 nt lds
Zf lgkmcnt(7)
Ze v[44:47],v[52:55],v[16:19],v[44:47]
Zf lgkmcnt(6)
Ze v[32:35],v[20:23],v[16:19],v[32:35]
Ze v[40:43],v[48:51],v[16:19],v[40:43]
Zi v[48:51],v5 offset:26624
Zi v[52:55],v5 offset:27648
Zs v12,s11
Zu v12,off,s[4:7],s26 sc1
Zp m0,24320
v_lshrrev_b32 v13, 2, v0
Za v13,s[4:7],s24 offen sc1 lds
Zf lgkmcnt(5)
Ze v[44:47],v[76:79],v[24:27],v[44:47]
Zs v21,0
Zs v22,0
Zf lgkmcnt(4)
Ze v[32:35],v[28:31],v[24:27],v[32:35]
Ze v[40:43],v[72:75],v[24:27],v[40:43]
Zp s23,0
SX_w3:
Zn v76,v44
Zn v77,v45
Zn v78,v46
Zn v79,v47
Zn v24,v32
Zn v25,v33
s_nop 0
Zn v72,v40
Zn v73,v41
Zn v74,v42
Zn v75,v43
Zj v18,v76,v77
Zj v19,v78,v79
Zj v16,v72,v73
Zj v17,v74,v75
Zj v20,v24,v25
Zj v23,v24,v25
Ze v[72:75],v[36:39],v[16:19],0
Zf vmcnt(7)
Ze v[24:27],v[64:67],v[16:19],0
Zf vmcnt(6)
Ze v[28:31],v[68:71],v[16:19],0
v_mfma_f32_16x16x16_bf16 v[72:75], v[36:37], v[20:21], v[72:75]
v_mfma_f32_16x16x16_bf16 v[24:27], v[14:15], v[20:21], v[24:27]
Zm v[76:77],0
Zm v[78:79],0
v_mfma_f32_16x16x16_bf16 v[28:31], v[14:15], v[22:23], v[28:31]
s_nop 2
v_subrev_u32 v73, s32, v72
v_rcp_f32 v74, v72
v_cmp_le_u32 vcc, s33, v73
Zs v75,v74
s_cbranch_vccnz FB_w3
SO_w3:
v_pk_mul_f32 v[24:25], v[24:25], v[74:75]
v_pk_mul_f32 v[26:27], v[26:27], v[74:75]
v_pk_mul_f32 v[28:29], v[28:29], v[74:75]
v_pk_mul_f32 v[30:31], v[30:31], v[74:75]
Zj v24,v24,v28
Zj v25,v25,v29
Zj v26,v26,v30
Zj v27,v27,v31
Zt v11,v[24:27]
Zm v[72:73],0
Zm v[74:75],0
Zm v[16:17],0
Zm v[18:19],0
Zm v[20:21],0
Zm v[22:23],0
Zm v[64:65],0
Zm v[66:67],0
Zm v[68:69],0
Zm v[70:71],0
Zf lgkmcnt(0)
s_barrier
Zi v[40:43],v0 offset:0
Zi v[44:47],v0 offset:1024
Zo s10,63
Zk CE_w3
Zm v[24:25],0
Zm v[26:27],0
Zm v[28:29],0
Zm v[30:31],0
Zb s17,s17,655360
Zf lgkmcnt(1)
Zg v[72:75],v[40:43],v[48:55],v1
Zm v[32:33],0
Zi v[48:51],v5 offset:28672
Zi v[52:55],v5 offset:29696
Zf lgkmcnt(2)
Zg v[72:75],v[44:47],v[56:63],v1
Zm v[34:35],0
Zi v[56:59],v5 offset:32768
Zi v[60:63],v5 offset:33792
Zg v[76:79],v[40:43],a[0:7],v1
Zm v[36:37],0
Zg v[76:79],v[44:47],a[8:15],v1
Zm v[38:39],0
Zg v[16:19],v[40:43],a[16:23],v1
Zl v72,v72,v74
Zg v[16:19],v[44:47],a[24:31],v1
Zl v73,v73,v75
Zg v[20:23],v[40:43],a[32:39],v1
Zl v76,v76,v78
Zf lgkmcnt(2)
Zg v[20:23],v[44:47],v[48:55],v1
Zl v77,v77,v79
Zf lgkmcnt(0)
Zg v[64:67],v[40:43],v[56:63],v1
Zl v16,v16,v18
Zg v[64:67],v[44:47],a[40:47],v1
Zl v17,v17,v19
Zg v[68:71],v[40:43],a[48:55],v1
Zl v20,v20,v22
Zj v12,v72,v76
Zg v[68:71],v[44:47],a[56:63],v1
Zl v21,v21,v23
Zj v48,v73,v77
Zg v[24:27],v[40:43],a[64:71],v1
Zl v64,v64,v66
Zj v13,v16,v20
Zg v[24:27],v[44:47],a[72:79],v1
Zl v65,v65,v67
Zj v49,v17,v21
Zg v[28:31],v[40:43],a[80:87],v1
Zl v68,v68,v70
v_bfi_b32 v12, 1, s39, v12
Zg v[28:31],v[44:47],a[88:95],v1
Zl v69,v69,v71
v_bfi_b32 v48, 1, s39, v48
Zg v[32:35],v[40:43],a[96:103],v1
Zl v24,v24,v26
Zj v14,v64,v68
Zg v[32:35],v[44:47],a[104:111],v1
Zl v25,v25,v27
Zj v50,v65,v69
Zg v[36:39],v[40:43],a[112:119],v1
Zl v28,v28,v30
Zj v15,v24,v28
Zr v[12:15],v2,s[4:7],s12 offen
Zg v[36:39],v[44:47],a[120:127],v1
Zl v29,v29,v31
Zj v51,v25,v29
Zr v[48:51],v2,s[4:7],s12 offen offset:1280
Zl v32,v32,v34
Zl v33,v33,v35
s_nop 2
Zl v36,v36,v38
Zj v56,v32,v36
v_bfi_b32 v56, 1, s39, v56
Zu v56,v3,s[4:7],s12 offen offset:0
Zl v37,v37,v39
Zj v57,v33,v37
v_bfi_b32 v57, 1, s39, v57
Zu v57,v3,s[4:7],s12 offen offset:1280
s_xor_b32 s16, s15, 0x4000
Zb s10,s10,1
Zb s11,s11,1
Zb s27,s27,655360
Zb s19,s18,0
Zh v[48:51],v0,s[4:7],s19 offen offset:0
Zh v[52:55],v0,s[4:7],s19 offen offset:1024
Zb s19,s18,6144
Zh v[56:59],v0,s[4:7],s19 offen offset:0
Zh v[60:63],v0,s[4:7],s19 offen offset:1024
Zf vmcnt(4)
Zs v14,24320
ds_read_b64 v[14:15], v14
Zf lgkmcnt(0)
v_min_u32 v14, v14, v15
s_nop 0
v_readfirstlane_b32 s22, v14
s_max_u32 s25, s25, s22
s_barrier
Zb s19,s18,10240
Zh v[64:67],v0,s[4:7],s19 offen offset:0
Zh v[68:71],v0,s[4:7],s19 offen offset:1024
Zm v[18:19],0
Zm v[20:21],0
Zm v[22:23],0
Zm v[24:25],0
Zm v[26:27],0
Zm v[28:29],0
Zm v[30:31],0
Zm v[32:33],0
Zm v[34:35],0
Zm v[36:37],0
Zm v[38:39],0
s_xor_b32 s39, s39, 1
Zb s22,s15,8192
Zf lgkmcnt(0)
Zh v[12:15],v0,s[4:7],s22 offen offset:0 sc1
Zh v[40:43],v0,s[4:7],s22 offen offset:1024 sc1
Zf vmcnt(1)
Zb s19,s18,14336
Zh v[72:75],v0,s[4:7],s19 offen offset:0
Zh v[76:79],v0,s[4:7],s19 offen offset:1024
v_max3_u32 v16, v12, v13, v14
Zf vmcnt(2)
v_max3_u32 v16, v16, v15, v40
v_max3_u32 v16, v16, v41, v42
v_max_u32 v16, v16, v43
v_cmp_eq_u32 vcc, -1, v16
Zm v[16:17],0
s_cbranch_vccz P2D_w3
P2_w3:
Zh v[12:15],v0,s[4:7],s22 offen offset:0 sc1
Zh v[40:43],v0,s[4:7],s22 offen offset:1024 sc1
Zf vmcnt(1)
v_max3_u32 v16, v12, v13, v14
Zf vmcnt(0)
v_max3_u32 v16, v16, v15, v40
v_max3_u32 v16, v16, v41, v42
v_max_u32 v16, v16, v43
v_cmp_eq_u32 vcc, -1, v16
Zm v[16:17],0
s_cbranch_vccz P2D_w3
s_sub_u32 s20, s20, 1
s_cmp_gt_i32 s20, 0
Zk P2_w3
P2D_w3:
Zp s15,s16
s_branch CS_w3
FB_w3:
s_cmp_lg_u32 s23, 0
Zk SO_w3
Zp s23,1
s_nop 11
v_max3_f32 v24, v40, v41, v42
v_max3_f32 v24, v24, v43, v44
v_max3_f32 v24, v24, v45, v46
v_max3_f32 v24, v24, v47, v32
v_max_f32 v24, v24, v33
Zs v25,v24
s_nop 1
v_permlane32_swap_b32 v24, v25
v_max_f32 v24, v24, v25
Zs v25,v24
s_nop 1
v_permlane16_swap_b32 v24, v25
v_max_f32 v24, v24, v25
Zx v40,v40,v24
Zx v41,v41,v24
Zx v42,v42,v24
Zx v43,v43,v24
Zx v44,v44,v24
Zx v45,v45,v24
Zx v46,v46,v24
Zx v47,v47,v24
Zx v32,v32,v24
Zx v33,v33,v24
Zf lgkmcnt(0)
s_branch SX_w3
CE_w3:
Zf vmcnt(0) lgkmcnt(0)
s_barrier
Zb s11,s11,1
Zb s27,s27,655360
Zb s17,s17,655360
Zs v12,s11
Zu v12,off,s[4:7],s26 sc1
Zp s15,2129920
Zf vmcnt(0)
s_cmp_lt_u32 s11, 128
Zk CL_w3
s_endpgm
.section .rodata,"a"
.p2align 6
.amdhsa_kernel prep_kernel
  .amdhsa_next_free_vgpr 512
  .amdhsa_next_free_sgpr 96
  .amdhsa_accum_offset 256
  .amdhsa_group_segment_fixed_size 0
  .amdhsa_kernarg_size 120
  .amdhsa_user_sgpr_count 2
  .amdhsa_user_sgpr_kernarg_segment_ptr 1
  .amdhsa_system_sgpr_workgroup_id_x 1
.end_amdhsa_kernel
.p2align 6
.amdhsa_kernel interleave_layers__grouped_kv_mqa__memory_aug_recurrent_mem_tr__prompt_kernel
  .amdhsa_next_free_vgpr 512
  .amdhsa_next_free_sgpr 96
  .amdhsa_accum_offset 256
  .amdhsa_group_segment_fixed_size 0
  .amdhsa_kernarg_size 120
  .amdhsa_user_sgpr_count 2
  .amdhsa_user_sgpr_kernarg_segment_ptr 1
  .amdhsa_system_sgpr_workgroup_id_x 1
.end_amdhsa_kernel
```
